```python
import torch

def _softmax(x, axis=-1):
    return torch.softmax(x, dim=axis)

def _gelu(x):
    return torch.nn.functional.gelu(x, approximate='tanh')

def _silu(x):
    return torch.nn.functional.silu(x)

def _sigmoid(x):
    return torch.sigmoid(x)

def _layernorm(x, axis=-1, eps=1e-05):
    m = x.mean(dim=axis, keepdim=True)
    v = x.var(dim=axis, keepdim=True, unbiased=False)
    return (x - m) / torch.sqrt(v + eps)

def _scatter_add(tgt, idx, src, axis=0):
    return tgt.clone().index_add_(axis, idx, src)

def _segment_sum(src, seg, n):
    out = torch.zeros((n,) + src.shape[1:], dtype=src.dtype)
    return out.index_add_(0, seg, src)

def _pad(x, pw):
    flat = tuple((v for pair in reversed(pw) for v in pair))
    return torch.nn.functional.pad(x, flat)
kernel_name = 'interleave_layers__memory_aug_recurrent_mem_tr__spectral_gfnet__prompt'

def setup_inputs():

    _w = lambda a: (lambda t: t.to(torch.bfloat16) if t.is_floating_point() else t)(torch.as_tensor(a))

    def _A_setup():
        B, S, Dm = (1, 2048, 448)
        H, Dh = (16, 256)
        M, seg = (8, 32)
        seg = min(seg, S)
        S = S // seg * seg
        return {'x': _w((lambda *s: torch.randn(*s, dtype=torch.bfloat16) * 0.05)(B, S, Dm)), 'mem0': _w((lambda *s: torch.randn(*s, dtype=torch.bfloat16) * 0.2)(B, M, Dm)), 'Wq': _w((lambda *s: torch.randn(*s, dtype=torch.bfloat16) * 1.6)(Dm, H, Dh) * Dm ** (-0.5)), 'Wk': _w((lambda *s: torch.randn(*s, dtype=torch.bfloat16) * 1.6)(Dm, H, Dh) * Dm ** (-0.5)), 'Wv': _w((lambda *s: torch.randn(*s, dtype=torch.bfloat16) * 0.2)(Dm, H, Dh) * Dm ** (-0.5)), 'Wo': _w((lambda *s: torch.randn(*s, dtype=torch.bfloat16) * 0.2)(H, Dh, Dm) * (H * Dh) ** (-0.5)), 'seg_len': seg}
    _A_in = _A_setup()

    def _B_setup():
        B, S, D = (1, 2048, 448)
        Df = D // 2 + 1
        return {'x': _w((lambda *s: torch.randn(*s, dtype=torch.bfloat16) * 0.05)(B, S, D)), 'w_r': _w((lambda *s: torch.randn(*s, dtype=torch.bfloat16) * 0.4)(S, Df) * 0.02), 'w_i': _w((lambda *s: torch.randn(*s, dtype=torch.bfloat16) * 0.4)(S, Df) * 0.02)}
    _B_in = _B_setup()
    return {'A_x': _A_in['x'], 'A_mem0': _A_in['mem0'], 'A_Wq': _A_in['Wq'], 'A_Wk': _A_in['Wk'], 'A_Wv': _A_in['Wv'], 'A_Wo': _A_in['Wo'], 'A_seg_len': _A_in['seg_len'], 'B_x': _B_in['x'], 'B_w_r': _B_in['w_r'], 'B_w_i': _B_in['w_i']}

def reference(A_x, A_mem0, A_Wq, A_Wk, A_Wv, A_Wo, A_seg_len, B_x, B_w_r, B_w_i):

    def _A_ref(x, mem0, Wq, Wk, Wv, Wo, seg_len):
        B, S, Dm = x.shape
        H, Dh = (Wq.shape[1], Wq.shape[2])
        M = mem0.shape[1]
        scale = Dh ** (-0.5)
        n_seg = S // seg_len
        L = M + seg_len
        idx = torch.arange(L)
        mask = (idx[:, None] < M) | (idx[:, None] >= idx[None, :])
        mem = mem0
        outs = []
        for s in range(n_seg):
            xs = x[:, s * seg_len:(s + 1) * seg_len, :].clone()
            h = torch.concatenate([mem, xs], axis=1)
            q = torch.einsum('btd,dhe->bhte', h, Wq)
            k = torch.einsum('btd,dhe->bhte', h, Wk)
            v = torch.einsum('btd,dhe->bhte', h, Wv)
            scores = torch.einsum('bhqe,bhke->bhqk', q, k) * scale
            scores = torch.where(mask[None, None], scores, -1000000000.0)
            p = _softmax(scores, axis=-1)
            o = torch.einsum('bhqk,bhke->bhqe', p, v)
            o = torch.einsum('bhte,hed->btd', o, Wo)
            mem = o[:, :M, :].clone()
            outs.append(o[:, M:, :])
        return torch.concatenate(outs, axis=1)

    def _B_ref(x, w_r, w_i):
        B, S, D = x.shape
        X = (lambda x, axes=(-2, -1): torch.fft.rfft2(x.float(), dim=axes))(x, axes=(-2, -1))
        W = w_r + 1j * w_i
        X = X * W
        y = (lambda x, s, axes=(-2, -1): torch.fft.irfft2(x, s=s, dim=axes).to(torch.bfloat16))(X, (S, D), axes=(-2, -1))
        return y
    x = A_x
    x = x + _A_ref(_layernorm(x, axis=-1), A_mem0, A_Wq, A_Wk, A_Wv, A_Wo, A_seg_len)
    x = x + _B_ref(_layernorm(x, axis=-1), B_w_r, B_w_i)
    x = x + _A_ref(_layernorm(x, axis=-1), A_mem0, A_Wq, A_Wk, A_Wv, A_Wo, A_seg_len)
    x = x + _B_ref(_layernorm(x, axis=-1), B_w_r, B_w_i)
    return x
```

```asm
; @launch kernel=mega_kernel grid=(256,1,1) block=(256,1,1) lds=155648
.amdgcn_target "amdgcn-amd-amdhsa--gfx950"
.text
.globl mega_kernel
.p2align 8
.type mega_kernel,@function
mega_kernel:

s_cmp_ge_u32 s2, 256
s_cbranch_scc1 mega_kernel_exit
s_load_dwordx2 s[4:5], s[0:1], 96
s_load_dwordx2 s[6:7], s[0:1], 88
v_lshrrev_b32 v1, 6, v0
v_and_b32 v0, 63, v0
s_waitcnt lgkmcnt(0)
v_readfirstlane_b32 s17, v1
s_mov_b32 s8, s4
s_mov_b32 s9, s5
s_mov_b32 s10, 0x10000000
s_mov_b32 s11, 0x00020000
s_mov_b32 s12, s6
s_mov_b32 s13, s7
s_mov_b32 s14, 256
s_mov_b32 s15, 0x00020000
s_add_u32 s21, s2, 1
s_and_b32 s21, s21, 7
s_lshl_b32 s21, s21, 2
s_lshr_b32 s21, 0x65432170, s21
s_and_b32 s21, s21, 7
s_lshl_b32 s21, s21, 5
s_lshr_b32 s22, s2, 3
s_add_u32 s16, s21, s22
s_cmp_ge_u32 s16, 32
s_cbranch_scc1 mega_kernel_wk
s_load_dwordx2 s[44:45], s[0:1], 8
s_waitcnt lgkmcnt(0)
s_mov_b32 s52, s44
s_mov_b32 s53, s45
s_mov_b32 s54, 7168
s_mov_b32 s55, 0x00020000
s_lshl_b32 s21, s17, 6
v_add_u32 v2, s21, v0
s_cmp_ge_u32 s16, 30
s_cselect_b32 s22, 448, 0
v_add_u32 v4, 0, v2
v_and_b32 v5, 7, v4
v_mul_u32_u24 v5, 896, v5
v_lshrrev_b32 v6, 3, v4
v_lshlrev_b32 v6, 4, v6
v_add_u32 v5, v5, v6
v_lshlrev_b32 v6, 4, v4
v_cmp_gt_u32 vcc, s22, v4
v_mov_b32 v7, 0x10000000
s_nop 0
v_cndmask_b32 v5, v7, v5, vcc
v_cndmask_b32 v108, v7, v6, vcc
buffer_load_dwordx4 v[100:103], v5, s[52:55], 0 offen
v_add_u32 v4, 256, v2
v_and_b32 v5, 7, v4
v_mul_u32_u24 v5, 896, v5
v_lshrrev_b32 v6, 3, v4
v_lshlrev_b32 v6, 4, v6
v_add_u32 v5, v5, v6
v_lshlrev_b32 v6, 4, v4
v_cmp_gt_u32 vcc, s22, v4
v_mov_b32 v7, 0x10000000
s_nop 0
v_cndmask_b32 v5, v7, v5, vcc
v_cndmask_b32 v109, v7, v6, vcc
buffer_load_dwordx4 v[104:107], v5, s[52:55], 0 offen
s_lshl_b32 s21, s16, 2
s_add_u32 s21, s21, s17
s_lshl_b32 s21, s21, 10
v_lshlrev_b32 v84, 4, v0
v_add_u32 v84, s21, v84
v_mov_b32 v85, 0x10000000
v_and_b32 v83, 1, v0
v_mov_b32 v72, -1
v_mov_b32 v76, 0
v_mov_b32 v73, -1
v_mov_b32 v77, 0
v_mov_b32 v74, -1
v_mov_b32 v78, 0
v_mov_b32 v75, -1
v_mov_b32 v79, 0
v_mov_b32 v80, 0
v_mov_b32 v81, 0
v_mov_b32 v82, 0
s_mov_b32 s22, 14336
v_cmp_gt_u32 vcc, s22, v84
s_nop 1
v_cndmask_b32 v86, v85, v84, vcc
s_mov_b32 s23, 118222848
buffer_store_dwordx4 v[80:83], v86, s[8:11], s23 offen sc1
s_mov_b32 s23, 68124672
buffer_store_dwordx4 v[76:79], v84, s[8:11], s23 offen sc1
s_mov_b32 s23, 118091776
buffer_store_dwordx4 v[76:79], v84, s[8:11], s23 offen sc1
s_mov_b32 s22, 69632
v_cmp_gt_u32 vcc, s22, v84
s_nop 1
v_cndmask_b32 v87, v85, v84, vcc
s_mov_b32 s23, 45875200
buffer_store_dwordx4 v[72:75], v87, s[8:11], s23 offen sc1
s_mov_b32 s23, 45952000
buffer_store_dwordx4 v[72:75], v84, s[8:11], s23 offen sc1
s_mov_b32 s23, 46083072
buffer_store_dwordx4 v[72:75], v84, s[8:11], s23 offen sc1
s_mov_b32 s23, 46214144
buffer_store_dwordx4 v[72:75], v84, s[8:11], s23 offen sc1
s_mov_b32 s22, 58368
v_cmp_gt_u32 vcc, s22, v84
s_nop 1
v_cndmask_b32 v88, v85, v84, vcc
s_mov_b32 s23, 46345216
buffer_store_dwordx4 v[72:75], v88, s[8:11], s23 offen sc1
s_mov_b32 s22, 57344
v_cmp_gt_u32 vcc, s22, v84
s_nop 1
v_cndmask_b32 v89, v85, v84, vcc
s_mov_b32 s23, 62517248
buffer_store_dwordx4 v[76:79], v89, s[8:11], s23 offen sc1
s_mov_b32 s22, 69632
v_cmp_gt_u32 vcc, s22, v84
s_nop 1
v_cndmask_b32 v90, v85, v84, vcc
s_mov_b32 s23, 101416960
buffer_store_dwordx4 v[72:75], v90, s[8:11], s23 offen sc1
s_mov_b32 s23, 101493760
buffer_store_dwordx4 v[72:75], v84, s[8:11], s23 offen sc1
s_mov_b32 s23, 101624832
buffer_store_dwordx4 v[72:75], v84, s[8:11], s23 offen sc1
s_mov_b32 s23, 101755904
buffer_store_dwordx4 v[72:75], v84, s[8:11], s23 offen sc1
s_mov_b32 s22, 58368
v_cmp_gt_u32 vcc, s22, v84
s_nop 1
v_cndmask_b32 v91, v85, v84, vcc
s_mov_b32 s23, 101886976
buffer_store_dwordx4 v[72:75], v91, s[8:11], s23 offen sc1
s_mov_b32 s22, 57344
v_cmp_gt_u32 vcc, s22, v84
s_nop 1
v_cndmask_b32 v92, v85, v84, vcc
s_mov_b32 s23, 115175424
buffer_store_dwordx4 v[76:79], v92, s[8:11], s23 offen sc1
s_mov_b32 s28, 101486592
s_cmp_eq_u32 s16, 31
s_cselect_b32 s28, 45944832, s28
s_waitcnt vmcnt(15)
buffer_store_dwordx4 v[100:103], v108, s[8:11], s28 offen sc1
buffer_store_dwordx4 v[104:107], v109, s[8:11], s28 offen sc1
s_getreg_b32 s29, hwreg(HW_REG_XCC_ID,0,4)
s_add_u32 s56, s29, 1
s_lshl_b32 s30, s17, 6
v_add_u32 v110, s30, v0
v_mov_b32 v111, 0x10000000
v_cmp_eq_u32 vcc, 0, v110
v_mov_b32 v112, s56
s_lshl_b32 s30, s16, 2
v_cndmask_b32 v111, v111, 0, vcc
s_waitcnt vmcnt(0)
s_barrier
buffer_store_dword v112, v111, s[12:15], s30 offen sc0 sc1
s_cmp_lg_u32 s17, 0
s_cbranch_scc1 .Lini_7
v_lshlrev_b32 v2, 2, v0
v_mov_b32 v3, 0x10000000
v_cmp_gt_u32 vcc, 32, v0
s_movk_i32 s21, 4000
s_mov_b32 s20, 1
v_cndmask_b32 v2, v3, v2, vcc
.Lini_4:
buffer_load_dword v3, v2, s[12:15], 0 offen sc0 sc1
s_waitcnt vmcnt(0)
v_cmp_ne_u32 vcc, 0, v3
s_nop 1
s_cmp_eq_u32 vcc_lo, -1
s_cbranch_scc1 .Lini_5
s_sub_u32 s21, s21, 1
s_cbranch_scc0 .Lini_4
s_branch .Lini_6
.Lini_5:
v_cmp_ne_u32 vcc, s56, v3
s_nop 1
s_cmp_lg_u32 vcc_lo, 0
s_cselect_b32 s20, 1, 0
.Lini_6:
v_mov_b32 v2, 0
v_mov_b32 v3, s20
ds_write_b32 v2, v3
s_waitcnt lgkmcnt(0)
.Lini_7:
s_waitcnt vmcnt(0)
s_barrier
v_mov_b32 v2, 0
ds_read_b32 v3, v2
s_waitcnt lgkmcnt(0)
v_readfirstlane_b32 s20, v3
s_barrier
s_cmp_lt_u32 s16, 30
s_cbranch_scc1 mega_kernel_rec
s_cmp_eq_u32 s16, 30
s_cbranch_scc1 .Lr30_8
s_cmp_lg_u32 s17, 3
s_cbranch_scc1 mega_kernel_exit
v_lshlrev_b32 v1, 4, v0
v_mov_b32 v3, 1
s_mov_b32 s19, 20000
v_lshlrev_b32 v2, 2, v0
v_mov_b32 v4, 0x10000000
v_cmp_gt_u32 vcc, 14, v0
s_mov_b32 s34, 68141056
s_mov_b32 s31, 45952000
v_cndmask_b32 v2, v4, v2, vcc
s_mov_b32 s30, 1
buffer_store_dword v3, v2, s[8:11], s34 offen sc1
v_lshlrev_b32 v5, 2, v0
v_cmp_gt_u32 vcc, 56, v0
s_mov_b32 s32, 68161312
s_nop 0
v_cndmask_b32 v5, v4, v5, vcc
.Lml_9:
s_add_u32 s34, s34, 64
s_add_u32 s33, s31, 4096
s_mov_b32 s28, s19
.Lmp_10:
s_sleep 4
buffer_load_dwordx4 v[8:11], v1, s[8:11], s31 offen offset:0 sc1
buffer_load_dwordx4 v[12:15], v1, s[8:11], s31 offen offset:1024 sc1
buffer_load_dwordx4 v[16:19], v1, s[8:11], s31 offen offset:2048 sc1
buffer_load_dwordx4 v[20:23], v1, s[8:11], s31 offen offset:3072 sc1
buffer_load_dwordx4 v[24:27], v1, s[8:11], s33 offen offset:0 sc1
buffer_load_dwordx4 v[28:31], v1, s[8:11], s33 offen offset:1024 sc1
buffer_load_dwordx4 v[32:35], v1, s[8:11], s33 offen offset:2048 sc1
s_waitcnt vmcnt(6)
v_max3_u32 v4, v8, v9, v10
v_max_u32 v4, v4, v11
s_waitcnt vmcnt(5)
v_max3_u32 v4, v4, v12, v13
v_max3_u32 v4, v4, v14, v15
s_waitcnt vmcnt(4)
v_max3_u32 v4, v4, v16, v17
v_max3_u32 v4, v4, v18, v19
s_waitcnt vmcnt(3)
v_max3_u32 v4, v4, v20, v21
v_max3_u32 v4, v4, v22, v23
s_waitcnt vmcnt(2)
v_max3_u32 v4, v4, v24, v25
v_max3_u32 v4, v4, v26, v27
s_waitcnt vmcnt(1)
v_max3_u32 v4, v4, v28, v29
v_max3_u32 v4, v4, v30, v31
s_waitcnt vmcnt(0)
v_max3_u32 v4, v4, v32, v33
v_max3_u32 v4, v4, v34, v35
v_cmp_eq_u32 vcc, -1, v4
s_cbranch_vccz .Lmo_11
s_sub_u32 s28, s28, 1
s_cbranch_scc0 .Lmp_10
s_mov_b32 s19, 0
.Lmo_11:
buffer_store_dwordx4 v[8:11], v1, s[8:11], s31 offen offset:0 sc1
buffer_store_dwordx4 v[12:15], v1, s[8:11], s31 offen offset:1024 sc1
buffer_store_dwordx4 v[16:19], v1, s[8:11], s31 offen offset:2048 sc1
buffer_store_dwordx4 v[20:23], v1, s[8:11], s31 offen offset:3072 sc1
buffer_store_dwordx4 v[24:27], v1, s[8:11], s33 offen offset:0 sc1
buffer_store_dwordx4 v[28:31], v1, s[8:11], s33 offen offset:1024 sc1
buffer_store_dwordx4 v[32:35], v1, s[8:11], s33 offen offset:2048 sc1
s_cmp_lt_u32 s30, 2
s_cbranch_scc1 .Lhq_12
buffer_store_dword v3, v5, s[8:11], s32 offen sc1
.Lhq_12:
s_add_u32 s32, s32, 224
s_waitcnt vmcnt(0)
buffer_store_dword v3, v2, s[8:11], s34 offen sc1
s_add_u32 s31, s31, 7168
s_add_u32 s30, s30, 1
s_cmp_lt_u32 s30, 64
s_cbranch_scc1 .Lml_9
s_waitcnt vmcnt(0)
v_lshlrev_b32 v1, 4, v0
v_mov_b32 v3, 1
s_mov_b32 s19, 20000
v_lshlrev_b32 v2, 2, v0
v_mov_b32 v4, 0x10000000
v_cmp_gt_u32 vcc, 14, v0
s_mov_b32 s34, 118108160
s_mov_b32 s31, 101493760
v_cndmask_b32 v2, v4, v2, vcc
s_mov_b32 s30, 1
buffer_store_dword v3, v2, s[8:11], s34 offen sc1
v_lshlrev_b32 v5, 2, v0
v_cmp_gt_u32 vcc, 56, v0
s_mov_b32 s32, 118128416
s_nop 0
v_cndmask_b32 v5, v4, v5, vcc
.Lml_13:
s_add_u32 s34, s34, 64
s_add_u32 s33, s31, 4096
s_mov_b32 s28, s19
.Lmp_14:
s_sleep 4
buffer_load_dwordx4 v[8:11], v1, s[8:11], s31 offen offset:0 sc1
buffer_load_dwordx4 v[12:15], v1, s[8:11], s31 offen offset:1024 sc1
buffer_load_dwordx4 v[16:19], v1, s[8:11], s31 offen offset:2048 sc1
buffer_load_dwordx4 v[20:23], v1, s[8:11], s31 offen offset:3072 sc1
buffer_load_dwordx4 v[24:27], v1, s[8:11], s33 offen offset:0 sc1
buffer_load_dwordx4 v[28:31], v1, s[8:11], s33 offen offset:1024 sc1
buffer_load_dwordx4 v[32:35], v1, s[8:11], s33 offen offset:2048 sc1
s_waitcnt vmcnt(6)
v_max3_u32 v4, v8, v9, v10
v_max_u32 v4, v4, v11
s_waitcnt vmcnt(5)
v_max3_u32 v4, v4, v12, v13
v_max3_u32 v4, v4, v14, v15
s_waitcnt vmcnt(4)
v_max3_u32 v4, v4, v16, v17
v_max3_u32 v4, v4, v18, v19
s_waitcnt vmcnt(3)
v_max3_u32 v4, v4, v20, v21
v_max3_u32 v4, v4, v22, v23
s_waitcnt vmcnt(2)
v_max3_u32 v4, v4, v24, v25
v_max3_u32 v4, v4, v26, v27
s_waitcnt vmcnt(1)
v_max3_u32 v4, v4, v28, v29
v_max3_u32 v4, v4, v30, v31
s_waitcnt vmcnt(0)
v_max3_u32 v4, v4, v32, v33
v_max3_u32 v4, v4, v34, v35
v_cmp_eq_u32 vcc, -1, v4
s_cbranch_vccz .Lmo_15
s_sub_u32 s28, s28, 1
s_cbranch_scc0 .Lmp_14
s_mov_b32 s19, 0
.Lmo_15:
buffer_store_dwordx4 v[8:11], v1, s[8:11], s31 offen offset:0 sc1
buffer_store_dwordx4 v[12:15], v1, s[8:11], s31 offen offset:1024 sc1
buffer_store_dwordx4 v[16:19], v1, s[8:11], s31 offen offset:2048 sc1
buffer_store_dwordx4 v[20:23], v1, s[8:11], s31 offen offset:3072 sc1
buffer_store_dwordx4 v[24:27], v1, s[8:11], s33 offen offset:0 sc1
buffer_store_dwordx4 v[28:31], v1, s[8:11], s33 offen offset:1024 sc1
buffer_store_dwordx4 v[32:35], v1, s[8:11], s33 offen offset:2048 sc1
s_cmp_lt_u32 s30, 2
s_cbranch_scc1 .Lhq_16
buffer_store_dword v3, v5, s[8:11], s32 offen sc1
.Lhq_16:
s_add_u32 s32, s32, 224
s_waitcnt vmcnt(0)
buffer_store_dword v3, v2, s[8:11], s34 offen sc1
s_add_u32 s31, s31, 7168
s_add_u32 s30, s30, 1
s_cmp_lt_u32 s30, 64
s_cbranch_scc1 .Lml_13
s_waitcnt vmcnt(0)
s_endpgm
.Lr30_8:
s_mov_b32 s39, 8000
s_mov_b32 s18, 224
s_cmp_lg_u32 s17, 0
s_cbranch_scc1 .Lww_17
s_mov_b32 s24, 68184064
v_lshlrev_b32 v248, 4, v0
v_mov_b32 v252, 0x10000000
v_cmp_gt_u32 vcc, 34, v0
s_mov_b32 s25, s39
s_nop 0
v_cndmask_b32 v248, v252, v248, vcc
.Lwr_18:
buffer_load_dwordx4 v[252:255], v248, s[8:11], s24 offen sc1
s_waitcnt vmcnt(0)
s_mov_b32 s26, 0
v_cmp_eq_u32 vcc, 1, v252
s_nop 1
s_and_b32 vcc_lo, vcc_lo, 0xffffffff
s_and_b32 vcc_hi, vcc_hi, 0x3
s_bcnt1_i32_b64 s27, vcc
s_add_u32 s26, s26, s27
v_cmp_eq_u32 vcc, 1, v253
s_nop 1
s_and_b32 vcc_lo, vcc_lo, 0xffffffff
s_and_b32 vcc_hi, vcc_hi, 0x3
s_bcnt1_i32_b64 s27, vcc
s_add_u32 s26, s26, s27
v_cmp_eq_u32 vcc, 1, v254
s_nop 1
s_and_b32 vcc_lo, vcc_lo, 0xffffffff
s_and_b32 vcc_hi, vcc_hi, 0x3
s_bcnt1_i32_b64 s27, vcc
s_add_u32 s26, s26, s27
v_cmp_eq_u32 vcc, 1, v255
s_nop 1
s_and_b32 vcc_lo, vcc_lo, 0xffffffff
s_and_b32 vcc_hi, vcc_hi, 0x3
s_bcnt1_i32_b64 s27, vcc
s_add_u32 s26, s26, s27
s_cmp_eq_u32 s26, 136
s_cbranch_scc1 .Lwo_19
s_sleep 32
s_sub_u32 s25, s25, 1
s_cbranch_scc0 .Lwr_18
s_mov_b32 s39, 0
.Lwo_19:
.Lww_17:
s_barrier
v_and_b32 v5, 15, v0
v_lshrrev_b32 v6, 4, v0
s_lshl_b32 s29, s17, 4
v_add_u32 v7, s29, v5
v_cvt_f32_u32 v8, v7
v_cvt_f32_u32 v9, v6
v_cvt_f32_u32 v10, v5
v_mul_f32 v11, 0x3c800000, v8
v_mul_f32 v162, 0x41000000, v9
v_add_f32 v156, 0x0, v162
v_mul_f32 v156, v156, v11
v_fract_f32 v156, v156
v_add_f32 v157, 0x3f800000, v162
v_mul_f32 v157, v157, v11
v_fract_f32 v157, v157
v_cos_f32 v158, v156
v_cos_f32 v159, v157
v_sin_f32 v160, v156
v_sin_f32 v161, v157
s_nop 0
v_cvt_pk_bf16_f32 v164, v158, v159
v_cvt_pk_bf16_f32 v172, v160, v161
v_add_f32 v156, 0x40000000, v162
v_mul_f32 v156, v156, v11
v_fract_f32 v156, v156
v_add_f32 v157, 0x40400000, v162
v_mul_f32 v157, v157, v11
v_fract_f32 v157, v157
v_cos_f32 v158, v156
v_cos_f32 v159, v157
v_sin_f32 v160, v156
v_sin_f32 v161, v157
s_nop 0
v_cvt_pk_bf16_f32 v165, v158, v159
v_cvt_pk_bf16_f32 v173, v160, v161
v_add_f32 v156, 0x40800000, v162
v_mul_f32 v156, v156, v11
v_fract_f32 v156, v156
v_add_f32 v157, 0x40a00000, v162
v_mul_f32 v157, v157, v11
v_fract_f32 v157, v157
v_cos_f32 v158, v156
v_cos_f32 v159, v157
v_sin_f32 v160, v156
v_sin_f32 v161, v157
s_nop 0
v_cvt_pk_bf16_f32 v166, v158, v159
v_cvt_pk_bf16_f32 v174, v160, v161
v_add_f32 v156, 0x40c00000, v162
v_mul_f32 v156, v156, v11
v_fract_f32 v156, v156
v_add_f32 v157, 0x40e00000, v162
v_mul_f32 v157, v157, v11
v_fract_f32 v157, v157
v_cos_f32 v158, v156
v_cos_f32 v159, v157
v_sin_f32 v160, v156
v_sin_f32 v161, v157
s_nop 0
v_cvt_pk_bf16_f32 v167, v158, v159
v_cvt_pk_bf16_f32 v175, v160, v161
v_add_f32 v156, 0x42000000, v162
v_mul_f32 v156, v156, v11
v_fract_f32 v156, v156
v_add_f32 v157, 0x42040000, v162
v_mul_f32 v157, v157, v11
v_fract_f32 v157, v157
v_cos_f32 v158, v156
v_cos_f32 v159, v157
v_sin_f32 v160, v156
v_sin_f32 v161, v157
s_nop 0
v_cvt_pk_bf16_f32 v168, v158, v159
v_cvt_pk_bf16_f32 v176, v160, v161
v_add_f32 v156, 0x42080000, v162
v_mul_f32 v156, v156, v11
v_fract_f32 v156, v156
v_add_f32 v157, 0x420c0000, v162
v_mul_f32 v157, v157, v11
v_fract_f32 v157, v157
v_cos_f32 v158, v156
v_cos_f32 v159, v157
v_sin_f32 v160, v156
v_sin_f32 v161, v157
s_nop 0
v_cvt_pk_bf16_f32 v169, v158, v159
v_cvt_pk_bf16_f32 v177, v160, v161
v_add_f32 v156, 0x42100000, v162
v_mul_f32 v156, v156, v11
v_fract_f32 v156, v156
v_add_f32 v157, 0x42140000, v162
v_mul_f32 v157, v157, v11
v_fract_f32 v157, v157
v_cos_f32 v158, v156
v_cos_f32 v159, v157
v_sin_f32 v160, v156
v_sin_f32 v161, v157
s_nop 0
v_cvt_pk_bf16_f32 v170, v158, v159
v_cvt_pk_bf16_f32 v178, v160, v161
v_add_f32 v156, 0x42180000, v162
v_mul_f32 v156, v156, v11
v_fract_f32 v156, v156
v_add_f32 v157, 0x421c0000, v162
v_mul_f32 v157, v157, v11
v_fract_f32 v157, v157
v_cos_f32 v158, v156
v_cos_f32 v159, v157
v_sin_f32 v160, v156
v_sin_f32 v161, v157
s_nop 0
v_cvt_pk_bf16_f32 v171, v158, v159
v_cvt_pk_bf16_f32 v179, v160, v161
v_xor_b32 v180, 0x80008000, v172
v_xor_b32 v181, 0x80008000, v173
v_xor_b32 v182, 0x80008000, v174
v_xor_b32 v183, 0x80008000, v175
v_xor_b32 v184, 0x80008000, v176
v_xor_b32 v185, 0x80008000, v177
v_xor_b32 v186, 0x80008000, v178
v_xor_b32 v187, 0x80008000, v179
v_mul_f32 v162, 4.0, v9
v_add_f32 v156, 0x0, v162
v_add_f32 v163, 0x0, v10
v_mul_f32 v156, v156, v163
v_mul_f32 v156, 0x3d000000, v156
v_fract_f32 v156, v156
v_add_f32 v157, 0x3f800000, v162
v_add_f32 v163, 0x0, v10
v_mul_f32 v157, v157, v163
v_mul_f32 v157, 0x3d000000, v157
v_fract_f32 v157, v157
v_cos_f32 v158, v156
v_cos_f32 v159, v157
v_sin_f32 v160, v156
v_sin_f32 v161, v157
s_nop 0
v_cvt_pk_bf16_f32 v188, v158, v159
v_cvt_pk_bf16_f32 v196, v160, v161
v_add_f32 v156, 0x40000000, v162
v_add_f32 v163, 0x0, v10
v_mul_f32 v156, v156, v163
v_mul_f32 v156, 0x3d000000, v156
v_fract_f32 v156, v156
v_add_f32 v157, 0x40400000, v162
v_add_f32 v163, 0x0, v10
v_mul_f32 v157, v157, v163
v_mul_f32 v157, 0x3d000000, v157
v_fract_f32 v157, v157
v_cos_f32 v158, v156
v_cos_f32 v159, v157
v_sin_f32 v160, v156
v_sin_f32 v161, v157
s_nop 0
v_cvt_pk_bf16_f32 v189, v158, v159
v_cvt_pk_bf16_f32 v197, v160, v161
v_add_f32 v156, 0x41800000, v162
v_add_f32 v163, 0x0, v10
v_mul_f32 v156, v156, v163
v_mul_f32 v156, 0x3d000000, v156
v_fract_f32 v156, v156
v_add_f32 v157, 0x41880000, v162
v_add_f32 v163, 0x0, v10
v_mul_f32 v157, v157, v163
v_mul_f32 v157, 0x3d000000, v157
v_fract_f32 v157, v157
v_cos_f32 v158, v156
v_cos_f32 v159, v157
v_sin_f32 v160, v156
v_sin_f32 v161, v157
s_nop 0
v_cvt_pk_bf16_f32 v190, v158, v159
v_cvt_pk_bf16_f32 v198, v160, v161
v_add_f32 v156, 0x41900000, v162
v_add_f32 v163, 0x0, v10
v_mul_f32 v156, v156, v163
v_mul_f32 v156, 0x3d000000, v156
v_fract_f32 v156, v156
v_add_f32 v157, 0x41980000, v162
v_add_f32 v163, 0x0, v10
v_mul_f32 v157, v157, v163
v_mul_f32 v157, 0x3d000000, v157
v_fract_f32 v157, v157
v_cos_f32 v158, v156
v_cos_f32 v159, v157
v_sin_f32 v160, v156
v_sin_f32 v161, v157
s_nop 0
v_cvt_pk_bf16_f32 v191, v158, v159
v_cvt_pk_bf16_f32 v199, v160, v161
v_add_f32 v156, 0x0, v162
v_add_f32 v163, 0x41800000, v10
v_mul_f32 v156, v156, v163
v_mul_f32 v156, 0x3d000000, v156
v_fract_f32 v156, v156
v_add_f32 v157, 0x3f800000, v162
v_add_f32 v163, 0x41800000, v10
v_mul_f32 v157, v157, v163
v_mul_f32 v157, 0x3d000000, v157
v_fract_f32 v157, v157
v_cos_f32 v158, v156
v_cos_f32 v159, v157
v_sin_f32 v160, v156
v_sin_f32 v161, v157
s_nop 0
v_cvt_pk_bf16_f32 v192, v158, v159
v_cvt_pk_bf16_f32 v200, v160, v161
v_add_f32 v156, 0x40000000, v162
v_add_f32 v163, 0x41800000, v10
v_mul_f32 v156, v156, v163
v_mul_f32 v156, 0x3d000000, v156
v_fract_f32 v156, v156
v_add_f32 v157, 0x40400000, v162
v_add_f32 v163, 0x41800000, v10
v_mul_f32 v157, v157, v163
v_mul_f32 v157, 0x3d000000, v157
v_fract_f32 v157, v157
v_cos_f32 v158, v156
v_cos_f32 v159, v157
v_sin_f32 v160, v156
v_sin_f32 v161, v157
s_nop 0
v_cvt_pk_bf16_f32 v193, v158, v159
v_cvt_pk_bf16_f32 v201, v160, v161
v_add_f32 v156, 0x41800000, v162
v_add_f32 v163, 0x41800000, v10
v_mul_f32 v156, v156, v163
v_mul_f32 v156, 0x3d000000, v156
v_fract_f32 v156, v156
v_add_f32 v157, 0x41880000, v162
v_add_f32 v163, 0x41800000, v10
v_mul_f32 v157, v157, v163
v_mul_f32 v157, 0x3d000000, v157
v_fract_f32 v157, v157
v_cos_f32 v158, v156
v_cos_f32 v159, v157
v_sin_f32 v160, v156
v_sin_f32 v161, v157
s_nop 0
v_cvt_pk_bf16_f32 v194, v158, v159
v_cvt_pk_bf16_f32 v202, v160, v161
v_add_f32 v156, 0x41900000, v162
v_add_f32 v163, 0x41800000, v10
v_mul_f32 v156, v156, v163
v_mul_f32 v156, 0x3d000000, v156
v_fract_f32 v156, v156
v_add_f32 v157, 0x41980000, v162
v_add_f32 v163, 0x41800000, v10
v_mul_f32 v157, v157, v163
v_mul_f32 v157, 0x3d000000, v157
v_fract_f32 v157, v157
v_cos_f32 v158, v156
v_cos_f32 v159, v157
v_sin_f32 v160, v156
v_sin_f32 v161, v157
s_nop 0
v_cvt_pk_bf16_f32 v195, v158, v159
v_cvt_pk_bf16_f32 v203, v160, v161
v_xor_b32 v204, 0x80008000, v196
v_xor_b32 v205, 0x80008000, v197
v_xor_b32 v206, 0x80008000, v198
v_xor_b32 v207, 0x80008000, v199
v_xor_b32 v208, 0x80008000, v200
v_xor_b32 v209, 0x80008000, v201
v_xor_b32 v210, 0x80008000, v202
v_xor_b32 v211, 0x80008000, v203
v_mul_f32 v11, 0x3a000000, v8
v_add_f32 v156, 0x0, v162
v_mul_f32 v156, v156, v11
v_cos_f32 v212, v156
v_sin_f32 v220, v156
v_add_f32 v156, 0x3f800000, v162
v_mul_f32 v156, v156, v11
v_cos_f32 v213, v156
v_sin_f32 v221, v156
v_add_f32 v156, 0x40000000, v162
v_mul_f32 v156, v156, v11
v_cos_f32 v214, v156
v_sin_f32 v222, v156
v_add_f32 v156, 0x40400000, v162
v_mul_f32 v156, v156, v11
v_cos_f32 v215, v156
v_sin_f32 v223, v156
v_add_f32 v156, 0x41800000, v162
v_mul_f32 v156, v156, v11
v_cos_f32 v216, v156
v_sin_f32 v224, v156
v_add_f32 v156, 0x41880000, v162
v_mul_f32 v156, v156, v11
v_cos_f32 v217, v156
v_sin_f32 v225, v156
v_add_f32 v156, 0x41900000, v162
v_mul_f32 v156, v156, v11
v_cos_f32 v218, v156
v_sin_f32 v226, v156
v_add_f32 v156, 0x41980000, v162
v_mul_f32 v156, v156, v11
v_cos_f32 v219, v156
v_sin_f32 v227, v156
v_lshlrev_b32 v1, 4, v0
s_lshl_b32 s28, s18, 13
s_lshl_b32 s29, s17, 11
s_add_u32 s28, s28, s29
s_add_u32 s28, s28, 63660032
buffer_load_dwordx4 v[228:231], v1, s[8:11], s28 offen
buffer_load_dwordx4 v[232:235], v1, s[8:11], s28 offen offset:1024
v_lshlrev_b32 v1, 4, v0
v_and_b32 v5, 15, v0
v_lshrrev_b32 v6, 4, v0
s_lshl_b32 s29, s17, 4
v_add_u32 v7, s29, v5
v_lshlrev_b32 v2, 9, v6
v_lshrrev_b32 v156, 2, v5
v_lshlrev_b32 v156, 6, v156
v_and_b32 v157, 3, v0
v_lshlrev_b32 v157, 3, v157
v_add3_u32 v2, v2, v156, v157
v_lshlrev_b32 v3, 6, v7
v_lshlrev_b32 v156, 3, v6
v_add_u32 v3, v3, v156
v_lshlrev_b32 v4, 6, v7
v_and_b32 v156, 1, v6
v_lshlrev_b32 v156, 5, v156
v_lshrrev_b32 v157, 1, v6
v_lshlrev_b32 v157, 4, v157
v_add3_u32 v4, v4, v156, v157
s_cmp_lg_u32 s17, 0
s_cbranch_scc1 .Lww_20
s_mov_b32 s24, 68180736
v_lshlrev_b32 v248, 2, v0
v_mov_b32 v252, 0x10000000
v_cmp_gt_u32 vcc, 1, v0
s_mov_b32 s25, s39
s_nop 0
v_cndmask_b32 v248, v252, v248, vcc
.Lwr_21:
buffer_load_dword v252, v248, s[8:11], s24 offen sc1
s_waitcnt vmcnt(0)
v_cmp_eq_u32 vcc, 1, v252
s_nop 1
s_bcnt1_i32_b64 s26, vcc
s_cmp_eq_u32 s26, 1
s_cbranch_scc1 .Lwo_22
s_sleep 32
s_sub_u32 s25, s25, 1
s_cbranch_scc0 .Lwr_21
s_mov_b32 s39, 0
.Lwo_22:
s_mov_b32 s24, 68180800
v_lshlrev_b32 v248, 2, v0
v_mov_b32 v252, 0x10000000
v_cmp_gt_u32 vcc, 16, v0
s_mov_b32 s25, s39
s_nop 0
v_cndmask_b32 v248, v252, v248, vcc
.Lwr_23:
buffer_load_dword v252, v248, s[8:11], s24 offen sc1
s_waitcnt vmcnt(0)
v_cmp_eq_u32 vcc, 1, v252
s_nop 1
s_bcnt1_i32_b64 s26, vcc
s_cmp_eq_u32 s26, 16
s_cbranch_scc1 .Lwo_24
s_sleep 2
s_sub_u32 s25, s25, 1
s_cbranch_scc0 .Lwr_23
s_mov_b32 s39, 0
.Lwo_24:
.Lww_20:
s_barrier
s_cmp_eq_u32 s17, 3
s_cselect_b32 s28, 32, 64
v_mov_b32 v156, 0x10000000
v_cmp_gt_u32 vcc, s28, v0
s_nop 1
v_cndmask_b32 v156, v156, v1, vcc
s_mul_i32 s24, s18, 4096
s_lshl_b32 s25, s17, 10
s_add_u32 s26, s24, s25
s_add_u32 s26, s26, 58462208
s_mov_b32 m0, s25
s_add_u32 s27, s26, 921600
buffer_load_dwordx4 v156, s[8:11], s26 offen lds
s_add_u32 m0, s25, 4096
s_nop 0
buffer_load_dwordx4 v156, s[8:11], s27 offen lds
s_cmp_lg_u32 s17, 3
s_cbranch_scc1 .Lftk_25
v_lshlrev_b32 v157, 3, v0
v_add_u32 v157, 3584, v157
s_add_u32 s28, s24, 58462208
s_add_u32 s29, s28, 921600
s_mov_b32 s30, s39
.Lftr_26:
buffer_load_dwordx2 v[158:159], v157, s[8:11], s28 offen sc1
buffer_load_dwordx2 v[160:161], v157, s[8:11], s29 offen sc1
s_waitcnt vmcnt(0)
v_max_u32 v162, v158, v159
v_max3_u32 v162, v162, v160, v161
v_cmp_eq_u32 vcc, -1, v162
s_cbranch_vccz .Lfto_27
s_sub_u32 s30, s30, 1
s_cbranch_scc0 .Lftr_26
s_mov_b32 s39, 0
.Lfto_27:
ds_write_b64 v157, v[158:159]
ds_write_b64 v157, v[160:161] offset:4096
s_waitcnt lgkmcnt(0)
.Lftk_25:
s_waitcnt vmcnt(0)
s_barrier
ds_read_b64_tr_b16 v[84:85], v2 offset:0
ds_read_b64_tr_b16 v[86:87], v2 offset:256
ds_read_b64_tr_b16 v[88:89], v2 offset:2048
ds_read_b64_tr_b16 v[90:91], v2 offset:2304
ds_read_b64_tr_b16 v[92:93], v2 offset:32
ds_read_b64_tr_b16 v[94:95], v2 offset:288
ds_read_b64_tr_b16 v[96:97], v2 offset:2080
ds_read_b64_tr_b16 v[98:99], v2 offset:2336
ds_read_b64_tr_b16 v[100:101], v2 offset:4096
ds_read_b64_tr_b16 v[102:103], v2 offset:4352
ds_read_b64_tr_b16 v[104:105], v2 offset:6144
ds_read_b64_tr_b16 v[106:107], v2 offset:6400
ds_read_b64_tr_b16 v[108:109], v2 offset:4128
ds_read_b64_tr_b16 v[110:111], v2 offset:4384
ds_read_b64_tr_b16 v[112:113], v2 offset:6176
ds_read_b64_tr_b16 v[114:115], v2 offset:6432
s_waitcnt lgkmcnt(0)
v_mfma_f32_16x16x32_bf16 v[116:119], v[84:87], v[164:167], 0
v_mfma_f32_16x16x32_bf16 v[124:127], v[100:103], v[164:167], 0
v_mfma_f32_16x16x32_bf16 v[120:123], v[92:95], v[164:167], 0
v_mfma_f32_16x16x32_bf16 v[128:131], v[108:111], v[164:167], 0
v_mfma_f32_16x16x32_bf16 v[116:119], v[88:91], v[168:171], v[116:119]
v_mfma_f32_16x16x32_bf16 v[124:127], v[104:107], v[168:171], v[124:127]
v_mfma_f32_16x16x32_bf16 v[120:123], v[96:99], v[168:171], v[120:123]
v_mfma_f32_16x16x32_bf16 v[128:131], v[112:115], v[168:171], v[128:131]
v_mfma_f32_16x16x32_bf16 v[116:119], v[100:103], v[172:175], v[116:119]
v_mfma_f32_16x16x32_bf16 v[124:127], v[84:87], v[180:183], v[124:127]
v_mfma_f32_16x16x32_bf16 v[120:123], v[108:111], v[172:175], v[120:123]
v_mfma_f32_16x16x32_bf16 v[128:131], v[92:95], v[180:183], v[128:131]
v_mfma_f32_16x16x32_bf16 v[116:119], v[104:107], v[176:179], v[116:119]
v_mfma_f32_16x16x32_bf16 v[124:127], v[88:91], v[184:187], v[124:127]
v_mfma_f32_16x16x32_bf16 v[120:123], v[112:115], v[176:179], v[120:123]
v_mfma_f32_16x16x32_bf16 v[128:131], v[96:99], v[184:187], v[128:131]
s_nop 7
v_mul_f32 v156, v116, v212
v_mul_f32 v157, v124, v212
v_fma_f32 v156, v124, v220, v156
v_fma_f32 v124, -v116, v220, v157
v_mov_b32 v116, v156
v_mul_f32 v156, v117, v213
v_mul_f32 v157, v125, v213
v_fma_f32 v156, v125, v221, v156
v_fma_f32 v125, -v117, v221, v157
v_mov_b32 v117, v156
v_mul_f32 v156, v118, v214
v_mul_f32 v157, v126, v214
v_fma_f32 v156, v126, v222, v156
v_fma_f32 v126, -v118, v222, v157
v_mov_b32 v118, v156
v_mul_f32 v156, v119, v215
v_mul_f32 v157, v127, v215
v_fma_f32 v156, v127, v223, v156
v_fma_f32 v127, -v119, v223, v157
v_mov_b32 v119, v156
v_mul_f32 v156, v120, v216
v_mul_f32 v157, v128, v216
v_fma_f32 v156, v128, v224, v156
v_fma_f32 v128, -v120, v224, v157
v_mov_b32 v120, v156
v_mul_f32 v156, v121, v217
v_mul_f32 v157, v129, v217
v_fma_f32 v156, v129, v225, v156
v_fma_f32 v129, -v121, v225, v157
v_mov_b32 v121, v156
v_mul_f32 v156, v122, v218
v_mul_f32 v157, v130, v218
v_fma_f32 v156, v130, v226, v156
v_fma_f32 v130, -v122, v226, v157
v_mov_b32 v122, v156
v_mul_f32 v156, v123, v219
v_mul_f32 v157, v131, v219
v_fma_f32 v156, v131, v227, v156
v_fma_f32 v131, -v123, v227, v157
v_mov_b32 v123, v156
v_cvt_pk_bf16_f32 v132, v116, v117
v_cvt_pk_bf16_f32 v133, v118, v119
v_cvt_pk_bf16_f32 v134, v120, v121
v_cvt_pk_bf16_f32 v135, v122, v123
v_cvt_pk_bf16_f32 v136, v124, v125
v_cvt_pk_bf16_f32 v137, v126, v127
v_cvt_pk_bf16_f32 v138, v128, v129
v_cvt_pk_bf16_f32 v139, v130, v131
v_mul_f32 v212, 0x3a000000, v212
v_mul_f32 v220, 0x3a000000, v220
v_mul_f32 v213, 0x3a000000, v213
v_mul_f32 v221, 0x3a000000, v221
v_mul_f32 v214, 0x3a000000, v214
v_mul_f32 v222, 0x3a000000, v222
v_mul_f32 v215, 0x3a000000, v215
v_mul_f32 v223, 0x3a000000, v223
v_mul_f32 v216, 0x3a000000, v216
v_mul_f32 v224, 0x3a000000, v224
v_mul_f32 v217, 0x3a000000, v217
v_mul_f32 v225, 0x3a000000, v225
v_mul_f32 v218, 0x3a000000, v218
v_mul_f32 v226, 0x3a000000, v226
v_mul_f32 v219, 0x3a000000, v219
v_mul_f32 v227, 0x3a000000, v227
v_mfma_f32_16x16x32_bf16 v[140:143], v[188:191], v[132:135], 0
v_mfma_f32_16x16x32_bf16 v[148:151], v[188:191], v[136:139], 0
v_mfma_f32_16x16x32_bf16 v[144:147], v[192:195], v[132:135], 0
v_mfma_f32_16x16x32_bf16 v[152:155], v[192:195], v[136:139], 0
v_mfma_f32_16x16x32_bf16 v[140:143], v[196:199], v[136:139], v[140:143]
v_mfma_f32_16x16x32_bf16 v[148:151], v[204:207], v[132:135], v[148:151]
v_mfma_f32_16x16x32_bf16 v[144:147], v[200:203], v[136:139], v[144:147]
v_mfma_f32_16x16x32_bf16 v[152:155], v[208:211], v[132:135], v[152:155]
s_waitcnt vmcnt(0)
s_nop 6
v_lshlrev_b32 v156, 16, v228
v_and_b32 v157, 0xffff0000, v228
v_mul_f32 v158, v140, v156
v_mul_f32 v159, v148, v156
v_fma_f32 v158, -v148, v157, v158
v_fma_f32 v148, v140, v157, v159
v_mov_b32 v140, v158
v_lshlrev_b32 v156, 16, v229
v_and_b32 v157, 0xffff0000, v229
v_mul_f32 v158, v141, v156
v_mul_f32 v159, v149, v156
v_fma_f32 v158, -v149, v157, v158
v_fma_f32 v149, v141, v157, v159
v_mov_b32 v141, v158
v_lshlrev_b32 v156, 16, v230
v_and_b32 v157, 0xffff0000, v230
v_mul_f32 v158, v142, v156
v_mul_f32 v159, v150, v156
v_fma_f32 v158, -v150, v157, v158
v_fma_f32 v150, v142, v157, v159
v_mov_b32 v142, v158
v_lshlrev_b32 v156, 16, v231
v_and_b32 v157, 0xffff0000, v231
v_mul_f32 v158, v143, v156
v_mul_f32 v159, v151, v156
v_fma_f32 v158, -v151, v157, v158
v_fma_f32 v151, v143, v157, v159
v_mov_b32 v143, v158
v_lshlrev_b32 v156, 16, v232
v_and_b32 v157, 0xffff0000, v232
v_mul_f32 v158, v144, v156
v_mul_f32 v159, v152, v156
v_fma_f32 v158, -v152, v157, v158
v_fma_f32 v152, v144, v157, v159
v_mov_b32 v144, v158
v_lshlrev_b32 v156, 16, v233
v_and_b32 v157, 0xffff0000, v233
v_mul_f32 v158, v145, v156
v_mul_f32 v159, v153, v156
v_fma_f32 v158, -v153, v157, v158
v_fma_f32 v153, v145, v157, v159
v_mov_b32 v145, v158
v_lshlrev_b32 v156, 16, v234
v_and_b32 v157, 0xffff0000, v234
v_mul_f32 v158, v146, v156
v_mul_f32 v159, v154, v156
v_fma_f32 v158, -v154, v157, v158
v_fma_f32 v154, v146, v157, v159
v_mov_b32 v146, v158
v_lshlrev_b32 v156, 16, v235
v_and_b32 v157, 0xffff0000, v235
v_mul_f32 v158, v147, v156
v_mul_f32 v159, v155, v156
v_fma_f32 v158, -v155, v157, v158
v_fma_f32 v155, v147, v157, v159
v_mov_b32 v147, v158
v_cvt_pk_bf16_f32 v132, v140, v141
v_cvt_pk_bf16_f32 v133, v142, v143
v_cvt_pk_bf16_f32 v134, v144, v145
v_cvt_pk_bf16_f32 v135, v146, v147
v_cvt_pk_bf16_f32 v136, v148, v149
v_cvt_pk_bf16_f32 v137, v150, v151
v_cvt_pk_bf16_f32 v138, v152, v153
v_cvt_pk_bf16_f32 v139, v154, v155
s_nop 1
v_mfma_f32_16x16x32_bf16 v[116:119], v[188:191], v[132:135], 0
v_mfma_f32_16x16x32_bf16 v[124:127], v[188:191], v[136:139], 0
v_mfma_f32_16x16x32_bf16 v[120:123], v[192:195], v[132:135], 0
v_mfma_f32_16x16x32_bf16 v[128:131], v[192:195], v[136:139], 0
v_mfma_f32_16x16x32_bf16 v[116:119], v[204:207], v[136:139], v[116:119]
v_mfma_f32_16x16x32_bf16 v[124:127], v[196:199], v[132:135], v[124:127]
v_mfma_f32_16x16x32_bf16 v[120:123], v[208:211], v[136:139], v[120:123]
v_mfma_f32_16x16x32_bf16 v[128:131], v[200:203], v[132:135], v[128:131]
s_nop 7
v_mul_f32 v156, v116, v212
v_mul_f32 v157, v124, v212
v_fma_f32 v156, -v124, v220, v156
v_fma_f32 v124, v116, v220, v157
v_mov_b32 v116, v156
v_mul_f32 v156, v117, v213
v_mul_f32 v157, v125, v213
v_fma_f32 v156, -v125, v221, v156
v_fma_f32 v125, v117, v221, v157
v_mov_b32 v117, v156
v_mul_f32 v156, v118, v214
v_mul_f32 v157, v126, v214
v_fma_f32 v156, -v126, v222, v156
v_fma_f32 v126, v118, v222, v157
v_mov_b32 v118, v156
v_mul_f32 v156, v119, v215
v_mul_f32 v157, v127, v215
v_fma_f32 v156, -v127, v223, v156
v_fma_f32 v127, v119, v223, v157
v_mov_b32 v119, v156
v_mul_f32 v156, v120, v216
v_mul_f32 v157, v128, v216
v_fma_f32 v156, -v128, v224, v156
v_fma_f32 v128, v120, v224, v157
v_mov_b32 v120, v156
v_mul_f32 v156, v121, v217
v_mul_f32 v157, v129, v217
v_fma_f32 v156, -v129, v225, v156
v_fma_f32 v129, v121, v225, v157
v_mov_b32 v121, v156
v_mul_f32 v156, v122, v218
v_mul_f32 v157, v130, v218
v_fma_f32 v156, -v130, v226, v156
v_fma_f32 v130, v122, v226, v157
v_mov_b32 v122, v156
v_mul_f32 v156, v123, v219
v_mul_f32 v157, v131, v219
v_fma_f32 v156, -v131, v227, v156
v_fma_f32 v131, v123, v227, v157
v_mov_b32 v123, v156
v_cvt_pk_bf16_f32 v132, v116, v117
v_cvt_pk_bf16_f32 v133, v118, v119
v_cvt_pk_bf16_f32 v134, v120, v121
v_cvt_pk_bf16_f32 v135, v122, v123
v_cvt_pk_bf16_f32 v136, v124, v125
v_cvt_pk_bf16_f32 v137, v126, v127
v_cvt_pk_bf16_f32 v138, v128, v129
v_cvt_pk_bf16_f32 v139, v130, v131
ds_write_b64 v3, v[132:133] offset:8192
ds_write_b64 v3, v[134:135] offset:8224
ds_write_b64 v3, v[136:137] offset:12288
ds_write_b64 v3, v[138:139] offset:12320
s_waitcnt lgkmcnt(0)
s_barrier
ds_read_b64_tr_b16 v[84:85], v2 offset:8192
ds_read_b64_tr_b16 v[86:87], v2 offset:8448
ds_read_b64_tr_b16 v[88:89], v2 offset:10240
ds_read_b64_tr_b16 v[90:91], v2 offset:10496
ds_read_b64_tr_b16 v[92:93], v2 offset:8224
ds_read_b64_tr_b16 v[94:95], v2 offset:8480
ds_read_b64_tr_b16 v[96:97], v2 offset:10272
ds_read_b64_tr_b16 v[98:99], v2 offset:10528
ds_read_b64_tr_b16 v[100:101], v2 offset:12288
ds_read_b64_tr_b16 v[102:103], v2 offset:12544
ds_read_b64_tr_b16 v[104:105], v2 offset:14336
ds_read_b64_tr_b16 v[106:107], v2 offset:14592
ds_read_b64_tr_b16 v[108:109], v2 offset:12320
ds_read_b64_tr_b16 v[110:111], v2 offset:12576
ds_read_b64_tr_b16 v[112:113], v2 offset:14368
ds_read_b64_tr_b16 v[114:115], v2 offset:14624
s_waitcnt lgkmcnt(0)
v_mfma_f32_16x16x32_bf16 v[116:119], v[84:87], v[164:167], 0
v_mfma_f32_16x16x32_bf16 v[124:127], v[100:103], v[164:167], 0
v_mfma_f32_16x16x32_bf16 v[120:123], v[92:95], v[164:167], 0
v_mfma_f32_16x16x32_bf16 v[128:131], v[108:111], v[164:167], 0
v_mfma_f32_16x16x32_bf16 v[116:119], v[88:91], v[168:171], v[116:119]
v_mfma_f32_16x16x32_bf16 v[124:127], v[104:107], v[168:171], v[124:127]
v_mfma_f32_16x16x32_bf16 v[120:123], v[96:99], v[168:171], v[120:123]
v_mfma_f32_16x16x32_bf16 v[128:131], v[112:115], v[168:171], v[128:131]
v_mfma_f32_16x16x32_bf16 v[116:119], v[100:103], v[180:183], v[116:119]
v_mfma_f32_16x16x32_bf16 v[124:127], v[84:87], v[172:175], v[124:127]
v_mfma_f32_16x16x32_bf16 v[120:123], v[108:111], v[180:183], v[120:123]
v_mfma_f32_16x16x32_bf16 v[128:131], v[92:95], v[172:175], v[128:131]
v_mfma_f32_16x16x32_bf16 v[116:119], v[104:107], v[184:187], v[116:119]
v_mfma_f32_16x16x32_bf16 v[124:127], v[88:91], v[176:179], v[124:127]
v_mfma_f32_16x16x32_bf16 v[120:123], v[112:115], v[184:187], v[120:123]
v_mfma_f32_16x16x32_bf16 v[128:131], v[96:99], v[176:179], v[128:131]
s_mul_i32 s24, s18, 4096
s_add_u32 s24, s24, 60674048
s_add_u32 s25, s24, 921600
s_nop 5
v_cvt_pk_bf16_f32 v132, v116, v117
v_cvt_pk_bf16_f32 v133, v118, v119
v_cvt_pk_bf16_f32 v134, v120, v121
v_cvt_pk_bf16_f32 v135, v122, v123
s_nop 1
v_permlane16_swap_b32 v132, v134
v_permlane16_swap_b32 v133, v135
buffer_store_dwordx4 v[132:135], v4, s[8:11], s24 offen sc1
v_cvt_pk_bf16_f32 v136, v124, v125
v_cvt_pk_bf16_f32 v137, v126, v127
v_cvt_pk_bf16_f32 v138, v128, v129
v_cvt_pk_bf16_f32 v139, v130, v131
s_nop 1
v_permlane16_swap_b32 v136, v138
v_permlane16_swap_b32 v137, v139
buffer_store_dwordx4 v[136:139], v4, s[8:11], s25 offen sc1
s_mov_b32 s24, 68191104
s_lshl_b32 s25, s17, 6
v_add_u32 v4, s25, v0
v_cmp_gt_u32 vcc, 8, v4
v_lshlrev_b32 v4, 10, v4
v_mov_b32 v5, 0x10000000
v_cndmask_b32 v4, v5, v4, vcc
v_mov_b32 v5, 1
s_waitcnt vmcnt(0) lgkmcnt(0)
s_barrier
buffer_store_dword v5, v4, s[8:11], s24 offen sc1
v_and_b32 v5, 15, v0
v_lshrrev_b32 v6, 4, v0
s_lshl_b32 s29, s17, 4
v_add_u32 v7, s29, v5
v_cvt_f32_u32 v8, v7
v_cvt_f32_u32 v9, v6
v_cvt_f32_u32 v10, v5
v_mul_f32 v11, 0x3c800000, v8
v_mul_f32 v162, 0x41000000, v9
v_add_f32 v156, 0x0, v162
v_mul_f32 v156, v156, v11
v_fract_f32 v156, v156
v_add_f32 v157, 0x3f800000, v162
v_mul_f32 v157, v157, v11
v_fract_f32 v157, v157
v_cos_f32 v158, v156
v_cos_f32 v159, v157
v_sin_f32 v160, v156
v_sin_f32 v161, v157
s_nop 0
v_cvt_pk_bf16_f32 v164, v158, v159
v_cvt_pk_bf16_f32 v172, v160, v161
v_add_f32 v156, 0x40000000, v162
v_mul_f32 v156, v156, v11
v_fract_f32 v156, v156
v_add_f32 v157, 0x40400000, v162
v_mul_f32 v157, v157, v11
v_fract_f32 v157, v157
v_cos_f32 v158, v156
v_cos_f32 v159, v157
v_sin_f32 v160, v156
v_sin_f32 v161, v157
s_nop 0
v_cvt_pk_bf16_f32 v165, v158, v159
v_cvt_pk_bf16_f32 v173, v160, v161
v_add_f32 v156, 0x40800000, v162
v_mul_f32 v156, v156, v11
v_fract_f32 v156, v156
v_add_f32 v157, 0x40a00000, v162
v_mul_f32 v157, v157, v11
v_fract_f32 v157, v157
v_cos_f32 v158, v156
v_cos_f32 v159, v157
v_sin_f32 v160, v156
v_sin_f32 v161, v157
s_nop 0
v_cvt_pk_bf16_f32 v166, v158, v159
v_cvt_pk_bf16_f32 v174, v160, v161
v_add_f32 v156, 0x40c00000, v162
v_mul_f32 v156, v156, v11
v_fract_f32 v156, v156
v_add_f32 v157, 0x40e00000, v162
v_mul_f32 v157, v157, v11
v_fract_f32 v157, v157
v_cos_f32 v158, v156
v_cos_f32 v159, v157
v_sin_f32 v160, v156
v_sin_f32 v161, v157
s_nop 0
v_cvt_pk_bf16_f32 v167, v158, v159
v_cvt_pk_bf16_f32 v175, v160, v161
v_add_f32 v156, 0x42000000, v162
v_mul_f32 v156, v156, v11
v_fract_f32 v156, v156
v_add_f32 v157, 0x42040000, v162
v_mul_f32 v157, v157, v11
v_fract_f32 v157, v157
v_cos_f32 v158, v156
v_cos_f32 v159, v157
v_sin_f32 v160, v156
v_sin_f32 v161, v157
s_nop 0
v_cvt_pk_bf16_f32 v168, v158, v159
v_cvt_pk_bf16_f32 v176, v160, v161
v_add_f32 v156, 0x42080000, v162
v_mul_f32 v156, v156, v11
v_fract_f32 v156, v156
v_add_f32 v157, 0x420c0000, v162
v_mul_f32 v157, v157, v11
v_fract_f32 v157, v157
v_cos_f32 v158, v156
v_cos_f32 v159, v157
v_sin_f32 v160, v156
v_sin_f32 v161, v157
s_nop 0
v_cvt_pk_bf16_f32 v169, v158, v159
v_cvt_pk_bf16_f32 v177, v160, v161
v_add_f32 v156, 0x42100000, v162
v_mul_f32 v156, v156, v11
v_fract_f32 v156, v156
v_add_f32 v157, 0x42140000, v162
v_mul_f32 v157, v157, v11
v_fract_f32 v157, v157
v_cos_f32 v158, v156
v_cos_f32 v159, v157
v_sin_f32 v160, v156
v_sin_f32 v161, v157
s_nop 0
v_cvt_pk_bf16_f32 v170, v158, v159
v_cvt_pk_bf16_f32 v178, v160, v161
v_add_f32 v156, 0x42180000, v162
v_mul_f32 v156, v156, v11
v_fract_f32 v156, v156
v_add_f32 v157, 0x421c0000, v162
v_mul_f32 v157, v157, v11
v_fract_f32 v157, v157
v_cos_f32 v158, v156
v_cos_f32 v159, v157
v_sin_f32 v160, v156
v_sin_f32 v161, v157
s_nop 0
v_cvt_pk_bf16_f32 v171, v158, v159
v_cvt_pk_bf16_f32 v179, v160, v161
v_xor_b32 v180, 0x80008000, v172
v_xor_b32 v181, 0x80008000, v173
v_xor_b32 v182, 0x80008000, v174
v_xor_b32 v183, 0x80008000, v175
v_xor_b32 v184, 0x80008000, v176
v_xor_b32 v185, 0x80008000, v177
v_xor_b32 v186, 0x80008000, v178
v_xor_b32 v187, 0x80008000, v179
v_mul_f32 v162, 4.0, v9
v_add_f32 v156, 0x0, v162
v_add_f32 v163, 0x0, v10
v_mul_f32 v156, v156, v163
v_mul_f32 v156, 0x3d000000, v156
v_fract_f32 v156, v156
v_add_f32 v157, 0x3f800000, v162
v_add_f32 v163, 0x0, v10
v_mul_f32 v157, v157, v163
v_mul_f32 v157, 0x3d000000, v157
v_fract_f32 v157, v157
v_cos_f32 v158, v156
v_cos_f32 v159, v157
v_sin_f32 v160, v156
v_sin_f32 v161, v157
s_nop 0
v_cvt_pk_bf16_f32 v188, v158, v159
v_cvt_pk_bf16_f32 v196, v160, v161
v_add_f32 v156, 0x40000000, v162
v_add_f32 v163, 0x0, v10
v_mul_f32 v156, v156, v163
v_mul_f32 v156, 0x3d000000, v156
v_fract_f32 v156, v156
v_add_f32 v157, 0x40400000, v162
v_add_f32 v163, 0x0, v10
v_mul_f32 v157, v157, v163
v_mul_f32 v157, 0x3d000000, v157
v_fract_f32 v157, v157
v_cos_f32 v158, v156
v_cos_f32 v159, v157
v_sin_f32 v160, v156
v_sin_f32 v161, v157
s_nop 0
v_cvt_pk_bf16_f32 v189, v158, v159
v_cvt_pk_bf16_f32 v197, v160, v161
v_add_f32 v156, 0x41800000, v162
v_add_f32 v163, 0x0, v10
v_mul_f32 v156, v156, v163
v_mul_f32 v156, 0x3d000000, v156
v_fract_f32 v156, v156
v_add_f32 v157, 0x41880000, v162
v_add_f32 v163, 0x0, v10
v_mul_f32 v157, v157, v163
v_mul_f32 v157, 0x3d000000, v157
v_fract_f32 v157, v157
v_cos_f32 v158, v156
v_cos_f32 v159, v157
v_sin_f32 v160, v156
v_sin_f32 v161, v157
s_nop 0
v_cvt_pk_bf16_f32 v190, v158, v159
v_cvt_pk_bf16_f32 v198, v160, v161
v_add_f32 v156, 0x41900000, v162
v_add_f32 v163, 0x0, v10
v_mul_f32 v156, v156, v163
v_mul_f32 v156, 0x3d000000, v156
v_fract_f32 v156, v156
v_add_f32 v157, 0x41980000, v162
v_add_f32 v163, 0x0, v10
v_mul_f32 v157, v157, v163
v_mul_f32 v157, 0x3d000000, v157
v_fract_f32 v157, v157
v_cos_f32 v158, v156
v_cos_f32 v159, v157
v_sin_f32 v160, v156
v_sin_f32 v161, v157
s_nop 0
v_cvt_pk_bf16_f32 v191, v158, v159
v_cvt_pk_bf16_f32 v199, v160, v161
v_add_f32 v156, 0x0, v162
v_add_f32 v163, 0x41800000, v10
v_mul_f32 v156, v156, v163
v_mul_f32 v156, 0x3d000000, v156
v_fract_f32 v156, v156
v_add_f32 v157, 0x3f800000, v162
v_add_f32 v163, 0x41800000, v10
v_mul_f32 v157, v157, v163
v_mul_f32 v157, 0x3d000000, v157
v_fract_f32 v157, v157
v_cos_f32 v158, v156
v_cos_f32 v159, v157
v_sin_f32 v160, v156
v_sin_f32 v161, v157
s_nop 0
v_cvt_pk_bf16_f32 v192, v158, v159
v_cvt_pk_bf16_f32 v200, v160, v161
v_add_f32 v156, 0x40000000, v162
v_add_f32 v163, 0x41800000, v10
v_mul_f32 v156, v156, v163
v_mul_f32 v156, 0x3d000000, v156
v_fract_f32 v156, v156
v_add_f32 v157, 0x40400000, v162
v_add_f32 v163, 0x41800000, v10
v_mul_f32 v157, v157, v163
v_mul_f32 v157, 0x3d000000, v157
v_fract_f32 v157, v157
v_cos_f32 v158, v156
v_cos_f32 v159, v157
v_sin_f32 v160, v156
v_sin_f32 v161, v157
s_nop 0
v_cvt_pk_bf16_f32 v193, v158, v159
v_cvt_pk_bf16_f32 v201, v160, v161
v_add_f32 v156, 0x41800000, v162
v_add_f32 v163, 0x41800000, v10
v_mul_f32 v156, v156, v163
v_mul_f32 v156, 0x3d000000, v156
v_fract_f32 v156, v156
v_add_f32 v157, 0x41880000, v162
v_add_f32 v163, 0x41800000, v10
v_mul_f32 v157, v157, v163
v_mul_f32 v157, 0x3d000000, v157
v_fract_f32 v157, v157
v_cos_f32 v158, v156
v_cos_f32 v159, v157
v_sin_f32 v160, v156
v_sin_f32 v161, v157
s_nop 0
v_cvt_pk_bf16_f32 v194, v158, v159
v_cvt_pk_bf16_f32 v202, v160, v161
v_add_f32 v156, 0x41900000, v162
v_add_f32 v163, 0x41800000, v10
v_mul_f32 v156, v156, v163
v_mul_f32 v156, 0x3d000000, v156
v_fract_f32 v156, v156
v_add_f32 v157, 0x41980000, v162
v_add_f32 v163, 0x41800000, v10
v_mul_f32 v157, v157, v163
v_mul_f32 v157, 0x3d000000, v157
v_fract_f32 v157, v157
v_cos_f32 v158, v156
v_cos_f32 v159, v157
v_sin_f32 v160, v156
v_sin_f32 v161, v157
s_nop 0
v_cvt_pk_bf16_f32 v195, v158, v159
v_cvt_pk_bf16_f32 v203, v160, v161
v_xor_b32 v204, 0x80008000, v196
v_xor_b32 v205, 0x80008000, v197
v_xor_b32 v206, 0x80008000, v198
v_xor_b32 v207, 0x80008000, v199
v_xor_b32 v208, 0x80008000, v200
v_xor_b32 v209, 0x80008000, v201
v_xor_b32 v210, 0x80008000, v202
v_xor_b32 v211, 0x80008000, v203
v_mul_f32 v11, 0x3a000000, v8
v_add_f32 v156, 0x0, v162
v_mul_f32 v156, v156, v11
v_cos_f32 v212, v156
v_sin_f32 v220, v156
v_add_f32 v156, 0x3f800000, v162
v_mul_f32 v156, v156, v11
v_cos_f32 v213, v156
v_sin_f32 v221, v156
v_add_f32 v156, 0x40000000, v162
v_mul_f32 v156, v156, v11
v_cos_f32 v214, v156
v_sin_f32 v222, v156
v_add_f32 v156, 0x40400000, v162
v_mul_f32 v156, v156, v11
v_cos_f32 v215, v156
v_sin_f32 v223, v156
v_add_f32 v156, 0x41800000, v162
v_mul_f32 v156, v156, v11
v_cos_f32 v216, v156
v_sin_f32 v224, v156
v_add_f32 v156, 0x41880000, v162
v_mul_f32 v156, v156, v11
v_cos_f32 v217, v156
v_sin_f32 v225, v156
v_add_f32 v156, 0x41900000, v162
v_mul_f32 v156, v156, v11
v_cos_f32 v218, v156
v_sin_f32 v226, v156
v_add_f32 v156, 0x41980000, v162
v_mul_f32 v156, v156, v11
v_cos_f32 v219, v156
v_sin_f32 v227, v156
v_lshlrev_b32 v1, 4, v0
s_lshl_b32 s28, s18, 13
s_lshl_b32 s29, s17, 11
s_add_u32 s28, s28, s29
s_add_u32 s28, s28, 63660032
buffer_load_dwordx4 v[228:231], v1, s[8:11], s28 offen
buffer_load_dwordx4 v[232:235], v1, s[8:11], s28 offen offset:1024
v_lshlrev_b32 v1, 4, v0
v_and_b32 v5, 15, v0
v_lshrrev_b32 v6, 4, v0
s_lshl_b32 s29, s17, 4
v_add_u32 v7, s29, v5
v_lshlrev_b32 v2, 9, v6
v_lshrrev_b32 v156, 2, v5
v_lshlrev_b32 v156, 6, v156
v_and_b32 v157, 3, v0
v_lshlrev_b32 v157, 3, v157
v_add3_u32 v2, v2, v156, v157
v_lshlrev_b32 v3, 6, v7
v_lshlrev_b32 v156, 3, v6
v_add_u32 v3, v3, v156
v_lshlrev_b32 v4, 6, v7
v_and_b32 v156, 1, v6
v_lshlrev_b32 v156, 5, v156
v_lshrrev_b32 v157, 1, v6
v_lshlrev_b32 v157, 4, v157
v_add3_u32 v4, v4, v156, v157
s_cmp_lg_u32 s17, 0
s_cbranch_scc1 .Lww_28
s_mov_b32 s24, 118147840
v_lshlrev_b32 v248, 2, v0
v_mov_b32 v252, 0x10000000
v_cmp_gt_u32 vcc, 1, v0
s_mov_b32 s25, s39
s_nop 0
v_cndmask_b32 v248, v252, v248, vcc
.Lwr_29:
buffer_load_dword v252, v248, s[8:11], s24 offen sc1
s_waitcnt vmcnt(0)
v_cmp_eq_u32 vcc, 1, v252
s_nop 1
s_bcnt1_i32_b64 s26, vcc
s_cmp_eq_u32 s26, 1
s_cbranch_scc1 .Lwo_30
s_sleep 32
s_sub_u32 s25, s25, 1
s_cbranch_scc0 .Lwr_29
s_mov_b32 s39, 0
.Lwo_30:
s_mov_b32 s24, 118147904
v_lshlrev_b32 v248, 2, v0
v_mov_b32 v252, 0x10000000
v_cmp_gt_u32 vcc, 16, v0
s_mov_b32 s25, s39
s_nop 0
v_cndmask_b32 v248, v252, v248, vcc
.Lwr_31:
buffer_load_dword v252, v248, s[8:11], s24 offen sc1
s_waitcnt vmcnt(0)
v_cmp_eq_u32 vcc, 1, v252
s_nop 1
s_bcnt1_i32_b64 s26, vcc
s_cmp_eq_u32 s26, 16
s_cbranch_scc1 .Lwo_32
s_sleep 2
s_sub_u32 s25, s25, 1
s_cbranch_scc0 .Lwr_31
s_mov_b32 s39, 0
.Lwo_32:
.Lww_28:
s_barrier
s_cmp_eq_u32 s17, 3
s_cselect_b32 s28, 32, 64
v_mov_b32 v156, 0x10000000
v_cmp_gt_u32 vcc, s28, v0
s_nop 1
v_cndmask_b32 v156, v156, v1, vcc
s_mul_i32 s24, s18, 4096
s_lshl_b32 s25, s17, 10
s_add_u32 s26, s24, s25
s_add_u32 s26, s26, 111120384
s_mov_b32 m0, s25
s_add_u32 s27, s26, 921600
buffer_load_dwordx4 v156, s[8:11], s26 offen lds
s_add_u32 m0, s25, 4096
s_nop 0
buffer_load_dwordx4 v156, s[8:11], s27 offen lds
s_cmp_lg_u32 s17, 3
s_cbranch_scc1 .Lftk_33
v_lshlrev_b32 v157, 3, v0
v_add_u32 v157, 3584, v157
s_add_u32 s28, s24, 111120384
s_add_u32 s29, s28, 921600
s_mov_b32 s30, s39
.Lftr_34:
buffer_load_dwordx2 v[158:159], v157, s[8:11], s28 offen sc1
buffer_load_dwordx2 v[160:161], v157, s[8:11], s29 offen sc1
s_waitcnt vmcnt(0)
v_max_u32 v162, v158, v159
v_max3_u32 v162, v162, v160, v161
v_cmp_eq_u32 vcc, -1, v162
s_cbranch_vccz .Lfto_35
s_sub_u32 s30, s30, 1
s_cbranch_scc0 .Lftr_34
s_mov_b32 s39, 0
.Lfto_35:
ds_write_b64 v157, v[158:159]
ds_write_b64 v157, v[160:161] offset:4096
s_waitcnt lgkmcnt(0)
.Lftk_33:
s_waitcnt vmcnt(0)
s_barrier
ds_read_b64_tr_b16 v[84:85], v2 offset:0
ds_read_b64_tr_b16 v[86:87], v2 offset:256
ds_read_b64_tr_b16 v[88:89], v2 offset:2048
ds_read_b64_tr_b16 v[90:91], v2 offset:2304
ds_read_b64_tr_b16 v[92:93], v2 offset:32
ds_read_b64_tr_b16 v[94:95], v2 offset:288
ds_read_b64_tr_b16 v[96:97], v2 offset:2080
ds_read_b64_tr_b16 v[98:99], v2 offset:2336
ds_read_b64_tr_b16 v[100:101], v2 offset:4096
ds_read_b64_tr_b16 v[102:103], v2 offset:4352
ds_read_b64_tr_b16 v[104:105], v2 offset:6144
ds_read_b64_tr_b16 v[106:107], v2 offset:6400
ds_read_b64_tr_b16 v[108:109], v2 offset:4128
ds_read_b64_tr_b16 v[110:111], v2 offset:4384
ds_read_b64_tr_b16 v[112:113], v2 offset:6176
ds_read_b64_tr_b16 v[114:115], v2 offset:6432
s_waitcnt lgkmcnt(0)
v_mfma_f32_16x16x32_bf16 v[116:119], v[84:87], v[164:167], 0
v_mfma_f32_16x16x32_bf16 v[124:127], v[100:103], v[164:167], 0
v_mfma_f32_16x16x32_bf16 v[120:123], v[92:95], v[164:167], 0
v_mfma_f32_16x16x32_bf16 v[128:131], v[108:111], v[164:167], 0
v_mfma_f32_16x16x32_bf16 v[116:119], v[88:91], v[168:171], v[116:119]
v_mfma_f32_16x16x32_bf16 v[124:127], v[104:107], v[168:171], v[124:127]
v_mfma_f32_16x16x32_bf16 v[120:123], v[96:99], v[168:171], v[120:123]
v_mfma_f32_16x16x32_bf16 v[128:131], v[112:115], v[168:171], v[128:131]
v_mfma_f32_16x16x32_bf16 v[116:119], v[100:103], v[172:175], v[116:119]
v_mfma_f32_16x16x32_bf16 v[124:127], v[84:87], v[180:183], v[124:127]
v_mfma_f32_16x16x32_bf16 v[120:123], v[108:111], v[172:175], v[120:123]
v_mfma_f32_16x16x32_bf16 v[128:131], v[92:95], v[180:183], v[128:131]
v_mfma_f32_16x16x32_bf16 v[116:119], v[104:107], v[176:179], v[116:119]
v_mfma_f32_16x16x32_bf16 v[124:127], v[88:91], v[184:187], v[124:127]
v_mfma_f32_16x16x32_bf16 v[120:123], v[112:115], v[176:179], v[120:123]
v_mfma_f32_16x16x32_bf16 v[128:131], v[96:99], v[184:187], v[128:131]
s_nop 7
v_mul_f32 v156, v116, v212
v_mul_f32 v157, v124, v212
v_fma_f32 v156, v124, v220, v156
v_fma_f32 v124, -v116, v220, v157
v_mov_b32 v116, v156
v_mul_f32 v156, v117, v213
v_mul_f32 v157, v125, v213
v_fma_f32 v156, v125, v221, v156
v_fma_f32 v125, -v117, v221, v157
v_mov_b32 v117, v156
v_mul_f32 v156, v118, v214
v_mul_f32 v157, v126, v214
v_fma_f32 v156, v126, v222, v156
v_fma_f32 v126, -v118, v222, v157
v_mov_b32 v118, v156
v_mul_f32 v156, v119, v215
v_mul_f32 v157, v127, v215
v_fma_f32 v156, v127, v223, v156
v_fma_f32 v127, -v119, v223, v157
v_mov_b32 v119, v156
v_mul_f32 v156, v120, v216
v_mul_f32 v157, v128, v216
v_fma_f32 v156, v128, v224, v156
v_fma_f32 v128, -v120, v224, v157
v_mov_b32 v120, v156
v_mul_f32 v156, v121, v217
v_mul_f32 v157, v129, v217
v_fma_f32 v156, v129, v225, v156
v_fma_f32 v129, -v121, v225, v157
v_mov_b32 v121, v156
v_mul_f32 v156, v122, v218
v_mul_f32 v157, v130, v218
v_fma_f32 v156, v130, v226, v156
v_fma_f32 v130, -v122, v226, v157
v_mov_b32 v122, v156
v_mul_f32 v156, v123, v219
v_mul_f32 v157, v131, v219
v_fma_f32 v156, v131, v227, v156
v_fma_f32 v131, -v123, v227, v157
v_mov_b32 v123, v156
v_cvt_pk_bf16_f32 v132, v116, v117
v_cvt_pk_bf16_f32 v133, v118, v119
v_cvt_pk_bf16_f32 v134, v120, v121
v_cvt_pk_bf16_f32 v135, v122, v123
v_cvt_pk_bf16_f32 v136, v124, v125
v_cvt_pk_bf16_f32 v137, v126, v127
v_cvt_pk_bf16_f32 v138, v128, v129
v_cvt_pk_bf16_f32 v139, v130, v131
v_mul_f32 v212, 0x3a000000, v212
v_mul_f32 v220, 0x3a000000, v220
v_mul_f32 v213, 0x3a000000, v213
v_mul_f32 v221, 0x3a000000, v221
v_mul_f32 v214, 0x3a000000, v214
v_mul_f32 v222, 0x3a000000, v222
v_mul_f32 v215, 0x3a000000, v215
v_mul_f32 v223, 0x3a000000, v223
v_mul_f32 v216, 0x3a000000, v216
v_mul_f32 v224, 0x3a000000, v224
v_mul_f32 v217, 0x3a000000, v217
v_mul_f32 v225, 0x3a000000, v225
v_mul_f32 v218, 0x3a000000, v218
v_mul_f32 v226, 0x3a000000, v226
v_mul_f32 v219, 0x3a000000, v219
v_mul_f32 v227, 0x3a000000, v227
v_mfma_f32_16x16x32_bf16 v[140:143], v[188:191], v[132:135], 0
v_mfma_f32_16x16x32_bf16 v[148:151], v[188:191], v[136:139], 0
v_mfma_f32_16x16x32_bf16 v[144:147], v[192:195], v[132:135], 0
v_mfma_f32_16x16x32_bf16 v[152:155], v[192:195], v[136:139], 0
v_mfma_f32_16x16x32_bf16 v[140:143], v[196:199], v[136:139], v[140:143]
v_mfma_f32_16x16x32_bf16 v[148:151], v[204:207], v[132:135], v[148:151]
v_mfma_f32_16x16x32_bf16 v[144:147], v[200:203], v[136:139], v[144:147]
v_mfma_f32_16x16x32_bf16 v[152:155], v[208:211], v[132:135], v[152:155]
s_waitcnt vmcnt(0)
s_nop 6
v_lshlrev_b32 v156, 16, v228
v_and_b32 v157, 0xffff0000, v228
v_mul_f32 v158, v140, v156
v_mul_f32 v159, v148, v156
v_fma_f32 v158, -v148, v157, v158
v_fma_f32 v148, v140, v157, v159
v_mov_b32 v140, v158
v_lshlrev_b32 v156, 16, v229
v_and_b32 v157, 0xffff0000, v229
v_mul_f32 v158, v141, v156
v_mul_f32 v159, v149, v156
v_fma_f32 v158, -v149, v157, v158
v_fma_f32 v149, v141, v157, v159
v_mov_b32 v141, v158
v_lshlrev_b32 v156, 16, v230
v_and_b32 v157, 0xffff0000, v230
v_mul_f32 v158, v142, v156
v_mul_f32 v159, v150, v156
v_fma_f32 v158, -v150, v157, v158
v_fma_f32 v150, v142, v157, v159
v_mov_b32 v142, v158
v_lshlrev_b32 v156, 16, v231
v_and_b32 v157, 0xffff0000, v231
v_mul_f32 v158, v143, v156
v_mul_f32 v159, v151, v156
v_fma_f32 v158, -v151, v157, v158
v_fma_f32 v151, v143, v157, v159
v_mov_b32 v143, v158
v_lshlrev_b32 v156, 16, v232
v_and_b32 v157, 0xffff0000, v232
v_mul_f32 v158, v144, v156
v_mul_f32 v159, v152, v156
v_fma_f32 v158, -v152, v157, v158
v_fma_f32 v152, v144, v157, v159
v_mov_b32 v144, v158
v_lshlrev_b32 v156, 16, v233
v_and_b32 v157, 0xffff0000, v233
v_mul_f32 v158, v145, v156
v_mul_f32 v159, v153, v156
v_fma_f32 v158, -v153, v157, v158
v_fma_f32 v153, v145, v157, v159
v_mov_b32 v145, v158
v_lshlrev_b32 v156, 16, v234
v_and_b32 v157, 0xffff0000, v234
v_mul_f32 v158, v146, v156
v_mul_f32 v159, v154, v156
v_fma_f32 v158, -v154, v157, v158
v_fma_f32 v154, v146, v157, v159
v_mov_b32 v146, v158
v_lshlrev_b32 v156, 16, v235
v_and_b32 v157, 0xffff0000, v235
v_mul_f32 v158, v147, v156
v_mul_f32 v159, v155, v156
v_fma_f32 v158, -v155, v157, v158
v_fma_f32 v155, v147, v157, v159
v_mov_b32 v147, v158
v_cvt_pk_bf16_f32 v132, v140, v141
v_cvt_pk_bf16_f32 v133, v142, v143
v_cvt_pk_bf16_f32 v134, v144, v145
v_cvt_pk_bf16_f32 v135, v146, v147
v_cvt_pk_bf16_f32 v136, v148, v149
v_cvt_pk_bf16_f32 v137, v150, v151
v_cvt_pk_bf16_f32 v138, v152, v153
v_cvt_pk_bf16_f32 v139, v154, v155
s_nop 1
v_mfma_f32_16x16x32_bf16 v[116:119], v[188:191], v[132:135], 0
v_mfma_f32_16x16x32_bf16 v[124:127], v[188:191], v[136:139], 0
v_mfma_f32_16x16x32_bf16 v[120:123], v[192:195], v[132:135], 0
v_mfma_f32_16x16x32_bf16 v[128:131], v[192:195], v[136:139], 0
v_mfma_f32_16x16x32_bf16 v[116:119], v[204:207], v[136:139], v[116:119]
v_mfma_f32_16x16x32_bf16 v[124:127], v[196:199], v[132:135], v[124:127]
v_mfma_f32_16x16x32_bf16 v[120:123], v[208:211], v[136:139], v[120:123]
v_mfma_f32_16x16x32_bf16 v[128:131], v[200:203], v[132:135], v[128:131]
s_nop 7
v_mul_f32 v156, v116, v212
v_mul_f32 v157, v124, v212
v_fma_f32 v156, -v124, v220, v156
v_fma_f32 v124, v116, v220, v157
v_mov_b32 v116, v156
v_mul_f32 v156, v117, v213
v_mul_f32 v157, v125, v213
v_fma_f32 v156, -v125, v221, v156
v_fma_f32 v125, v117, v221, v157
v_mov_b32 v117, v156
v_mul_f32 v156, v118, v214
v_mul_f32 v157, v126, v214
v_fma_f32 v156, -v126, v222, v156
v_fma_f32 v126, v118, v222, v157
v_mov_b32 v118, v156
v_mul_f32 v156, v119, v215
v_mul_f32 v157, v127, v215
v_fma_f32 v156, -v127, v223, v156
v_fma_f32 v127, v119, v223, v157
v_mov_b32 v119, v156
v_mul_f32 v156, v120, v216
v_mul_f32 v157, v128, v216
v_fma_f32 v156, -v128, v224, v156
v_fma_f32 v128, v120, v224, v157
v_mov_b32 v120, v156
v_mul_f32 v156, v121, v217
v_mul_f32 v157, v129, v217
v_fma_f32 v156, -v129, v225, v156
v_fma_f32 v129, v121, v225, v157
v_mov_b32 v121, v156
v_mul_f32 v156, v122, v218
v_mul_f32 v157, v130, v218
v_fma_f32 v156, -v130, v226, v156
v_fma_f32 v130, v122, v226, v157
v_mov_b32 v122, v156
v_mul_f32 v156, v123, v219
v_mul_f32 v157, v131, v219
v_fma_f32 v156, -v131, v227, v156
v_fma_f32 v131, v123, v227, v157
v_mov_b32 v123, v156
v_cvt_pk_bf16_f32 v132, v116, v117
v_cvt_pk_bf16_f32 v133, v118, v119
v_cvt_pk_bf16_f32 v134, v120, v121
v_cvt_pk_bf16_f32 v135, v122, v123
v_cvt_pk_bf16_f32 v136, v124, v125
v_cvt_pk_bf16_f32 v137, v126, v127
v_cvt_pk_bf16_f32 v138, v128, v129
v_cvt_pk_bf16_f32 v139, v130, v131
ds_write_b64 v3, v[132:133] offset:8192
ds_write_b64 v3, v[134:135] offset:8224
ds_write_b64 v3, v[136:137] offset:12288
ds_write_b64 v3, v[138:139] offset:12320
s_waitcnt lgkmcnt(0)
s_barrier
ds_read_b64_tr_b16 v[84:85], v2 offset:8192
ds_read_b64_tr_b16 v[86:87], v2 offset:8448
ds_read_b64_tr_b16 v[88:89], v2 offset:10240
ds_read_b64_tr_b16 v[90:91], v2 offset:10496
ds_read_b64_tr_b16 v[92:93], v2 offset:8224
ds_read_b64_tr_b16 v[94:95], v2 offset:8480
ds_read_b64_tr_b16 v[96:97], v2 offset:10272
ds_read_b64_tr_b16 v[98:99], v2 offset:10528
ds_read_b64_tr_b16 v[100:101], v2 offset:12288
ds_read_b64_tr_b16 v[102:103], v2 offset:12544
ds_read_b64_tr_b16 v[104:105], v2 offset:14336
ds_read_b64_tr_b16 v[106:107], v2 offset:14592
ds_read_b64_tr_b16 v[108:109], v2 offset:12320
ds_read_b64_tr_b16 v[110:111], v2 offset:12576
ds_read_b64_tr_b16 v[112:113], v2 offset:14368
ds_read_b64_tr_b16 v[114:115], v2 offset:14624
s_waitcnt lgkmcnt(0)
v_mfma_f32_16x16x32_bf16 v[116:119], v[84:87], v[164:167], 0
v_mfma_f32_16x16x32_bf16 v[124:127], v[100:103], v[164:167], 0
v_mfma_f32_16x16x32_bf16 v[120:123], v[92:95], v[164:167], 0
v_mfma_f32_16x16x32_bf16 v[128:131], v[108:111], v[164:167], 0
v_mfma_f32_16x16x32_bf16 v[116:119], v[88:91], v[168:171], v[116:119]
v_mfma_f32_16x16x32_bf16 v[124:127], v[104:107], v[168:171], v[124:127]
v_mfma_f32_16x16x32_bf16 v[120:123], v[96:99], v[168:171], v[120:123]
v_mfma_f32_16x16x32_bf16 v[128:131], v[112:115], v[168:171], v[128:131]
v_mfma_f32_16x16x32_bf16 v[116:119], v[100:103], v[180:183], v[116:119]
v_mfma_f32_16x16x32_bf16 v[124:127], v[84:87], v[172:175], v[124:127]
v_mfma_f32_16x16x32_bf16 v[120:123], v[108:111], v[180:183], v[120:123]
v_mfma_f32_16x16x32_bf16 v[128:131], v[92:95], v[172:175], v[128:131]
v_mfma_f32_16x16x32_bf16 v[116:119], v[104:107], v[184:187], v[116:119]
v_mfma_f32_16x16x32_bf16 v[124:127], v[88:91], v[176:179], v[124:127]
v_mfma_f32_16x16x32_bf16 v[120:123], v[112:115], v[184:187], v[120:123]
v_mfma_f32_16x16x32_bf16 v[128:131], v[96:99], v[176:179], v[128:131]
s_mul_i32 s24, s18, 4096
s_add_u32 s24, s24, 113332224
s_add_u32 s25, s24, 921600
s_nop 5
v_cvt_pk_bf16_f32 v132, v116, v117
v_cvt_pk_bf16_f32 v133, v118, v119
v_cvt_pk_bf16_f32 v134, v120, v121
v_cvt_pk_bf16_f32 v135, v122, v123
s_nop 1
v_permlane16_swap_b32 v132, v134
v_permlane16_swap_b32 v133, v135
buffer_store_dwordx4 v[132:135], v4, s[8:11], s24 offen sc1
v_cvt_pk_bf16_f32 v136, v124, v125
v_cvt_pk_bf16_f32 v137, v126, v127
v_cvt_pk_bf16_f32 v138, v128, v129
v_cvt_pk_bf16_f32 v139, v130, v131
s_nop 1
v_permlane16_swap_b32 v136, v138
v_permlane16_swap_b32 v137, v139
buffer_store_dwordx4 v[136:139], v4, s[8:11], s25 offen sc1
s_mov_b32 s24, 118158208
s_lshl_b32 s25, s17, 6
v_add_u32 v4, s25, v0
v_cmp_gt_u32 vcc, 8, v4
v_lshlrev_b32 v4, 10, v4
v_mov_b32 v5, 0x10000000
v_cndmask_b32 v4, v5, v4, vcc
v_mov_b32 v5, 1
s_waitcnt vmcnt(0) lgkmcnt(0)
s_barrier
buffer_store_dword v5, v4, s[8:11], s24 offen sc1
s_waitcnt vmcnt(0)
s_endpgm
mega_kernel_rec:
s_cmp_lg_u32 s20, 0
s_cbranch_scc1 mega_kernel_m1
s_cmp_ge_u32 s16, 16
s_cbranch_scc1 mega_kernel_val0
v_lshlrev_b32 v90, 4, v0
s_mul_i32 s21, s16, 401408
s_mul_i32 s22, s17, 100352
s_add_u32 s21, s21, s22
s_add_u32 s21, s21, 0
v_and_b32 v2, 8, v0
v_mov_b32 v1, 0x44444444
v_mov_b32 v3, 0xeeeeeeee
v_cmp_ne_u32 vcc, 0, v2
v_mov_b32 v104, -1
v_mov_b32 v105, -1
v_cndmask_b32 v1, v1, v3, vcc
s_lshl_b32 s22, s17, 10
v_add_u32 v91, s22, v90
v_mov_b32 v102, v91
v_lshrrev_b32 v2, 4, v0
v_and_b32 v3, 15, v0
v_lshlrev_b32 v2, 2, v2
v_sub_u32 v3, v3, v2
v_mov_b32 v4, 0x3f80
v_mov_b32 v5, 0x3f800000
v_mov_b32 v112, 0
v_mov_b32 v113, 0
v_cmp_eq_u32 vcc, 0, v3
s_nop 1
v_cndmask_b32 v112, v112, v4, vcc
v_cmp_eq_u32 vcc, 1, v3
s_nop 1
v_cndmask_b32 v112, v112, v5, vcc
v_cmp_eq_u32 vcc, 2, v3
s_nop 1
v_cndmask_b32 v113, v113, v4, vcc
v_cmp_eq_u32 vcc, 3, v3
s_nop 1
v_cndmask_b32 v113, v113, v5, vcc
s_movk_i32 s23, 4096
s_cmp_eq_u32 s17, 3
s_cselect_b32 s23, 0x10000000, s23
v_add_u32 v103, s23, v102
v_mov_b32 v106, v103
s_cmp_eq_u32 s17, 3
s_cselect_b32 s23, 0, 4096
s_cselect_b32 s24, 0, s17
s_lshl_b32 s24, s24, 10
s_add_u32 s23, s23, s24
v_add_u32 v106, s23, v90
v_lshrrev_b32 v2, 4, v0
v_and_b32 v3, 7, v0
v_lshlrev_b32 v3, 4, v3
s_mul_i32 s22, s17, 1792
v_lshlrev_b32 v4, 7, v2
v_add3_u32 v92, v4, v3, s22
v_lshrrev_b32 v4, 1, v2
v_lshlrev_b32 v4, 7, v4
v_and_b32 v5, 1, v2
v_lshlrev_b32 v5, 3, v5
s_add_u32 s22, s22, 1536
v_add3_u32 v93, v4, v3, s22
v_add_u32 v93, v93, v5
s_mul_i32 s22, s17, 7168
s_add_u32 s22, s22, 8192
v_add_u32 v94, s22, v90
v_lshlrev_b32 v4, 3, v0
s_add_u32 s22, s22, 6144
v_add_u32 v95, s22, v4
s_mul_i32 s22, s17, 3584
s_add_u32 s22, s22, 36864
v_and_b32 v3, 15, v0
v_lshrrev_b32 v4, 2, v3
v_xor_b32 v4, v4, v2
v_lshlrev_b32 v4, 3, v4
v_lshlrev_b32 v5, 5, v3
v_add3_u32 v96, v4, v5, s22
v_and_b32 v4, 3, v0
v_xor_b32 v4, v4, v2
v_lshlrev_b32 v4, 3, v4
v_lshrrev_b32 v5, 2, v0
v_lshlrev_b32 v5, 5, v5
v_add3_u32 v97, v4, v5, s22
s_lshl_b32 s22, s17, 11
s_add_u32 s22, s22, 51200
v_and_b32 v4, 7, v0
v_lshrrev_b32 v5, 3, v3
v_lshlrev_b32 v6, 2, v5
v_add_u32 v6, v6, v2
v_lshrrev_b32 v7, 1, v6
v_add_u32 v7, v7, v4
v_and_b32 v7, 7, v7
v_lshlrev_b32 v7, 4, v7
v_lshlrev_b32 v6, 7, v6
v_add3_u32 v98, v6, v7, s22
v_add_u32 v6, 8, v2
v_lshrrev_b32 v7, 1, v6
v_add_u32 v7, v7, v4
v_and_b32 v7, 7, v7
v_lshlrev_b32 v7, 4, v7
v_lshlrev_b32 v6, 7, v6
v_add3_u32 v99, v6, v7, s22
v_lshrrev_b32 v6, 1, v2
v_or_b32 v6, v6, v5
v_add_u32 v7, 59392, v90
v_cmp_ne_u32 vcc, 0, v6
s_nop 1
v_cndmask_b32 v99, v99, v7, vcc
s_lshl_b32 s22, s17, 2
v_add_u32 v4, s22, v2
v_and_b32 v4, 7, v4
v_lshrrev_b32 v5, 1, v3
v_add_u32 v5, v5, v4
v_and_b32 v5, 7, v5
v_lshlrev_b32 v5, 4, v5
v_lshlrev_b32 v6, 7, v3
v_add_u32 v6, 51200, v6
v_add_u32 v100, v6, v5
s_lshr_b32 s22, s16, 2
s_lshl_b32 s23, s22, 11
s_and_b32 s24, s16, 3
s_lshl_b32 s24, s24, 8
s_add_u32 s23, s23, s24
v_lshrrev_b32 v5, 2, v3
v_lshlrev_b32 v5, 10, v5
v_lshrrev_b32 v6, 1, v3
v_and_b32 v6, 1, v6
v_lshlrev_b32 v6, 7, v6
v_lshlrev_b32 v7, 4, v4
v_add3_u32 v5, v5, v6, v7
v_and_b32 v6, 1, v3
v_lshlrev_b32 v8, 3, v6
v_add3_u32 v5, v5, v8, s23
s_lshl_b32 s23, s22, 9
s_and_b32 s24, s16, 1
s_lshl_b32 s24, s24, 8
s_add_u32 s23, s23, s24
s_lshr_b32 s24, s16, 1
s_and_b32 s24, s24, 1
s_lshl_b32 s24, s24, 3
s_add_u32 s23, s23, s24
s_add_u32 s23, s23, 8192
v_lshlrev_b32 v8, 7, v6
v_add3_u32 v8, v8, v7, s23
v_cmp_gt_u32 vcc, 8, v3
s_nop 1
v_cndmask_b32 v5, v8, v5, vcc
v_mov_b32 v8, 0x10000000
v_cmp_gt_u32 vcc, 10, v3
s_nop 1
v_cndmask_b32 v101, v8, v5, vcc
s_lshl_b32 s22, s17, 11
s_add_u32 s22, s22, 51200
v_lshlrev_b32 v2, 5, v0
v_add_u32 v2, s22, v2
v_mov_b32 v4, 0xf149f2ca
v_mov_b32 v5, v4
v_mov_b32 v6, v4
v_mov_b32 v7, v4
ds_write_b128 v2, v[4:7]
ds_write_b128 v2, v[4:7] offset:16
s_lshl_b32 s22, s16, 2
s_add_u32 s22, s22, s17
s_mul_i32 s22, s22, 5
v_add_u32 v2, s22, v0
v_lshlrev_b32 v3, 7, v2
v_mov_b32 v4, 0x10000000
v_cmp_gt_u32 vcc, 5, v0
s_movk_i32 s22, 544
s_nop 0
v_cndmask_b32 v3, v4, v3, vcc
v_cmp_gt_u32 vcc, s22, v2
s_mov_b32 s22, 45875200
s_nop 0
v_cndmask_b32 v3, v4, v3, vcc
buffer_load_dword v111, v3, s[8:11], s22 offen
s_mul_i32 s22, s17, 1
v_lshrrev_b32 v2, 3, v0
v_lshlrev_b32 v3, 2, v2
v_add_u32 v3, s22, v3
s_lshr_b32 s22, s17, 1
s_add_u32 s22, s22, 12
v_mov_b32 v4, s22
v_cmp_eq_u32 vcc, 3, v2
s_mul_i32 s23, s16, 448
s_add_u32 s23, s23, 118222848
v_cndmask_b32 v3, v3, v4, vcc
v_lshlrev_b32 v3, 5, v3
v_and_b32 v4, 7, v0
v_lshlrev_b32 v4, 2, v4
v_add3_u32 v3, v3, v4, s23
v_mov_b32 v4, 0x10000000
v_cmp_gt_u32 vcc, 32, v0
s_mov_b32 s47, 0
s_nop 0
v_cndmask_b32 v3, v4, v3, vcc
s_mul_i32 s48, s16, 401408
s_mul_i32 s22, s17, 100352
s_add_u32 s48, s48, s22
s_add_u32 s48, s48, 0
s_mov_b32 s22, s17
s_lshl_b32 s40, s22, 11
s_add_u32 s22, s22, 4
s_sub_u32 s23, s22, 7
s_cselect_b32 s22, s22, s23
s_lshl_b32 s41, s22, 11
s_add_u32 s22, s22, 4
s_sub_u32 s23, s22, 7
s_cselect_b32 s22, s22, s23
s_lshl_b32 s42, s22, 11
s_add_u32 s22, s22, 4
s_sub_u32 s23, s22, 7
s_cselect_b32 s22, s22, s23
s_lshl_b32 s43, s22, 11
s_add_u32 s22, s22, 4
s_sub_u32 s23, s22, 7
s_cselect_b32 s22, s22, s23
s_lshl_b32 s44, s22, 11
s_add_u32 s22, s22, 4
s_sub_u32 s23, s22, 7
s_cselect_b32 s22, s22, s23
s_lshl_b32 s45, s22, 11
s_add_u32 s22, s22, 4
s_sub_u32 s23, s22, 7
s_cselect_b32 s22, s22, s23
s_lshl_b32 s46, s22, 11
s_movk_i32 s28, 8000
.Lsw_37:
s_and_b32 s22, s47, 0xff
s_cmp_eq_u32 s22, 0xff
s_cbranch_scc1 .Lsw_38
buffer_load_dword v2, v3, s[8:11], 0 offen sc1
s_waitcnt vmcnt(0)
v_cmp_eq_u32 vcc, 1, v2
s_sleep 1
s_mov_b32 s47, vcc_lo
s_sub_u32 s28, s28, 1
s_cbranch_scc0 .Lsw_37
.Lsw_38:
s_add_u32 s22, s48, s40
buffer_load_dwordx4 a[0:3], v90, s[8:11], s22 offen nt
buffer_load_dwordx4 a[4:7], v90, s[8:11], s22 offen offset:1024 nt
s_add_u32 s22, s48, s41
buffer_load_dwordx4 a[8:11], v90, s[8:11], s22 offen nt
buffer_load_dwordx4 a[12:15], v90, s[8:11], s22 offen offset:1024 nt
s_add_u32 s22, s48, s42
buffer_load_dwordx4 a[16:19], v90, s[8:11], s22 offen nt
buffer_load_dwordx4 a[20:23], v90, s[8:11], s22 offen offset:1024 nt
s_add_u32 s22, s48, s43
buffer_load_dwordx4 a[24:27], v90, s[8:11], s22 offen nt
buffer_load_dwordx4 a[28:31], v90, s[8:11], s22 offen offset:1024 nt
s_add_u32 s22, s48, s44
buffer_load_dwordx4 a[32:35], v90, s[8:11], s22 offen nt
buffer_load_dwordx4 a[36:39], v90, s[8:11], s22 offen offset:1024 nt
s_add_u32 s22, s48, s45
buffer_load_dwordx4 a[40:43], v90, s[8:11], s22 offen nt
buffer_load_dwordx4 a[44:47], v90, s[8:11], s22 offen offset:1024 nt
s_add_u32 s22, s48, s46
buffer_load_dwordx4 a[48:51], v90, s[8:11], s22 offen nt
buffer_load_dwordx4 a[52:55], v90, s[8:11], s22 offen offset:1024 nt
s_add_u32 s48, s48, 14336
s_add_u32 s22, s48, s40
buffer_load_dwordx4 a[56:59], v90, s[8:11], s22 offen nt
buffer_load_dwordx4 a[60:63], v90, s[8:11], s22 offen offset:1024 nt
s_add_u32 s22, s48, s41
buffer_load_dwordx4 a[64:67], v90, s[8:11], s22 offen nt
buffer_load_dwordx4 a[68:71], v90, s[8:11], s22 offen offset:1024 nt
s_add_u32 s22, s48, s42
buffer_load_dwordx4 a[72:75], v90, s[8:11], s22 offen nt
buffer_load_dwordx4 a[76:79], v90, s[8:11], s22 offen offset:1024 nt
s_add_u32 s22, s48, s43
buffer_load_dwordx4 a[80:83], v90, s[8:11], s22 offen nt
buffer_load_dwordx4 a[84:87], v90, s[8:11], s22 offen offset:1024 nt
s_add_u32 s22, s48, s44
buffer_load_dwordx4 a[88:91], v90, s[8:11], s22 offen nt
buffer_load_dwordx4 a[92:95], v90, s[8:11], s22 offen offset:1024 nt
s_add_u32 s22, s48, s45
buffer_load_dwordx4 a[96:99], v90, s[8:11], s22 offen nt
buffer_load_dwordx4 a[100:103], v90, s[8:11], s22 offen offset:1024 nt
s_add_u32 s22, s48, s46
buffer_load_dwordx4 a[104:107], v90, s[8:11], s22 offen nt
buffer_load_dwordx4 a[108:111], v90, s[8:11], s22 offen offset:1024 nt
s_add_u32 s48, s48, 14336
s_movk_i32 s28, 8000
.Lsw_39:
s_and_b32 s22, s47, 0xff00
s_cmp_eq_u32 s22, 0xff00
s_cbranch_scc1 .Lsw_40
buffer_load_dword v2, v3, s[8:11], 0 offen sc1
s_waitcnt vmcnt(0)
v_cmp_eq_u32 vcc, 1, v2
s_sleep 1
s_mov_b32 s47, vcc_lo
s_sub_u32 s28, s28, 1
s_cbranch_scc0 .Lsw_39
.Lsw_40:
s_add_u32 s22, s48, s40
buffer_load_dwordx4 a[112:115], v90, s[8:11], s22 offen nt
buffer_load_dwordx4 a[116:119], v90, s[8:11], s22 offen offset:1024 nt
s_add_u32 s22, s48, s41
buffer_load_dwordx4 a[120:123], v90, s[8:11], s22 offen nt
buffer_load_dwordx4 a[124:127], v90, s[8:11], s22 offen offset:1024 nt
s_add_u32 s22, s48, s42
buffer_load_dwordx4 a[128:131], v90, s[8:11], s22 offen nt
buffer_load_dwordx4 a[132:135], v90, s[8:11], s22 offen offset:1024 nt
s_add_u32 s22, s48, s43
buffer_load_dwordx4 a[136:139], v90, s[8:11], s22 offen nt
buffer_load_dwordx4 a[140:143], v90, s[8:11], s22 offen offset:1024 nt
s_add_u32 s22, s48, s44
buffer_load_dwordx4 a[144:147], v90, s[8:11], s22 offen nt
buffer_load_dwordx4 a[148:151], v90, s[8:11], s22 offen offset:1024 nt
s_add_u32 s22, s48, s45
buffer_load_dwordx4 a[152:155], v90, s[8:11], s22 offen nt
buffer_load_dwordx4 a[156:159], v90, s[8:11], s22 offen offset:1024 nt
s_add_u32 s22, s48, s46
buffer_load_dwordx4 a[160:163], v90, s[8:11], s22 offen nt
buffer_load_dwordx4 a[164:167], v90, s[8:11], s22 offen offset:1024 nt
s_add_u32 s48, s48, 14336
s_add_u32 s22, s48, s40
buffer_load_dwordx4 a[168:171], v90, s[8:11], s22 offen nt
buffer_load_dwordx4 a[172:175], v90, s[8:11], s22 offen offset:1024 nt
s_add_u32 s22, s48, s41
buffer_load_dwordx4 a[176:179], v90, s[8:11], s22 offen nt
buffer_load_dwordx4 a[180:183], v90, s[8:11], s22 offen offset:1024 nt
s_add_u32 s22, s48, s42
buffer_load_dwordx4 a[184:187], v90, s[8:11], s22 offen nt
buffer_load_dwordx4 a[188:191], v90, s[8:11], s22 offen offset:1024 nt
s_add_u32 s22, s48, s43
buffer_load_dwordx4 a[192:195], v90, s[8:11], s22 offen nt
buffer_load_dwordx4 a[196:199], v90, s[8:11], s22 offen offset:1024 nt
s_add_u32 s22, s48, s44
buffer_load_dwordx4 a[200:203], v90, s[8:11], s22 offen nt
buffer_load_dwordx4 a[204:207], v90, s[8:11], s22 offen offset:1024 nt
s_add_u32 s22, s48, s45
buffer_load_dwordx4 a[208:211], v90, s[8:11], s22 offen nt
buffer_load_dwordx4 a[212:215], v90, s[8:11], s22 offen offset:1024 nt
s_add_u32 s22, s48, s46
buffer_load_dwordx4 a[216:219], v90, s[8:11], s22 offen nt
buffer_load_dwordx4 a[220:223], v90, s[8:11], s22 offen offset:1024 nt
s_add_u32 s48, s48, 14336
s_movk_i32 s28, 8000
.Lsw_41:
s_and_b32 s22, s47, 0xff0000
s_cmp_eq_u32 s22, 0xff0000
s_cbranch_scc1 .Lsw_42
buffer_load_dword v2, v3, s[8:11], 0 offen sc1
s_waitcnt vmcnt(0)
v_cmp_eq_u32 vcc, 1, v2
s_sleep 1
s_mov_b32 s47, vcc_lo
s_sub_u32 s28, s28, 1
s_cbranch_scc0 .Lsw_41
.Lsw_42:
s_add_u32 s22, s48, s40
buffer_load_dwordx4 a[224:227], v90, s[8:11], s22 offen nt
buffer_load_dwordx4 a[228:231], v90, s[8:11], s22 offen offset:1024 nt
s_add_u32 s22, s48, s41
buffer_load_dwordx4 a[232:235], v90, s[8:11], s22 offen nt
buffer_load_dwordx4 a[236:239], v90, s[8:11], s22 offen offset:1024 nt
s_add_u32 s22, s48, s42
buffer_load_dwordx4 a[240:243], v90, s[8:11], s22 offen nt
buffer_load_dwordx4 a[244:247], v90, s[8:11], s22 offen offset:1024 nt
s_add_u32 s22, s48, s43
buffer_load_dwordx4 a[248:251], v90, s[8:11], s22 offen nt
buffer_load_dwordx4 a[252:255], v90, s[8:11], s22 offen offset:1024 nt
s_add_u32 s22, s48, s44
buffer_load_dwordx4 v[120:123], v90, s[8:11], s22 offen nt
buffer_load_dwordx4 v[124:127], v90, s[8:11], s22 offen offset:1024 nt
s_add_u32 s22, s48, s45
buffer_load_dwordx4 v[128:131], v90, s[8:11], s22 offen nt
buffer_load_dwordx4 v[132:135], v90, s[8:11], s22 offen offset:1024 nt
s_add_u32 s22, s48, s46
buffer_load_dwordx4 v[136:139], v90, s[8:11], s22 offen nt
buffer_load_dwordx4 v[140:143], v90, s[8:11], s22 offen offset:1024 nt
s_add_u32 s48, s48, 14336
s_add_u32 s22, s48, s40
buffer_load_dwordx4 v[144:147], v90, s[8:11], s22 offen nt
buffer_load_dwordx4 v[148:151], v90, s[8:11], s22 offen offset:1024 nt
s_add_u32 s22, s48, s41
buffer_load_dwordx4 v[152:155], v90, s[8:11], s22 offen nt
buffer_load_dwordx4 v[156:159], v90, s[8:11], s22 offen offset:1024 nt
s_add_u32 s22, s48, s42
buffer_load_dwordx4 v[160:163], v90, s[8:11], s22 offen nt
buffer_load_dwordx4 v[164:167], v90, s[8:11], s22 offen offset:1024 nt
s_add_u32 s22, s48, s43
buffer_load_dwordx4 v[168:171], v90, s[8:11], s22 offen nt
buffer_load_dwordx4 v[172:175], v90, s[8:11], s22 offen offset:1024 nt
s_add_u32 s22, s48, s44
buffer_load_dwordx4 v[176:179], v90, s[8:11], s22 offen nt
buffer_load_dwordx4 v[180:183], v90, s[8:11], s22 offen offset:1024 nt
s_add_u32 s22, s48, s45
buffer_load_dwordx4 v[184:187], v90, s[8:11], s22 offen nt
buffer_load_dwordx4 v[188:191], v90, s[8:11], s22 offen offset:1024 nt
s_add_u32 s22, s48, s46
buffer_load_dwordx4 v[192:195], v90, s[8:11], s22 offen nt
buffer_load_dwordx4 v[196:199], v90, s[8:11], s22 offen offset:1024 nt
s_add_u32 s48, s48, 14336
s_sub_u32 s22, s17, 2
s_mul_i32 s22, s22, 14336
s_add_u32 s33, s22, 14680064
s_add_u32 s26, s22, 8192
s_cmp_lt_u32 s17, 2
s_cbranch_scc1 .Lxk_36
s_mov_b32 s19, 20000
s_mov_b32 s50, 68183040
v_lshlrev_b32 v4, 4, v0
v_mov_b32 v8, 0x10000000
v_cmp_gt_u32 vcc, 32, v0
s_mov_b32 s51, s19
s_nop 0
v_cndmask_b32 v4, v8, v4, vcc
.Lwr_44:
buffer_load_dwordx4 v[8:11], v4, s[8:11], s50 offen sc1
s_waitcnt vmcnt(0)
s_mov_b32 s52, 0
v_cmp_eq_u32 vcc, 1, v8
s_nop 1
s_and_b32 vcc_lo, vcc_lo, 0xffffffff
s_and_b32 vcc_hi, vcc_hi, 0x0
s_bcnt1_i32_b64 s53, vcc
s_add_u32 s52, s52, s53
v_cmp_eq_u32 vcc, 1, v9
s_nop 1
s_and_b32 vcc_lo, vcc_lo, 0xffffffff
s_and_b32 vcc_hi, vcc_hi, 0x0
s_bcnt1_i32_b64 s53, vcc
s_add_u32 s52, s52, s53
v_cmp_eq_u32 vcc, 1, v10
s_nop 1
s_and_b32 vcc_lo, vcc_lo, 0xffffffff
s_and_b32 vcc_hi, vcc_hi, 0x0
s_bcnt1_i32_b64 s53, vcc
s_add_u32 s52, s52, s53
v_cmp_eq_u32 vcc, 1, v11
s_nop 1
s_and_b32 vcc_lo, vcc_lo, 0xffffffff
s_and_b32 vcc_hi, vcc_hi, 0x0
s_bcnt1_i32_b64 s53, vcc
s_add_u32 s52, s52, s53
s_cmp_eq_u32 s52, 128
s_cbranch_scc1 .Lwo_45
s_sleep 2
s_sub_u32 s51, s51, 1
s_cbranch_scc0 .Lwr_44
s_mov_b32 s19, 0
.Lwo_45:
s_mov_b32 m0, s26
s_add_u32 s27, s33, 0
buffer_load_dwordx4 v90, s[8:11], s27 offen lds
s_add_u32 m0, s26, 1024
s_add_u32 s27, s33, 1024
buffer_load_dwordx4 v90, s[8:11], s27 offen lds
s_add_u32 m0, s26, 2048
s_add_u32 s27, s33, 2048
buffer_load_dwordx4 v90, s[8:11], s27 offen lds
s_add_u32 m0, s26, 3072
s_add_u32 s27, s33, 3072
buffer_load_dwordx4 v90, s[8:11], s27 offen lds
s_add_u32 m0, s26, 4096
s_add_u32 s27, s33, 4096
buffer_load_dwordx4 v90, s[8:11], s27 offen lds
s_add_u32 m0, s26, 5120
s_add_u32 s27, s33, 5120
buffer_load_dwordx4 v90, s[8:11], s27 offen lds
s_add_u32 m0, s26, 6144
s_add_u32 s27, s33, 6144
buffer_load_dwordx4 v90, s[8:11], s27 offen lds
s_add_u32 m0, s26, 7168
s_add_u32 s27, s33, 7168
buffer_load_dwordx4 v90, s[8:11], s27 offen lds
s_add_u32 m0, s26, 8192
s_add_u32 s27, s33, 8192
buffer_load_dwordx4 v90, s[8:11], s27 offen lds
s_add_u32 m0, s26, 9216
s_add_u32 s27, s33, 9216
buffer_load_dwordx4 v90, s[8:11], s27 offen lds
s_add_u32 m0, s26, 10240
s_add_u32 s27, s33, 10240
buffer_load_dwordx4 v90, s[8:11], s27 offen lds
s_add_u32 m0, s26, 11264
s_add_u32 s27, s33, 11264
buffer_load_dwordx4 v90, s[8:11], s27 offen lds
s_add_u32 m0, s26, 12288
s_add_u32 s27, s33, 12288
buffer_load_dwordx4 v90, s[8:11], s27 offen lds
s_add_u32 m0, s26, 13312
s_add_u32 s27, s33, 13312
buffer_load_dwordx4 v90, s[8:11], s27 offen lds
.Lxk_36:
s_movk_i32 s28, 8000
.Lsw_46:
s_and_b32 s22, s47, 0xff000000
s_cmp_eq_u32 s22, 0xff000000
s_cbranch_scc1 .Lsw_47
buffer_load_dword v2, v3, s[8:11], 0 offen sc1
s_waitcnt vmcnt(0)
v_cmp_eq_u32 vcc, 1, v2
s_sleep 1
s_mov_b32 s47, vcc_lo
s_sub_u32 s28, s28, 1
s_cbranch_scc0 .Lsw_46
.Lsw_47:
s_add_u32 s22, s48, s40
buffer_load_dwordx4 v[200:203], v90, s[8:11], s22 offen nt
buffer_load_dwordx4 v[204:207], v90, s[8:11], s22 offen offset:1024 nt
s_add_u32 s22, s48, s41
buffer_load_dwordx4 v[208:211], v90, s[8:11], s22 offen nt
buffer_load_dwordx4 v[212:215], v90, s[8:11], s22 offen offset:1024 nt
s_add_u32 s22, s48, s42
buffer_load_dwordx4 v[216:219], v90, s[8:11], s22 offen nt
buffer_load_dwordx4 v[220:223], v90, s[8:11], s22 offen offset:1024 nt
s_add_u32 s22, s48, s43
buffer_load_dwordx4 v[224:227], v90, s[8:11], s22 offen nt
buffer_load_dwordx4 v[228:231], v90, s[8:11], s22 offen offset:1024 nt
s_add_u32 s22, s48, s44
buffer_load_dwordx4 v[232:235], v90, s[8:11], s22 offen nt
buffer_load_dwordx4 v[236:239], v90, s[8:11], s22 offen offset:1024 nt
s_add_u32 s22, s48, s45
buffer_load_dwordx4 v[240:243], v90, s[8:11], s22 offen nt
buffer_load_dwordx4 v[244:247], v90, s[8:11], s22 offen offset:1024 nt
s_add_u32 s22, s48, s46
buffer_load_dwordx4 v[248:251], v90, s[8:11], s22 offen nt
buffer_load_dwordx4 v[252:255], v90, s[8:11], s22 offen offset:1024 nt
s_add_u32 s48, s48, 14336
s_mov_b32 s18, 0
s_mov_b32 s19, 20000
s_mov_b32 s29, 45944832
s_mov_b32 s34, 68157440
v_min_u32 v107, 55, v0
v_lshlrev_b32 v107, 2, v107
s_lshl_b32 s22, s16, 1
s_add_u32 s22, s22, s17
s_lshl_b32 s22, s22, 2
s_add_u32 s22, s22, 256
v_mov_b32 v2, s22
v_mov_b32 v3, 0x10000000
v_cmp_eq_u32 vcc, 0, v0
v_mov_b32 v109, 1
s_nop 0
v_cndmask_b32 v108, v3, v2, vcc
s_mov_b32 s22, s17
s_lshl_b32 s40, s22, 10
s_add_u32 s22, s22, 4
s_sub_u32 s23, s22, 7
s_cselect_b32 s22, s22, s23
s_lshl_b32 s41, s22, 10
s_add_u32 s22, s22, 4
s_sub_u32 s23, s22, 7
s_cselect_b32 s22, s22, s23
s_lshl_b32 s42, s22, 10
s_add_u32 s22, s22, 4
s_sub_u32 s23, s22, 7
s_cselect_b32 s22, s22, s23
s_lshl_b32 s43, s22, 10
s_add_u32 s22, s22, 4
s_sub_u32 s23, s22, 7
s_cselect_b32 s22, s22, s23
s_lshl_b32 s44, s22, 10
s_add_u32 s22, s22, 4
s_sub_u32 s23, s22, 7
s_cselect_b32 s22, s22, s23
s_lshl_b32 s45, s22, 10
s_add_u32 s22, s22, 4
s_sub_u32 s23, s22, 7
s_cselect_b32 s22, s22, s23
s_lshl_b32 s46, s22, 10
v_add_u32 v107, s42, v90
v_add_u32 v108, s43, v90
v_add_u32 v109, s44, v90
v_add_u32 v118, s45, v90
v_add_u32 v119, s46, v90
.p2align 6
.Lsloop_48:
v_mov_b64 v[32:33], 0
v_mov_b64 v[34:35], 0
v_mov_b64 v[36:37], 0
v_mov_b64 v[38:39], 0
v_mov_b64 v[40:41], 0
v_mov_b64 v[42:43], 0
v_mov_b64 v[86:87], 0
v_mov_b64 v[88:89], 0
v_mov_b64 v[4:5], 0
v_mov_b64 v[6:7], 0
v_mov_b64 v[8:9], 0
v_mov_b64 v[10:11], 0
v_mov_b64 v[114:115], 0
v_mov_b64 v[116:117], 0
s_mov_b32 s28, s19
s_waitcnt vmcnt(0)
buffer_load_dwordx4 v[62:65], v102, s[8:11], s29 offen sc1
buffer_load_dwordx4 v[66:69], v106, s[8:11], s29 offen sc1
s_sleep 3
buffer_load_dwordx4 v[70:73], v102, s[8:11], s29 offen sc1
buffer_load_dwordx4 v[74:77], v106, s[8:11], s29 offen sc1
.Lspoll_49:
s_waitcnt vmcnt(3)
ds_write_b128 v91, v[62:65]
v_max3_u32 v2, v62, v63, v64
v_max_u32 v2, v2, v65
s_waitcnt vmcnt(2)
ds_write_b128 v91, v[66:69] offset:4096
v_max3_u32 v2, v2, v66, v67
v_max3_u32 v2, v2, v68, v69
v_cmp_eq_u32 vcc, -1, v2
s_cbranch_vccnz .Lsfail_54
.Lspok_51:
v_smfmac_f32_16x16x64_bf16 v[32:35], v[62:65], a[0:7], v1
v_smfmac_f32_16x16x64_bf16 v[36:39], v[62:65], a[56:63], v1
v_smfmac_f32_16x16x64_bf16 v[40:43], v[62:65], a[112:119], v1
v_smfmac_f32_16x16x64_bf16 v[86:89], v[62:65], a[168:175], v1
s_waitcnt lgkmcnt(0)
s_barrier
ds_read_b128 v[12:15], v107
ds_read_b128 v[16:19], v108
ds_read_b128 v[20:23], v109
ds_read_b128 v[24:27], v118
ds_read_b128 v[28:31], v119
v_smfmac_f32_16x16x64_bf16 v[4:7], v[62:65], a[224:231], v1
v_smfmac_f32_16x16x64_bf16 v[8:11], v[62:65], v[144:151], v1
v_smfmac_f32_16x16x64_bf16 v[114:117], v[62:65], v[200:207], v1
v_smfmac_f32_16x16x64_bf16 v[32:35], v[66:69], a[8:15], v1
v_smfmac_f32_16x16x64_bf16 v[36:39], v[66:69], a[64:71], v1
v_smfmac_f32_16x16x64_bf16 v[40:43], v[66:69], a[120:127], v1
v_smfmac_f32_16x16x64_bf16 v[86:89], v[66:69], a[176:183], v1
v_smfmac_f32_16x16x64_bf16 v[4:7], v[66:69], a[232:239], v1
v_smfmac_f32_16x16x64_bf16 v[8:11], v[66:69], v[152:159], v1
v_smfmac_f32_16x16x64_bf16 v[114:117], v[66:69], v[208:215], v1
s_branch .Lkc_53
.Lsfail_54:
buffer_load_dwordx4 v[62:65], v102, s[8:11], s29 offen sc1
buffer_load_dwordx4 v[66:69], v106, s[8:11], s29 offen sc1
.Lschk_56:
s_waitcnt vmcnt(3)
ds_write_b128 v91, v[70:73]
v_max3_u32 v2, v70, v71, v72
v_max_u32 v2, v2, v73
s_waitcnt vmcnt(2)
ds_write_b128 v91, v[74:77] offset:4096
v_max3_u32 v2, v2, v74, v75
v_max3_u32 v2, v2, v76, v77
v_cmp_eq_u32 vcc, -1, v2
s_cbranch_vccnz .Lsfail_55
.Lspok_52:
v_smfmac_f32_16x16x64_bf16 v[32:35], v[70:73], a[0:7], v1
v_smfmac_f32_16x16x64_bf16 v[36:39], v[70:73], a[56:63], v1
v_smfmac_f32_16x16x64_bf16 v[40:43], v[70:73], a[112:119], v1
v_smfmac_f32_16x16x64_bf16 v[86:89], v[70:73], a[168:175], v1
s_waitcnt lgkmcnt(0)
s_barrier
ds_read_b128 v[12:15], v107
ds_read_b128 v[16:19], v108
ds_read_b128 v[20:23], v109
ds_read_b128 v[24:27], v118
ds_read_b128 v[28:31], v119
v_smfmac_f32_16x16x64_bf16 v[4:7], v[70:73], a[224:231], v1
v_smfmac_f32_16x16x64_bf16 v[8:11], v[70:73], v[144:151], v1
v_smfmac_f32_16x16x64_bf16 v[114:117], v[70:73], v[200:207], v1
v_smfmac_f32_16x16x64_bf16 v[32:35], v[74:77], a[8:15], v1
v_smfmac_f32_16x16x64_bf16 v[36:39], v[74:77], a[64:71], v1
v_smfmac_f32_16x16x64_bf16 v[40:43], v[74:77], a[120:127], v1
v_smfmac_f32_16x16x64_bf16 v[86:89], v[74:77], a[176:183], v1
v_smfmac_f32_16x16x64_bf16 v[4:7], v[74:77], a[232:239], v1
v_smfmac_f32_16x16x64_bf16 v[8:11], v[74:77], v[152:159], v1
v_smfmac_f32_16x16x64_bf16 v[114:117], v[74:77], v[208:215], v1
.Lkc_53:
s_add_u32 s21, s18, 1
s_and_b32 s21, s21, 3
s_mul_i32 s21, s21, 7168
s_add_u32 s29, s21, 45875200
s_and_b32 s21, s18, 3
s_mul_i32 s21, s21, 10240
s_add_u32 s31, s21, 45903872
s_add_u32 s21, s18, 2
s_and_b32 s21, s21, 3
s_mul_i32 s21, s21, 10240
s_add_u32 s32, s21, 45903872
s_waitcnt lgkmcnt(4)
v_smfmac_f32_16x16x64_bf16 v[32:35], v[12:15], a[16:23], v1
ds_read_b128 v[78:81], v94 offset:1024
s_waitcnt lgkmcnt(4)
v_smfmac_f32_16x16x64_bf16 v[32:35], v[16:19], a[24:31], v1
ds_read_b128 v[82:85], v94 offset:4096
s_waitcnt lgkmcnt(4)
v_smfmac_f32_16x16x64_bf16 v[32:35], v[20:23], a[32:39], v1
s_waitcnt vmcnt(0)
ds_read_b128 v[62:65], v92 offset:0
s_waitcnt lgkmcnt(4)
v_smfmac_f32_16x16x64_bf16 v[32:35], v[24:27], a[40:47], v1
ds_read_b128 v[66:69], v94 offset:0
s_waitcnt lgkmcnt(4)
v_smfmac_f32_16x16x64_bf16 v[32:35], v[28:31], a[48:55], v1
ds_read_b128 v[70:73], v94 offset:3072
v_smfmac_f32_16x16x64_bf16 v[36:39], v[12:15], a[72:79], v1
ds_read_b128 v[74:77], v92 offset:512
v_smfmac_f32_16x16x64_bf16 v[36:39], v[16:19], a[80:87], v1
v_cvt_pk_bf16_f32 v44, v32, v33
v_smfmac_f32_16x16x64_bf16 v[36:39], v[20:23], a[88:95], v1
v_cvt_pk_bf16_f32 v45, v34, v35
v_smfmac_f32_16x16x64_bf16 v[36:39], v[24:27], a[96:103], v1
ds_write_b32 v96, v44 offset:0
v_smfmac_f32_16x16x64_bf16 v[36:39], v[28:31], a[104:111], v1
ds_write_b32 v96, v45 offset:4
v_smfmac_f32_16x16x64_bf16 v[40:43], v[12:15], a[128:135], v1
ds_read_b64_tr_b16 v[48:49], v97 offset:0
v_smfmac_f32_16x16x64_bf16 v[40:43], v[16:19], a[136:143], v1
v_cvt_pk_bf16_f32 v46, v36, v37
v_smfmac_f32_16x16x64_bf16 v[40:43], v[20:23], a[144:151], v1
v_cvt_pk_bf16_f32 v47, v38, v39
v_smfmac_f32_16x16x64_bf16 v[40:43], v[24:27], a[152:159], v1
ds_write_b32 v96, v46 offset:512
v_smfmac_f32_16x16x64_bf16 v[40:43], v[28:31], a[160:167], v1
ds_write_b32 v96, v47 offset:516
v_smfmac_f32_16x16x64_bf16 v[86:89], v[12:15], a[184:191], v1
ds_read_b64_tr_b16 v[50:51], v97 offset:512
v_smfmac_f32_16x16x64_bf16 v[86:89], v[16:19], a[192:199], v1
v_cvt_pk_bf16_f32 v44, v40, v41
v_smfmac_f32_16x16x64_bf16 v[86:89], v[20:23], a[200:207], v1
v_cvt_pk_bf16_f32 v45, v42, v43
v_smfmac_f32_16x16x64_bf16 v[86:89], v[24:27], a[208:215], v1
ds_write_b32 v96, v44 offset:1024
v_smfmac_f32_16x16x64_bf16 v[86:89], v[28:31], a[216:223], v1
ds_write_b32 v96, v45 offset:1028
v_smfmac_f32_16x16x64_bf16 v[4:7], v[12:15], a[240:247], v1
ds_read_b64_tr_b16 v[52:53], v97 offset:1024
v_smfmac_f32_16x16x64_bf16 v[4:7], v[16:19], a[248:255], v1
v_cvt_pk_bf16_f32 v46, v86, v87
v_smfmac_f32_16x16x64_bf16 v[4:7], v[20:23], v[120:127], v1
v_cvt_pk_bf16_f32 v47, v88, v89
v_smfmac_f32_16x16x64_bf16 v[4:7], v[24:27], v[128:135], v1
ds_write_b32 v96, v46 offset:1536
v_smfmac_f32_16x16x64_bf16 v[4:7], v[28:31], v[136:143], v1
ds_write_b32 v96, v47 offset:1540
v_smfmac_f32_16x16x64_bf16 v[8:11], v[12:15], v[160:167], v1
ds_read_b64_tr_b16 v[54:55], v97 offset:1536
v_smfmac_f32_16x16x64_bf16 v[8:11], v[16:19], v[168:175], v1
v_cvt_pk_bf16_f32 v44, v4, v5
v_smfmac_f32_16x16x64_bf16 v[8:11], v[20:23], v[176:183], v1
v_cvt_pk_bf16_f32 v45, v6, v7
v_smfmac_f32_16x16x64_bf16 v[8:11], v[24:27], v[184:191], v1
ds_write_b32 v96, v44 offset:2048
v_smfmac_f32_16x16x64_bf16 v[8:11], v[28:31], v[192:199], v1
ds_write_b32 v96, v45 offset:2052
v_smfmac_f32_16x16x64_bf16 v[114:117], v[12:15], v[216:223], v1
ds_read_b64_tr_b16 v[56:57], v97 offset:2048
v_smfmac_f32_16x16x64_bf16 v[114:117], v[16:19], v[224:231], v1
v_cvt_pk_bf16_f32 v46, v8, v9
v_smfmac_f32_16x16x64_bf16 v[114:117], v[20:23], v[232:239], v1
v_cvt_pk_bf16_f32 v47, v10, v11
v_smfmac_f32_16x16x64_bf16 v[114:117], v[24:27], v[240:247], v1
ds_write_b32 v96, v46 offset:2560
v_smfmac_f32_16x16x64_bf16 v[114:117], v[28:31], v[248:255], v1
ds_write_b32 v96, v47 offset:2564
s_waitcnt lgkmcnt(15)
s_waitcnt lgkmcnt(11)
v_mfma_f32_16x16x32_bf16 v[32:35], v[62:65], v[48:51], 0
ds_read_b64_tr_b16 v[58:59], v97 offset:2560
ds_read_b128 v[12:15], v92 offset:1024
v_mfma_f32_16x16x32_bf16 v[36:39], v[66:69], v[48:51], 0
v_cvt_pk_bf16_f32 v44, v114, v115
v_cvt_pk_bf16_f32 v45, v116, v117
v_mfma_f32_16x16x32_bf16 v[40:43], v[70:73], v[48:51], 0
ds_read_b128 v[16:19], v94 offset:2048
v_mfma_f32_16x16x16_bf16 v[86:89], v[44:45], v[112:113], 0
ds_read_b128 v[20:23], v94 offset:5120
s_waitcnt lgkmcnt(9)
v_mfma_f32_16x16x32_bf16 v[32:35], v[74:77], v[52:55], v[32:35]
ds_read_b64 v[24:25], v93
v_mfma_f32_16x16x32_bf16 v[36:39], v[78:81], v[52:55], v[36:39]
ds_read_b64 v[26:27], v95 offset:0
v_mfma_f32_16x16x32_bf16 v[40:43], v[82:85], v[52:55], v[40:43]
v_cvt_pk_bf16_f32 v60, v86, v87
ds_read_b64 v[28:29], v95 offset:512
s_waitcnt lgkmcnt(5)
v_mfma_f32_16x16x32_bf16 v[32:35], v[12:15], v[56:59], v[32:35]
v_cvt_pk_bf16_f32 v61, v88, v89
s_waitcnt lgkmcnt(4)
v_mfma_f32_16x16x32_bf16 v[36:39], v[16:19], v[56:59], v[36:39]
s_waitcnt lgkmcnt(3)
v_mfma_f32_16x16x32_bf16 v[40:43], v[20:23], v[56:59], v[40:43]
s_waitcnt lgkmcnt(2)
v_mfma_f32_16x16x16_bf16 v[32:35], v[24:25], v[60:61], v[32:35]
s_waitcnt lgkmcnt(1)
v_mfma_f32_16x16x16_bf16 v[36:39], v[26:27], v[60:61], v[36:39]
s_waitcnt lgkmcnt(0)
v_mfma_f32_16x16x16_bf16 v[40:43], v[28:29], v[60:61], v[40:43]
v_add_f32_dpp v4, v32, v32 row_ror:8 row_mask:0xf bank_mask:0xf
v_add_f32_dpp v5, v33, v33 row_ror:8 row_mask:0xf bank_mask:0xf
v_add_f32_dpp v6, v34, v34 row_ror:8 row_mask:0xf bank_mask:0xf
v_add_f32_dpp v7, v35, v35 row_ror:8 row_mask:0xf bank_mask:0xf
ds_write_b128 v99, v[4:7]
v_add_f32_dpp v8, v36, v36 row_ror:8 row_mask:0xf bank_mask:0x3
v_add_f32_dpp v9, v37, v37 row_ror:8 row_mask:0xf bank_mask:0x3
v_add_f32_dpp v10, v38, v38 row_ror:8 row_mask:0xf bank_mask:0x3
v_add_f32_dpp v11, v39, v39 row_ror:8 row_mask:0xf bank_mask:0x3
v_add_f32_dpp v8, v40, v40 row_ror:8 row_mask:0xf bank_mask:0xc
v_add_f32_dpp v9, v41, v41 row_ror:8 row_mask:0xf bank_mask:0xc
v_add_f32_dpp v10, v42, v42 row_ror:8 row_mask:0xf bank_mask:0xc
v_add_f32_dpp v11, v43, v43 row_ror:8 row_mask:0xf bank_mask:0xc
ds_write_b128 v98, v[8:11]
s_cmp_ge_u32 s17, 2
s_cbranch_scc1 .Lxk_57
s_waitcnt lgkmcnt(0)
s_barrier
ds_read_b128 v[4:7], v100 offset:0
ds_read_b128 v[8:11], v100 offset:2048
ds_read_b128 v[12:15], v100 offset:4096
ds_read_b128 v[16:19], v100 offset:6144
s_waitcnt lgkmcnt(2)
v_pk_add_f32 v[4:5], v[4:5], v[8:9]
v_pk_add_f32 v[6:7], v[6:7], v[10:11]
s_waitcnt lgkmcnt(0)
v_pk_add_f32 v[12:13], v[12:13], v[16:17]
v_pk_add_f32 v[14:15], v[14:15], v[18:19]
v_pk_add_f32 v[4:5], v[4:5], v[12:13]
v_pk_add_f32 v[6:7], v[6:7], v[14:15]
v_max3_f32 v8, v4, v5, v6
v_max_f32 v8, v8, v7
s_nop 1
v_max_f32_dpp v9, v8, v8 row_ror:4 row_mask:0xf bank_mask:0xf
v_max_f32_dpp v9, v8, v9 row_ror:8 row_mask:0xf bank_mask:0xf
v_max_f32_dpp v9, v8, v9 row_ror:12 row_mask:0xf bank_mask:0xf
s_nop 1
v_max_f32_dpp v10, v9, v9 row_ror:1 row_mask:0xf bank_mask:0xf
v_max_f32_dpp v10, v9, v10 row_ror:2 row_mask:0xf bank_mask:0xf
v_max_f32_dpp v10, v9, v10 row_ror:3 row_mask:0xf bank_mask:0xf
v_pk_add_f32 v[4:5], v[4:5], v[10:11] op_sel_hi:[1,0] neg_lo:[0,1] neg_hi:[0,1]
v_pk_add_f32 v[6:7], v[6:7], v[10:11] op_sel_hi:[1,0] neg_lo:[0,1] neg_hi:[0,1]
v_exp_f32 v4, v4
v_exp_f32 v5, v5
v_exp_f32 v6, v6
v_exp_f32 v7, v7
v_add_f32 v8, v4, v5
v_add_f32 v9, v6, v7
v_add_f32 v8, v8, v9
s_nop 1
v_add_f32_dpp v9, v8, v8 row_ror:4 row_mask:0xf bank_mask:0xf
v_add_f32_dpp v9, v8, v9 row_ror:8 row_mask:0xf bank_mask:0xf
v_add_f32_dpp v9, v8, v9 row_ror:12 row_mask:0xf bank_mask:0xf
s_nop 1
v_add_f32_dpp v10, v9, v9 row_ror:1 row_mask:0xf bank_mask:0xf
v_add_f32_dpp v10, v9, v10 row_ror:2 row_mask:0xf bank_mask:0xf
v_add_f32_dpp v10, v9, v10 row_ror:3 row_mask:0xf bank_mask:0xf
v_rcp_f32 v10, v10
s_nop 0
v_pk_mul_f32 v[4:5], v[4:5], v[10:11] op_sel_hi:[1,0]
v_pk_mul_f32 v[6:7], v[6:7], v[10:11] op_sel_hi:[1,0]
v_cvt_pk_bf16_f32 v4, v4, v5
v_cvt_pk_bf16_f32 v5, v6, v7
buffer_store_dwordx2 v[4:5], v101, s[8:11], s31 offen
buffer_store_dwordx2 v[104:105], v101, s[8:11], s32 offen
s_barrier
s_branch .Lsnext_58
.Lxk_57:
s_waitcnt lgkmcnt(0)
s_barrier
s_barrier
s_add_u32 s33, s33, 28672
s_mov_b32 m0, s26
s_add_u32 s27, s33, 0
buffer_load_dwordx4 v90, s[8:11], s27 offen lds
s_add_u32 m0, s26, 1024
s_add_u32 s27, s33, 1024
buffer_load_dwordx4 v90, s[8:11], s27 offen lds
s_add_u32 m0, s26, 2048
s_add_u32 s27, s33, 2048
buffer_load_dwordx4 v90, s[8:11], s27 offen lds
s_add_u32 m0, s26, 3072
s_add_u32 s27, s33, 3072
buffer_load_dwordx4 v90, s[8:11], s27 offen lds
s_add_u32 m0, s26, 4096
s_add_u32 s27, s33, 4096
buffer_load_dwordx4 v90, s[8:11], s27 offen lds
s_add_u32 m0, s26, 5120
s_add_u32 s27, s33, 5120
buffer_load_dwordx4 v90, s[8:11], s27 offen lds
s_add_u32 m0, s26, 6144
s_add_u32 s27, s33, 6144
buffer_load_dwordx4 v90, s[8:11], s27 offen lds
s_add_u32 m0, s26, 7168
s_add_u32 s27, s33, 7168
buffer_load_dwordx4 v90, s[8:11], s27 offen lds
s_add_u32 m0, s26, 8192
s_add_u32 s27, s33, 8192
buffer_load_dwordx4 v90, s[8:11], s27 offen lds
s_add_u32 m0, s26, 9216
s_add_u32 s27, s33, 9216
buffer_load_dwordx4 v90, s[8:11], s27 offen lds
s_add_u32 m0, s26, 10240
s_add_u32 s27, s33, 10240
buffer_load_dwordx4 v90, s[8:11], s27 offen lds
s_add_u32 m0, s26, 11264
s_add_u32 s27, s33, 11264
buffer_load_dwordx4 v90, s[8:11], s27 offen lds
s_add_u32 m0, s26, 12288
s_add_u32 s27, s33, 12288
buffer_load_dwordx4 v90, s[8:11], s27 offen lds
s_add_u32 m0, s26, 13312
s_add_u32 s27, s33, 13312
buffer_load_dwordx4 v90, s[8:11], s27 offen lds
.Lsnext_58:
s_add_u32 s18, s18, 1
s_cmp_lt_u32 s18, 63
s_cbranch_scc1 .Lsloop_48
s_waitcnt vmcnt(0)
s_barrier
s_branch .Lsend_59
.Lsfail_55:
buffer_load_dwordx4 v[70:73], v102, s[8:11], s29 offen sc1
buffer_load_dwordx4 v[74:77], v106, s[8:11], s29 offen sc1
s_sub_u32 s28, s28, 1
s_cbranch_scc0 .Lspoll_49
s_mov_b32 s19, 0
s_branch .Lspok_51
.Lsend_59:
v_lshlrev_b32 v90, 4, v0
s_mul_i32 s21, s16, 401408
s_mul_i32 s22, s17, 100352
s_add_u32 s21, s21, s22
s_add_u32 s21, s21, 0
v_and_b32 v2, 8, v0
v_mov_b32 v1, 0x44444444
v_mov_b32 v3, 0xeeeeeeee
v_cmp_ne_u32 vcc, 0, v2
v_mov_b32 v104, -1
v_mov_b32 v105, -1
v_cndmask_b32 v1, v1, v3, vcc
s_lshl_b32 s22, s17, 10
v_add_u32 v91, s22, v90
v_mov_b32 v102, v91
v_lshrrev_b32 v2, 4, v0
v_and_b32 v3, 15, v0
v_lshlrev_b32 v2, 2, v2
v_sub_u32 v3, v3, v2
v_mov_b32 v4, 0x3f80
v_mov_b32 v5, 0x3f800000
v_mov_b32 v112, 0
v_mov_b32 v113, 0
v_cmp_eq_u32 vcc, 0, v3
s_nop 1
v_cndmask_b32 v112, v112, v4, vcc
v_cmp_eq_u32 vcc, 1, v3
s_nop 1
v_cndmask_b32 v112, v112, v5, vcc
v_cmp_eq_u32 vcc, 2, v3
s_nop 1
v_cndmask_b32 v113, v113, v4, vcc
v_cmp_eq_u32 vcc, 3, v3
s_nop 1
v_cndmask_b32 v113, v113, v5, vcc
s_movk_i32 s23, 4096
s_cmp_eq_u32 s17, 3
s_cselect_b32 s23, 0x10000000, s23
v_add_u32 v103, s23, v102
v_mov_b32 v106, v103
s_cmp_eq_u32 s17, 3
s_cselect_b32 s23, 0, 4096
s_cselect_b32 s24, 0, s17
s_lshl_b32 s24, s24, 10
s_add_u32 s23, s23, s24
v_add_u32 v106, s23, v90
v_lshrrev_b32 v2, 4, v0
v_and_b32 v3, 7, v0
v_lshlrev_b32 v3, 4, v3
s_mul_i32 s22, s17, 1792
v_lshlrev_b32 v4, 7, v2
v_add3_u32 v92, v4, v3, s22
v_lshrrev_b32 v4, 1, v2
v_lshlrev_b32 v4, 7, v4
v_and_b32 v5, 1, v2
v_lshlrev_b32 v5, 3, v5
s_add_u32 s22, s22, 1536
v_add3_u32 v93, v4, v3, s22
v_add_u32 v93, v93, v5
s_mul_i32 s22, s17, 7168
s_add_u32 s22, s22, 8192
v_add_u32 v94, s22, v90
v_lshlrev_b32 v4, 3, v0
s_add_u32 s22, s22, 6144
v_add_u32 v95, s22, v4
s_mul_i32 s22, s17, 3584
s_add_u32 s22, s22, 36864
v_and_b32 v3, 15, v0
v_lshrrev_b32 v4, 2, v3
v_xor_b32 v4, v4, v2
v_lshlrev_b32 v4, 3, v4
v_lshlrev_b32 v5, 5, v3
v_add3_u32 v96, v4, v5, s22
v_and_b32 v4, 3, v0
v_xor_b32 v4, v4, v2
v_lshlrev_b32 v4, 3, v4
v_lshrrev_b32 v5, 2, v0
v_lshlrev_b32 v5, 5, v5
v_add3_u32 v97, v4, v5, s22
s_lshl_b32 s22, s17, 11
s_add_u32 s22, s22, 51200
v_and_b32 v4, 7, v0
v_lshrrev_b32 v5, 3, v3
v_lshlrev_b32 v6, 2, v5
v_add_u32 v6, v6, v2
v_lshrrev_b32 v7, 1, v6
v_add_u32 v7, v7, v4
v_and_b32 v7, 7, v7
v_lshlrev_b32 v7, 4, v7
v_lshlrev_b32 v6, 7, v6
v_add3_u32 v98, v6, v7, s22
v_add_u32 v6, 8, v2
v_lshrrev_b32 v7, 1, v6
v_add_u32 v7, v7, v4
v_and_b32 v7, 7, v7
v_lshlrev_b32 v7, 4, v7
v_lshlrev_b32 v6, 7, v6
v_add3_u32 v99, v6, v7, s22
v_lshrrev_b32 v6, 1, v2
v_or_b32 v6, v6, v5
v_add_u32 v7, 59392, v90
v_cmp_ne_u32 vcc, 0, v6
s_nop 1
v_cndmask_b32 v99, v99, v7, vcc
s_lshl_b32 s22, s17, 2
v_add_u32 v4, s22, v2
v_and_b32 v4, 7, v4
v_lshrrev_b32 v5, 1, v3
v_add_u32 v5, v5, v4
v_and_b32 v5, 7, v5
v_lshlrev_b32 v5, 4, v5
v_lshlrev_b32 v6, 7, v3
v_add_u32 v6, 51200, v6
v_add_u32 v100, v6, v5
s_lshr_b32 s22, s16, 2
s_lshl_b32 s23, s22, 11
s_and_b32 s24, s16, 3
s_lshl_b32 s24, s24, 8
s_add_u32 s23, s23, s24
v_lshrrev_b32 v5, 2, v3
v_lshlrev_b32 v5, 10, v5
v_lshrrev_b32 v6, 1, v3
v_and_b32 v6, 1, v6
v_lshlrev_b32 v6, 7, v6
v_lshlrev_b32 v7, 4, v4
v_add3_u32 v5, v5, v6, v7
v_and_b32 v6, 1, v3
v_lshlrev_b32 v8, 3, v6
v_add3_u32 v5, v5, v8, s23
s_lshl_b32 s23, s22, 9
s_and_b32 s24, s16, 1
s_lshl_b32 s24, s24, 8
s_add_u32 s23, s23, s24
s_lshr_b32 s24, s16, 1
s_and_b32 s24, s24, 1
s_lshl_b32 s24, s24, 3
s_add_u32 s23, s23, s24
s_add_u32 s23, s23, 8192
v_lshlrev_b32 v8, 7, v6
v_add3_u32 v8, v8, v7, s23
v_cmp_gt_u32 vcc, 8, v3
s_nop 1
v_cndmask_b32 v5, v8, v5, vcc
v_mov_b32 v8, 0x10000000
v_cmp_gt_u32 vcc, 10, v3
s_nop 1
v_cndmask_b32 v101, v8, v5, vcc
s_lshl_b32 s22, s17, 11
s_add_u32 s22, s22, 51200
v_lshlrev_b32 v2, 5, v0
v_add_u32 v2, s22, v2
v_mov_b32 v4, 0xf149f2ca
v_mov_b32 v5, v4
v_mov_b32 v6, v4
v_mov_b32 v7, v4
ds_write_b128 v2, v[4:7]
ds_write_b128 v2, v[4:7] offset:16
s_lshl_b32 s22, s16, 2
s_add_u32 s22, s22, s17
s_mul_i32 s22, s22, 5
v_add_u32 v2, s22, v0
v_lshlrev_b32 v3, 7, v2
v_mov_b32 v4, 0x10000000
v_cmp_gt_u32 vcc, 5, v0
s_movk_i32 s22, 544
s_nop 0
v_cndmask_b32 v3, v4, v3, vcc
v_cmp_gt_u32 vcc, s22, v2
s_mov_b32 s22, 101416960
s_nop 0
v_cndmask_b32 v3, v4, v3, vcc
buffer_load_dword v111, v3, s[8:11], s22 offen
s_mov_b32 s19, 20000
s_and_b32 s47, s16, 7
s_lshl_b32 s47, s47, 10
s_add_u32 s47, s47, 118165504
s_lshl_b32 s48, s16, 6
s_add_u32 s48, s48, 118188032
s_cmp_lg_u32 s17, 0
s_cbranch_scc1 .Lww_61
s_mov_b32 s24, s48
v_lshlrev_b32 v4, 2, v0
v_mov_b32 v8, 0x10000000
v_cmp_gt_u32 vcc, 2, v0
s_mov_b32 s25, s19
s_nop 0
v_cndmask_b32 v4, v8, v4, vcc
.Lwr_62:
buffer_load_dword v8, v4, s[8:11], s24 offen sc1
s_waitcnt vmcnt(0)
v_cmp_eq_u32 vcc, 1, v8
s_nop 1
s_bcnt1_i32_b64 s26, vcc
s_cmp_eq_u32 s26, 2
s_cbranch_scc1 .Lwo_63
s_sleep 1
s_sub_u32 s25, s25, 1
s_cbranch_scc0 .Lwr_62
s_mov_b32 s19, 0
.Lwo_63:
.Lww_61:
s_barrier
s_sub_u32 s22, s17, 2
s_mul_i32 s22, s22, 14336
s_add_u32 s33, s22, 70221824
s_add_u32 s26, s22, 8192
s_cmp_lt_u32 s17, 2
s_cbranch_scc1 .Lxk_60
s_mov_b32 m0, s26
s_add_u32 s27, s33, 0
buffer_load_dwordx4 v90, s[8:11], s27 offen lds
s_add_u32 m0, s26, 1024
s_add_u32 s27, s33, 1024
buffer_load_dwordx4 v90, s[8:11], s27 offen lds
s_add_u32 m0, s26, 2048
s_add_u32 s27, s33, 2048
buffer_load_dwordx4 v90, s[8:11], s27 offen lds
s_add_u32 m0, s26, 3072
s_add_u32 s27, s33, 3072
buffer_load_dwordx4 v90, s[8:11], s27 offen lds
s_add_u32 m0, s26, 4096
s_add_u32 s27, s33, 4096
buffer_load_dwordx4 v90, s[8:11], s27 offen lds
s_add_u32 m0, s26, 5120
s_add_u32 s27, s33, 5120
buffer_load_dwordx4 v90, s[8:11], s27 offen lds
s_add_u32 m0, s26, 6144
s_add_u32 s27, s33, 6144
buffer_load_dwordx4 v90, s[8:11], s27 offen lds
s_add_u32 m0, s26, 7168
s_add_u32 s27, s33, 7168
buffer_load_dwordx4 v90, s[8:11], s27 offen lds
s_add_u32 m0, s26, 8192
s_add_u32 s27, s33, 8192
buffer_load_dwordx4 v90, s[8:11], s27 offen lds
s_add_u32 m0, s26, 9216
s_add_u32 s27, s33, 9216
buffer_load_dwordx4 v90, s[8:11], s27 offen lds
s_add_u32 m0, s26, 10240
s_add_u32 s27, s33, 10240
buffer_load_dwordx4 v90, s[8:11], s27 offen lds
s_add_u32 m0, s26, 11264
s_add_u32 s27, s33, 11264
buffer_load_dwordx4 v90, s[8:11], s27 offen lds
s_add_u32 m0, s26, 12288
s_add_u32 s27, s33, 12288
buffer_load_dwordx4 v90, s[8:11], s27 offen lds
s_add_u32 m0, s26, 13312
s_add_u32 s27, s33, 13312
buffer_load_dwordx4 v90, s[8:11], s27 offen lds
.Lxk_60:
s_mov_b32 s18, 0
s_mov_b32 s19, 20000
s_mov_b32 s29, 101486592
s_mov_b32 s34, 118124544
v_min_u32 v107, 55, v0
v_lshlrev_b32 v107, 2, v107
s_lshl_b32 s22, s16, 1
s_add_u32 s22, s22, s17
s_lshl_b32 s22, s22, 2
s_add_u32 s22, s22, 256
v_mov_b32 v2, s22
v_mov_b32 v3, 0x10000000
v_cmp_eq_u32 vcc, 0, v0
v_mov_b32 v109, 1
s_nop 0
v_cndmask_b32 v108, v3, v2, vcc
s_mov_b32 s22, s17
s_lshl_b32 s40, s22, 10
s_add_u32 s22, s22, 4
s_sub_u32 s23, s22, 7
s_cselect_b32 s22, s22, s23
s_lshl_b32 s41, s22, 10
s_add_u32 s22, s22, 4
s_sub_u32 s23, s22, 7
s_cselect_b32 s22, s22, s23
s_lshl_b32 s42, s22, 10
s_add_u32 s22, s22, 4
s_sub_u32 s23, s22, 7
s_cselect_b32 s22, s22, s23
s_lshl_b32 s43, s22, 10
s_add_u32 s22, s22, 4
s_sub_u32 s23, s22, 7
s_cselect_b32 s22, s22, s23
s_lshl_b32 s44, s22, 10
s_add_u32 s22, s22, 4
s_sub_u32 s23, s22, 7
s_cselect_b32 s22, s22, s23
s_lshl_b32 s45, s22, 10
s_add_u32 s22, s22, 4
s_sub_u32 s23, s22, 7
s_cselect_b32 s22, s22, s23
s_lshl_b32 s46, s22, 10
v_add_u32 v107, s42, v90
v_add_u32 v108, s43, v90
v_add_u32 v109, s44, v90
v_add_u32 v118, s45, v90
v_add_u32 v119, s46, v90
.p2align 6
.Lsloop_64:
v_mov_b64 v[32:33], 0
v_mov_b64 v[34:35], 0
v_mov_b64 v[36:37], 0
v_mov_b64 v[38:39], 0
v_mov_b64 v[40:41], 0
v_mov_b64 v[42:43], 0
v_mov_b64 v[86:87], 0
v_mov_b64 v[88:89], 0
v_mov_b64 v[4:5], 0
v_mov_b64 v[6:7], 0
v_mov_b64 v[8:9], 0
v_mov_b64 v[10:11], 0
v_mov_b64 v[114:115], 0
v_mov_b64 v[116:117], 0
s_mov_b32 s28, s19
s_waitcnt vmcnt(0)
buffer_load_dwordx4 v[62:65], v102, s[8:11], s29 offen sc1
buffer_load_dwordx4 v[66:69], v106, s[8:11], s29 offen sc1
s_sleep 3
buffer_load_dwordx4 v[70:73], v102, s[8:11], s29 offen sc1
buffer_load_dwordx4 v[74:77], v106, s[8:11], s29 offen sc1
.Lspoll_65:
s_waitcnt vmcnt(3)
ds_write_b128 v91, v[62:65]
v_max3_u32 v2, v62, v63, v64
v_max_u32 v2, v2, v65
s_waitcnt vmcnt(2)
ds_write_b128 v91, v[66:69] offset:4096
v_max3_u32 v2, v2, v66, v67
v_max3_u32 v2, v2, v68, v69
v_cmp_eq_u32 vcc, -1, v2
s_cbranch_vccnz .Lsfail_70
.Lspok_67:
v_smfmac_f32_16x16x64_bf16 v[32:35], v[62:65], a[0:7], v1
v_smfmac_f32_16x16x64_bf16 v[36:39], v[62:65], a[56:63], v1
v_smfmac_f32_16x16x64_bf16 v[40:43], v[62:65], a[112:119], v1
v_smfmac_f32_16x16x64_bf16 v[86:89], v[62:65], a[168:175], v1
s_waitcnt lgkmcnt(0)
s_barrier
ds_read_b128 v[12:15], v107
ds_read_b128 v[16:19], v108
ds_read_b128 v[20:23], v109
ds_read_b128 v[24:27], v118
ds_read_b128 v[28:31], v119
v_smfmac_f32_16x16x64_bf16 v[4:7], v[62:65], a[224:231], v1
v_smfmac_f32_16x16x64_bf16 v[8:11], v[62:65], v[144:151], v1
v_smfmac_f32_16x16x64_bf16 v[114:117], v[62:65], v[200:207], v1
v_smfmac_f32_16x16x64_bf16 v[32:35], v[66:69], a[8:15], v1
v_smfmac_f32_16x16x64_bf16 v[36:39], v[66:69], a[64:71], v1
v_smfmac_f32_16x16x64_bf16 v[40:43], v[66:69], a[120:127], v1
v_smfmac_f32_16x16x64_bf16 v[86:89], v[66:69], a[176:183], v1
v_smfmac_f32_16x16x64_bf16 v[4:7], v[66:69], a[232:239], v1
v_smfmac_f32_16x16x64_bf16 v[8:11], v[66:69], v[152:159], v1
v_smfmac_f32_16x16x64_bf16 v[114:117], v[66:69], v[208:215], v1
s_branch .Lkc_69
.Lsfail_70:
buffer_load_dwordx4 v[62:65], v102, s[8:11], s29 offen sc1
buffer_load_dwordx4 v[66:69], v106, s[8:11], s29 offen sc1
.Lschk_72:
s_waitcnt vmcnt(3)
ds_write_b128 v91, v[70:73]
v_max3_u32 v2, v70, v71, v72
v_max_u32 v2, v2, v73
s_waitcnt vmcnt(2)
ds_write_b128 v91, v[74:77] offset:4096
v_max3_u32 v2, v2, v74, v75
v_max3_u32 v2, v2, v76, v77
v_cmp_eq_u32 vcc, -1, v2
s_cbranch_vccnz .Lsfail_71
.Lspok_68:
v_smfmac_f32_16x16x64_bf16 v[32:35], v[70:73], a[0:7], v1
v_smfmac_f32_16x16x64_bf16 v[36:39], v[70:73], a[56:63], v1
v_smfmac_f32_16x16x64_bf16 v[40:43], v[70:73], a[112:119], v1
v_smfmac_f32_16x16x64_bf16 v[86:89], v[70:73], a[168:175], v1
s_waitcnt lgkmcnt(0)
s_barrier
ds_read_b128 v[12:15], v107
ds_read_b128 v[16:19], v108
ds_read_b128 v[20:23], v109
ds_read_b128 v[24:27], v118
ds_read_b128 v[28:31], v119
v_smfmac_f32_16x16x64_bf16 v[4:7], v[70:73], a[224:231], v1
v_smfmac_f32_16x16x64_bf16 v[8:11], v[70:73], v[144:151], v1
v_smfmac_f32_16x16x64_bf16 v[114:117], v[70:73], v[200:207], v1
v_smfmac_f32_16x16x64_bf16 v[32:35], v[74:77], a[8:15], v1
v_smfmac_f32_16x16x64_bf16 v[36:39], v[74:77], a[64:71], v1
v_smfmac_f32_16x16x64_bf16 v[40:43], v[74:77], a[120:127], v1
v_smfmac_f32_16x16x64_bf16 v[86:89], v[74:77], a[176:183], v1
v_smfmac_f32_16x16x64_bf16 v[4:7], v[74:77], a[232:239], v1
v_smfmac_f32_16x16x64_bf16 v[8:11], v[74:77], v[152:159], v1
v_smfmac_f32_16x16x64_bf16 v[114:117], v[74:77], v[208:215], v1
.Lkc_69:
s_add_u32 s21, s18, 1
s_and_b32 s21, s21, 3
s_mul_i32 s21, s21, 7168
s_add_u32 s29, s21, 101416960
s_and_b32 s21, s18, 3
s_mul_i32 s21, s21, 10240
s_add_u32 s31, s21, 101445632
s_add_u32 s21, s18, 2
s_and_b32 s21, s21, 3
s_mul_i32 s21, s21, 10240
s_add_u32 s32, s21, 101445632
s_waitcnt lgkmcnt(4)
v_smfmac_f32_16x16x64_bf16 v[32:35], v[12:15], a[16:23], v1
ds_read_b128 v[78:81], v94 offset:1024
s_waitcnt lgkmcnt(4)
v_smfmac_f32_16x16x64_bf16 v[32:35], v[16:19], a[24:31], v1
ds_read_b128 v[82:85], v94 offset:4096
s_waitcnt lgkmcnt(4)
v_smfmac_f32_16x16x64_bf16 v[32:35], v[20:23], a[32:39], v1
s_waitcnt vmcnt(0)
ds_read_b128 v[62:65], v92 offset:0
s_waitcnt lgkmcnt(4)
v_smfmac_f32_16x16x64_bf16 v[32:35], v[24:27], a[40:47], v1
ds_read_b128 v[66:69], v94 offset:0
s_waitcnt lgkmcnt(4)
v_smfmac_f32_16x16x64_bf16 v[32:35], v[28:31], a[48:55], v1
ds_read_b128 v[70:73], v94 offset:3072
v_smfmac_f32_16x16x64_bf16 v[36:39], v[12:15], a[72:79], v1
ds_read_b128 v[74:77], v92 offset:512
v_smfmac_f32_16x16x64_bf16 v[36:39], v[16:19], a[80:87], v1
v_cvt_pk_bf16_f32 v44, v32, v33
v_smfmac_f32_16x16x64_bf16 v[36:39], v[20:23], a[88:95], v1
v_cvt_pk_bf16_f32 v45, v34, v35
v_smfmac_f32_16x16x64_bf16 v[36:39], v[24:27], a[96:103], v1
ds_write_b32 v96, v44 offset:0
v_smfmac_f32_16x16x64_bf16 v[36:39], v[28:31], a[104:111], v1
ds_write_b32 v96, v45 offset:4
v_smfmac_f32_16x16x64_bf16 v[40:43], v[12:15], a[128:135], v1
ds_read_b64_tr_b16 v[48:49], v97 offset:0
v_smfmac_f32_16x16x64_bf16 v[40:43], v[16:19], a[136:143], v1
v_cvt_pk_bf16_f32 v46, v36, v37
v_smfmac_f32_16x16x64_bf16 v[40:43], v[20:23], a[144:151], v1
v_cvt_pk_bf16_f32 v47, v38, v39
v_smfmac_f32_16x16x64_bf16 v[40:43], v[24:27], a[152:159], v1
ds_write_b32 v96, v46 offset:512
v_smfmac_f32_16x16x64_bf16 v[40:43], v[28:31], a[160:167], v1
ds_write_b32 v96, v47 offset:516
v_smfmac_f32_16x16x64_bf16 v[86:89], v[12:15], a[184:191], v1
ds_read_b64_tr_b16 v[50:51], v97 offset:512
v_smfmac_f32_16x16x64_bf16 v[86:89], v[16:19], a[192:199], v1
v_cvt_pk_bf16_f32 v44, v40, v41
v_smfmac_f32_16x16x64_bf16 v[86:89], v[20:23], a[200:207], v1
v_cvt_pk_bf16_f32 v45, v42, v43
v_smfmac_f32_16x16x64_bf16 v[86:89], v[24:27], a[208:215], v1
ds_write_b32 v96, v44 offset:1024
v_smfmac_f32_16x16x64_bf16 v[86:89], v[28:31], a[216:223], v1
ds_write_b32 v96, v45 offset:1028
v_smfmac_f32_16x16x64_bf16 v[4:7], v[12:15], a[240:247], v1
ds_read_b64_tr_b16 v[52:53], v97 offset:1024
v_smfmac_f32_16x16x64_bf16 v[4:7], v[16:19], a[248:255], v1
v_cvt_pk_bf16_f32 v46, v86, v87
v_smfmac_f32_16x16x64_bf16 v[4:7], v[20:23], v[120:127], v1
v_cvt_pk_bf16_f32 v47, v88, v89
v_smfmac_f32_16x16x64_bf16 v[4:7], v[24:27], v[128:135], v1
ds_write_b32 v96, v46 offset:1536
v_smfmac_f32_16x16x64_bf16 v[4:7], v[28:31], v[136:143], v1
ds_write_b32 v96, v47 offset:1540
v_smfmac_f32_16x16x64_bf16 v[8:11], v[12:15], v[160:167], v1
ds_read_b64_tr_b16 v[54:55], v97 offset:1536
v_smfmac_f32_16x16x64_bf16 v[8:11], v[16:19], v[168:175], v1
v_cvt_pk_bf16_f32 v44, v4, v5
v_smfmac_f32_16x16x64_bf16 v[8:11], v[20:23], v[176:183], v1
v_cvt_pk_bf16_f32 v45, v6, v7
v_smfmac_f32_16x16x64_bf16 v[8:11], v[24:27], v[184:191], v1
ds_write_b32 v96, v44 offset:2048
v_smfmac_f32_16x16x64_bf16 v[8:11], v[28:31], v[192:199], v1
ds_write_b32 v96, v45 offset:2052
v_smfmac_f32_16x16x64_bf16 v[114:117], v[12:15], v[216:223], v1
ds_read_b64_tr_b16 v[56:57], v97 offset:2048
v_smfmac_f32_16x16x64_bf16 v[114:117], v[16:19], v[224:231], v1
v_cvt_pk_bf16_f32 v46, v8, v9
v_smfmac_f32_16x16x64_bf16 v[114:117], v[20:23], v[232:239], v1
v_cvt_pk_bf16_f32 v47, v10, v11
v_smfmac_f32_16x16x64_bf16 v[114:117], v[24:27], v[240:247], v1
ds_write_b32 v96, v46 offset:2560
v_smfmac_f32_16x16x64_bf16 v[114:117], v[28:31], v[248:255], v1
ds_write_b32 v96, v47 offset:2564
s_waitcnt lgkmcnt(15)
s_waitcnt lgkmcnt(11)
v_mfma_f32_16x16x32_bf16 v[32:35], v[62:65], v[48:51], 0
ds_read_b64_tr_b16 v[58:59], v97 offset:2560
ds_read_b128 v[12:15], v92 offset:1024
v_mfma_f32_16x16x32_bf16 v[36:39], v[66:69], v[48:51], 0
v_cvt_pk_bf16_f32 v44, v114, v115
v_cvt_pk_bf16_f32 v45, v116, v117
v_mfma_f32_16x16x32_bf16 v[40:43], v[70:73], v[48:51], 0
ds_read_b128 v[16:19], v94 offset:2048
v_mfma_f32_16x16x16_bf16 v[86:89], v[44:45], v[112:113], 0
ds_read_b128 v[20:23], v94 offset:5120
s_waitcnt lgkmcnt(9)
v_mfma_f32_16x16x32_bf16 v[32:35], v[74:77], v[52:55], v[32:35]
ds_read_b64 v[24:25], v93
v_mfma_f32_16x16x32_bf16 v[36:39], v[78:81], v[52:55], v[36:39]
ds_read_b64 v[26:27], v95 offset:0
v_mfma_f32_16x16x32_bf16 v[40:43], v[82:85], v[52:55], v[40:43]
v_cvt_pk_bf16_f32 v60, v86, v87
ds_read_b64 v[28:29], v95 offset:512
s_waitcnt lgkmcnt(5)
v_mfma_f32_16x16x32_bf16 v[32:35], v[12:15], v[56:59], v[32:35]
v_cvt_pk_bf16_f32 v61, v88, v89
s_waitcnt lgkmcnt(4)
v_mfma_f32_16x16x32_bf16 v[36:39], v[16:19], v[56:59], v[36:39]
s_waitcnt lgkmcnt(3)
v_mfma_f32_16x16x32_bf16 v[40:43], v[20:23], v[56:59], v[40:43]
s_waitcnt lgkmcnt(2)
v_mfma_f32_16x16x16_bf16 v[32:35], v[24:25], v[60:61], v[32:35]
s_waitcnt lgkmcnt(1)
v_mfma_f32_16x16x16_bf16 v[36:39], v[26:27], v[60:61], v[36:39]
s_waitcnt lgkmcnt(0)
v_mfma_f32_16x16x16_bf16 v[40:43], v[28:29], v[60:61], v[40:43]
v_add_f32_dpp v4, v32, v32 row_ror:8 row_mask:0xf bank_mask:0xf
v_add_f32_dpp v5, v33, v33 row_ror:8 row_mask:0xf bank_mask:0xf
v_add_f32_dpp v6, v34, v34 row_ror:8 row_mask:0xf bank_mask:0xf
v_add_f32_dpp v7, v35, v35 row_ror:8 row_mask:0xf bank_mask:0xf
ds_write_b128 v99, v[4:7]
v_add_f32_dpp v8, v36, v36 row_ror:8 row_mask:0xf bank_mask:0x3
v_add_f32_dpp v9, v37, v37 row_ror:8 row_mask:0xf bank_mask:0x3
v_add_f32_dpp v10, v38, v38 row_ror:8 row_mask:0xf bank_mask:0x3
v_add_f32_dpp v11, v39, v39 row_ror:8 row_mask:0xf bank_mask:0x3
v_add_f32_dpp v8, v40, v40 row_ror:8 row_mask:0xf bank_mask:0xc
v_add_f32_dpp v9, v41, v41 row_ror:8 row_mask:0xf bank_mask:0xc
v_add_f32_dpp v10, v42, v42 row_ror:8 row_mask:0xf bank_mask:0xc
v_add_f32_dpp v11, v43, v43 row_ror:8 row_mask:0xf bank_mask:0xc
ds_write_b128 v98, v[8:11]
s_cmp_ge_u32 s17, 2
s_cbranch_scc1 .Lxk_73
s_waitcnt lgkmcnt(0)
s_barrier
ds_read_b128 v[4:7], v100 offset:0
ds_read_b128 v[8:11], v100 offset:2048
ds_read_b128 v[12:15], v100 offset:4096
ds_read_b128 v[16:19], v100 offset:6144
s_waitcnt lgkmcnt(2)
v_pk_add_f32 v[4:5], v[4:5], v[8:9]
v_pk_add_f32 v[6:7], v[6:7], v[10:11]
s_waitcnt lgkmcnt(0)
v_pk_add_f32 v[12:13], v[12:13], v[16:17]
v_pk_add_f32 v[14:15], v[14:15], v[18:19]
v_pk_add_f32 v[4:5], v[4:5], v[12:13]
v_pk_add_f32 v[6:7], v[6:7], v[14:15]
v_max3_f32 v8, v4, v5, v6
v_max_f32 v8, v8, v7
s_nop 1
v_max_f32_dpp v9, v8, v8 row_ror:4 row_mask:0xf bank_mask:0xf
v_max_f32_dpp v9, v8, v9 row_ror:8 row_mask:0xf bank_mask:0xf
v_max_f32_dpp v9, v8, v9 row_ror:12 row_mask:0xf bank_mask:0xf
s_nop 1
v_max_f32_dpp v10, v9, v9 row_ror:1 row_mask:0xf bank_mask:0xf
v_max_f32_dpp v10, v9, v10 row_ror:2 row_mask:0xf bank_mask:0xf
v_max_f32_dpp v10, v9, v10 row_ror:3 row_mask:0xf bank_mask:0xf
v_pk_add_f32 v[4:5], v[4:5], v[10:11] op_sel_hi:[1,0] neg_lo:[0,1] neg_hi:[0,1]
v_pk_add_f32 v[6:7], v[6:7], v[10:11] op_sel_hi:[1,0] neg_lo:[0,1] neg_hi:[0,1]
v_exp_f32 v4, v4
v_exp_f32 v5, v5
v_exp_f32 v6, v6
v_exp_f32 v7, v7
v_add_f32 v8, v4, v5
v_add_f32 v9, v6, v7
v_add_f32 v8, v8, v9
s_nop 1
v_add_f32_dpp v9, v8, v8 row_ror:4 row_mask:0xf bank_mask:0xf
v_add_f32_dpp v9, v8, v9 row_ror:8 row_mask:0xf bank_mask:0xf
v_add_f32_dpp v9, v8, v9 row_ror:12 row_mask:0xf bank_mask:0xf
s_nop 1
v_add_f32_dpp v10, v9, v9 row_ror:1 row_mask:0xf bank_mask:0xf
v_add_f32_dpp v10, v9, v10 row_ror:2 row_mask:0xf bank_mask:0xf
v_add_f32_dpp v10, v9, v10 row_ror:3 row_mask:0xf bank_mask:0xf
v_rcp_f32 v10, v10
s_nop 0
v_pk_mul_f32 v[4:5], v[4:5], v[10:11] op_sel_hi:[1,0]
v_pk_mul_f32 v[6:7], v[6:7], v[10:11] op_sel_hi:[1,0]
v_cvt_pk_bf16_f32 v4, v4, v5
v_cvt_pk_bf16_f32 v5, v6, v7
buffer_store_dwordx2 v[4:5], v101, s[8:11], s31 offen
buffer_store_dwordx2 v[104:105], v101, s[8:11], s32 offen
s_barrier
s_branch .Lsnext_74
.Lxk_73:
s_waitcnt lgkmcnt(0)
s_barrier
s_barrier
s_cmp_gt_u32 s18, 1
s_cbranch_scc1 .Llfa_75
s_cmp_eq_u32 s18, 1
s_cbranch_scc1 .Llfa_76
s_lshl_b32 s52, s16, 6
s_add_u32 s52, s52, 118188040
s_mov_b32 s48, s52
v_lshlrev_b32 v2, 2, v0
v_mov_b32 v4, 0x10000000
v_cmp_gt_u32 vcc, 2, v0
s_mov_b32 s49, s19
s_nop 0
v_cndmask_b32 v2, v4, v2, vcc
.Lwr_78:
buffer_load_dword v4, v2, s[8:11], s48 offen sc1
s_waitcnt vmcnt(0)
v_cmp_eq_u32 vcc, 1, v4
s_nop 1
s_bcnt1_i32_b64 s50, vcc
s_cmp_eq_u32 s50, 2
s_cbranch_scc1 .Lwo_79
s_sleep 1
s_sub_u32 s49, s49, 1
s_cbranch_scc0 .Lwr_78
s_mov_b32 s19, 0
.Lwo_79:
s_branch .Llfa_75
.Llfa_76:
s_mov_b32 s48, s47
v_lshlrev_b32 v2, 4, v0
v_mov_b32 v4, 0x10000000
v_cmp_gt_u32 vcc, 32, v0
s_mov_b32 s49, s19
s_nop 0
v_cndmask_b32 v2, v4, v2, vcc
.Lwr_81:
buffer_load_dwordx4 v[4:7], v2, s[8:11], s48 offen sc1
s_waitcnt vmcnt(0)
s_mov_b32 s50, 0
v_cmp_eq_u32 vcc, 1, v4
s_nop 1
s_and_b32 vcc_lo, vcc_lo, 0xffffffff
s_and_b32 vcc_hi, vcc_hi, 0x0
s_bcnt1_i32_b64 s51, vcc
s_add_u32 s50, s50, s51
v_cmp_eq_u32 vcc, 1, v5
s_nop 1
s_and_b32 vcc_lo, vcc_lo, 0xffffffff
s_and_b32 vcc_hi, vcc_hi, 0x0
s_bcnt1_i32_b64 s51, vcc
s_add_u32 s50, s50, s51
v_cmp_eq_u32 vcc, 1, v6
s_nop 1
s_and_b32 vcc_lo, vcc_lo, 0xffffffff
s_and_b32 vcc_hi, vcc_hi, 0x0
s_bcnt1_i32_b64 s51, vcc
s_add_u32 s50, s50, s51
v_cmp_eq_u32 vcc, 1, v7
s_nop 1
s_and_b32 vcc_lo, vcc_lo, 0xffffffff
s_and_b32 vcc_hi, vcc_hi, 0x0
s_bcnt1_i32_b64 s51, vcc
s_add_u32 s50, s50, s51
s_cmp_eq_u32 s50, 128
s_cbranch_scc1 .Lwo_82
s_sleep 2
s_sub_u32 s49, s49, 1
s_cbranch_scc0 .Lwr_81
s_mov_b32 s19, 0
.Lwo_82:
.Llfa_75:
s_add_u32 s33, s33, 28672
s_mov_b32 m0, s26
s_add_u32 s27, s33, 0
buffer_load_dwordx4 v90, s[8:11], s27 offen lds
s_add_u32 m0, s26, 1024
s_add_u32 s27, s33, 1024
buffer_load_dwordx4 v90, s[8:11], s27 offen lds
s_add_u32 m0, s26, 2048
s_add_u32 s27, s33, 2048
buffer_load_dwordx4 v90, s[8:11], s27 offen lds
s_add_u32 m0, s26, 3072
s_add_u32 s27, s33, 3072
buffer_load_dwordx4 v90, s[8:11], s27 offen lds
s_add_u32 m0, s26, 4096
s_add_u32 s27, s33, 4096
buffer_load_dwordx4 v90, s[8:11], s27 offen lds
s_add_u32 m0, s26, 5120
s_add_u32 s27, s33, 5120
buffer_load_dwordx4 v90, s[8:11], s27 offen lds
s_add_u32 m0, s26, 6144
s_add_u32 s27, s33, 6144
buffer_load_dwordx4 v90, s[8:11], s27 offen lds
s_add_u32 m0, s26, 7168
s_add_u32 s27, s33, 7168
buffer_load_dwordx4 v90, s[8:11], s27 offen lds
s_add_u32 m0, s26, 8192
s_add_u32 s27, s33, 8192
buffer_load_dwordx4 v90, s[8:11], s27 offen lds
s_add_u32 m0, s26, 9216
s_add_u32 s27, s33, 9216
buffer_load_dwordx4 v90, s[8:11], s27 offen lds
s_add_u32 m0, s26, 10240
s_add_u32 s27, s33, 10240
buffer_load_dwordx4 v90, s[8:11], s27 offen lds
s_add_u32 m0, s26, 11264
s_add_u32 s27, s33, 11264
buffer_load_dwordx4 v90, s[8:11], s27 offen lds
s_add_u32 m0, s26, 12288
s_add_u32 s27, s33, 12288
buffer_load_dwordx4 v90, s[8:11], s27 offen lds
s_add_u32 m0, s26, 13312
s_add_u32 s27, s33, 13312
buffer_load_dwordx4 v90, s[8:11], s27 offen lds
.Lsnext_74:
s_add_u32 s18, s18, 1
s_cmp_lt_u32 s18, 63
s_cbranch_scc1 .Lsloop_64
s_waitcnt vmcnt(0)
s_endpgm
.Lsfail_71:
buffer_load_dwordx4 v[70:73], v102, s[8:11], s29 offen sc1
buffer_load_dwordx4 v[74:77], v106, s[8:11], s29 offen sc1
s_sub_u32 s28, s28, 1
s_cbranch_scc0 .Lspoll_65
s_mov_b32 s19, 0
s_branch .Lspok_67
mega_kernel_val0:
s_sub_u32 s29, s16, 16
v_lshlrev_b32 v108, 4, v0
s_lshl_b32 s21, s29, 2
s_add_u32 s21, s21, s17
s_mul_i32 s21, s21, 114688
s_add_u32 s21, s21, 6422528
s_lshl_b32 s22, s17, 2
s_add_u32 s22, s22, 16
v_lshrrev_b32 v2, 3, v0
v_add_u32 v2, s22, v2
v_mul_u32_u24 v2, 448, v2
v_and_b32 v3, 7, v0
v_lshlrev_b32 v3, 2, v3
s_lshl_b32 s22, s29, 5
s_add_u32 s22, s22, 118222848
v_add3_u32 v2, v2, v3, s22
v_mov_b32 v3, 0x10000000
v_cmp_gt_u32 vcc, 32, v0
s_movk_i32 s28, 8000
s_nop 0
v_cndmask_b32 v2, v3, v2, vcc
.Lvw_84:
buffer_load_dword v3, v2, s[8:11], 0 offen sc1
s_waitcnt vmcnt(0)
v_cmp_eq_u32 vcc, 1, v3
s_nop 1
s_cmp_eq_u32 vcc_lo, -1
s_cbranch_scc1 .Lvw_85
s_sleep 2
s_sub_u32 s28, s28, 1
s_cbranch_scc0 .Lvw_84
.Lvw_85:
buffer_load_dwordx4 a[0:3], v108, s[8:11], s21 offen nt
buffer_load_dwordx4 a[4:7], v108, s[8:11], s21 offen offset:1024 nt
buffer_load_dwordx4 a[8:11], v108, s[8:11], s21 offen offset:2048 nt
buffer_load_dwordx4 a[12:15], v108, s[8:11], s21 offen offset:3072 nt
s_add_u32 s21, s21, 4096
buffer_load_dwordx4 a[16:19], v108, s[8:11], s21 offen nt
buffer_load_dwordx4 a[20:23], v108, s[8:11], s21 offen offset:1024 nt
buffer_load_dwordx4 a[24:27], v108, s[8:11], s21 offen offset:2048 nt
buffer_load_dwordx4 a[28:31], v108, s[8:11], s21 offen offset:3072 nt
s_add_u32 s21, s21, 4096
buffer_load_dwordx4 a[32:35], v108, s[8:11], s21 offen nt
buffer_load_dwordx4 a[36:39], v108, s[8:11], s21 offen offset:1024 nt
buffer_load_dwordx4 a[40:43], v108, s[8:11], s21 offen offset:2048 nt
buffer_load_dwordx4 a[44:47], v108, s[8:11], s21 offen offset:3072 nt
s_add_u32 s21, s21, 4096
buffer_load_dwordx4 a[48:51], v108, s[8:11], s21 offen nt
buffer_load_dwordx4 a[52:55], v108, s[8:11], s21 offen offset:1024 nt
buffer_load_dwordx4 a[56:59], v108, s[8:11], s21 offen offset:2048 nt
buffer_load_dwordx4 a[60:63], v108, s[8:11], s21 offen offset:3072 nt
s_add_u32 s21, s21, 4096
buffer_load_dwordx4 a[64:67], v108, s[8:11], s21 offen nt
buffer_load_dwordx4 a[68:71], v108, s[8:11], s21 offen offset:1024 nt
buffer_load_dwordx4 a[72:75], v108, s[8:11], s21 offen offset:2048 nt
buffer_load_dwordx4 a[76:79], v108, s[8:11], s21 offen offset:3072 nt
s_add_u32 s21, s21, 4096
buffer_load_dwordx4 a[80:83], v108, s[8:11], s21 offen nt
buffer_load_dwordx4 a[84:87], v108, s[8:11], s21 offen offset:1024 nt
buffer_load_dwordx4 a[88:91], v108, s[8:11], s21 offen offset:2048 nt
buffer_load_dwordx4 a[92:95], v108, s[8:11], s21 offen offset:3072 nt
s_add_u32 s21, s21, 4096
buffer_load_dwordx4 a[96:99], v108, s[8:11], s21 offen nt
buffer_load_dwordx4 a[100:103], v108, s[8:11], s21 offen offset:1024 nt
buffer_load_dwordx4 a[104:107], v108, s[8:11], s21 offen offset:2048 nt
buffer_load_dwordx4 a[108:111], v108, s[8:11], s21 offen offset:3072 nt
s_add_u32 s21, s21, 4096
buffer_load_dwordx4 a[112:115], v108, s[8:11], s21 offen nt
buffer_load_dwordx4 a[116:119], v108, s[8:11], s21 offen offset:1024 nt
buffer_load_dwordx4 a[120:123], v108, s[8:11], s21 offen offset:2048 nt
buffer_load_dwordx4 a[124:127], v108, s[8:11], s21 offen offset:3072 nt
s_add_u32 s21, s21, 4096
buffer_load_dwordx4 a[128:131], v108, s[8:11], s21 offen nt
buffer_load_dwordx4 a[132:135], v108, s[8:11], s21 offen offset:1024 nt
buffer_load_dwordx4 a[136:139], v108, s[8:11], s21 offen offset:2048 nt
buffer_load_dwordx4 a[140:143], v108, s[8:11], s21 offen offset:3072 nt
s_add_u32 s21, s21, 4096
buffer_load_dwordx4 a[144:147], v108, s[8:11], s21 offen nt
buffer_load_dwordx4 a[148:151], v108, s[8:11], s21 offen offset:1024 nt
buffer_load_dwordx4 a[152:155], v108, s[8:11], s21 offen offset:2048 nt
buffer_load_dwordx4 a[156:159], v108, s[8:11], s21 offen offset:3072 nt
s_add_u32 s21, s21, 4096
buffer_load_dwordx4 a[160:163], v108, s[8:11], s21 offen nt
buffer_load_dwordx4 a[164:167], v108, s[8:11], s21 offen offset:1024 nt
buffer_load_dwordx4 a[168:171], v108, s[8:11], s21 offen offset:2048 nt
buffer_load_dwordx4 a[172:175], v108, s[8:11], s21 offen offset:3072 nt
s_add_u32 s21, s21, 4096
buffer_load_dwordx4 a[176:179], v108, s[8:11], s21 offen nt
buffer_load_dwordx4 a[180:183], v108, s[8:11], s21 offen offset:1024 nt
buffer_load_dwordx4 a[184:187], v108, s[8:11], s21 offen offset:2048 nt
buffer_load_dwordx4 a[188:191], v108, s[8:11], s21 offen offset:3072 nt
s_add_u32 s21, s21, 4096
buffer_load_dwordx4 a[192:195], v108, s[8:11], s21 offen nt
buffer_load_dwordx4 a[196:199], v108, s[8:11], s21 offen offset:1024 nt
buffer_load_dwordx4 a[200:203], v108, s[8:11], s21 offen offset:2048 nt
buffer_load_dwordx4 a[204:207], v108, s[8:11], s21 offen offset:3072 nt
s_add_u32 s21, s21, 4096
buffer_load_dwordx4 a[208:211], v108, s[8:11], s21 offen nt
buffer_load_dwordx4 a[212:215], v108, s[8:11], s21 offen offset:1024 nt
buffer_load_dwordx4 a[216:219], v108, s[8:11], s21 offen offset:2048 nt
buffer_load_dwordx4 a[220:223], v108, s[8:11], s21 offen offset:3072 nt
s_add_u32 s21, s21, 4096
buffer_load_dwordx4 a[224:227], v108, s[8:11], s21 offen nt
buffer_load_dwordx4 a[228:231], v108, s[8:11], s21 offen offset:1024 nt
buffer_load_dwordx4 a[232:235], v108, s[8:11], s21 offen offset:2048 nt
buffer_load_dwordx4 a[236:239], v108, s[8:11], s21 offen offset:3072 nt
s_add_u32 s21, s21, 4096
buffer_load_dwordx4 a[240:243], v108, s[8:11], s21 offen nt
buffer_load_dwordx4 a[244:247], v108, s[8:11], s21 offen offset:1024 nt
buffer_load_dwordx4 a[248:251], v108, s[8:11], s21 offen offset:2048 nt
buffer_load_dwordx4 a[252:255], v108, s[8:11], s21 offen offset:3072 nt
s_add_u32 s21, s21, 4096
buffer_load_dwordx4 v[128:131], v108, s[8:11], s21 offen nt
buffer_load_dwordx4 v[132:135], v108, s[8:11], s21 offen offset:1024 nt
buffer_load_dwordx4 v[136:139], v108, s[8:11], s21 offen offset:2048 nt
buffer_load_dwordx4 v[140:143], v108, s[8:11], s21 offen offset:3072 nt
s_add_u32 s21, s21, 4096
buffer_load_dwordx4 v[144:147], v108, s[8:11], s21 offen nt
buffer_load_dwordx4 v[148:151], v108, s[8:11], s21 offen offset:1024 nt
buffer_load_dwordx4 v[152:155], v108, s[8:11], s21 offen offset:2048 nt
buffer_load_dwordx4 v[156:159], v108, s[8:11], s21 offen offset:3072 nt
s_add_u32 s21, s21, 4096
buffer_load_dwordx4 v[160:163], v108, s[8:11], s21 offen nt
buffer_load_dwordx4 v[164:167], v108, s[8:11], s21 offen offset:1024 nt
buffer_load_dwordx4 v[168:171], v108, s[8:11], s21 offen offset:2048 nt
buffer_load_dwordx4 v[172:175], v108, s[8:11], s21 offen offset:3072 nt
s_add_u32 s21, s21, 4096
buffer_load_dwordx4 v[176:179], v108, s[8:11], s21 offen nt
buffer_load_dwordx4 v[180:183], v108, s[8:11], s21 offen offset:1024 nt
buffer_load_dwordx4 v[184:187], v108, s[8:11], s21 offen offset:2048 nt
buffer_load_dwordx4 v[188:191], v108, s[8:11], s21 offen offset:3072 nt
s_add_u32 s21, s21, 4096
buffer_load_dwordx4 v[192:195], v108, s[8:11], s21 offen nt
buffer_load_dwordx4 v[196:199], v108, s[8:11], s21 offen offset:1024 nt
buffer_load_dwordx4 v[200:203], v108, s[8:11], s21 offen offset:2048 nt
buffer_load_dwordx4 v[204:207], v108, s[8:11], s21 offen offset:3072 nt
s_add_u32 s21, s21, 4096
buffer_load_dwordx4 v[208:211], v108, s[8:11], s21 offen nt
buffer_load_dwordx4 v[212:215], v108, s[8:11], s21 offen offset:1024 nt
buffer_load_dwordx4 v[216:219], v108, s[8:11], s21 offen offset:2048 nt
buffer_load_dwordx4 v[220:223], v108, s[8:11], s21 offen offset:3072 nt
s_add_u32 s21, s21, 4096
buffer_load_dwordx4 v[224:227], v108, s[8:11], s21 offen nt
buffer_load_dwordx4 v[228:231], v108, s[8:11], s21 offen offset:1024 nt
buffer_load_dwordx4 v[232:235], v108, s[8:11], s21 offen offset:2048 nt
buffer_load_dwordx4 v[236:239], v108, s[8:11], s21 offen offset:3072 nt
s_add_u32 s21, s21, 4096
buffer_load_dwordx4 v[240:243], v108, s[8:11], s21 offen nt
buffer_load_dwordx4 v[244:247], v108, s[8:11], s21 offen offset:1024 nt
buffer_load_dwordx4 v[248:251], v108, s[8:11], s21 offen offset:2048 nt
buffer_load_dwordx4 v[252:255], v108, s[8:11], s21 offen offset:3072 nt
s_add_u32 s21, s21, 4096
s_lshl_b32 s22, s17, 14
s_add_u32 s22, s22, 8192
s_add_u32 m0, s22, 0
s_add_u32 s23, s21, 0
buffer_load_dwordx4 v108, s[8:11], s23 offen lds
s_add_u32 m0, s22, 1024
s_add_u32 s23, s21, 1024
buffer_load_dwordx4 v108, s[8:11], s23 offen lds
s_add_u32 m0, s22, 2048
s_add_u32 s23, s21, 2048
buffer_load_dwordx4 v108, s[8:11], s23 offen lds
s_add_u32 m0, s22, 3072
s_add_u32 s23, s21, 3072
buffer_load_dwordx4 v108, s[8:11], s23 offen lds
s_add_u32 m0, s22, 4096
s_add_u32 s23, s21, 4096
buffer_load_dwordx4 v108, s[8:11], s23 offen lds
s_add_u32 m0, s22, 5120
s_add_u32 s23, s21, 5120
buffer_load_dwordx4 v108, s[8:11], s23 offen lds
s_add_u32 m0, s22, 6144
s_add_u32 s23, s21, 6144
buffer_load_dwordx4 v108, s[8:11], s23 offen lds
s_add_u32 m0, s22, 7168
s_add_u32 s23, s21, 7168
buffer_load_dwordx4 v108, s[8:11], s23 offen lds
s_add_u32 m0, s22, 8192
s_add_u32 s23, s21, 8192
buffer_load_dwordx4 v108, s[8:11], s23 offen lds
s_add_u32 m0, s22, 9216
s_add_u32 s23, s21, 9216
buffer_load_dwordx4 v108, s[8:11], s23 offen lds
s_add_u32 m0, s22, 10240
s_add_u32 s23, s21, 10240
buffer_load_dwordx4 v108, s[8:11], s23 offen lds
s_add_u32 m0, s22, 11264
s_add_u32 s23, s21, 11264
buffer_load_dwordx4 v108, s[8:11], s23 offen lds
s_add_u32 m0, s22, 12288
s_add_u32 s23, s21, 12288
buffer_load_dwordx4 v108, s[8:11], s23 offen lds
s_add_u32 m0, s22, 13312
s_add_u32 s23, s21, 13312
buffer_load_dwordx4 v108, s[8:11], s23 offen lds
s_add_u32 m0, s22, 14336
s_add_u32 s23, s21, 14336
buffer_load_dwordx4 v108, s[8:11], s23 offen lds
s_add_u32 m0, s22, 15360
s_add_u32 s23, s21, 15360
buffer_load_dwordx4 v108, s[8:11], s23 offen lds
v_add_u32 v112, s22, v108
v_and_b32 v2, 8, v0
v_mov_b32 v1, 0x44444444
v_mov_b32 v3, 0xeeeeeeee
v_cmp_ne_u32 vcc, 0, v2
v_mov_b32 v118, -1
v_mov_b32 v119, -1
v_cndmask_b32 v1, v1, v3, vcc
s_lshl_b32 s22, s17, 10
v_add_u32 v109, s22, v108
s_movk_i32 s23, 4096
s_cmp_eq_u32 s17, 3
s_cselect_b32 s23, 0x10000000, s23
v_add_u32 v111, s23, v109
s_lshl_b32 s22, s17, 11
v_add_u32 v113, s22, v108
s_lshl_b32 s22, s17, 9
s_add_u32 s22, s22, 8192
v_lshrrev_b32 v2, 4, v0
v_and_b32 v3, 15, v0
v_lshlrev_b32 v4, 7, v2
v_lshlrev_b32 v5, 4, v3
v_add3_u32 v4, v4, v5, s22
v_mov_b32 v5, 0x10000000
v_cmp_gt_u32 vcc, 8, v3
s_nop 1
v_cndmask_b32 v114, v5, v4, vcc
s_lshl_b32 s22, s17, 10
s_add_u32 s22, s22, 73728
v_lshlrev_b32 v4, 2, v0
v_add_u32 v115, s22, v4
v_add_u32 v116, 73728, v108
v_lshrrev_b32 v2, 4, v0
v_lshrrev_b32 v3, 2, v0
v_and_b32 v3, 1, v3
v_lshlrev_b32 v3, 2, v3
v_add_u32 v2, v2, v3
v_lshlrev_b32 v2, 4, v2
v_lshrrev_b32 v3, 3, v0
v_and_b32 v3, 1, v3
v_lshlrev_b32 v3, 1, v3
v_lshrrev_b32 v4, 1, v0
v_and_b32 v4, 1, v4
v_add_u32 v3, v3, v4
v_lshlrev_b32 v3, 7, v3
v_and_b32 v4, 1, v0
v_lshlrev_b32 v4, 3, v4
v_add3_u32 v2, v2, v3, v4
s_lshl_b32 s22, s29, 9
v_add_u32 v117, s22, v2
s_lshl_b32 s22, s29, 15
s_lshl_b32 s23, s17, 13
s_add_u32 s35, s22, s23
s_add_u32 s35, s35, 16515072
s_lshl_b32 s22, s29, 13
s_lshl_b32 s23, s17, 11
s_add_u32 s38, s22, s23
s_add_u32 s38, s38, 46403584
s_mov_b32 s18, 0
s_mov_b32 s19, 20000
s_mov_b32 s30, 45944832
s_mov_b32 s34, 45952000
s_mov_b32 s57, 68157440
v_min_u32 v125, 55, v0
v_lshlrev_b32 v125, 2, v125
v_and_b32 v124, 31, v0
v_lshlrev_b32 v124, 2, v124
v_add_u32 v124, 256, v124
s_lshl_b32 s22, s29, 2
s_add_u32 s22, s22, s17
s_lshl_b32 s22, s22, 2
v_mov_b32 v2, s22
v_mov_b32 v3, 0x10000000
v_cmp_eq_u32 vcc, 0, v0
v_mov_b32 v122, 1
s_nop 0
v_cndmask_b32 v126, v3, v2, vcc
v_mov_b32 v121, 0
v_mov_b32 v122, 1
s_lshl_b32 s22, s29, 4
s_lshl_b32 s23, s17, 2
s_add_u32 s39, s22, s23
s_add_u32 s39, s39, 68124672
s_lshl_b32 s22, s29, 2
s_add_u32 s56, s22, 68141056
s_lshl_b32 s22, s17, 6
v_add_u32 v2, s22, v0
v_mov_b32 v3, 64
v_cmp_eq_u32 vcc, v2, v3
v_mov_b32 v3, 0x10000000
s_nop 0
v_cndmask_b32 v123, v3, 0, vcc
s_lshl_b32 s22, s16, 2
s_add_u32 s22, s22, s17
s_mul_i32 s22, s22, 5
v_add_u32 v2, s22, v0
v_lshlrev_b32 v3, 7, v2
v_mov_b32 v4, 0x10000000
v_cmp_gt_u32 vcc, 5, v0
s_movk_i32 s22, 544
s_nop 0
v_cndmask_b32 v3, v4, v3, vcc
v_cmp_gt_u32 vcc, s22, v2
s_mov_b32 s22, 45875200
s_nop 0
v_cndmask_b32 v3, v4, v3, vcc
buffer_load_dword v124, v3, s[8:11], s22 offen
s_mov_b32 s28, s19
.Ldfp_86:
buffer_load_dword v120, v121, s[8:11], s39 offen sc1
s_waitcnt vmcnt(0)
v_readfirstlane_b32 s21, v120
s_nop 3
s_cmp_lg_u32 s21, 0
s_cbranch_scc1 .Ldfo_87
s_sub_u32 s28, s28, 1
s_cbranch_scc0 .Ldfp_86
s_mov_b32 s19, 0
.Ldfo_87:
.p2align 6
.Lvloop_88:
v_mov_b64 v[72:73], 0
v_mov_b64 v[88:89], 0
v_mov_b64 v[74:75], 0
v_mov_b64 v[90:91], 0
s_add_u32 s59, s18, 1
s_mov_b32 s28, s19
.Lvpoll_89:
buffer_load_dwordx4 v[32:35], v109, s[8:11], s30 offen sc1
buffer_load_dwordx4 v[36:39], v111, s[8:11], s30 offen sc1
s_waitcnt vmcnt(1)
ds_write_b128 v109, v[32:35]
v_max3_u32 v2, v32, v33, v34
v_max_u32 v2, v2, v35
s_waitcnt vmcnt(0)
ds_write_b128 v109, v[36:39] offset:4096
v_max3_u32 v2, v2, v36, v37
v_max3_u32 v2, v2, v38, v39
v_cmp_eq_u32 vcc, -1, v2
s_cbranch_vccnz .Lmfail_91
.Lvpok_90:
s_waitcnt lgkmcnt(0)
s_barrier
ds_read_b128 v[4:7], v108 offset:0
ds_read_b128 v[8:11], v108 offset:1024
ds_read_b128 v[12:15], v108 offset:2048
ds_read_b128 v[16:19], v108 offset:3072
ds_read_b128 v[20:23], v108 offset:4096
ds_read_b128 v[24:27], v108 offset:5120
ds_read_b128 v[28:31], v108 offset:6144
s_cmp_gt_u32 s18, 12
s_cbranch_scc1 .Ldq_92
v_readfirstlane_b32 s21, v120
s_nop 3
s_cmp_lg_u32 s21, 0
s_cbranch_scc1 .Ldok_95
s_mov_b32 s28, s19
.Ldfp_96:
buffer_load_dword v120, v121, s[8:11], s39 offen sc1
s_waitcnt vmcnt(0)
v_readfirstlane_b32 s21, v120
s_nop 3
s_cmp_lg_u32 s21, 0
s_cbranch_scc1 .Ldfo_97
s_sub_u32 s28, s28, 1
s_cbranch_scc0 .Ldfp_96
s_mov_b32 s19, 0
.Ldfo_97:
.Ldok_95:
s_cmp_lg_u32 s18, 12
s_cbranch_scc1 .Ldq_92
v_cmp_eq_u32 vcc, 0, v125
s_cbranch_vccz .Ldq_92
s_lshl_b32 s22, s29, 4
s_lshl_b32 s23, s17, 2
s_add_u32 s22, s22, s23
s_add_u32 s22, s22, 68138112
v_and_b32 v2, 3, v0
v_mul_u32_u24 v2, 224, v2
s_mov_b32 s28, s19
.Ldr_93:
buffer_load_dword v120, v2, s[8:11], s22 offen sc1
s_waitcnt vmcnt(0)
v_cmp_eq_u32 vcc, 0, v120
s_cbranch_vccz .Ldo_94
s_sub_u32 s28, s28, 1
s_cbranch_scc0 .Ldr_93
s_mov_b32 s19, 0
.Ldo_94:
.Ldq_92:
s_add_u32 s60, s35, 4096
s_cmp_eq_u32 s18, 0
s_cselect_b32 s62, 68255744, s38
s_cselect_b32 s21, 0, 114688
s_add_u32 s38, s38, s21
buffer_load_dwordx4 v[32:35], v108, s[8:11], s35 offen offset:0 sc1
buffer_load_dwordx4 v[36:39], v108, s[8:11], s35 offen offset:1024 sc1
buffer_load_dwordx4 v[40:43], v108, s[8:11], s35 offen offset:2048 sc1
s_cmp_ge_u32 s18, 12
s_cbranch_scc1 .Lfle_98
s_add_u32 s39, s39, 224
buffer_load_dword v120, v121, s[8:11], s39 offen sc1
s_cmp_lg_u32 s18, 11
s_cbranch_scc1 .Lfle_98
s_lshl_b32 s22, s29, 4
s_lshl_b32 s23, s17, 2
s_add_u32 s22, s22, s23
s_add_u32 s22, s22, 68138112
v_and_b32 v124, 3, v0
v_mul_u32_u24 v124, 224, v124
buffer_load_dword v125, v124, s[8:11], s22 offen sc1
.Lfle_98:
s_add_u32 s21, s18, 1
s_and_b32 s21, s21, 3
s_mul_i32 s21, s21, 7168
s_add_u32 s32, s21, 45875200
s_add_u32 s21, s18, 3
s_and_b32 s21, s21, 3
s_mul_i32 s21, s21, 7168
s_add_u32 s33, s21, 45875200
s_and_b32 s21, s18, 3
s_mul_i32 s21, s21, 10240
s_add_u32 s31, s21, 45903872
s_mov_b32 s30, s32
buffer_store_dwordx4 v[64:67], v108, s[8:11], s62 offen sc1
buffer_store_dwordx4 v[68:71], v108, s[8:11], s62 offen offset:1024 sc1
s_waitcnt lgkmcnt(6)
v_smfmac_f32_16x16x64_bf16 v[72:75], v[4:7], a[0:7], v1
v_mov_b64 v[76:77], 0
ds_read_b128 v[92:95], v112 offset:2048
ds_read_b128 v[96:99], v112 offset:3072
s_waitcnt lgkmcnt(7)
v_smfmac_f32_16x16x64_bf16 v[72:75], v[8:11], a[8:15], v1
v_mov_b64 v[78:79], 0
buffer_load_dwordx4 v[44:47], v108, s[8:11], s35 offen offset:3072 sc1
s_waitcnt lgkmcnt(6)
v_smfmac_f32_16x16x64_bf16 v[72:75], v[12:15], a[16:23], v1
s_waitcnt lgkmcnt(5)
v_smfmac_f32_16x16x64_bf16 v[72:75], v[16:19], a[24:31], v1
buffer_load_dwordx4 v[48:51], v108, s[8:11], s60 offen offset:0 sc1
s_waitcnt lgkmcnt(4)
v_smfmac_f32_16x16x64_bf16 v[72:75], v[20:23], a[32:39], v1
s_waitcnt lgkmcnt(3)
v_smfmac_f32_16x16x64_bf16 v[72:75], v[24:27], a[40:47], v1
buffer_load_dwordx4 v[52:55], v108, s[8:11], s60 offen offset:1024 sc1
s_waitcnt lgkmcnt(2)
v_smfmac_f32_16x16x64_bf16 v[72:75], v[28:31], a[48:55], v1
s_waitcnt lgkmcnt(0)
v_smfmac_f32_16x16x64_bf16 v[88:91], v[4:7], v[92:99], v1
v_smfmac_f32_16x16x64_bf16 v[76:79], v[4:7], a[112:119], v1
v_mov_b64 v[80:81], 0
ds_read_b128 v[92:95], v112 offset:4096
ds_read_b128 v[96:99], v112 offset:5120
buffer_load_dwordx4 v[56:59], v108, s[8:11], s60 offen offset:2048 sc1
v_smfmac_f32_16x16x64_bf16 v[76:79], v[8:11], a[120:127], v1
v_mov_b64 v[82:83], 0
v_smfmac_f32_16x16x64_bf16 v[76:79], v[12:15], a[128:135], v1
buffer_load_dwordx4 v[60:63], v108, s[8:11], s60 offen offset:3072 sc1
v_smfmac_f32_16x16x64_bf16 v[76:79], v[16:19], a[136:143], v1
v_smfmac_f32_16x16x64_bf16 v[76:79], v[20:23], a[144:151], v1
v_smfmac_f32_16x16x64_bf16 v[76:79], v[24:27], a[152:159], v1
v_smfmac_f32_16x16x64_bf16 v[76:79], v[28:31], a[160:167], v1
s_waitcnt lgkmcnt(0)
v_smfmac_f32_16x16x64_bf16 v[88:91], v[8:11], v[92:99], v1
v_smfmac_f32_16x16x64_bf16 v[80:83], v[4:7], a[224:231], v1
v_mov_b64 v[84:85], 0
ds_read_b128 v[92:95], v112 offset:6144
ds_read_b128 v[96:99], v112 offset:7168
v_smfmac_f32_16x16x64_bf16 v[80:83], v[8:11], a[232:239], v1
v_mov_b64 v[86:87], 0
v_smfmac_f32_16x16x64_bf16 v[80:83], v[12:15], a[240:247], v1
v_permlane32_swap_b32 v72, v76
v_smfmac_f32_16x16x64_bf16 v[80:83], v[16:19], a[248:255], v1
v_permlane32_swap_b32 v73, v77
v_smfmac_f32_16x16x64_bf16 v[80:83], v[20:23], v[128:135], v1
v_permlane32_swap_b32 v74, v78
v_smfmac_f32_16x16x64_bf16 v[80:83], v[24:27], v[136:143], v1
v_permlane32_swap_b32 v75, v79
v_smfmac_f32_16x16x64_bf16 v[80:83], v[28:31], v[144:151], v1
v_add_f32 v72, v72, v76
s_waitcnt lgkmcnt(0)
v_smfmac_f32_16x16x64_bf16 v[88:91], v[12:15], v[92:99], v1
v_add_f32 v73, v73, v77
v_smfmac_f32_16x16x64_bf16 v[84:87], v[4:7], v[208:215], v1
v_add_f32 v74, v74, v78
ds_read_b128 v[92:95], v112 offset:8192
ds_read_b128 v[96:99], v112 offset:9216
v_smfmac_f32_16x16x64_bf16 v[84:87], v[8:11], v[216:223], v1
v_add_f32 v75, v75, v79
ds_read_b128 v[100:103], v112 offset:0
ds_read_b128 v[104:107], v112 offset:1024
v_smfmac_f32_16x16x64_bf16 v[84:87], v[12:15], v[224:231], v1
v_cvt_pk_bf16_f32 v64, v72, v73
v_smfmac_f32_16x16x64_bf16 v[84:87], v[16:19], v[232:239], v1
v_cvt_pk_bf16_f32 v65, v74, v75
v_smfmac_f32_16x16x64_bf16 v[84:87], v[20:23], v[240:247], v1
v_mov_b64 v[72:73], 0
v_smfmac_f32_16x16x64_bf16 v[84:87], v[24:27], v[248:255], v1
v_mov_b64 v[74:75], 0
s_waitcnt lgkmcnt(0)
v_smfmac_f32_16x16x64_bf16 v[84:87], v[28:31], v[100:107], v1
v_smfmac_f32_16x16x64_bf16 v[88:91], v[16:19], v[92:99], v1
v_smfmac_f32_16x16x64_bf16 v[72:75], v[4:7], a[56:63], v1
v_mov_b64 v[76:77], 0
ds_read_b128 v[92:95], v112 offset:10240
ds_read_b128 v[96:99], v112 offset:11264
v_smfmac_f32_16x16x64_bf16 v[72:75], v[8:11], a[64:71], v1
v_mov_b64 v[78:79], 0
v_smfmac_f32_16x16x64_bf16 v[72:75], v[12:15], a[72:79], v1
v_permlane32_swap_b32 v80, v84
v_smfmac_f32_16x16x64_bf16 v[72:75], v[16:19], a[80:87], v1
v_permlane32_swap_b32 v81, v85
v_smfmac_f32_16x16x64_bf16 v[72:75], v[20:23], a[88:95], v1
v_permlane32_swap_b32 v82, v86
v_smfmac_f32_16x16x64_bf16 v[72:75], v[24:27], a[96:103], v1
v_permlane32_swap_b32 v83, v87
v_smfmac_f32_16x16x64_bf16 v[72:75], v[28:31], a[104:111], v1
v_add_f32 v80, v80, v84
s_waitcnt lgkmcnt(0)
v_smfmac_f32_16x16x64_bf16 v[88:91], v[20:23], v[92:99], v1
v_add_f32 v81, v81, v85
v_smfmac_f32_16x16x64_bf16 v[76:79], v[4:7], a[168:175], v1
v_add_f32 v82, v82, v86
ds_read_b128 v[92:95], v112 offset:12288
ds_read_b128 v[96:99], v112 offset:13312
v_smfmac_f32_16x16x64_bf16 v[76:79], v[8:11], a[176:183], v1
v_add_f32 v83, v83, v87
v_smfmac_f32_16x16x64_bf16 v[76:79], v[12:15], a[184:191], v1
v_cvt_pk_bf16_f32 v66, v80, v81
v_smfmac_f32_16x16x64_bf16 v[76:79], v[16:19], a[192:199], v1
v_cvt_pk_bf16_f32 v67, v82, v83
v_smfmac_f32_16x16x64_bf16 v[76:79], v[20:23], a[200:207], v1
v_mov_b64 v[80:81], 0
v_smfmac_f32_16x16x64_bf16 v[76:79], v[24:27], a[208:215], v1
v_mov_b64 v[82:83], 0
v_smfmac_f32_16x16x64_bf16 v[76:79], v[28:31], a[216:223], v1
s_waitcnt lgkmcnt(0)
v_smfmac_f32_16x16x64_bf16 v[88:91], v[24:27], v[92:99], v1
v_smfmac_f32_16x16x64_bf16 v[80:83], v[4:7], v[152:159], v1
ds_read_b128 v[92:95], v112 offset:14336
ds_read_b128 v[96:99], v112 offset:15360
v_smfmac_f32_16x16x64_bf16 v[80:83], v[8:11], v[160:167], v1
v_smfmac_f32_16x16x64_bf16 v[80:83], v[12:15], v[168:175], v1
v_permlane32_swap_b32 v72, v76
v_smfmac_f32_16x16x64_bf16 v[80:83], v[16:19], v[176:183], v1
v_permlane32_swap_b32 v73, v77
v_smfmac_f32_16x16x64_bf16 v[80:83], v[20:23], v[184:191], v1
v_permlane32_swap_b32 v74, v78
v_smfmac_f32_16x16x64_bf16 v[80:83], v[24:27], v[192:199], v1
v_permlane32_swap_b32 v75, v79
v_smfmac_f32_16x16x64_bf16 v[80:83], v[28:31], v[200:207], v1
v_add_f32 v72, v72, v76
s_waitcnt lgkmcnt(0)
v_smfmac_f32_16x16x64_bf16 v[88:91], v[28:31], v[92:99], v1
v_add_f32 v73, v73, v77
s_add_u32 s35, s35, 458752
v_add_f32 v74, v74, v78
v_add_f32 v75, v75, v79
v_cvt_pk_bf16_f32 v68, v72, v73
v_cvt_pk_bf16_f32 v69, v74, v75
s_nop 3
v_permlane32_swap_b32 v80, v88
v_permlane32_swap_b32 v81, v89
v_permlane32_swap_b32 v82, v90
v_permlane32_swap_b32 v83, v91
v_add_f32 v80, v80, v88
v_add_f32 v81, v81, v89
v_add_f32 v82, v82, v90
v_add_f32 v83, v83, v91
v_cvt_pk_bf16_f32 v70, v80, v81
v_cvt_pk_bf16_f32 v71, v82, v83
s_cmp_ge_u32 s18, 63
s_cbranch_scc1 .Lvfin_99
s_sleep 1
s_mov_b32 s28, s19
buffer_load_dwordx4 v[12:15], v114, s[8:11], s31 offen sc1
buffer_load_dwordx4 v[4:7], v113, s[8:11], s31 offen sc1
buffer_load_dwordx4 v[8:11], v113, s[8:11], s31 offen offset:1024 sc1
s_sleep 2
buffer_load_dwordx4 v[24:27], v114, s[8:11], s31 offen sc1
buffer_load_dwordx4 v[16:19], v113, s[8:11], s31 offen sc1
buffer_load_dwordx4 v[20:23], v113, s[8:11], s31 offen offset:1024 sc1
.Lppoll_100:
s_waitcnt vmcnt(5)
v_mfma_f32_16x16x32_bf16 v[72:75], v[12:15], v[64:67], 0
v_max3_u32 v2, v12, v13, v14
v_mfma_f32_16x16x32_bf16 v[76:79], v[12:15], v[68:71], 0
s_waitcnt vmcnt(4)
v_smfmac_f32_16x16x64_bf16 v[72:75], v[4:7], v[32:39], v1
v_max3_u32 v2, v2, v15, v4
v_max3_u32 v2, v2, v5, v6
v_smfmac_f32_16x16x64_bf16 v[76:79], v[4:7], v[48:55], v1
s_waitcnt vmcnt(3)
v_smfmac_f32_16x16x64_bf16 v[72:75], v[8:11], v[40:47], v1
v_max3_u32 v2, v2, v7, v8
v_max3_u32 v2, v2, v9, v10
v_smfmac_f32_16x16x64_bf16 v[76:79], v[8:11], v[56:63], v1
v_max_u32 v2, v2, v11
v_cmp_eq_u32 vcc, -1, v2
s_cbranch_vccnz .Lpfail_102
.Lppok_101:
s_nop 4
v_permlane32_swap_b32 v72, v76
v_permlane32_swap_b32 v73, v77
v_permlane32_swap_b32 v74, v78
v_permlane32_swap_b32 v75, v79
v_add_f32 v72, v72, v76
v_add_f32 v73, v73, v77
v_add_f32 v74, v74, v78
v_add_f32 v75, v75, v79
ds_write2st64_b32 v115, v72, v73 offset0:0 offset1:1
ds_write2st64_b32 v115, v74, v75 offset0:2 offset1:3
s_cmp_lg_u32 s17, 0
s_cbranch_scc1 .Lvoth_104
s_waitcnt lgkmcnt(0)
s_barrier
ds_read_b128 v[32:35], v116 offset:0
ds_read_b128 v[36:39], v116 offset:1024
ds_read_b128 v[40:43], v116 offset:2048
ds_read_b128 v[44:47], v116 offset:3072
s_waitcnt lgkmcnt(2)
v_pk_add_f32 v[32:33], v[32:33], v[36:37]
v_pk_add_f32 v[34:35], v[34:35], v[38:39]
s_waitcnt lgkmcnt(0)
v_pk_add_f32 v[40:41], v[40:41], v[44:45]
v_pk_add_f32 v[42:43], v[42:43], v[46:47]
v_pk_add_f32 v[32:33], v[32:33], v[40:41]
v_pk_add_f32 v[34:35], v[34:35], v[42:43]
v_cvt_pk_bf16_f32 v32, v32, v33
v_cvt_pk_bf16_f32 v33, v34, v35
buffer_store_dwordx2 v[32:33], v117, s[8:11], s32 offen
buffer_store_dwordx2 v[118:119], v117, s[8:11], s33 offen
s_cmp_eq_u32 s18, 62
s_cbranch_scc1 .Lvma_105
buffer_store_dwordx2 v[32:33], v117, s[8:11], s34 offen
s_branch .Lvma_106
.Lvma_105:
buffer_store_dwordx2 v[32:33], v117, s[8:11], s34 offen sc1
.Lvma_106:
.Lvnext_103:
s_barrier
s_add_u32 s34, s34, 7168
s_add_u32 s18, s18, 1
s_branch .Lvloop_88
.Lmfail_91:
s_sub_u32 s28, s28, 1
s_cbranch_scc0 .Lvpoll_89
s_mov_b32 s19, 0
s_branch .Lvpok_90
.Lpfail_102:
buffer_load_dwordx4 v[12:15], v114, s[8:11], s31 offen sc1
buffer_load_dwordx4 v[4:7], v113, s[8:11], s31 offen sc1
buffer_load_dwordx4 v[8:11], v113, s[8:11], s31 offen offset:1024 sc1
s_waitcnt vmcnt(5)
v_mfma_f32_16x16x32_bf16 v[72:75], v[24:27], v[64:67], 0
v_max3_u32 v2, v24, v25, v26
v_mfma_f32_16x16x32_bf16 v[76:79], v[24:27], v[68:71], 0
s_waitcnt vmcnt(4)
v_smfmac_f32_16x16x64_bf16 v[72:75], v[16:19], v[32:39], v1
v_max3_u32 v2, v2, v27, v16
v_max3_u32 v2, v2, v17, v18
v_smfmac_f32_16x16x64_bf16 v[76:79], v[16:19], v[48:55], v1
s_waitcnt vmcnt(3)
v_smfmac_f32_16x16x64_bf16 v[72:75], v[20:23], v[40:47], v1
v_max3_u32 v2, v2, v19, v20
v_max3_u32 v2, v2, v21, v22
v_smfmac_f32_16x16x64_bf16 v[76:79], v[20:23], v[56:63], v1
v_max_u32 v2, v2, v23
v_cmp_eq_u32 vcc, -1, v2
s_cbranch_vccz .Lppok_101
buffer_load_dwordx4 v[24:27], v114, s[8:11], s31 offen sc1
buffer_load_dwordx4 v[16:19], v113, s[8:11], s31 offen sc1
buffer_load_dwordx4 v[20:23], v113, s[8:11], s31 offen offset:1024 sc1
s_sub_u32 s28, s28, 1
s_cbranch_scc0 .Lppoll_100
s_mov_b32 s19, 0
s_branch .Lppok_101
.Lvoth_104:
s_waitcnt lgkmcnt(0)
s_barrier
s_branch .Lvnext_103
.Lvfin_99:
buffer_store_dwordx4 v[64:67], v108, s[8:11], s38 offen sc1
buffer_store_dwordx4 v[68:71], v108, s[8:11], s38 offen offset:1024 sc1
s_add_u32 s38, s38, 114688
s_waitcnt vmcnt(0)
s_mov_b32 s21, 68175424
buffer_store_dword v122, v126, s[8:11], s21 offen sc1
buffer_store_dword v122, v126, s[8:11], s21 offen offset:224 sc1
s_waitcnt vmcnt(0)
s_barrier
s_sub_u32 s29, s16, 16
v_lshlrev_b32 v108, 4, v0
s_lshl_b32 s21, s29, 2
s_add_u32 s21, s21, s17
s_mul_i32 s21, s21, 114688
s_add_u32 s21, s21, 6422528
s_lshl_b32 s22, s17, 14
s_add_u32 s22, s22, 8192
v_add_u32 v112, s22, v108
v_and_b32 v2, 8, v0
v_mov_b32 v1, 0x44444444
v_mov_b32 v3, 0xeeeeeeee
v_cmp_ne_u32 vcc, 0, v2
v_mov_b32 v118, -1
v_mov_b32 v119, -1
v_cndmask_b32 v1, v1, v3, vcc
s_lshl_b32 s22, s17, 10
v_add_u32 v109, s22, v108
s_movk_i32 s23, 4096
s_cmp_eq_u32 s17, 3
s_cselect_b32 s23, 0x10000000, s23
v_add_u32 v111, s23, v109
s_lshl_b32 s22, s17, 11
v_add_u32 v113, s22, v108
s_lshl_b32 s22, s17, 9
s_add_u32 s22, s22, 8192
v_lshrrev_b32 v2, 4, v0
v_and_b32 v3, 15, v0
v_lshlrev_b32 v4, 7, v2
v_lshlrev_b32 v5, 4, v3
v_add3_u32 v4, v4, v5, s22
v_mov_b32 v5, 0x10000000
v_cmp_gt_u32 vcc, 8, v3
s_nop 1
v_cndmask_b32 v114, v5, v4, vcc
s_lshl_b32 s22, s17, 10
s_add_u32 s22, s22, 73728
v_lshlrev_b32 v4, 2, v0
v_add_u32 v115, s22, v4
v_add_u32 v116, 73728, v108
v_lshrrev_b32 v2, 4, v0
v_lshrrev_b32 v3, 2, v0
v_and_b32 v3, 1, v3
v_lshlrev_b32 v3, 2, v3
v_add_u32 v2, v2, v3
v_lshlrev_b32 v2, 4, v2
v_lshrrev_b32 v3, 3, v0
v_and_b32 v3, 1, v3
v_lshlrev_b32 v3, 1, v3
v_lshrrev_b32 v4, 1, v0
v_and_b32 v4, 1, v4
v_add_u32 v3, v3, v4
v_lshlrev_b32 v3, 7, v3
v_and_b32 v4, 1, v0
v_lshlrev_b32 v4, 3, v4
v_add3_u32 v2, v2, v3, v4
s_lshl_b32 s22, s29, 9
v_add_u32 v117, s22, v2
s_lshl_b32 s22, s29, 15
s_lshl_b32 s23, s17, 13
s_add_u32 s35, s22, s23
s_add_u32 s35, s35, 72056832
s_lshl_b32 s22, s29, 13
s_lshl_b32 s23, s17, 11
s_add_u32 s38, s22, s23
s_add_u32 s38, s38, 101945344
s_mov_b32 s18, 0
s_mov_b32 s19, 20000
s_mov_b32 s30, 101486592
s_mov_b32 s34, 101493760
s_mov_b32 s57, 118124544
v_min_u32 v125, 55, v0
v_lshlrev_b32 v125, 2, v125
v_and_b32 v124, 31, v0
v_lshlrev_b32 v124, 2, v124
v_add_u32 v124, 256, v124
s_lshl_b32 s22, s29, 2
s_add_u32 s22, s22, s17
s_lshl_b32 s22, s22, 2
v_mov_b32 v2, s22
v_mov_b32 v3, 0x10000000
v_cmp_eq_u32 vcc, 0, v0
v_mov_b32 v122, 1
s_nop 0
v_cndmask_b32 v126, v3, v2, vcc
v_mov_b32 v121, 0
v_mov_b32 v122, 1
s_lshl_b32 s22, s29, 4
s_lshl_b32 s23, s17, 2
s_add_u32 s39, s22, s23
s_add_u32 s39, s39, 118091776
s_lshl_b32 s22, s29, 2
s_add_u32 s56, s22, 118108160
s_lshl_b32 s22, s17, 6
v_add_u32 v2, s22, v0
v_mov_b32 v3, 64
v_cmp_eq_u32 vcc, v2, v3
v_mov_b32 v3, 0x10000000
s_nop 0
v_cndmask_b32 v123, v3, 0, vcc
s_lshl_b32 s22, s16, 2
s_add_u32 s22, s22, s17
s_mul_i32 s22, s22, 5
v_add_u32 v2, s22, v0
v_lshlrev_b32 v3, 7, v2
v_mov_b32 v4, 0x10000000
v_cmp_gt_u32 vcc, 5, v0
s_movk_i32 s22, 544
s_nop 0
v_cndmask_b32 v3, v4, v3, vcc
v_cmp_gt_u32 vcc, s22, v2
s_mov_b32 s22, 101416960
s_nop 0
v_cndmask_b32 v3, v4, v3, vcc
buffer_load_dword v124, v3, s[8:11], s22 offen
v_mov_b32 v120, 1
.p2align 6
.Lvloop_107:
v_mov_b64 v[72:73], 0
v_mov_b64 v[88:89], 0
v_mov_b64 v[74:75], 0
v_mov_b64 v[90:91], 0
s_add_u32 s59, s18, 1
s_mov_b32 s28, s19
.Lvpoll_108:
buffer_load_dwordx4 v[32:35], v109, s[8:11], s30 offen sc1
buffer_load_dwordx4 v[36:39], v111, s[8:11], s30 offen sc1
s_waitcnt vmcnt(1)
ds_write_b128 v109, v[32:35]
v_max3_u32 v2, v32, v33, v34
v_max_u32 v2, v2, v35
s_waitcnt vmcnt(0)
ds_write_b128 v109, v[36:39] offset:4096
v_max3_u32 v2, v2, v36, v37
v_max3_u32 v2, v2, v38, v39
v_cmp_eq_u32 vcc, -1, v2
s_cbranch_vccnz .Lmfail_110
.Lvpok_109:
s_waitcnt lgkmcnt(0)
s_barrier
ds_read_b128 v[4:7], v108 offset:0
ds_read_b128 v[8:11], v108 offset:1024
ds_read_b128 v[12:15], v108 offset:2048
ds_read_b128 v[16:19], v108 offset:3072
ds_read_b128 v[20:23], v108 offset:4096
ds_read_b128 v[24:27], v108 offset:5120
ds_read_b128 v[28:31], v108 offset:6144
s_cmp_gt_u32 s18, 12
s_cbranch_scc1 .Ldq_111
v_readfirstlane_b32 s21, v120
s_nop 3
s_cmp_lg_u32 s21, 0
s_cbranch_scc1 .Ldok_114
s_mov_b32 s28, s19
.Ldfp_115:
buffer_load_dword v120, v121, s[8:11], s39 offen sc1
s_waitcnt vmcnt(0)
v_readfirstlane_b32 s21, v120
s_nop 3
s_cmp_lg_u32 s21, 0
s_cbranch_scc1 .Ldfo_116
s_sub_u32 s28, s28, 1
s_cbranch_scc0 .Ldfp_115
s_mov_b32 s19, 0
.Ldfo_116:
.Ldok_114:
s_cmp_lg_u32 s18, 12
s_cbranch_scc1 .Ldq_111
v_cmp_eq_u32 vcc, 0, v125
s_cbranch_vccz .Ldq_111
s_lshl_b32 s22, s29, 4
s_lshl_b32 s23, s17, 2
s_add_u32 s22, s22, s23
s_add_u32 s22, s22, 118105216
v_and_b32 v2, 3, v0
v_mul_u32_u24 v2, 224, v2
s_mov_b32 s28, s19
.Ldr_112:
buffer_load_dword v120, v2, s[8:11], s22 offen sc1
s_waitcnt vmcnt(0)
v_cmp_eq_u32 vcc, 0, v120
s_cbranch_vccz .Ldo_113
s_sub_u32 s28, s28, 1
s_cbranch_scc0 .Ldr_112
s_mov_b32 s19, 0
.Ldo_113:
.Ldq_111:
s_add_u32 s60, s35, 4096
s_cmp_eq_u32 s18, 0
s_cselect_b32 s62, 68255744, s38
s_cselect_b32 s21, 0, 114688
s_add_u32 s38, s38, s21
buffer_load_dwordx4 v[32:35], v108, s[8:11], s35 offen offset:0 sc1
buffer_load_dwordx4 v[36:39], v108, s[8:11], s35 offen offset:1024 sc1
buffer_load_dwordx4 v[40:43], v108, s[8:11], s35 offen offset:2048 sc1
s_cmp_ge_u32 s18, 12
s_cbranch_scc1 .Lfle_117
s_add_u32 s39, s39, 224
buffer_load_dword v120, v121, s[8:11], s39 offen sc1
s_cmp_lg_u32 s18, 11
s_cbranch_scc1 .Lfle_117
s_lshl_b32 s22, s29, 4
s_lshl_b32 s23, s17, 2
s_add_u32 s22, s22, s23
s_add_u32 s22, s22, 118105216
v_and_b32 v124, 3, v0
v_mul_u32_u24 v124, 224, v124
buffer_load_dword v125, v124, s[8:11], s22 offen sc1
.Lfle_117:
s_add_u32 s21, s18, 1
s_and_b32 s21, s21, 3
s_mul_i32 s21, s21, 7168
s_add_u32 s32, s21, 101416960
s_add_u32 s21, s18, 3
s_and_b32 s21, s21, 3
s_mul_i32 s21, s21, 7168
s_add_u32 s33, s21, 101416960
s_and_b32 s21, s18, 3
s_mul_i32 s21, s21, 10240
s_add_u32 s31, s21, 101445632
s_mov_b32 s30, s32
buffer_store_dwordx4 v[64:67], v108, s[8:11], s62 offen sc1
buffer_store_dwordx4 v[68:71], v108, s[8:11], s62 offen offset:1024 sc1
s_waitcnt lgkmcnt(6)
v_smfmac_f32_16x16x64_bf16 v[72:75], v[4:7], a[0:7], v1
v_mov_b64 v[76:77], 0
ds_read_b128 v[92:95], v112 offset:2048
ds_read_b128 v[96:99], v112 offset:3072
s_waitcnt lgkmcnt(7)
v_smfmac_f32_16x16x64_bf16 v[72:75], v[8:11], a[8:15], v1
v_mov_b64 v[78:79], 0
buffer_load_dwordx4 v[44:47], v108, s[8:11], s35 offen offset:3072 sc1
s_waitcnt lgkmcnt(6)
v_smfmac_f32_16x16x64_bf16 v[72:75], v[12:15], a[16:23], v1
s_waitcnt lgkmcnt(5)
v_smfmac_f32_16x16x64_bf16 v[72:75], v[16:19], a[24:31], v1
buffer_load_dwordx4 v[48:51], v108, s[8:11], s60 offen offset:0 sc1
s_waitcnt lgkmcnt(4)
v_smfmac_f32_16x16x64_bf16 v[72:75], v[20:23], a[32:39], v1
s_waitcnt lgkmcnt(3)
v_smfmac_f32_16x16x64_bf16 v[72:75], v[24:27], a[40:47], v1
buffer_load_dwordx4 v[52:55], v108, s[8:11], s60 offen offset:1024 sc1
s_waitcnt lgkmcnt(2)
v_smfmac_f32_16x16x64_bf16 v[72:75], v[28:31], a[48:55], v1
s_waitcnt lgkmcnt(0)
v_smfmac_f32_16x16x64_bf16 v[88:91], v[4:7], v[92:99], v1
v_smfmac_f32_16x16x64_bf16 v[76:79], v[4:7], a[112:119], v1
v_mov_b64 v[80:81], 0
ds_read_b128 v[92:95], v112 offset:4096
ds_read_b128 v[96:99], v112 offset:5120
buffer_load_dwordx4 v[56:59], v108, s[8:11], s60 offen offset:2048 sc1
v_smfmac_f32_16x16x64_bf16 v[76:79], v[8:11], a[120:127], v1
v_mov_b64 v[82:83], 0
v_smfmac_f32_16x16x64_bf16 v[76:79], v[12:15], a[128:135], v1
buffer_load_dwordx4 v[60:63], v108, s[8:11], s60 offen offset:3072 sc1
v_smfmac_f32_16x16x64_bf16 v[76:79], v[16:19], a[136:143], v1
v_smfmac_f32_16x16x64_bf16 v[76:79], v[20:23], a[144:151], v1
v_smfmac_f32_16x16x64_bf16 v[76:79], v[24:27], a[152:159], v1
v_smfmac_f32_16x16x64_bf16 v[76:79], v[28:31], a[160:167], v1
s_waitcnt lgkmcnt(0)
v_smfmac_f32_16x16x64_bf16 v[88:91], v[8:11], v[92:99], v1
v_smfmac_f32_16x16x64_bf16 v[80:83], v[4:7], a[224:231], v1
v_mov_b64 v[84:85], 0
ds_read_b128 v[92:95], v112 offset:6144
ds_read_b128 v[96:99], v112 offset:7168
v_smfmac_f32_16x16x64_bf16 v[80:83], v[8:11], a[232:239], v1
v_mov_b64 v[86:87], 0
v_smfmac_f32_16x16x64_bf16 v[80:83], v[12:15], a[240:247], v1
v_permlane32_swap_b32 v72, v76
v_smfmac_f32_16x16x64_bf16 v[80:83], v[16:19], a[248:255], v1
v_permlane32_swap_b32 v73, v77
v_smfmac_f32_16x16x64_bf16 v[80:83], v[20:23], v[128:135], v1
v_permlane32_swap_b32 v74, v78
v_smfmac_f32_16x16x64_bf16 v[80:83], v[24:27], v[136:143], v1
v_permlane32_swap_b32 v75, v79
v_smfmac_f32_16x16x64_bf16 v[80:83], v[28:31], v[144:151], v1
v_add_f32 v72, v72, v76
s_waitcnt lgkmcnt(0)
v_smfmac_f32_16x16x64_bf16 v[88:91], v[12:15], v[92:99], v1
v_add_f32 v73, v73, v77
v_smfmac_f32_16x16x64_bf16 v[84:87], v[4:7], v[208:215], v1
v_add_f32 v74, v74, v78
ds_read_b128 v[92:95], v112 offset:8192
ds_read_b128 v[96:99], v112 offset:9216
v_smfmac_f32_16x16x64_bf16 v[84:87], v[8:11], v[216:223], v1
v_add_f32 v75, v75, v79
ds_read_b128 v[100:103], v112 offset:0
ds_read_b128 v[104:107], v112 offset:1024
v_smfmac_f32_16x16x64_bf16 v[84:87], v[12:15], v[224:231], v1
v_cvt_pk_bf16_f32 v64, v72, v73
v_smfmac_f32_16x16x64_bf16 v[84:87], v[16:19], v[232:239], v1
v_cvt_pk_bf16_f32 v65, v74, v75
v_smfmac_f32_16x16x64_bf16 v[84:87], v[20:23], v[240:247], v1
v_mov_b64 v[72:73], 0
v_smfmac_f32_16x16x64_bf16 v[84:87], v[24:27], v[248:255], v1
v_mov_b64 v[74:75], 0
s_waitcnt lgkmcnt(0)
v_smfmac_f32_16x16x64_bf16 v[84:87], v[28:31], v[100:107], v1
v_smfmac_f32_16x16x64_bf16 v[88:91], v[16:19], v[92:99], v1
v_smfmac_f32_16x16x64_bf16 v[72:75], v[4:7], a[56:63], v1
v_mov_b64 v[76:77], 0
ds_read_b128 v[92:95], v112 offset:10240
ds_read_b128 v[96:99], v112 offset:11264
v_smfmac_f32_16x16x64_bf16 v[72:75], v[8:11], a[64:71], v1
v_mov_b64 v[78:79], 0
v_smfmac_f32_16x16x64_bf16 v[72:75], v[12:15], a[72:79], v1
v_permlane32_swap_b32 v80, v84
v_smfmac_f32_16x16x64_bf16 v[72:75], v[16:19], a[80:87], v1
v_permlane32_swap_b32 v81, v85
v_smfmac_f32_16x16x64_bf16 v[72:75], v[20:23], a[88:95], v1
v_permlane32_swap_b32 v82, v86
v_smfmac_f32_16x16x64_bf16 v[72:75], v[24:27], a[96:103], v1
v_permlane32_swap_b32 v83, v87
v_smfmac_f32_16x16x64_bf16 v[72:75], v[28:31], a[104:111], v1
v_add_f32 v80, v80, v84
s_waitcnt lgkmcnt(0)
v_smfmac_f32_16x16x64_bf16 v[88:91], v[20:23], v[92:99], v1
v_add_f32 v81, v81, v85
v_smfmac_f32_16x16x64_bf16 v[76:79], v[4:7], a[168:175], v1
v_add_f32 v82, v82, v86
ds_read_b128 v[92:95], v112 offset:12288
ds_read_b128 v[96:99], v112 offset:13312
v_smfmac_f32_16x16x64_bf16 v[76:79], v[8:11], a[176:183], v1
v_add_f32 v83, v83, v87
v_smfmac_f32_16x16x64_bf16 v[76:79], v[12:15], a[184:191], v1
v_cvt_pk_bf16_f32 v66, v80, v81
v_smfmac_f32_16x16x64_bf16 v[76:79], v[16:19], a[192:199], v1
v_cvt_pk_bf16_f32 v67, v82, v83
v_smfmac_f32_16x16x64_bf16 v[76:79], v[20:23], a[200:207], v1
v_mov_b64 v[80:81], 0
v_smfmac_f32_16x16x64_bf16 v[76:79], v[24:27], a[208:215], v1
v_mov_b64 v[82:83], 0
v_smfmac_f32_16x16x64_bf16 v[76:79], v[28:31], a[216:223], v1
s_waitcnt lgkmcnt(0)
v_smfmac_f32_16x16x64_bf16 v[88:91], v[24:27], v[92:99], v1
v_smfmac_f32_16x16x64_bf16 v[80:83], v[4:7], v[152:159], v1
ds_read_b128 v[92:95], v112 offset:14336
ds_read_b128 v[96:99], v112 offset:15360
v_smfmac_f32_16x16x64_bf16 v[80:83], v[8:11], v[160:167], v1
v_smfmac_f32_16x16x64_bf16 v[80:83], v[12:15], v[168:175], v1
v_permlane32_swap_b32 v72, v76
v_smfmac_f32_16x16x64_bf16 v[80:83], v[16:19], v[176:183], v1
v_permlane32_swap_b32 v73, v77
v_smfmac_f32_16x16x64_bf16 v[80:83], v[20:23], v[184:191], v1
v_permlane32_swap_b32 v74, v78
v_smfmac_f32_16x16x64_bf16 v[80:83], v[24:27], v[192:199], v1
v_permlane32_swap_b32 v75, v79
v_smfmac_f32_16x16x64_bf16 v[80:83], v[28:31], v[200:207], v1
v_add_f32 v72, v72, v76
s_waitcnt lgkmcnt(0)
v_smfmac_f32_16x16x64_bf16 v[88:91], v[28:31], v[92:99], v1
v_add_f32 v73, v73, v77
s_add_u32 s35, s35, 458752
v_add_f32 v74, v74, v78
v_add_f32 v75, v75, v79
v_cvt_pk_bf16_f32 v68, v72, v73
v_cvt_pk_bf16_f32 v69, v74, v75
s_nop 3
v_permlane32_swap_b32 v80, v88
v_permlane32_swap_b32 v81, v89
v_permlane32_swap_b32 v82, v90
v_permlane32_swap_b32 v83, v91
v_add_f32 v80, v80, v88
v_add_f32 v81, v81, v89
v_add_f32 v82, v82, v90
v_add_f32 v83, v83, v91
v_cvt_pk_bf16_f32 v70, v80, v81
v_cvt_pk_bf16_f32 v71, v82, v83
s_cmp_ge_u32 s18, 63
s_cbranch_scc1 .Lvfin_118
s_cmp_lg_u32 s18, 0
s_cbranch_scc1 .Ld0_119
s_lshl_b32 s21, s29, 15
s_lshl_b32 s22, s17, 13
s_add_u32 s21, s21, s22
s_add_u32 s21, s21, 72056832
s_add_u32 s22, s21, 4096
s_mov_b32 s28, s19
.Ld0_120:
s_waitcnt vmcnt(0)
v_max3_u32 v2, v32, v33, v34
v_max3_u32 v2, v2, v35, v36
v_max3_u32 v2, v2, v37, v38
v_max3_u32 v2, v2, v39, v40
v_max3_u32 v2, v2, v41, v42
v_max3_u32 v2, v2, v43, v44
v_max3_u32 v2, v2, v45, v46
v_max3_u32 v2, v2, v47, v48
v_max3_u32 v2, v2, v49, v50
v_max3_u32 v2, v2, v51, v52
v_max3_u32 v2, v2, v53, v54
v_max3_u32 v2, v2, v55, v56
v_max3_u32 v2, v2, v57, v58
v_max3_u32 v2, v2, v59, v60
v_max3_u32 v2, v2, v61, v62
v_max_u32 v2, v2, v63
s_nop 0
v_cmp_eq_u32 vcc, -1, v2
s_cbranch_vccz .Ld0_119
buffer_load_dwordx4 v[32:35], v108, s[8:11], s21 offen offset:0 sc1
buffer_load_dwordx4 v[36:39], v108, s[8:11], s21 offen offset:1024 sc1
buffer_load_dwordx4 v[40:43], v108, s[8:11], s21 offen offset:2048 sc1
buffer_load_dwordx4 v[44:47], v108, s[8:11], s21 offen offset:3072 sc1
buffer_load_dwordx4 v[48:51], v108, s[8:11], s22 offen offset:0 sc1
buffer_load_dwordx4 v[52:55], v108, s[8:11], s22 offen offset:1024 sc1
buffer_load_dwordx4 v[56:59], v108, s[8:11], s22 offen offset:2048 sc1
buffer_load_dwordx4 v[60:63], v108, s[8:11], s22 offen offset:3072 sc1
s_sub_u32 s28, s28, 1
s_cbranch_scc0 .Ld0_120
s_mov_b32 s19, 0
s_waitcnt vmcnt(0)
.Ld0_119:
s_sleep 1
s_mov_b32 s28, s19
buffer_load_dwordx4 v[12:15], v114, s[8:11], s31 offen sc1
buffer_load_dwordx4 v[4:7], v113, s[8:11], s31 offen sc1
buffer_load_dwordx4 v[8:11], v113, s[8:11], s31 offen offset:1024 sc1
s_sleep 2
buffer_load_dwordx4 v[24:27], v114, s[8:11], s31 offen sc1
buffer_load_dwordx4 v[16:19], v113, s[8:11], s31 offen sc1
buffer_load_dwordx4 v[20:23], v113, s[8:11], s31 offen offset:1024 sc1
.Lppoll_122:
s_waitcnt vmcnt(5)
v_mfma_f32_16x16x32_bf16 v[72:75], v[12:15], v[64:67], 0
v_max3_u32 v2, v12, v13, v14
v_mfma_f32_16x16x32_bf16 v[76:79], v[12:15], v[68:71], 0
s_waitcnt vmcnt(4)
v_smfmac_f32_16x16x64_bf16 v[72:75], v[4:7], v[32:39], v1
v_max3_u32 v2, v2, v15, v4
v_max3_u32 v2, v2, v5, v6
v_smfmac_f32_16x16x64_bf16 v[76:79], v[4:7], v[48:55], v1
s_waitcnt vmcnt(3)
v_smfmac_f32_16x16x64_bf16 v[72:75], v[8:11], v[40:47], v1
v_max3_u32 v2, v2, v7, v8
v_max3_u32 v2, v2, v9, v10
v_smfmac_f32_16x16x64_bf16 v[76:79], v[8:11], v[56:63], v1
v_max_u32 v2, v2, v11
v_cmp_eq_u32 vcc, -1, v2
s_cbranch_vccnz .Lpfail_124
.Lppok_123:
s_nop 4
v_permlane32_swap_b32 v72, v76
v_permlane32_swap_b32 v73, v77
v_permlane32_swap_b32 v74, v78
v_permlane32_swap_b32 v75, v79
v_add_f32 v72, v72, v76
v_add_f32 v73, v73, v77
v_add_f32 v74, v74, v78
v_add_f32 v75, v75, v79
ds_write2st64_b32 v115, v72, v73 offset0:0 offset1:1
ds_write2st64_b32 v115, v74, v75 offset0:2 offset1:3
s_cmp_lg_u32 s17, 0
s_cbranch_scc1 .Lvoth_126
s_waitcnt lgkmcnt(0)
s_barrier
ds_read_b128 v[32:35], v116 offset:0
ds_read_b128 v[36:39], v116 offset:1024
ds_read_b128 v[40:43], v116 offset:2048
ds_read_b128 v[44:47], v116 offset:3072
s_waitcnt lgkmcnt(2)
v_pk_add_f32 v[32:33], v[32:33], v[36:37]
v_pk_add_f32 v[34:35], v[34:35], v[38:39]
s_waitcnt lgkmcnt(0)
v_pk_add_f32 v[40:41], v[40:41], v[44:45]
v_pk_add_f32 v[42:43], v[42:43], v[46:47]
v_pk_add_f32 v[32:33], v[32:33], v[40:41]
v_pk_add_f32 v[34:35], v[34:35], v[42:43]
v_cvt_pk_bf16_f32 v32, v32, v33
v_cvt_pk_bf16_f32 v33, v34, v35
buffer_store_dwordx2 v[32:33], v117, s[8:11], s32 offen
buffer_store_dwordx2 v[118:119], v117, s[8:11], s33 offen
s_cmp_eq_u32 s18, 62
s_cbranch_scc1 .Lvma_127
buffer_store_dwordx2 v[32:33], v117, s[8:11], s34 offen
s_branch .Lvma_128
.Lvma_127:
buffer_store_dwordx2 v[32:33], v117, s[8:11], s34 offen sc1
.Lvma_128:
.Lvnext_125:
s_barrier
s_add_u32 s34, s34, 7168
s_add_u32 s18, s18, 1
s_branch .Lvloop_107
.Lmfail_110:
s_sub_u32 s28, s28, 1
s_cbranch_scc0 .Lvpoll_108
s_mov_b32 s19, 0
s_branch .Lvpok_109
.Lpfail_124:
buffer_load_dwordx4 v[12:15], v114, s[8:11], s31 offen sc1
buffer_load_dwordx4 v[4:7], v113, s[8:11], s31 offen sc1
buffer_load_dwordx4 v[8:11], v113, s[8:11], s31 offen offset:1024 sc1
s_waitcnt vmcnt(5)
v_mfma_f32_16x16x32_bf16 v[72:75], v[24:27], v[64:67], 0
v_max3_u32 v2, v24, v25, v26
v_mfma_f32_16x16x32_bf16 v[76:79], v[24:27], v[68:71], 0
s_waitcnt vmcnt(4)
v_smfmac_f32_16x16x64_bf16 v[72:75], v[16:19], v[32:39], v1
v_max3_u32 v2, v2, v27, v16
v_max3_u32 v2, v2, v17, v18
v_smfmac_f32_16x16x64_bf16 v[76:79], v[16:19], v[48:55], v1
s_waitcnt vmcnt(3)
v_smfmac_f32_16x16x64_bf16 v[72:75], v[20:23], v[40:47], v1
v_max3_u32 v2, v2, v19, v20
v_max3_u32 v2, v2, v21, v22
v_smfmac_f32_16x16x64_bf16 v[76:79], v[20:23], v[56:63], v1
v_max_u32 v2, v2, v23
v_cmp_eq_u32 vcc, -1, v2
s_cbranch_vccz .Lppok_123
buffer_load_dwordx4 v[24:27], v114, s[8:11], s31 offen sc1
buffer_load_dwordx4 v[16:19], v113, s[8:11], s31 offen sc1
buffer_load_dwordx4 v[20:23], v113, s[8:11], s31 offen offset:1024 sc1
s_sub_u32 s28, s28, 1
s_cbranch_scc0 .Lppoll_122
s_mov_b32 s19, 0
s_branch .Lppok_123
.Lvoth_126:
s_waitcnt lgkmcnt(0)
s_barrier
s_branch .Lvnext_125
.Lvfin_118:
buffer_store_dwordx4 v[64:67], v108, s[8:11], s38 offen sc1
buffer_store_dwordx4 v[68:71], v108, s[8:11], s38 offen offset:1024 sc1
s_add_u32 s38, s38, 114688
s_waitcnt vmcnt(0)
s_mov_b32 s21, 118142528
buffer_store_dword v122, v126, s[8:11], s21 offen sc1
buffer_store_dword v122, v126, s[8:11], s21 offen offset:224 sc1
s_waitcnt vmcnt(0)
s_endpgm
mega_kernel_m1:
s_cmp_ge_u32 s16, 16
s_cbranch_scc1 mega_kernel_val1
v_lshlrev_b32 v90, 4, v0
s_mul_i32 s21, s16, 401408
s_mul_i32 s22, s17, 100352
s_add_u32 s21, s21, s22
s_add_u32 s21, s21, 0
v_and_b32 v2, 8, v0
v_mov_b32 v1, 0x44444444
v_mov_b32 v3, 0xeeeeeeee
v_cmp_ne_u32 vcc, 0, v2
v_mov_b32 v104, -1
v_mov_b32 v105, -1
v_cndmask_b32 v1, v1, v3, vcc
s_lshl_b32 s22, s17, 10
v_add_u32 v91, s22, v90
v_mov_b32 v102, v91
v_lshrrev_b32 v2, 4, v0
v_and_b32 v3, 15, v0
v_lshlrev_b32 v2, 2, v2
v_sub_u32 v3, v3, v2
v_mov_b32 v4, 0x3f80
v_mov_b32 v5, 0x3f800000
v_mov_b32 v112, 0
v_mov_b32 v113, 0
v_cmp_eq_u32 vcc, 0, v3
s_nop 1
v_cndmask_b32 v112, v112, v4, vcc
v_cmp_eq_u32 vcc, 1, v3
s_nop 1
v_cndmask_b32 v112, v112, v5, vcc
v_cmp_eq_u32 vcc, 2, v3
s_nop 1
v_cndmask_b32 v113, v113, v4, vcc
v_cmp_eq_u32 vcc, 3, v3
s_nop 1
v_cndmask_b32 v113, v113, v5, vcc
s_movk_i32 s23, 4096
s_cmp_eq_u32 s17, 3
s_cselect_b32 s23, 0x10000000, s23
v_add_u32 v103, s23, v102
v_mov_b32 v106, v103
s_cmp_eq_u32 s17, 3
s_cselect_b32 s23, 0, 4096
s_cselect_b32 s24, 0, s17
s_lshl_b32 s24, s24, 10
s_add_u32 s23, s23, s24
v_add_u32 v106, s23, v90
v_lshrrev_b32 v2, 4, v0
v_and_b32 v3, 7, v0
v_lshlrev_b32 v3, 4, v3
s_mul_i32 s22, s17, 1792
v_lshlrev_b32 v4, 7, v2
v_add3_u32 v92, v4, v3, s22
v_lshrrev_b32 v4, 1, v2
v_lshlrev_b32 v4, 7, v4
v_and_b32 v5, 1, v2
v_lshlrev_b32 v5, 3, v5
s_add_u32 s22, s22, 1536
v_add3_u32 v93, v4, v3, s22
v_add_u32 v93, v93, v5
s_mul_i32 s22, s17, 7168
s_add_u32 s22, s22, 8192
v_add_u32 v94, s22, v90
v_lshlrev_b32 v4, 3, v0
s_add_u32 s22, s22, 6144
v_add_u32 v95, s22, v4
s_mul_i32 s22, s17, 3584
s_add_u32 s22, s22, 36864
v_and_b32 v3, 15, v0
v_lshrrev_b32 v4, 2, v3
v_xor_b32 v4, v4, v2
v_lshlrev_b32 v4, 3, v4
v_lshlrev_b32 v5, 5, v3
v_add3_u32 v96, v4, v5, s22
v_and_b32 v4, 3, v0
v_xor_b32 v4, v4, v2
v_lshlrev_b32 v4, 3, v4
v_lshrrev_b32 v5, 2, v0
v_lshlrev_b32 v5, 5, v5
v_add3_u32 v97, v4, v5, s22
s_lshl_b32 s22, s17, 11
s_add_u32 s22, s22, 51200
v_and_b32 v4, 7, v0
v_lshrrev_b32 v5, 3, v3
v_lshlrev_b32 v6, 2, v5
v_add_u32 v6, v6, v2
v_lshrrev_b32 v7, 1, v6
v_add_u32 v7, v7, v4
v_and_b32 v7, 7, v7
v_lshlrev_b32 v7, 4, v7
v_lshlrev_b32 v6, 7, v6
v_add3_u32 v98, v6, v7, s22
v_add_u32 v6, 8, v2
v_lshrrev_b32 v7, 1, v6
v_add_u32 v7, v7, v4
v_and_b32 v7, 7, v7
v_lshlrev_b32 v7, 4, v7
v_lshlrev_b32 v6, 7, v6
v_add3_u32 v99, v6, v7, s22
v_lshrrev_b32 v6, 1, v2
v_or_b32 v6, v6, v5
v_add_u32 v7, 59392, v90
v_cmp_ne_u32 vcc, 0, v6
s_nop 1
v_cndmask_b32 v99, v99, v7, vcc
s_lshl_b32 s22, s17, 2
v_add_u32 v4, s22, v2
v_and_b32 v4, 7, v4
v_lshrrev_b32 v5, 1, v3
v_add_u32 v5, v5, v4
v_and_b32 v5, 7, v5
v_lshlrev_b32 v5, 4, v5
v_lshlrev_b32 v6, 7, v3
v_add_u32 v6, 51200, v6
v_add_u32 v100, v6, v5
s_lshr_b32 s22, s16, 2
s_lshl_b32 s23, s22, 11
s_and_b32 s24, s16, 3
s_lshl_b32 s24, s24, 8
s_add_u32 s23, s23, s24
v_lshrrev_b32 v5, 2, v3
v_lshlrev_b32 v5, 10, v5
v_lshrrev_b32 v6, 1, v3
v_and_b32 v6, 1, v6
v_lshlrev_b32 v6, 7, v6
v_lshlrev_b32 v7, 4, v4
v_add3_u32 v5, v5, v6, v7
v_and_b32 v6, 1, v3
v_lshlrev_b32 v8, 3, v6
v_add3_u32 v5, v5, v8, s23
s_lshl_b32 s23, s22, 9
s_and_b32 s24, s16, 1
s_lshl_b32 s24, s24, 8
s_add_u32 s23, s23, s24
s_lshr_b32 s24, s16, 1
s_and_b32 s24, s24, 1
s_lshl_b32 s24, s24, 3
s_add_u32 s23, s23, s24
s_add_u32 s23, s23, 8192
v_lshlrev_b32 v8, 7, v6
v_add3_u32 v8, v8, v7, s23
v_cmp_gt_u32 vcc, 8, v3
s_nop 1
v_cndmask_b32 v5, v8, v5, vcc
v_mov_b32 v8, 0x10000000
v_cmp_gt_u32 vcc, 10, v3
s_nop 1
v_cndmask_b32 v101, v8, v5, vcc
s_lshl_b32 s22, s17, 11
s_add_u32 s22, s22, 51200
v_lshlrev_b32 v2, 5, v0
v_add_u32 v2, s22, v2
v_mov_b32 v4, 0xf149f2ca
v_mov_b32 v5, v4
v_mov_b32 v6, v4
v_mov_b32 v7, v4
ds_write_b128 v2, v[4:7]
ds_write_b128 v2, v[4:7] offset:16
s_mul_i32 s22, s17, 1
v_lshrrev_b32 v2, 3, v0
v_lshlrev_b32 v3, 2, v2
v_add_u32 v3, s22, v3
s_lshr_b32 s22, s17, 1
s_add_u32 s22, s22, 12
v_mov_b32 v4, s22
v_cmp_eq_u32 vcc, 3, v2
s_mul_i32 s23, s16, 448
s_add_u32 s23, s23, 118222848
v_cndmask_b32 v3, v3, v4, vcc
v_lshlrev_b32 v3, 5, v3
v_and_b32 v4, 7, v0
v_lshlrev_b32 v4, 2, v4
v_add3_u32 v3, v3, v4, s23
v_mov_b32 v4, 0x10000000
v_cmp_gt_u32 vcc, 32, v0
s_mov_b32 s47, 0
s_nop 0
v_cndmask_b32 v3, v4, v3, vcc
s_mul_i32 s48, s16, 401408
s_mul_i32 s22, s17, 100352
s_add_u32 s48, s48, s22
s_add_u32 s48, s48, 0
s_mov_b32 s22, s17
s_lshl_b32 s40, s22, 11
s_add_u32 s22, s22, 4
s_sub_u32 s23, s22, 7
s_cselect_b32 s22, s22, s23
s_lshl_b32 s41, s22, 11
s_add_u32 s22, s22, 4
s_sub_u32 s23, s22, 7
s_cselect_b32 s22, s22, s23
s_lshl_b32 s42, s22, 11
s_add_u32 s22, s22, 4
s_sub_u32 s23, s22, 7
s_cselect_b32 s22, s22, s23
s_lshl_b32 s43, s22, 11
s_add_u32 s22, s22, 4
s_sub_u32 s23, s22, 7
s_cselect_b32 s22, s22, s23
s_lshl_b32 s44, s22, 11
s_add_u32 s22, s22, 4
s_sub_u32 s23, s22, 7
s_cselect_b32 s22, s22, s23
s_lshl_b32 s45, s22, 11
s_add_u32 s22, s22, 4
s_sub_u32 s23, s22, 7
s_cselect_b32 s22, s22, s23
s_lshl_b32 s46, s22, 11
s_movk_i32 s28, 8000
.Lsw_130:
s_and_b32 s22, s47, 0xff
s_cmp_eq_u32 s22, 0xff
s_cbranch_scc1 .Lsw_131
buffer_load_dword v2, v3, s[8:11], 0 offen sc1
s_waitcnt vmcnt(0)
v_cmp_eq_u32 vcc, 1, v2
s_sleep 1
s_mov_b32 s47, vcc_lo
s_sub_u32 s28, s28, 1
s_cbranch_scc0 .Lsw_130
.Lsw_131:
s_add_u32 s22, s48, s40
buffer_load_dwordx4 a[0:3], v90, s[8:11], s22 offen nt
buffer_load_dwordx4 a[4:7], v90, s[8:11], s22 offen offset:1024 nt
s_add_u32 s22, s48, s41
buffer_load_dwordx4 a[8:11], v90, s[8:11], s22 offen nt
buffer_load_dwordx4 a[12:15], v90, s[8:11], s22 offen offset:1024 nt
s_add_u32 s22, s48, s42
buffer_load_dwordx4 a[16:19], v90, s[8:11], s22 offen nt
buffer_load_dwordx4 a[20:23], v90, s[8:11], s22 offen offset:1024 nt
s_add_u32 s22, s48, s43
buffer_load_dwordx4 a[24:27], v90, s[8:11], s22 offen nt
buffer_load_dwordx4 a[28:31], v90, s[8:11], s22 offen offset:1024 nt
s_add_u32 s22, s48, s44
buffer_load_dwordx4 a[32:35], v90, s[8:11], s22 offen nt
buffer_load_dwordx4 a[36:39], v90, s[8:11], s22 offen offset:1024 nt
s_add_u32 s22, s48, s45
buffer_load_dwordx4 a[40:43], v90, s[8:11], s22 offen nt
buffer_load_dwordx4 a[44:47], v90, s[8:11], s22 offen offset:1024 nt
s_add_u32 s22, s48, s46
buffer_load_dwordx4 a[48:51], v90, s[8:11], s22 offen nt
buffer_load_dwordx4 a[52:55], v90, s[8:11], s22 offen offset:1024 nt
s_add_u32 s48, s48, 14336
s_add_u32 s22, s48, s40
buffer_load_dwordx4 a[56:59], v90, s[8:11], s22 offen nt
buffer_load_dwordx4 a[60:63], v90, s[8:11], s22 offen offset:1024 nt
s_add_u32 s22, s48, s41
buffer_load_dwordx4 a[64:67], v90, s[8:11], s22 offen nt
buffer_load_dwordx4 a[68:71], v90, s[8:11], s22 offen offset:1024 nt
s_add_u32 s22, s48, s42
buffer_load_dwordx4 a[72:75], v90, s[8:11], s22 offen nt
buffer_load_dwordx4 a[76:79], v90, s[8:11], s22 offen offset:1024 nt
s_add_u32 s22, s48, s43
buffer_load_dwordx4 a[80:83], v90, s[8:11], s22 offen nt
buffer_load_dwordx4 a[84:87], v90, s[8:11], s22 offen offset:1024 nt
s_add_u32 s22, s48, s44
buffer_load_dwordx4 a[88:91], v90, s[8:11], s22 offen nt
buffer_load_dwordx4 a[92:95], v90, s[8:11], s22 offen offset:1024 nt
s_add_u32 s22, s48, s45
buffer_load_dwordx4 a[96:99], v90, s[8:11], s22 offen nt
buffer_load_dwordx4 a[100:103], v90, s[8:11], s22 offen offset:1024 nt
s_add_u32 s22, s48, s46
buffer_load_dwordx4 a[104:107], v90, s[8:11], s22 offen nt
buffer_load_dwordx4 a[108:111], v90, s[8:11], s22 offen offset:1024 nt
s_add_u32 s48, s48, 14336
s_movk_i32 s28, 8000
.Lsw_132:
s_and_b32 s22, s47, 0xff00
s_cmp_eq_u32 s22, 0xff00
s_cbranch_scc1 .Lsw_133
buffer_load_dword v2, v3, s[8:11], 0 offen sc1
s_waitcnt vmcnt(0)
v_cmp_eq_u32 vcc, 1, v2
s_sleep 1
s_mov_b32 s47, vcc_lo
s_sub_u32 s28, s28, 1
s_cbranch_scc0 .Lsw_132
.Lsw_133:
s_add_u32 s22, s48, s40
buffer_load_dwordx4 a[112:115], v90, s[8:11], s22 offen nt
buffer_load_dwordx4 a[116:119], v90, s[8:11], s22 offen offset:1024 nt
s_add_u32 s22, s48, s41
buffer_load_dwordx4 a[120:123], v90, s[8:11], s22 offen nt
buffer_load_dwordx4 a[124:127], v90, s[8:11], s22 offen offset:1024 nt
s_add_u32 s22, s48, s42
buffer_load_dwordx4 a[128:131], v90, s[8:11], s22 offen nt
buffer_load_dwordx4 a[132:135], v90, s[8:11], s22 offen offset:1024 nt
s_add_u32 s22, s48, s43
buffer_load_dwordx4 a[136:139], v90, s[8:11], s22 offen nt
buffer_load_dwordx4 a[140:143], v90, s[8:11], s22 offen offset:1024 nt
s_add_u32 s22, s48, s44
buffer_load_dwordx4 a[144:147], v90, s[8:11], s22 offen nt
buffer_load_dwordx4 a[148:151], v90, s[8:11], s22 offen offset:1024 nt
s_add_u32 s22, s48, s45
buffer_load_dwordx4 a[152:155], v90, s[8:11], s22 offen nt
buffer_load_dwordx4 a[156:159], v90, s[8:11], s22 offen offset:1024 nt
s_add_u32 s22, s48, s46
buffer_load_dwordx4 a[160:163], v90, s[8:11], s22 offen nt
buffer_load_dwordx4 a[164:167], v90, s[8:11], s22 offen offset:1024 nt
s_add_u32 s48, s48, 14336
s_add_u32 s22, s48, s40
buffer_load_dwordx4 a[168:171], v90, s[8:11], s22 offen nt
buffer_load_dwordx4 a[172:175], v90, s[8:11], s22 offen offset:1024 nt
s_add_u32 s22, s48, s41
buffer_load_dwordx4 a[176:179], v90, s[8:11], s22 offen nt
buffer_load_dwordx4 a[180:183], v90, s[8:11], s22 offen offset:1024 nt
s_add_u32 s22, s48, s42
buffer_load_dwordx4 a[184:187], v90, s[8:11], s22 offen nt
buffer_load_dwordx4 a[188:191], v90, s[8:11], s22 offen offset:1024 nt
s_add_u32 s22, s48, s43
buffer_load_dwordx4 a[192:195], v90, s[8:11], s22 offen nt
buffer_load_dwordx4 a[196:199], v90, s[8:11], s22 offen offset:1024 nt
s_add_u32 s22, s48, s44
buffer_load_dwordx4 a[200:203], v90, s[8:11], s22 offen nt
buffer_load_dwordx4 a[204:207], v90, s[8:11], s22 offen offset:1024 nt
s_add_u32 s22, s48, s45
buffer_load_dwordx4 a[208:211], v90, s[8:11], s22 offen nt
buffer_load_dwordx4 a[212:215], v90, s[8:11], s22 offen offset:1024 nt
s_add_u32 s22, s48, s46
buffer_load_dwordx4 a[216:219], v90, s[8:11], s22 offen nt
buffer_load_dwordx4 a[220:223], v90, s[8:11], s22 offen offset:1024 nt
s_add_u32 s48, s48, 14336
s_movk_i32 s28, 8000
.Lsw_134:
s_and_b32 s22, s47, 0xff0000
s_cmp_eq_u32 s22, 0xff0000
s_cbranch_scc1 .Lsw_135
buffer_load_dword v2, v3, s[8:11], 0 offen sc1
s_waitcnt vmcnt(0)
v_cmp_eq_u32 vcc, 1, v2
s_sleep 1
s_mov_b32 s47, vcc_lo
s_sub_u32 s28, s28, 1
s_cbranch_scc0 .Lsw_134
.Lsw_135:
s_add_u32 s22, s48, s40
buffer_load_dwordx4 a[224:227], v90, s[8:11], s22 offen nt
buffer_load_dwordx4 a[228:231], v90, s[8:11], s22 offen offset:1024 nt
s_add_u32 s22, s48, s41
buffer_load_dwordx4 a[232:235], v90, s[8:11], s22 offen nt
buffer_load_dwordx4 a[236:239], v90, s[8:11], s22 offen offset:1024 nt
s_add_u32 s22, s48, s42
buffer_load_dwordx4 a[240:243], v90, s[8:11], s22 offen nt
buffer_load_dwordx4 a[244:247], v90, s[8:11], s22 offen offset:1024 nt
s_add_u32 s22, s48, s43
buffer_load_dwordx4 a[248:251], v90, s[8:11], s22 offen nt
buffer_load_dwordx4 a[252:255], v90, s[8:11], s22 offen offset:1024 nt
s_add_u32 s22, s48, s44
buffer_load_dwordx4 v[120:123], v90, s[8:11], s22 offen nt
buffer_load_dwordx4 v[124:127], v90, s[8:11], s22 offen offset:1024 nt
s_add_u32 s22, s48, s45
buffer_load_dwordx4 v[128:131], v90, s[8:11], s22 offen nt
buffer_load_dwordx4 v[132:135], v90, s[8:11], s22 offen offset:1024 nt
s_add_u32 s22, s48, s46
buffer_load_dwordx4 v[136:139], v90, s[8:11], s22 offen nt
buffer_load_dwordx4 v[140:143], v90, s[8:11], s22 offen offset:1024 nt
s_add_u32 s48, s48, 14336
s_add_u32 s22, s48, s40
buffer_load_dwordx4 v[144:147], v90, s[8:11], s22 offen nt
buffer_load_dwordx4 v[148:151], v90, s[8:11], s22 offen offset:1024 nt
s_add_u32 s22, s48, s41
buffer_load_dwordx4 v[152:155], v90, s[8:11], s22 offen nt
buffer_load_dwordx4 v[156:159], v90, s[8:11], s22 offen offset:1024 nt
s_add_u32 s22, s48, s42
buffer_load_dwordx4 v[160:163], v90, s[8:11], s22 offen nt
buffer_load_dwordx4 v[164:167], v90, s[8:11], s22 offen offset:1024 nt
s_add_u32 s22, s48, s43
buffer_load_dwordx4 v[168:171], v90, s[8:11], s22 offen nt
buffer_load_dwordx4 v[172:175], v90, s[8:11], s22 offen offset:1024 nt
s_add_u32 s22, s48, s44
buffer_load_dwordx4 v[176:179], v90, s[8:11], s22 offen nt
buffer_load_dwordx4 v[180:183], v90, s[8:11], s22 offen offset:1024 nt
s_add_u32 s22, s48, s45
buffer_load_dwordx4 v[184:187], v90, s[8:11], s22 offen nt
buffer_load_dwordx4 v[188:191], v90, s[8:11], s22 offen offset:1024 nt
s_add_u32 s22, s48, s46
buffer_load_dwordx4 v[192:195], v90, s[8:11], s22 offen nt
buffer_load_dwordx4 v[196:199], v90, s[8:11], s22 offen offset:1024 nt
s_add_u32 s48, s48, 14336
s_sub_u32 s22, s17, 2
s_mul_i32 s22, s22, 14336
s_add_u32 s33, s22, 14680064
s_add_u32 s26, s22, 8192
s_cmp_lt_u32 s17, 2
s_cbranch_scc1 .Lxk_129
s_mov_b32 s19, 20000
s_mov_b32 s50, 68183040
v_lshlrev_b32 v4, 4, v0
v_mov_b32 v8, 0x10000000
v_cmp_gt_u32 vcc, 32, v0
s_mov_b32 s51, s19
s_nop 0
v_cndmask_b32 v4, v8, v4, vcc
.Lwr_137:
buffer_load_dwordx4 v[8:11], v4, s[8:11], s50 offen sc1
s_waitcnt vmcnt(0)
s_mov_b32 s52, 0
v_cmp_eq_u32 vcc, 1, v8
s_nop 1
s_and_b32 vcc_lo, vcc_lo, 0xffffffff
s_and_b32 vcc_hi, vcc_hi, 0x0
s_bcnt1_i32_b64 s53, vcc
s_add_u32 s52, s52, s53
v_cmp_eq_u32 vcc, 1, v9
s_nop 1
s_and_b32 vcc_lo, vcc_lo, 0xffffffff
s_and_b32 vcc_hi, vcc_hi, 0x0
s_bcnt1_i32_b64 s53, vcc
s_add_u32 s52, s52, s53
v_cmp_eq_u32 vcc, 1, v10
s_nop 1
s_and_b32 vcc_lo, vcc_lo, 0xffffffff
s_and_b32 vcc_hi, vcc_hi, 0x0
s_bcnt1_i32_b64 s53, vcc
s_add_u32 s52, s52, s53
v_cmp_eq_u32 vcc, 1, v11
s_nop 1
s_and_b32 vcc_lo, vcc_lo, 0xffffffff
s_and_b32 vcc_hi, vcc_hi, 0x0
s_bcnt1_i32_b64 s53, vcc
s_add_u32 s52, s52, s53
s_cmp_eq_u32 s52, 128
s_cbranch_scc1 .Lwo_138
s_sleep 2
s_sub_u32 s51, s51, 1
s_cbranch_scc0 .Lwr_137
s_mov_b32 s19, 0
.Lwo_138:
s_mov_b32 m0, s26
s_add_u32 s27, s33, 0
buffer_load_dwordx4 v90, s[8:11], s27 offen lds
s_add_u32 m0, s26, 1024
s_add_u32 s27, s33, 1024
buffer_load_dwordx4 v90, s[8:11], s27 offen lds
s_add_u32 m0, s26, 2048
s_add_u32 s27, s33, 2048
buffer_load_dwordx4 v90, s[8:11], s27 offen lds
s_add_u32 m0, s26, 3072
s_add_u32 s27, s33, 3072
buffer_load_dwordx4 v90, s[8:11], s27 offen lds
s_add_u32 m0, s26, 4096
s_add_u32 s27, s33, 4096
buffer_load_dwordx4 v90, s[8:11], s27 offen lds
s_add_u32 m0, s26, 5120
s_add_u32 s27, s33, 5120
buffer_load_dwordx4 v90, s[8:11], s27 offen lds
s_add_u32 m0, s26, 6144
s_add_u32 s27, s33, 6144
buffer_load_dwordx4 v90, s[8:11], s27 offen lds
s_add_u32 m0, s26, 7168
s_add_u32 s27, s33, 7168
buffer_load_dwordx4 v90, s[8:11], s27 offen lds
s_add_u32 m0, s26, 8192
s_add_u32 s27, s33, 8192
buffer_load_dwordx4 v90, s[8:11], s27 offen lds
s_add_u32 m0, s26, 9216
s_add_u32 s27, s33, 9216
buffer_load_dwordx4 v90, s[8:11], s27 offen lds
s_add_u32 m0, s26, 10240
s_add_u32 s27, s33, 10240
buffer_load_dwordx4 v90, s[8:11], s27 offen lds
s_add_u32 m0, s26, 11264
s_add_u32 s27, s33, 11264
buffer_load_dwordx4 v90, s[8:11], s27 offen lds
s_add_u32 m0, s26, 12288
s_add_u32 s27, s33, 12288
buffer_load_dwordx4 v90, s[8:11], s27 offen lds
s_add_u32 m0, s26, 13312
s_add_u32 s27, s33, 13312
buffer_load_dwordx4 v90, s[8:11], s27 offen lds
.Lxk_129:
s_movk_i32 s28, 8000
.Lsw_139:
s_and_b32 s22, s47, 0xff000000
s_cmp_eq_u32 s22, 0xff000000
s_cbranch_scc1 .Lsw_140
buffer_load_dword v2, v3, s[8:11], 0 offen sc1
s_waitcnt vmcnt(0)
v_cmp_eq_u32 vcc, 1, v2
s_sleep 1
s_mov_b32 s47, vcc_lo
s_sub_u32 s28, s28, 1
s_cbranch_scc0 .Lsw_139
.Lsw_140:
s_add_u32 s22, s48, s40
buffer_load_dwordx4 v[200:203], v90, s[8:11], s22 offen nt
buffer_load_dwordx4 v[204:207], v90, s[8:11], s22 offen offset:1024 nt
s_add_u32 s22, s48, s41
buffer_load_dwordx4 v[208:211], v90, s[8:11], s22 offen nt
buffer_load_dwordx4 v[212:215], v90, s[8:11], s22 offen offset:1024 nt
s_add_u32 s22, s48, s42
buffer_load_dwordx4 v[216:219], v90, s[8:11], s22 offen nt
buffer_load_dwordx4 v[220:223], v90, s[8:11], s22 offen offset:1024 nt
s_add_u32 s22, s48, s43
buffer_load_dwordx4 v[224:227], v90, s[8:11], s22 offen nt
buffer_load_dwordx4 v[228:231], v90, s[8:11], s22 offen offset:1024 nt
s_add_u32 s22, s48, s44
buffer_load_dwordx4 v[232:235], v90, s[8:11], s22 offen nt
buffer_load_dwordx4 v[236:239], v90, s[8:11], s22 offen offset:1024 nt
s_add_u32 s22, s48, s45
buffer_load_dwordx4 v[240:243], v90, s[8:11], s22 offen nt
buffer_load_dwordx4 v[244:247], v90, s[8:11], s22 offen offset:1024 nt
s_add_u32 s22, s48, s46
buffer_load_dwordx4 v[248:251], v90, s[8:11], s22 offen nt
buffer_load_dwordx4 v[252:255], v90, s[8:11], s22 offen offset:1024 nt
s_add_u32 s48, s48, 14336
s_mov_b32 s18, 0
s_mov_b32 s19, 20000
s_mov_b32 s29, 45944832
s_mov_b32 s34, 68157440
v_min_u32 v107, 55, v0
v_lshlrev_b32 v107, 2, v107
s_lshl_b32 s22, s16, 1
s_add_u32 s22, s22, s17
s_lshl_b32 s22, s22, 2
s_add_u32 s22, s22, 256
v_mov_b32 v2, s22
v_mov_b32 v3, 0x10000000
v_cmp_eq_u32 vcc, 0, v0
v_mov_b32 v109, 1
s_nop 0
v_cndmask_b32 v108, v3, v2, vcc
s_mov_b32 s22, s17
s_lshl_b32 s40, s22, 10
s_add_u32 s22, s22, 4
s_sub_u32 s23, s22, 7
s_cselect_b32 s22, s22, s23
s_lshl_b32 s41, s22, 10
s_add_u32 s22, s22, 4
s_sub_u32 s23, s22, 7
s_cselect_b32 s22, s22, s23
s_lshl_b32 s42, s22, 10
s_add_u32 s22, s22, 4
s_sub_u32 s23, s22, 7
s_cselect_b32 s22, s22, s23
s_lshl_b32 s43, s22, 10
s_add_u32 s22, s22, 4
s_sub_u32 s23, s22, 7
s_cselect_b32 s22, s22, s23
s_lshl_b32 s44, s22, 10
s_add_u32 s22, s22, 4
s_sub_u32 s23, s22, 7
s_cselect_b32 s22, s22, s23
s_lshl_b32 s45, s22, 10
s_add_u32 s22, s22, 4
s_sub_u32 s23, s22, 7
s_cselect_b32 s22, s22, s23
s_lshl_b32 s46, s22, 10
v_add_u32 v107, s42, v90
v_add_u32 v108, s43, v90
v_add_u32 v109, s44, v90
v_add_u32 v118, s45, v90
v_add_u32 v119, s46, v90
.p2align 6
.Lsloop_141:
v_mov_b64 v[32:33], 0
v_mov_b64 v[34:35], 0
v_mov_b64 v[36:37], 0
v_mov_b64 v[38:39], 0
v_mov_b64 v[40:41], 0
v_mov_b64 v[42:43], 0
v_mov_b64 v[86:87], 0
v_mov_b64 v[88:89], 0
v_mov_b64 v[4:5], 0
v_mov_b64 v[6:7], 0
v_mov_b64 v[8:9], 0
v_mov_b64 v[10:11], 0
v_mov_b64 v[114:115], 0
v_mov_b64 v[116:117], 0
s_mov_b32 s28, s19
s_waitcnt vmcnt(0)
buffer_load_dwordx4 v[62:65], v102, s[8:11], s29 offen sc1
buffer_load_dwordx4 v[66:69], v106, s[8:11], s29 offen sc1
s_sleep 3
buffer_load_dwordx4 v[70:73], v102, s[8:11], s29 offen sc1
buffer_load_dwordx4 v[74:77], v106, s[8:11], s29 offen sc1
.Lspoll_142:
s_waitcnt vmcnt(3)
ds_write_b128 v91, v[62:65]
v_max3_u32 v2, v62, v63, v64
v_max_u32 v2, v2, v65
s_waitcnt vmcnt(2)
ds_write_b128 v91, v[66:69] offset:4096
v_max3_u32 v2, v2, v66, v67
v_max3_u32 v2, v2, v68, v69
v_cmp_eq_u32 vcc, -1, v2
s_cbranch_vccnz .Lsfail_147
.Lspok_144:
v_smfmac_f32_16x16x64_bf16 v[32:35], v[62:65], a[0:7], v1
v_smfmac_f32_16x16x64_bf16 v[36:39], v[62:65], a[56:63], v1
v_smfmac_f32_16x16x64_bf16 v[40:43], v[62:65], a[112:119], v1
v_smfmac_f32_16x16x64_bf16 v[86:89], v[62:65], a[168:175], v1
s_waitcnt lgkmcnt(0)
s_barrier
ds_read_b128 v[12:15], v107
ds_read_b128 v[16:19], v108
ds_read_b128 v[20:23], v109
ds_read_b128 v[24:27], v118
ds_read_b128 v[28:31], v119
v_smfmac_f32_16x16x64_bf16 v[4:7], v[62:65], a[224:231], v1
v_smfmac_f32_16x16x64_bf16 v[8:11], v[62:65], v[144:151], v1
v_smfmac_f32_16x16x64_bf16 v[114:117], v[62:65], v[200:207], v1
v_smfmac_f32_16x16x64_bf16 v[32:35], v[66:69], a[8:15], v1
v_smfmac_f32_16x16x64_bf16 v[36:39], v[66:69], a[64:71], v1
v_smfmac_f32_16x16x64_bf16 v[40:43], v[66:69], a[120:127], v1
v_smfmac_f32_16x16x64_bf16 v[86:89], v[66:69], a[176:183], v1
v_smfmac_f32_16x16x64_bf16 v[4:7], v[66:69], a[232:239], v1
v_smfmac_f32_16x16x64_bf16 v[8:11], v[66:69], v[152:159], v1
v_smfmac_f32_16x16x64_bf16 v[114:117], v[66:69], v[208:215], v1
s_branch .Lkc_146
.Lsfail_147:
buffer_load_dwordx4 v[62:65], v102, s[8:11], s29 offen sc1
buffer_load_dwordx4 v[66:69], v106, s[8:11], s29 offen sc1
.Lschk_149:
s_waitcnt vmcnt(3)
ds_write_b128 v91, v[70:73]
v_max3_u32 v2, v70, v71, v72
v_max_u32 v2, v2, v73
s_waitcnt vmcnt(2)
ds_write_b128 v91, v[74:77] offset:4096
v_max3_u32 v2, v2, v74, v75
v_max3_u32 v2, v2, v76, v77
v_cmp_eq_u32 vcc, -1, v2
s_cbranch_vccnz .Lsfail_148
.Lspok_145:
v_smfmac_f32_16x16x64_bf16 v[32:35], v[70:73], a[0:7], v1
v_smfmac_f32_16x16x64_bf16 v[36:39], v[70:73], a[56:63], v1
v_smfmac_f32_16x16x64_bf16 v[40:43], v[70:73], a[112:119], v1
v_smfmac_f32_16x16x64_bf16 v[86:89], v[70:73], a[168:175], v1
s_waitcnt lgkmcnt(0)
s_barrier
ds_read_b128 v[12:15], v107
ds_read_b128 v[16:19], v108
ds_read_b128 v[20:23], v109
ds_read_b128 v[24:27], v118
ds_read_b128 v[28:31], v119
v_smfmac_f32_16x16x64_bf16 v[4:7], v[70:73], a[224:231], v1
v_smfmac_f32_16x16x64_bf16 v[8:11], v[70:73], v[144:151], v1
v_smfmac_f32_16x16x64_bf16 v[114:117], v[70:73], v[200:207], v1
v_smfmac_f32_16x16x64_bf16 v[32:35], v[74:77], a[8:15], v1
v_smfmac_f32_16x16x64_bf16 v[36:39], v[74:77], a[64:71], v1
v_smfmac_f32_16x16x64_bf16 v[40:43], v[74:77], a[120:127], v1
v_smfmac_f32_16x16x64_bf16 v[86:89], v[74:77], a[176:183], v1
v_smfmac_f32_16x16x64_bf16 v[4:7], v[74:77], a[232:239], v1
v_smfmac_f32_16x16x64_bf16 v[8:11], v[74:77], v[152:159], v1
v_smfmac_f32_16x16x64_bf16 v[114:117], v[74:77], v[208:215], v1
.Lkc_146:
s_add_u32 s21, s18, 1
s_and_b32 s21, s21, 3
s_mul_i32 s21, s21, 7168
s_add_u32 s29, s21, 45875200
s_and_b32 s21, s18, 3
s_mul_i32 s21, s21, 10240
s_add_u32 s31, s21, 45903872
s_add_u32 s21, s18, 2
s_and_b32 s21, s21, 3
s_mul_i32 s21, s21, 10240
s_add_u32 s32, s21, 45903872
s_waitcnt lgkmcnt(4)
v_smfmac_f32_16x16x64_bf16 v[32:35], v[12:15], a[16:23], v1
ds_read_b128 v[78:81], v94 offset:1024
s_waitcnt lgkmcnt(4)
v_smfmac_f32_16x16x64_bf16 v[32:35], v[16:19], a[24:31], v1
ds_read_b128 v[82:85], v94 offset:4096
s_waitcnt lgkmcnt(4)
v_smfmac_f32_16x16x64_bf16 v[32:35], v[20:23], a[32:39], v1
s_waitcnt vmcnt(0)
ds_read_b128 v[62:65], v92 offset:0
s_waitcnt lgkmcnt(4)
v_smfmac_f32_16x16x64_bf16 v[32:35], v[24:27], a[40:47], v1
ds_read_b128 v[66:69], v94 offset:0
s_waitcnt lgkmcnt(4)
v_smfmac_f32_16x16x64_bf16 v[32:35], v[28:31], a[48:55], v1
ds_read_b128 v[70:73], v94 offset:3072
v_smfmac_f32_16x16x64_bf16 v[36:39], v[12:15], a[72:79], v1
ds_read_b128 v[74:77], v92 offset:512
v_smfmac_f32_16x16x64_bf16 v[36:39], v[16:19], a[80:87], v1
v_cvt_pk_bf16_f32 v44, v32, v33
v_smfmac_f32_16x16x64_bf16 v[36:39], v[20:23], a[88:95], v1
v_cvt_pk_bf16_f32 v45, v34, v35
v_smfmac_f32_16x16x64_bf16 v[36:39], v[24:27], a[96:103], v1
ds_write_b32 v96, v44 offset:0
v_smfmac_f32_16x16x64_bf16 v[36:39], v[28:31], a[104:111], v1
ds_write_b32 v96, v45 offset:4
v_smfmac_f32_16x16x64_bf16 v[40:43], v[12:15], a[128:135], v1
ds_read_b64_tr_b16 v[48:49], v97 offset:0
v_smfmac_f32_16x16x64_bf16 v[40:43], v[16:19], a[136:143], v1
v_cvt_pk_bf16_f32 v46, v36, v37
v_smfmac_f32_16x16x64_bf16 v[40:43], v[20:23], a[144:151], v1
v_cvt_pk_bf16_f32 v47, v38, v39
v_smfmac_f32_16x16x64_bf16 v[40:43], v[24:27], a[152:159], v1
ds_write_b32 v96, v46 offset:512
v_smfmac_f32_16x16x64_bf16 v[40:43], v[28:31], a[160:167], v1
ds_write_b32 v96, v47 offset:516
v_smfmac_f32_16x16x64_bf16 v[86:89], v[12:15], a[184:191], v1
ds_read_b64_tr_b16 v[50:51], v97 offset:512
v_smfmac_f32_16x16x64_bf16 v[86:89], v[16:19], a[192:199], v1
v_cvt_pk_bf16_f32 v44, v40, v41
v_smfmac_f32_16x16x64_bf16 v[86:89], v[20:23], a[200:207], v1
v_cvt_pk_bf16_f32 v45, v42, v43
v_smfmac_f32_16x16x64_bf16 v[86:89], v[24:27], a[208:215], v1
ds_write_b32 v96, v44 offset:1024
v_smfmac_f32_16x16x64_bf16 v[86:89], v[28:31], a[216:223], v1
ds_write_b32 v96, v45 offset:1028
v_smfmac_f32_16x16x64_bf16 v[4:7], v[12:15], a[240:247], v1
ds_read_b64_tr_b16 v[52:53], v97 offset:1024
v_smfmac_f32_16x16x64_bf16 v[4:7], v[16:19], a[248:255], v1
v_cvt_pk_bf16_f32 v46, v86, v87
v_smfmac_f32_16x16x64_bf16 v[4:7], v[20:23], v[120:127], v1
v_cvt_pk_bf16_f32 v47, v88, v89
v_smfmac_f32_16x16x64_bf16 v[4:7], v[24:27], v[128:135], v1
ds_write_b32 v96, v46 offset:1536
v_smfmac_f32_16x16x64_bf16 v[4:7], v[28:31], v[136:143], v1
ds_write_b32 v96, v47 offset:1540
v_smfmac_f32_16x16x64_bf16 v[8:11], v[12:15], v[160:167], v1
ds_read_b64_tr_b16 v[54:55], v97 offset:1536
v_smfmac_f32_16x16x64_bf16 v[8:11], v[16:19], v[168:175], v1
v_cvt_pk_bf16_f32 v44, v4, v5
v_smfmac_f32_16x16x64_bf16 v[8:11], v[20:23], v[176:183], v1
v_cvt_pk_bf16_f32 v45, v6, v7
v_smfmac_f32_16x16x64_bf16 v[8:11], v[24:27], v[184:191], v1
ds_write_b32 v96, v44 offset:2048
v_smfmac_f32_16x16x64_bf16 v[8:11], v[28:31], v[192:199], v1
ds_write_b32 v96, v45 offset:2052
v_smfmac_f32_16x16x64_bf16 v[114:117], v[12:15], v[216:223], v1
ds_read_b64_tr_b16 v[56:57], v97 offset:2048
v_smfmac_f32_16x16x64_bf16 v[114:117], v[16:19], v[224:231], v1
v_cvt_pk_bf16_f32 v46, v8, v9
v_smfmac_f32_16x16x64_bf16 v[114:117], v[20:23], v[232:239], v1
v_cvt_pk_bf16_f32 v47, v10, v11
v_smfmac_f32_16x16x64_bf16 v[114:117], v[24:27], v[240:247], v1
ds_write_b32 v96, v46 offset:2560
v_smfmac_f32_16x16x64_bf16 v[114:117], v[28:31], v[248:255], v1
ds_write_b32 v96, v47 offset:2564
s_waitcnt lgkmcnt(15)
s_waitcnt lgkmcnt(11)
v_mfma_f32_16x16x32_bf16 v[32:35], v[62:65], v[48:51], 0
ds_read_b64_tr_b16 v[58:59], v97 offset:2560
ds_read_b128 v[12:15], v92 offset:1024
v_mfma_f32_16x16x32_bf16 v[36:39], v[66:69], v[48:51], 0
v_cvt_pk_bf16_f32 v44, v114, v115
v_cvt_pk_bf16_f32 v45, v116, v117
v_mfma_f32_16x16x32_bf16 v[40:43], v[70:73], v[48:51], 0
ds_read_b128 v[16:19], v94 offset:2048
v_mfma_f32_16x16x16_bf16 v[86:89], v[44:45], v[112:113], 0
ds_read_b128 v[20:23], v94 offset:5120
s_waitcnt lgkmcnt(9)
v_mfma_f32_16x16x32_bf16 v[32:35], v[74:77], v[52:55], v[32:35]
ds_read_b64 v[24:25], v93
v_mfma_f32_16x16x32_bf16 v[36:39], v[78:81], v[52:55], v[36:39]
ds_read_b64 v[26:27], v95 offset:0
v_mfma_f32_16x16x32_bf16 v[40:43], v[82:85], v[52:55], v[40:43]
v_cvt_pk_bf16_f32 v60, v86, v87
ds_read_b64 v[28:29], v95 offset:512
s_waitcnt lgkmcnt(5)
v_mfma_f32_16x16x32_bf16 v[32:35], v[12:15], v[56:59], v[32:35]
v_cvt_pk_bf16_f32 v61, v88, v89
s_waitcnt lgkmcnt(4)
v_mfma_f32_16x16x32_bf16 v[36:39], v[16:19], v[56:59], v[36:39]
s_waitcnt lgkmcnt(3)
v_mfma_f32_16x16x32_bf16 v[40:43], v[20:23], v[56:59], v[40:43]
s_waitcnt lgkmcnt(2)
v_mfma_f32_16x16x16_bf16 v[32:35], v[24:25], v[60:61], v[32:35]
s_waitcnt lgkmcnt(1)
v_mfma_f32_16x16x16_bf16 v[36:39], v[26:27], v[60:61], v[36:39]
s_waitcnt lgkmcnt(0)
v_mfma_f32_16x16x16_bf16 v[40:43], v[28:29], v[60:61], v[40:43]
v_add_f32_dpp v4, v32, v32 row_ror:8 row_mask:0xf bank_mask:0xf
v_add_f32_dpp v5, v33, v33 row_ror:8 row_mask:0xf bank_mask:0xf
v_add_f32_dpp v6, v34, v34 row_ror:8 row_mask:0xf bank_mask:0xf
v_add_f32_dpp v7, v35, v35 row_ror:8 row_mask:0xf bank_mask:0xf
ds_write_b128 v99, v[4:7]
v_add_f32_dpp v8, v36, v36 row_ror:8 row_mask:0xf bank_mask:0x3
v_add_f32_dpp v9, v37, v37 row_ror:8 row_mask:0xf bank_mask:0x3
v_add_f32_dpp v10, v38, v38 row_ror:8 row_mask:0xf bank_mask:0x3
v_add_f32_dpp v11, v39, v39 row_ror:8 row_mask:0xf bank_mask:0x3
v_add_f32_dpp v8, v40, v40 row_ror:8 row_mask:0xf bank_mask:0xc
v_add_f32_dpp v9, v41, v41 row_ror:8 row_mask:0xf bank_mask:0xc
v_add_f32_dpp v10, v42, v42 row_ror:8 row_mask:0xf bank_mask:0xc
v_add_f32_dpp v11, v43, v43 row_ror:8 row_mask:0xf bank_mask:0xc
ds_write_b128 v98, v[8:11]
s_cmp_ge_u32 s17, 2
s_cbranch_scc1 .Lxk_150
s_waitcnt lgkmcnt(0)
s_barrier
ds_read_b128 v[4:7], v100 offset:0
ds_read_b128 v[8:11], v100 offset:2048
ds_read_b128 v[12:15], v100 offset:4096
ds_read_b128 v[16:19], v100 offset:6144
s_waitcnt lgkmcnt(2)
v_pk_add_f32 v[4:5], v[4:5], v[8:9]
v_pk_add_f32 v[6:7], v[6:7], v[10:11]
s_waitcnt lgkmcnt(0)
v_pk_add_f32 v[12:13], v[12:13], v[16:17]
v_pk_add_f32 v[14:15], v[14:15], v[18:19]
v_pk_add_f32 v[4:5], v[4:5], v[12:13]
v_pk_add_f32 v[6:7], v[6:7], v[14:15]
v_max3_f32 v8, v4, v5, v6
v_max_f32 v8, v8, v7
s_nop 1
v_max_f32_dpp v9, v8, v8 row_ror:4 row_mask:0xf bank_mask:0xf
v_max_f32_dpp v9, v8, v9 row_ror:8 row_mask:0xf bank_mask:0xf
v_max_f32_dpp v9, v8, v9 row_ror:12 row_mask:0xf bank_mask:0xf
s_nop 1
v_max_f32_dpp v10, v9, v9 row_ror:1 row_mask:0xf bank_mask:0xf
v_max_f32_dpp v10, v9, v10 row_ror:2 row_mask:0xf bank_mask:0xf
v_max_f32_dpp v10, v9, v10 row_ror:3 row_mask:0xf bank_mask:0xf
v_pk_add_f32 v[4:5], v[4:5], v[10:11] op_sel_hi:[1,0] neg_lo:[0,1] neg_hi:[0,1]
v_pk_add_f32 v[6:7], v[6:7], v[10:11] op_sel_hi:[1,0] neg_lo:[0,1] neg_hi:[0,1]
v_exp_f32 v4, v4
v_exp_f32 v5, v5
v_exp_f32 v6, v6
v_exp_f32 v7, v7
v_add_f32 v8, v4, v5
v_add_f32 v9, v6, v7
v_add_f32 v8, v8, v9
s_nop 1
v_add_f32_dpp v9, v8, v8 row_ror:4 row_mask:0xf bank_mask:0xf
v_add_f32_dpp v9, v8, v9 row_ror:8 row_mask:0xf bank_mask:0xf
v_add_f32_dpp v9, v8, v9 row_ror:12 row_mask:0xf bank_mask:0xf
s_nop 1
v_add_f32_dpp v10, v9, v9 row_ror:1 row_mask:0xf bank_mask:0xf
v_add_f32_dpp v10, v9, v10 row_ror:2 row_mask:0xf bank_mask:0xf
v_add_f32_dpp v10, v9, v10 row_ror:3 row_mask:0xf bank_mask:0xf
v_rcp_f32 v10, v10
s_nop 0
v_pk_mul_f32 v[4:5], v[4:5], v[10:11] op_sel_hi:[1,0]
v_pk_mul_f32 v[6:7], v[6:7], v[10:11] op_sel_hi:[1,0]
v_cvt_pk_bf16_f32 v4, v4, v5
v_cvt_pk_bf16_f32 v5, v6, v7
buffer_store_dwordx2 v[4:5], v101, s[8:11], s31 offen sc1
buffer_store_dwordx2 v[104:105], v101, s[8:11], s32 offen sc1
s_barrier
s_branch .Lsnext_151
.Lxk_150:
s_waitcnt lgkmcnt(0)
s_barrier
s_barrier
s_add_u32 s33, s33, 28672
s_mov_b32 m0, s26
s_add_u32 s27, s33, 0
buffer_load_dwordx4 v90, s[8:11], s27 offen lds
s_add_u32 m0, s26, 1024
s_add_u32 s27, s33, 1024
buffer_load_dwordx4 v90, s[8:11], s27 offen lds
s_add_u32 m0, s26, 2048
s_add_u32 s27, s33, 2048
buffer_load_dwordx4 v90, s[8:11], s27 offen lds
s_add_u32 m0, s26, 3072
s_add_u32 s27, s33, 3072
buffer_load_dwordx4 v90, s[8:11], s27 offen lds
s_add_u32 m0, s26, 4096
s_add_u32 s27, s33, 4096
buffer_load_dwordx4 v90, s[8:11], s27 offen lds
s_add_u32 m0, s26, 5120
s_add_u32 s27, s33, 5120
buffer_load_dwordx4 v90, s[8:11], s27 offen lds
s_add_u32 m0, s26, 6144
s_add_u32 s27, s33, 6144
buffer_load_dwordx4 v90, s[8:11], s27 offen lds
s_add_u32 m0, s26, 7168
s_add_u32 s27, s33, 7168
buffer_load_dwordx4 v90, s[8:11], s27 offen lds
s_add_u32 m0, s26, 8192
s_add_u32 s27, s33, 8192
buffer_load_dwordx4 v90, s[8:11], s27 offen lds
s_add_u32 m0, s26, 9216
s_add_u32 s27, s33, 9216
buffer_load_dwordx4 v90, s[8:11], s27 offen lds
s_add_u32 m0, s26, 10240
s_add_u32 s27, s33, 10240
buffer_load_dwordx4 v90, s[8:11], s27 offen lds
s_add_u32 m0, s26, 11264
s_add_u32 s27, s33, 11264
buffer_load_dwordx4 v90, s[8:11], s27 offen lds
s_add_u32 m0, s26, 12288
s_add_u32 s27, s33, 12288
buffer_load_dwordx4 v90, s[8:11], s27 offen lds
s_add_u32 m0, s26, 13312
s_add_u32 s27, s33, 13312
buffer_load_dwordx4 v90, s[8:11], s27 offen lds
.Lsnext_151:
s_add_u32 s18, s18, 1
s_cmp_lt_u32 s18, 63
s_cbranch_scc1 .Lsloop_141
s_waitcnt vmcnt(0)
s_barrier
s_branch .Lsend_152
.Lsfail_148:
buffer_load_dwordx4 v[70:73], v102, s[8:11], s29 offen sc1
buffer_load_dwordx4 v[74:77], v106, s[8:11], s29 offen sc1
s_sub_u32 s28, s28, 1
s_cbranch_scc0 .Lspoll_142
s_mov_b32 s19, 0
s_branch .Lspok_144
.Lsend_152:
v_lshlrev_b32 v90, 4, v0
s_mul_i32 s21, s16, 401408
s_mul_i32 s22, s17, 100352
s_add_u32 s21, s21, s22
s_add_u32 s21, s21, 0
v_and_b32 v2, 8, v0
v_mov_b32 v1, 0x44444444
v_mov_b32 v3, 0xeeeeeeee
v_cmp_ne_u32 vcc, 0, v2
v_mov_b32 v104, -1
v_mov_b32 v105, -1
v_cndmask_b32 v1, v1, v3, vcc
s_lshl_b32 s22, s17, 10
v_add_u32 v91, s22, v90
v_mov_b32 v102, v91
v_lshrrev_b32 v2, 4, v0
v_and_b32 v3, 15, v0
v_lshlrev_b32 v2, 2, v2
v_sub_u32 v3, v3, v2
v_mov_b32 v4, 0x3f80
v_mov_b32 v5, 0x3f800000
v_mov_b32 v112, 0
v_mov_b32 v113, 0
v_cmp_eq_u32 vcc, 0, v3
s_nop 1
v_cndmask_b32 v112, v112, v4, vcc
v_cmp_eq_u32 vcc, 1, v3
s_nop 1
v_cndmask_b32 v112, v112, v5, vcc
v_cmp_eq_u32 vcc, 2, v3
s_nop 1
v_cndmask_b32 v113, v113, v4, vcc
v_cmp_eq_u32 vcc, 3, v3
s_nop 1
v_cndmask_b32 v113, v113, v5, vcc
s_movk_i32 s23, 4096
s_cmp_eq_u32 s17, 3
s_cselect_b32 s23, 0x10000000, s23
v_add_u32 v103, s23, v102
v_mov_b32 v106, v103
s_cmp_eq_u32 s17, 3
s_cselect_b32 s23, 0, 4096
s_cselect_b32 s24, 0, s17
s_lshl_b32 s24, s24, 10
s_add_u32 s23, s23, s24
v_add_u32 v106, s23, v90
v_lshrrev_b32 v2, 4, v0
v_and_b32 v3, 7, v0
v_lshlrev_b32 v3, 4, v3
s_mul_i32 s22, s17, 1792
v_lshlrev_b32 v4, 7, v2
v_add3_u32 v92, v4, v3, s22
v_lshrrev_b32 v4, 1, v2
v_lshlrev_b32 v4, 7, v4
v_and_b32 v5, 1, v2
v_lshlrev_b32 v5, 3, v5
s_add_u32 s22, s22, 1536
v_add3_u32 v93, v4, v3, s22
v_add_u32 v93, v93, v5
s_mul_i32 s22, s17, 7168
s_add_u32 s22, s22, 8192
v_add_u32 v94, s22, v90
v_lshlrev_b32 v4, 3, v0
s_add_u32 s22, s22, 6144
v_add_u32 v95, s22, v4
s_mul_i32 s22, s17, 3584
s_add_u32 s22, s22, 36864
v_and_b32 v3, 15, v0
v_lshrrev_b32 v4, 2, v3
v_xor_b32 v4, v4, v2
v_lshlrev_b32 v4, 3, v4
v_lshlrev_b32 v5, 5, v3
v_add3_u32 v96, v4, v5, s22
v_and_b32 v4, 3, v0
v_xor_b32 v4, v4, v2
v_lshlrev_b32 v4, 3, v4
v_lshrrev_b32 v5, 2, v0
v_lshlrev_b32 v5, 5, v5
v_add3_u32 v97, v4, v5, s22
s_lshl_b32 s22, s17, 11
s_add_u32 s22, s22, 51200
v_and_b32 v4, 7, v0
v_lshrrev_b32 v5, 3, v3
v_lshlrev_b32 v6, 2, v5
v_add_u32 v6, v6, v2
v_lshrrev_b32 v7, 1, v6
v_add_u32 v7, v7, v4
v_and_b32 v7, 7, v7
v_lshlrev_b32 v7, 4, v7
v_lshlrev_b32 v6, 7, v6
v_add3_u32 v98, v6, v7, s22
v_add_u32 v6, 8, v2
v_lshrrev_b32 v7, 1, v6
v_add_u32 v7, v7, v4
v_and_b32 v7, 7, v7
v_lshlrev_b32 v7, 4, v7
v_lshlrev_b32 v6, 7, v6
v_add3_u32 v99, v6, v7, s22
v_lshrrev_b32 v6, 1, v2
v_or_b32 v6, v6, v5
v_add_u32 v7, 59392, v90
v_cmp_ne_u32 vcc, 0, v6
s_nop 1
v_cndmask_b32 v99, v99, v7, vcc
s_lshl_b32 s22, s17, 2
v_add_u32 v4, s22, v2
v_and_b32 v4, 7, v4
v_lshrrev_b32 v5, 1, v3
v_add_u32 v5, v5, v4
v_and_b32 v5, 7, v5
v_lshlrev_b32 v5, 4, v5
v_lshlrev_b32 v6, 7, v3
v_add_u32 v6, 51200, v6
v_add_u32 v100, v6, v5
s_lshr_b32 s22, s16, 2
s_lshl_b32 s23, s22, 11
s_and_b32 s24, s16, 3
s_lshl_b32 s24, s24, 8
s_add_u32 s23, s23, s24
v_lshrrev_b32 v5, 2, v3
v_lshlrev_b32 v5, 10, v5
v_lshrrev_b32 v6, 1, v3
v_and_b32 v6, 1, v6
v_lshlrev_b32 v6, 7, v6
v_lshlrev_b32 v7, 4, v4
v_add3_u32 v5, v5, v6, v7
v_and_b32 v6, 1, v3
v_lshlrev_b32 v8, 3, v6
v_add3_u32 v5, v5, v8, s23
s_lshl_b32 s23, s22, 9
s_and_b32 s24, s16, 1
s_lshl_b32 s24, s24, 8
s_add_u32 s23, s23, s24
s_lshr_b32 s24, s16, 1
s_and_b32 s24, s24, 1
s_lshl_b32 s24, s24, 3
s_add_u32 s23, s23, s24
s_add_u32 s23, s23, 8192
v_lshlrev_b32 v8, 7, v6
v_add3_u32 v8, v8, v7, s23
v_cmp_gt_u32 vcc, 8, v3
s_nop 1
v_cndmask_b32 v5, v8, v5, vcc
v_mov_b32 v8, 0x10000000
v_cmp_gt_u32 vcc, 10, v3
s_nop 1
v_cndmask_b32 v101, v8, v5, vcc
s_lshl_b32 s22, s17, 11
s_add_u32 s22, s22, 51200
v_lshlrev_b32 v2, 5, v0
v_add_u32 v2, s22, v2
v_mov_b32 v4, 0xf149f2ca
v_mov_b32 v5, v4
v_mov_b32 v6, v4
v_mov_b32 v7, v4
ds_write_b128 v2, v[4:7]
ds_write_b128 v2, v[4:7] offset:16
s_mov_b32 s19, 20000
s_and_b32 s47, s16, 7
s_lshl_b32 s47, s47, 10
s_add_u32 s47, s47, 118165504
s_lshl_b32 s48, s16, 6
s_add_u32 s48, s48, 118188032
s_cmp_lg_u32 s17, 0
s_cbranch_scc1 .Lww_154
s_mov_b32 s24, s48
v_lshlrev_b32 v4, 2, v0
v_mov_b32 v8, 0x10000000
v_cmp_gt_u32 vcc, 2, v0
s_mov_b32 s25, s19
s_nop 0
v_cndmask_b32 v4, v8, v4, vcc
.Lwr_155:
buffer_load_dword v8, v4, s[8:11], s24 offen sc1
s_waitcnt vmcnt(0)
v_cmp_eq_u32 vcc, 1, v8
s_nop 1
s_bcnt1_i32_b64 s26, vcc
s_cmp_eq_u32 s26, 2
s_cbranch_scc1 .Lwo_156
s_sleep 1
s_sub_u32 s25, s25, 1
s_cbranch_scc0 .Lwr_155
s_mov_b32 s19, 0
.Lwo_156:
.Lww_154:
s_barrier
s_sub_u32 s22, s17, 2
s_mul_i32 s22, s22, 14336
s_add_u32 s33, s22, 70221824
s_add_u32 s26, s22, 8192
s_cmp_lt_u32 s17, 2
s_cbranch_scc1 .Lxk_153
s_mov_b32 m0, s26
s_add_u32 s27, s33, 0
buffer_load_dwordx4 v90, s[8:11], s27 offen lds
s_add_u32 m0, s26, 1024
s_add_u32 s27, s33, 1024
buffer_load_dwordx4 v90, s[8:11], s27 offen lds
s_add_u32 m0, s26, 2048
s_add_u32 s27, s33, 2048
buffer_load_dwordx4 v90, s[8:11], s27 offen lds
s_add_u32 m0, s26, 3072
s_add_u32 s27, s33, 3072
buffer_load_dwordx4 v90, s[8:11], s27 offen lds
s_add_u32 m0, s26, 4096
s_add_u32 s27, s33, 4096
buffer_load_dwordx4 v90, s[8:11], s27 offen lds
s_add_u32 m0, s26, 5120
s_add_u32 s27, s33, 5120
buffer_load_dwordx4 v90, s[8:11], s27 offen lds
s_add_u32 m0, s26, 6144
s_add_u32 s27, s33, 6144
buffer_load_dwordx4 v90, s[8:11], s27 offen lds
s_add_u32 m0, s26, 7168
s_add_u32 s27, s33, 7168
buffer_load_dwordx4 v90, s[8:11], s27 offen lds
s_add_u32 m0, s26, 8192
s_add_u32 s27, s33, 8192
buffer_load_dwordx4 v90, s[8:11], s27 offen lds
s_add_u32 m0, s26, 9216
s_add_u32 s27, s33, 9216
buffer_load_dwordx4 v90, s[8:11], s27 offen lds
s_add_u32 m0, s26, 10240
s_add_u32 s27, s33, 10240
buffer_load_dwordx4 v90, s[8:11], s27 offen lds
s_add_u32 m0, s26, 11264
s_add_u32 s27, s33, 11264
buffer_load_dwordx4 v90, s[8:11], s27 offen lds
s_add_u32 m0, s26, 12288
s_add_u32 s27, s33, 12288
buffer_load_dwordx4 v90, s[8:11], s27 offen lds
s_add_u32 m0, s26, 13312
s_add_u32 s27, s33, 13312
buffer_load_dwordx4 v90, s[8:11], s27 offen lds
.Lxk_153:
s_mov_b32 s18, 0
s_mov_b32 s19, 20000
s_mov_b32 s29, 101486592
s_mov_b32 s34, 118124544
v_min_u32 v107, 55, v0
v_lshlrev_b32 v107, 2, v107
s_lshl_b32 s22, s16, 1
s_add_u32 s22, s22, s17
s_lshl_b32 s22, s22, 2
s_add_u32 s22, s22, 256
v_mov_b32 v2, s22
v_mov_b32 v3, 0x10000000
v_cmp_eq_u32 vcc, 0, v0
v_mov_b32 v109, 1
s_nop 0
v_cndmask_b32 v108, v3, v2, vcc
s_mov_b32 s22, s17
s_lshl_b32 s40, s22, 10
s_add_u32 s22, s22, 4
s_sub_u32 s23, s22, 7
s_cselect_b32 s22, s22, s23
s_lshl_b32 s41, s22, 10
s_add_u32 s22, s22, 4
s_sub_u32 s23, s22, 7
s_cselect_b32 s22, s22, s23
s_lshl_b32 s42, s22, 10
s_add_u32 s22, s22, 4
s_sub_u32 s23, s22, 7
s_cselect_b32 s22, s22, s23
s_lshl_b32 s43, s22, 10
s_add_u32 s22, s22, 4
s_sub_u32 s23, s22, 7
s_cselect_b32 s22, s22, s23
s_lshl_b32 s44, s22, 10
s_add_u32 s22, s22, 4
s_sub_u32 s23, s22, 7
s_cselect_b32 s22, s22, s23
s_lshl_b32 s45, s22, 10
s_add_u32 s22, s22, 4
s_sub_u32 s23, s22, 7
s_cselect_b32 s22, s22, s23
s_lshl_b32 s46, s22, 10
v_add_u32 v107, s42, v90
v_add_u32 v108, s43, v90
v_add_u32 v109, s44, v90
v_add_u32 v118, s45, v90
v_add_u32 v119, s46, v90
.p2align 6
.Lsloop_157:
v_mov_b64 v[32:33], 0
v_mov_b64 v[34:35], 0
v_mov_b64 v[36:37], 0
v_mov_b64 v[38:39], 0
v_mov_b64 v[40:41], 0
v_mov_b64 v[42:43], 0
v_mov_b64 v[86:87], 0
v_mov_b64 v[88:89], 0
v_mov_b64 v[4:5], 0
v_mov_b64 v[6:7], 0
v_mov_b64 v[8:9], 0
v_mov_b64 v[10:11], 0
v_mov_b64 v[114:115], 0
v_mov_b64 v[116:117], 0
s_mov_b32 s28, s19
s_waitcnt vmcnt(0)
buffer_load_dwordx4 v[62:65], v102, s[8:11], s29 offen sc1
buffer_load_dwordx4 v[66:69], v106, s[8:11], s29 offen sc1
s_sleep 3
buffer_load_dwordx4 v[70:73], v102, s[8:11], s29 offen sc1
buffer_load_dwordx4 v[74:77], v106, s[8:11], s29 offen sc1
.Lspoll_158:
s_waitcnt vmcnt(3)
ds_write_b128 v91, v[62:65]
v_max3_u32 v2, v62, v63, v64
v_max_u32 v2, v2, v65
s_waitcnt vmcnt(2)
ds_write_b128 v91, v[66:69] offset:4096
v_max3_u32 v2, v2, v66, v67
v_max3_u32 v2, v2, v68, v69
v_cmp_eq_u32 vcc, -1, v2
s_cbranch_vccnz .Lsfail_163
.Lspok_160:
v_smfmac_f32_16x16x64_bf16 v[32:35], v[62:65], a[0:7], v1
v_smfmac_f32_16x16x64_bf16 v[36:39], v[62:65], a[56:63], v1
v_smfmac_f32_16x16x64_bf16 v[40:43], v[62:65], a[112:119], v1
v_smfmac_f32_16x16x64_bf16 v[86:89], v[62:65], a[168:175], v1
s_waitcnt lgkmcnt(0)
s_barrier
ds_read_b128 v[12:15], v107
ds_read_b128 v[16:19], v108
ds_read_b128 v[20:23], v109
ds_read_b128 v[24:27], v118
ds_read_b128 v[28:31], v119
v_smfmac_f32_16x16x64_bf16 v[4:7], v[62:65], a[224:231], v1
v_smfmac_f32_16x16x64_bf16 v[8:11], v[62:65], v[144:151], v1
v_smfmac_f32_16x16x64_bf16 v[114:117], v[62:65], v[200:207], v1
v_smfmac_f32_16x16x64_bf16 v[32:35], v[66:69], a[8:15], v1
v_smfmac_f32_16x16x64_bf16 v[36:39], v[66:69], a[64:71], v1
v_smfmac_f32_16x16x64_bf16 v[40:43], v[66:69], a[120:127], v1
v_smfmac_f32_16x16x64_bf16 v[86:89], v[66:69], a[176:183], v1
v_smfmac_f32_16x16x64_bf16 v[4:7], v[66:69], a[232:239], v1
v_smfmac_f32_16x16x64_bf16 v[8:11], v[66:69], v[152:159], v1
v_smfmac_f32_16x16x64_bf16 v[114:117], v[66:69], v[208:215], v1
s_branch .Lkc_162
.Lsfail_163:
buffer_load_dwordx4 v[62:65], v102, s[8:11], s29 offen sc1
buffer_load_dwordx4 v[66:69], v106, s[8:11], s29 offen sc1
.Lschk_165:
s_waitcnt vmcnt(3)
ds_write_b128 v91, v[70:73]
v_max3_u32 v2, v70, v71, v72
v_max_u32 v2, v2, v73
s_waitcnt vmcnt(2)
ds_write_b128 v91, v[74:77] offset:4096
v_max3_u32 v2, v2, v74, v75
v_max3_u32 v2, v2, v76, v77
v_cmp_eq_u32 vcc, -1, v2
s_cbranch_vccnz .Lsfail_164
.Lspok_161:
v_smfmac_f32_16x16x64_bf16 v[32:35], v[70:73], a[0:7], v1
v_smfmac_f32_16x16x64_bf16 v[36:39], v[70:73], a[56:63], v1
v_smfmac_f32_16x16x64_bf16 v[40:43], v[70:73], a[112:119], v1
v_smfmac_f32_16x16x64_bf16 v[86:89], v[70:73], a[168:175], v1
s_waitcnt lgkmcnt(0)
s_barrier
ds_read_b128 v[12:15], v107
ds_read_b128 v[16:19], v108
ds_read_b128 v[20:23], v109
ds_read_b128 v[24:27], v118
ds_read_b128 v[28:31], v119
v_smfmac_f32_16x16x64_bf16 v[4:7], v[70:73], a[224:231], v1
v_smfmac_f32_16x16x64_bf16 v[8:11], v[70:73], v[144:151], v1
v_smfmac_f32_16x16x64_bf16 v[114:117], v[70:73], v[200:207], v1
v_smfmac_f32_16x16x64_bf16 v[32:35], v[74:77], a[8:15], v1
v_smfmac_f32_16x16x64_bf16 v[36:39], v[74:77], a[64:71], v1
v_smfmac_f32_16x16x64_bf16 v[40:43], v[74:77], a[120:127], v1
v_smfmac_f32_16x16x64_bf16 v[86:89], v[74:77], a[176:183], v1
v_smfmac_f32_16x16x64_bf16 v[4:7], v[74:77], a[232:239], v1
v_smfmac_f32_16x16x64_bf16 v[8:11], v[74:77], v[152:159], v1
v_smfmac_f32_16x16x64_bf16 v[114:117], v[74:77], v[208:215], v1
.Lkc_162:
s_add_u32 s21, s18, 1
s_and_b32 s21, s21, 3
s_mul_i32 s21, s21, 7168
s_add_u32 s29, s21, 101416960
s_and_b32 s21, s18, 3
s_mul_i32 s21, s21, 10240
s_add_u32 s31, s21, 101445632
s_add_u32 s21, s18, 2
s_and_b32 s21, s21, 3
s_mul_i32 s21, s21, 10240
s_add_u32 s32, s21, 101445632
s_waitcnt lgkmcnt(4)
v_smfmac_f32_16x16x64_bf16 v[32:35], v[12:15], a[16:23], v1
ds_read_b128 v[78:81], v94 offset:1024
s_waitcnt lgkmcnt(4)
v_smfmac_f32_16x16x64_bf16 v[32:35], v[16:19], a[24:31], v1
ds_read_b128 v[82:85], v94 offset:4096
s_waitcnt lgkmcnt(4)
v_smfmac_f32_16x16x64_bf16 v[32:35], v[20:23], a[32:39], v1
s_waitcnt vmcnt(0)
ds_read_b128 v[62:65], v92 offset:0
s_waitcnt lgkmcnt(4)
v_smfmac_f32_16x16x64_bf16 v[32:35], v[24:27], a[40:47], v1
ds_read_b128 v[66:69], v94 offset:0
s_waitcnt lgkmcnt(4)
v_smfmac_f32_16x16x64_bf16 v[32:35], v[28:31], a[48:55], v1
ds_read_b128 v[70:73], v94 offset:3072
v_smfmac_f32_16x16x64_bf16 v[36:39], v[12:15], a[72:79], v1
ds_read_b128 v[74:77], v92 offset:512
v_smfmac_f32_16x16x64_bf16 v[36:39], v[16:19], a[80:87], v1
v_cvt_pk_bf16_f32 v44, v32, v33
v_smfmac_f32_16x16x64_bf16 v[36:39], v[20:23], a[88:95], v1
v_cvt_pk_bf16_f32 v45, v34, v35
v_smfmac_f32_16x16x64_bf16 v[36:39], v[24:27], a[96:103], v1
ds_write_b32 v96, v44 offset:0
v_smfmac_f32_16x16x64_bf16 v[36:39], v[28:31], a[104:111], v1
ds_write_b32 v96, v45 offset:4
v_smfmac_f32_16x16x64_bf16 v[40:43], v[12:15], a[128:135], v1
ds_read_b64_tr_b16 v[48:49], v97 offset:0
v_smfmac_f32_16x16x64_bf16 v[40:43], v[16:19], a[136:143], v1
v_cvt_pk_bf16_f32 v46, v36, v37
v_smfmac_f32_16x16x64_bf16 v[40:43], v[20:23], a[144:151], v1
v_cvt_pk_bf16_f32 v47, v38, v39
v_smfmac_f32_16x16x64_bf16 v[40:43], v[24:27], a[152:159], v1
ds_write_b32 v96, v46 offset:512
v_smfmac_f32_16x16x64_bf16 v[40:43], v[28:31], a[160:167], v1
ds_write_b32 v96, v47 offset:516
v_smfmac_f32_16x16x64_bf16 v[86:89], v[12:15], a[184:191], v1
ds_read_b64_tr_b16 v[50:51], v97 offset:512
v_smfmac_f32_16x16x64_bf16 v[86:89], v[16:19], a[192:199], v1
v_cvt_pk_bf16_f32 v44, v40, v41
v_smfmac_f32_16x16x64_bf16 v[86:89], v[20:23], a[200:207], v1
v_cvt_pk_bf16_f32 v45, v42, v43
v_smfmac_f32_16x16x64_bf16 v[86:89], v[24:27], a[208:215], v1
ds_write_b32 v96, v44 offset:1024
v_smfmac_f32_16x16x64_bf16 v[86:89], v[28:31], a[216:223], v1
ds_write_b32 v96, v45 offset:1028
v_smfmac_f32_16x16x64_bf16 v[4:7], v[12:15], a[240:247], v1
ds_read_b64_tr_b16 v[52:53], v97 offset:1024
v_smfmac_f32_16x16x64_bf16 v[4:7], v[16:19], a[248:255], v1
v_cvt_pk_bf16_f32 v46, v86, v87
v_smfmac_f32_16x16x64_bf16 v[4:7], v[20:23], v[120:127], v1
v_cvt_pk_bf16_f32 v47, v88, v89
v_smfmac_f32_16x16x64_bf16 v[4:7], v[24:27], v[128:135], v1
ds_write_b32 v96, v46 offset:1536
v_smfmac_f32_16x16x64_bf16 v[4:7], v[28:31], v[136:143], v1
ds_write_b32 v96, v47 offset:1540
v_smfmac_f32_16x16x64_bf16 v[8:11], v[12:15], v[160:167], v1
ds_read_b64_tr_b16 v[54:55], v97 offset:1536
v_smfmac_f32_16x16x64_bf16 v[8:11], v[16:19], v[168:175], v1
v_cvt_pk_bf16_f32 v44, v4, v5
v_smfmac_f32_16x16x64_bf16 v[8:11], v[20:23], v[176:183], v1
v_cvt_pk_bf16_f32 v45, v6, v7
v_smfmac_f32_16x16x64_bf16 v[8:11], v[24:27], v[184:191], v1
ds_write_b32 v96, v44 offset:2048
v_smfmac_f32_16x16x64_bf16 v[8:11], v[28:31], v[192:199], v1
ds_write_b32 v96, v45 offset:2052
v_smfmac_f32_16x16x64_bf16 v[114:117], v[12:15], v[216:223], v1
ds_read_b64_tr_b16 v[56:57], v97 offset:2048
v_smfmac_f32_16x16x64_bf16 v[114:117], v[16:19], v[224:231], v1
v_cvt_pk_bf16_f32 v46, v8, v9
v_smfmac_f32_16x16x64_bf16 v[114:117], v[20:23], v[232:239], v1
v_cvt_pk_bf16_f32 v47, v10, v11
v_smfmac_f32_16x16x64_bf16 v[114:117], v[24:27], v[240:247], v1
ds_write_b32 v96, v46 offset:2560
v_smfmac_f32_16x16x64_bf16 v[114:117], v[28:31], v[248:255], v1
ds_write_b32 v96, v47 offset:2564
s_waitcnt lgkmcnt(15)
s_waitcnt lgkmcnt(11)
v_mfma_f32_16x16x32_bf16 v[32:35], v[62:65], v[48:51], 0
ds_read_b64_tr_b16 v[58:59], v97 offset:2560
ds_read_b128 v[12:15], v92 offset:1024
v_mfma_f32_16x16x32_bf16 v[36:39], v[66:69], v[48:51], 0
v_cvt_pk_bf16_f32 v44, v114, v115
v_cvt_pk_bf16_f32 v45, v116, v117
v_mfma_f32_16x16x32_bf16 v[40:43], v[70:73], v[48:51], 0
ds_read_b128 v[16:19], v94 offset:2048
v_mfma_f32_16x16x16_bf16 v[86:89], v[44:45], v[112:113], 0
ds_read_b128 v[20:23], v94 offset:5120
s_waitcnt lgkmcnt(9)
v_mfma_f32_16x16x32_bf16 v[32:35], v[74:77], v[52:55], v[32:35]
ds_read_b64 v[24:25], v93
v_mfma_f32_16x16x32_bf16 v[36:39], v[78:81], v[52:55], v[36:39]
ds_read_b64 v[26:27], v95 offset:0
v_mfma_f32_16x16x32_bf16 v[40:43], v[82:85], v[52:55], v[40:43]
v_cvt_pk_bf16_f32 v60, v86, v87
ds_read_b64 v[28:29], v95 offset:512
s_waitcnt lgkmcnt(5)
v_mfma_f32_16x16x32_bf16 v[32:35], v[12:15], v[56:59], v[32:35]
v_cvt_pk_bf16_f32 v61, v88, v89
s_waitcnt lgkmcnt(4)
v_mfma_f32_16x16x32_bf16 v[36:39], v[16:19], v[56:59], v[36:39]
s_waitcnt lgkmcnt(3)
v_mfma_f32_16x16x32_bf16 v[40:43], v[20:23], v[56:59], v[40:43]
s_waitcnt lgkmcnt(2)
v_mfma_f32_16x16x16_bf16 v[32:35], v[24:25], v[60:61], v[32:35]
s_waitcnt lgkmcnt(1)
v_mfma_f32_16x16x16_bf16 v[36:39], v[26:27], v[60:61], v[36:39]
s_waitcnt lgkmcnt(0)
v_mfma_f32_16x16x16_bf16 v[40:43], v[28:29], v[60:61], v[40:43]
v_add_f32_dpp v4, v32, v32 row_ror:8 row_mask:0xf bank_mask:0xf
v_add_f32_dpp v5, v33, v33 row_ror:8 row_mask:0xf bank_mask:0xf
v_add_f32_dpp v6, v34, v34 row_ror:8 row_mask:0xf bank_mask:0xf
v_add_f32_dpp v7, v35, v35 row_ror:8 row_mask:0xf bank_mask:0xf
ds_write_b128 v99, v[4:7]
v_add_f32_dpp v8, v36, v36 row_ror:8 row_mask:0xf bank_mask:0x3
v_add_f32_dpp v9, v37, v37 row_ror:8 row_mask:0xf bank_mask:0x3
v_add_f32_dpp v10, v38, v38 row_ror:8 row_mask:0xf bank_mask:0x3
v_add_f32_dpp v11, v39, v39 row_ror:8 row_mask:0xf bank_mask:0x3
v_add_f32_dpp v8, v40, v40 row_ror:8 row_mask:0xf bank_mask:0xc
v_add_f32_dpp v9, v41, v41 row_ror:8 row_mask:0xf bank_mask:0xc
v_add_f32_dpp v10, v42, v42 row_ror:8 row_mask:0xf bank_mask:0xc
v_add_f32_dpp v11, v43, v43 row_ror:8 row_mask:0xf bank_mask:0xc
ds_write_b128 v98, v[8:11]
s_cmp_ge_u32 s17, 2
s_cbranch_scc1 .Lxk_166
s_waitcnt lgkmcnt(0)
s_barrier
ds_read_b128 v[4:7], v100 offset:0
ds_read_b128 v[8:11], v100 offset:2048
ds_read_b128 v[12:15], v100 offset:4096
ds_read_b128 v[16:19], v100 offset:6144
s_waitcnt lgkmcnt(2)
v_pk_add_f32 v[4:5], v[4:5], v[8:9]
v_pk_add_f32 v[6:7], v[6:7], v[10:11]
s_waitcnt lgkmcnt(0)
v_pk_add_f32 v[12:13], v[12:13], v[16:17]
v_pk_add_f32 v[14:15], v[14:15], v[18:19]
v_pk_add_f32 v[4:5], v[4:5], v[12:13]
v_pk_add_f32 v[6:7], v[6:7], v[14:15]
v_max3_f32 v8, v4, v5, v6
v_max_f32 v8, v8, v7
s_nop 1
v_max_f32_dpp v9, v8, v8 row_ror:4 row_mask:0xf bank_mask:0xf
v_max_f32_dpp v9, v8, v9 row_ror:8 row_mask:0xf bank_mask:0xf
v_max_f32_dpp v9, v8, v9 row_ror:12 row_mask:0xf bank_mask:0xf
s_nop 1
v_max_f32_dpp v10, v9, v9 row_ror:1 row_mask:0xf bank_mask:0xf
v_max_f32_dpp v10, v9, v10 row_ror:2 row_mask:0xf bank_mask:0xf
v_max_f32_dpp v10, v9, v10 row_ror:3 row_mask:0xf bank_mask:0xf
v_pk_add_f32 v[4:5], v[4:5], v[10:11] op_sel_hi:[1,0] neg_lo:[0,1] neg_hi:[0,1]
v_pk_add_f32 v[6:7], v[6:7], v[10:11] op_sel_hi:[1,0] neg_lo:[0,1] neg_hi:[0,1]
v_exp_f32 v4, v4
v_exp_f32 v5, v5
v_exp_f32 v6, v6
v_exp_f32 v7, v7
v_add_f32 v8, v4, v5
v_add_f32 v9, v6, v7
v_add_f32 v8, v8, v9
s_nop 1
v_add_f32_dpp v9, v8, v8 row_ror:4 row_mask:0xf bank_mask:0xf
v_add_f32_dpp v9, v8, v9 row_ror:8 row_mask:0xf bank_mask:0xf
v_add_f32_dpp v9, v8, v9 row_ror:12 row_mask:0xf bank_mask:0xf
s_nop 1
v_add_f32_dpp v10, v9, v9 row_ror:1 row_mask:0xf bank_mask:0xf
v_add_f32_dpp v10, v9, v10 row_ror:2 row_mask:0xf bank_mask:0xf
v_add_f32_dpp v10, v9, v10 row_ror:3 row_mask:0xf bank_mask:0xf
v_rcp_f32 v10, v10
s_nop 0
v_pk_mul_f32 v[4:5], v[4:5], v[10:11] op_sel_hi:[1,0]
v_pk_mul_f32 v[6:7], v[6:7], v[10:11] op_sel_hi:[1,0]
v_cvt_pk_bf16_f32 v4, v4, v5
v_cvt_pk_bf16_f32 v5, v6, v7
buffer_store_dwordx2 v[4:5], v101, s[8:11], s31 offen sc1
buffer_store_dwordx2 v[104:105], v101, s[8:11], s32 offen sc1
s_barrier
s_branch .Lsnext_167
.Lxk_166:
s_waitcnt lgkmcnt(0)
s_barrier
s_barrier
s_cmp_gt_u32 s18, 1
s_cbranch_scc1 .Llfa_168
s_cmp_eq_u32 s18, 1
s_cbranch_scc1 .Llfa_169
s_lshl_b32 s52, s16, 6
s_add_u32 s52, s52, 118188040
s_mov_b32 s48, s52
v_lshlrev_b32 v2, 2, v0
v_mov_b32 v4, 0x10000000
v_cmp_gt_u32 vcc, 2, v0
s_mov_b32 s49, s19
s_nop 0
v_cndmask_b32 v2, v4, v2, vcc
.Lwr_171:
buffer_load_dword v4, v2, s[8:11], s48 offen sc1
s_waitcnt vmcnt(0)
v_cmp_eq_u32 vcc, 1, v4
s_nop 1
s_bcnt1_i32_b64 s50, vcc
s_cmp_eq_u32 s50, 2
s_cbranch_scc1 .Lwo_172
s_sleep 1
s_sub_u32 s49, s49, 1
s_cbranch_scc0 .Lwr_171
s_mov_b32 s19, 0
.Lwo_172:
s_branch .Llfa_168
.Llfa_169:
s_mov_b32 s48, s47
v_lshlrev_b32 v2, 4, v0
v_mov_b32 v4, 0x10000000
v_cmp_gt_u32 vcc, 32, v0
s_mov_b32 s49, s19
s_nop 0
v_cndmask_b32 v2, v4, v2, vcc
.Lwr_174:
buffer_load_dwordx4 v[4:7], v2, s[8:11], s48 offen sc1
s_waitcnt vmcnt(0)
s_mov_b32 s50, 0
v_cmp_eq_u32 vcc, 1, v4
s_nop 1
s_and_b32 vcc_lo, vcc_lo, 0xffffffff
s_and_b32 vcc_hi, vcc_hi, 0x0
s_bcnt1_i32_b64 s51, vcc
s_add_u32 s50, s50, s51
v_cmp_eq_u32 vcc, 1, v5
s_nop 1
s_and_b32 vcc_lo, vcc_lo, 0xffffffff
s_and_b32 vcc_hi, vcc_hi, 0x0
s_bcnt1_i32_b64 s51, vcc
s_add_u32 s50, s50, s51
v_cmp_eq_u32 vcc, 1, v6
s_nop 1
s_and_b32 vcc_lo, vcc_lo, 0xffffffff
s_and_b32 vcc_hi, vcc_hi, 0x0
s_bcnt1_i32_b64 s51, vcc
s_add_u32 s50, s50, s51
v_cmp_eq_u32 vcc, 1, v7
s_nop 1
s_and_b32 vcc_lo, vcc_lo, 0xffffffff
s_and_b32 vcc_hi, vcc_hi, 0x0
s_bcnt1_i32_b64 s51, vcc
s_add_u32 s50, s50, s51
s_cmp_eq_u32 s50, 128
s_cbranch_scc1 .Lwo_175
s_sleep 2
s_sub_u32 s49, s49, 1
s_cbranch_scc0 .Lwr_174
s_mov_b32 s19, 0
.Lwo_175:
.Llfa_168:
s_add_u32 s33, s33, 28672
s_mov_b32 m0, s26
s_add_u32 s27, s33, 0
buffer_load_dwordx4 v90, s[8:11], s27 offen lds
s_add_u32 m0, s26, 1024
s_add_u32 s27, s33, 1024
buffer_load_dwordx4 v90, s[8:11], s27 offen lds
s_add_u32 m0, s26, 2048
s_add_u32 s27, s33, 2048
buffer_load_dwordx4 v90, s[8:11], s27 offen lds
s_add_u32 m0, s26, 3072
s_add_u32 s27, s33, 3072
buffer_load_dwordx4 v90, s[8:11], s27 offen lds
s_add_u32 m0, s26, 4096
s_add_u32 s27, s33, 4096
buffer_load_dwordx4 v90, s[8:11], s27 offen lds
s_add_u32 m0, s26, 5120
s_add_u32 s27, s33, 5120
buffer_load_dwordx4 v90, s[8:11], s27 offen lds
s_add_u32 m0, s26, 6144
s_add_u32 s27, s33, 6144
buffer_load_dwordx4 v90, s[8:11], s27 offen lds
s_add_u32 m0, s26, 7168
s_add_u32 s27, s33, 7168
buffer_load_dwordx4 v90, s[8:11], s27 offen lds
s_add_u32 m0, s26, 8192
s_add_u32 s27, s33, 8192
buffer_load_dwordx4 v90, s[8:11], s27 offen lds
s_add_u32 m0, s26, 9216
s_add_u32 s27, s33, 9216
buffer_load_dwordx4 v90, s[8:11], s27 offen lds
s_add_u32 m0, s26, 10240
s_add_u32 s27, s33, 10240
buffer_load_dwordx4 v90, s[8:11], s27 offen lds
s_add_u32 m0, s26, 11264
s_add_u32 s27, s33, 11264
buffer_load_dwordx4 v90, s[8:11], s27 offen lds
s_add_u32 m0, s26, 12288
s_add_u32 s27, s33, 12288
buffer_load_dwordx4 v90, s[8:11], s27 offen lds
s_add_u32 m0, s26, 13312
s_add_u32 s27, s33, 13312
buffer_load_dwordx4 v90, s[8:11], s27 offen lds
.Lsnext_167:
s_add_u32 s18, s18, 1
s_cmp_lt_u32 s18, 63
s_cbranch_scc1 .Lsloop_157
s_waitcnt vmcnt(0)
s_endpgm
.Lsfail_164:
buffer_load_dwordx4 v[70:73], v102, s[8:11], s29 offen sc1
buffer_load_dwordx4 v[74:77], v106, s[8:11], s29 offen sc1
s_sub_u32 s28, s28, 1
s_cbranch_scc0 .Lspoll_158
s_mov_b32 s19, 0
s_branch .Lspok_160
mega_kernel_val1:
s_sub_u32 s29, s16, 16
v_lshlrev_b32 v108, 4, v0
s_lshl_b32 s21, s29, 2
s_add_u32 s21, s21, s17
s_mul_i32 s21, s21, 114688
s_add_u32 s21, s21, 6422528
s_lshl_b32 s22, s17, 2
s_add_u32 s22, s22, 16
v_lshrrev_b32 v2, 3, v0
v_add_u32 v2, s22, v2
v_mul_u32_u24 v2, 448, v2
v_and_b32 v3, 7, v0
v_lshlrev_b32 v3, 2, v3
s_lshl_b32 s22, s29, 5
s_add_u32 s22, s22, 118222848
v_add3_u32 v2, v2, v3, s22
v_mov_b32 v3, 0x10000000
v_cmp_gt_u32 vcc, 32, v0
s_movk_i32 s28, 8000
s_nop 0
v_cndmask_b32 v2, v3, v2, vcc
.Lvw_177:
buffer_load_dword v3, v2, s[8:11], 0 offen sc1
s_waitcnt vmcnt(0)
v_cmp_eq_u32 vcc, 1, v3
s_nop 1
s_cmp_eq_u32 vcc_lo, -1
s_cbranch_scc1 .Lvw_178
s_sleep 2
s_sub_u32 s28, s28, 1
s_cbranch_scc0 .Lvw_177
.Lvw_178:
buffer_load_dwordx4 a[0:3], v108, s[8:11], s21 offen nt
buffer_load_dwordx4 a[4:7], v108, s[8:11], s21 offen offset:1024 nt
buffer_load_dwordx4 a[8:11], v108, s[8:11], s21 offen offset:2048 nt
buffer_load_dwordx4 a[12:15], v108, s[8:11], s21 offen offset:3072 nt
s_add_u32 s21, s21, 4096
buffer_load_dwordx4 a[16:19], v108, s[8:11], s21 offen nt
buffer_load_dwordx4 a[20:23], v108, s[8:11], s21 offen offset:1024 nt
buffer_load_dwordx4 a[24:27], v108, s[8:11], s21 offen offset:2048 nt
buffer_load_dwordx4 a[28:31], v108, s[8:11], s21 offen offset:3072 nt
s_add_u32 s21, s21, 4096
buffer_load_dwordx4 a[32:35], v108, s[8:11], s21 offen nt
buffer_load_dwordx4 a[36:39], v108, s[8:11], s21 offen offset:1024 nt
buffer_load_dwordx4 a[40:43], v108, s[8:11], s21 offen offset:2048 nt
buffer_load_dwordx4 a[44:47], v108, s[8:11], s21 offen offset:3072 nt
s_add_u32 s21, s21, 4096
buffer_load_dwordx4 a[48:51], v108, s[8:11], s21 offen nt
buffer_load_dwordx4 a[52:55], v108, s[8:11], s21 offen offset:1024 nt
buffer_load_dwordx4 a[56:59], v108, s[8:11], s21 offen offset:2048 nt
buffer_load_dwordx4 a[60:63], v108, s[8:11], s21 offen offset:3072 nt
s_add_u32 s21, s21, 4096
buffer_load_dwordx4 a[64:67], v108, s[8:11], s21 offen nt
buffer_load_dwordx4 a[68:71], v108, s[8:11], s21 offen offset:1024 nt
buffer_load_dwordx4 a[72:75], v108, s[8:11], s21 offen offset:2048 nt
buffer_load_dwordx4 a[76:79], v108, s[8:11], s21 offen offset:3072 nt
s_add_u32 s21, s21, 4096
buffer_load_dwordx4 a[80:83], v108, s[8:11], s21 offen nt
buffer_load_dwordx4 a[84:87], v108, s[8:11], s21 offen offset:1024 nt
buffer_load_dwordx4 a[88:91], v108, s[8:11], s21 offen offset:2048 nt
buffer_load_dwordx4 a[92:95], v108, s[8:11], s21 offen offset:3072 nt
s_add_u32 s21, s21, 4096
buffer_load_dwordx4 a[96:99], v108, s[8:11], s21 offen nt
buffer_load_dwordx4 a[100:103], v108, s[8:11], s21 offen offset:1024 nt
buffer_load_dwordx4 a[104:107], v108, s[8:11], s21 offen offset:2048 nt
buffer_load_dwordx4 a[108:111], v108, s[8:11], s21 offen offset:3072 nt
s_add_u32 s21, s21, 4096
buffer_load_dwordx4 a[112:115], v108, s[8:11], s21 offen nt
buffer_load_dwordx4 a[116:119], v108, s[8:11], s21 offen offset:1024 nt
buffer_load_dwordx4 a[120:123], v108, s[8:11], s21 offen offset:2048 nt
buffer_load_dwordx4 a[124:127], v108, s[8:11], s21 offen offset:3072 nt
s_add_u32 s21, s21, 4096
buffer_load_dwordx4 a[128:131], v108, s[8:11], s21 offen nt
buffer_load_dwordx4 a[132:135], v108, s[8:11], s21 offen offset:1024 nt
buffer_load_dwordx4 a[136:139], v108, s[8:11], s21 offen offset:2048 nt
buffer_load_dwordx4 a[140:143], v108, s[8:11], s21 offen offset:3072 nt
s_add_u32 s21, s21, 4096
buffer_load_dwordx4 a[144:147], v108, s[8:11], s21 offen nt
buffer_load_dwordx4 a[148:151], v108, s[8:11], s21 offen offset:1024 nt
buffer_load_dwordx4 a[152:155], v108, s[8:11], s21 offen offset:2048 nt
buffer_load_dwordx4 a[156:159], v108, s[8:11], s21 offen offset:3072 nt
s_add_u32 s21, s21, 4096
buffer_load_dwordx4 a[160:163], v108, s[8:11], s21 offen nt
buffer_load_dwordx4 a[164:167], v108, s[8:11], s21 offen offset:1024 nt
buffer_load_dwordx4 a[168:171], v108, s[8:11], s21 offen offset:2048 nt
buffer_load_dwordx4 a[172:175], v108, s[8:11], s21 offen offset:3072 nt
s_add_u32 s21, s21, 4096
buffer_load_dwordx4 a[176:179], v108, s[8:11], s21 offen nt
buffer_load_dwordx4 a[180:183], v108, s[8:11], s21 offen offset:1024 nt
buffer_load_dwordx4 a[184:187], v108, s[8:11], s21 offen offset:2048 nt
buffer_load_dwordx4 a[188:191], v108, s[8:11], s21 offen offset:3072 nt
s_add_u32 s21, s21, 4096
buffer_load_dwordx4 a[192:195], v108, s[8:11], s21 offen nt
buffer_load_dwordx4 a[196:199], v108, s[8:11], s21 offen offset:1024 nt
buffer_load_dwordx4 a[200:203], v108, s[8:11], s21 offen offset:2048 nt
buffer_load_dwordx4 a[204:207], v108, s[8:11], s21 offen offset:3072 nt
s_add_u32 s21, s21, 4096
buffer_load_dwordx4 a[208:211], v108, s[8:11], s21 offen nt
buffer_load_dwordx4 a[212:215], v108, s[8:11], s21 offen offset:1024 nt
buffer_load_dwordx4 a[216:219], v108, s[8:11], s21 offen offset:2048 nt
buffer_load_dwordx4 a[220:223], v108, s[8:11], s21 offen offset:3072 nt
s_add_u32 s21, s21, 4096
buffer_load_dwordx4 a[224:227], v108, s[8:11], s21 offen nt
buffer_load_dwordx4 a[228:231], v108, s[8:11], s21 offen offset:1024 nt
buffer_load_dwordx4 a[232:235], v108, s[8:11], s21 offen offset:2048 nt
buffer_load_dwordx4 a[236:239], v108, s[8:11], s21 offen offset:3072 nt
s_add_u32 s21, s21, 4096
buffer_load_dwordx4 a[240:243], v108, s[8:11], s21 offen nt
buffer_load_dwordx4 a[244:247], v108, s[8:11], s21 offen offset:1024 nt
buffer_load_dwordx4 a[248:251], v108, s[8:11], s21 offen offset:2048 nt
buffer_load_dwordx4 a[252:255], v108, s[8:11], s21 offen offset:3072 nt
s_add_u32 s21, s21, 4096
buffer_load_dwordx4 v[128:131], v108, s[8:11], s21 offen nt
buffer_load_dwordx4 v[132:135], v108, s[8:11], s21 offen offset:1024 nt
buffer_load_dwordx4 v[136:139], v108, s[8:11], s21 offen offset:2048 nt
buffer_load_dwordx4 v[140:143], v108, s[8:11], s21 offen offset:3072 nt
s_add_u32 s21, s21, 4096
buffer_load_dwordx4 v[144:147], v108, s[8:11], s21 offen nt
buffer_load_dwordx4 v[148:151], v108, s[8:11], s21 offen offset:1024 nt
buffer_load_dwordx4 v[152:155], v108, s[8:11], s21 offen offset:2048 nt
buffer_load_dwordx4 v[156:159], v108, s[8:11], s21 offen offset:3072 nt
s_add_u32 s21, s21, 4096
buffer_load_dwordx4 v[160:163], v108, s[8:11], s21 offen nt
buffer_load_dwordx4 v[164:167], v108, s[8:11], s21 offen offset:1024 nt
buffer_load_dwordx4 v[168:171], v108, s[8:11], s21 offen offset:2048 nt
buffer_load_dwordx4 v[172:175], v108, s[8:11], s21 offen offset:3072 nt
s_add_u32 s21, s21, 4096
buffer_load_dwordx4 v[176:179], v108, s[8:11], s21 offen nt
buffer_load_dwordx4 v[180:183], v108, s[8:11], s21 offen offset:1024 nt
buffer_load_dwordx4 v[184:187], v108, s[8:11], s21 offen offset:2048 nt
buffer_load_dwordx4 v[188:191], v108, s[8:11], s21 offen offset:3072 nt
s_add_u32 s21, s21, 4096
buffer_load_dwordx4 v[192:195], v108, s[8:11], s21 offen nt
buffer_load_dwordx4 v[196:199], v108, s[8:11], s21 offen offset:1024 nt
buffer_load_dwordx4 v[200:203], v108, s[8:11], s21 offen offset:2048 nt
buffer_load_dwordx4 v[204:207], v108, s[8:11], s21 offen offset:3072 nt
s_add_u32 s21, s21, 4096
buffer_load_dwordx4 v[208:211], v108, s[8:11], s21 offen nt
buffer_load_dwordx4 v[212:215], v108, s[8:11], s21 offen offset:1024 nt
buffer_load_dwordx4 v[216:219], v108, s[8:11], s21 offen offset:2048 nt
buffer_load_dwordx4 v[220:223], v108, s[8:11], s21 offen offset:3072 nt
s_add_u32 s21, s21, 4096
buffer_load_dwordx4 v[224:227], v108, s[8:11], s21 offen nt
buffer_load_dwordx4 v[228:231], v108, s[8:11], s21 offen offset:1024 nt
buffer_load_dwordx4 v[232:235], v108, s[8:11], s21 offen offset:2048 nt
buffer_load_dwordx4 v[236:239], v108, s[8:11], s21 offen offset:3072 nt
s_add_u32 s21, s21, 4096
buffer_load_dwordx4 v[240:243], v108, s[8:11], s21 offen nt
buffer_load_dwordx4 v[244:247], v108, s[8:11], s21 offen offset:1024 nt
buffer_load_dwordx4 v[248:251], v108, s[8:11], s21 offen offset:2048 nt
buffer_load_dwordx4 v[252:255], v108, s[8:11], s21 offen offset:3072 nt
s_add_u32 s21, s21, 4096
s_lshl_b32 s22, s17, 14
s_add_u32 s22, s22, 8192
s_add_u32 m0, s22, 0
s_add_u32 s23, s21, 0
buffer_load_dwordx4 v108, s[8:11], s23 offen lds
s_add_u32 m0, s22, 1024
s_add_u32 s23, s21, 1024
buffer_load_dwordx4 v108, s[8:11], s23 offen lds
s_add_u32 m0, s22, 2048
s_add_u32 s23, s21, 2048
buffer_load_dwordx4 v108, s[8:11], s23 offen lds
s_add_u32 m0, s22, 3072
s_add_u32 s23, s21, 3072
buffer_load_dwordx4 v108, s[8:11], s23 offen lds
s_add_u32 m0, s22, 4096
s_add_u32 s23, s21, 4096
buffer_load_dwordx4 v108, s[8:11], s23 offen lds
s_add_u32 m0, s22, 5120
s_add_u32 s23, s21, 5120
buffer_load_dwordx4 v108, s[8:11], s23 offen lds
s_add_u32 m0, s22, 6144
s_add_u32 s23, s21, 6144
buffer_load_dwordx4 v108, s[8:11], s23 offen lds
s_add_u32 m0, s22, 7168
s_add_u32 s23, s21, 7168
buffer_load_dwordx4 v108, s[8:11], s23 offen lds
s_add_u32 m0, s22, 8192
s_add_u32 s23, s21, 8192
buffer_load_dwordx4 v108, s[8:11], s23 offen lds
s_add_u32 m0, s22, 9216
s_add_u32 s23, s21, 9216
buffer_load_dwordx4 v108, s[8:11], s23 offen lds
s_add_u32 m0, s22, 10240
s_add_u32 s23, s21, 10240
buffer_load_dwordx4 v108, s[8:11], s23 offen lds
s_add_u32 m0, s22, 11264
s_add_u32 s23, s21, 11264
buffer_load_dwordx4 v108, s[8:11], s23 offen lds
s_add_u32 m0, s22, 12288
s_add_u32 s23, s21, 12288
buffer_load_dwordx4 v108, s[8:11], s23 offen lds
s_add_u32 m0, s22, 13312
s_add_u32 s23, s21, 13312
buffer_load_dwordx4 v108, s[8:11], s23 offen lds
s_add_u32 m0, s22, 14336
s_add_u32 s23, s21, 14336
buffer_load_dwordx4 v108, s[8:11], s23 offen lds
s_add_u32 m0, s22, 15360
s_add_u32 s23, s21, 15360
buffer_load_dwordx4 v108, s[8:11], s23 offen lds
v_add_u32 v112, s22, v108
v_and_b32 v2, 8, v0
v_mov_b32 v1, 0x44444444
v_mov_b32 v3, 0xeeeeeeee
v_cmp_ne_u32 vcc, 0, v2
v_mov_b32 v118, -1
v_mov_b32 v119, -1
v_cndmask_b32 v1, v1, v3, vcc
s_lshl_b32 s22, s17, 10
v_add_u32 v109, s22, v108
s_movk_i32 s23, 4096
s_cmp_eq_u32 s17, 3
s_cselect_b32 s23, 0x10000000, s23
v_add_u32 v111, s23, v109
s_lshl_b32 s22, s17, 11
v_add_u32 v113, s22, v108
s_lshl_b32 s22, s17, 9
s_add_u32 s22, s22, 8192
v_lshrrev_b32 v2, 4, v0
v_and_b32 v3, 15, v0
v_lshlrev_b32 v4, 7, v2
v_lshlrev_b32 v5, 4, v3
v_add3_u32 v4, v4, v5, s22
v_mov_b32 v5, 0x10000000
v_cmp_gt_u32 vcc, 8, v3
s_nop 1
v_cndmask_b32 v114, v5, v4, vcc
s_lshl_b32 s22, s17, 10
s_add_u32 s22, s22, 73728
v_lshlrev_b32 v4, 2, v0
v_add_u32 v115, s22, v4
v_add_u32 v116, 73728, v108
v_lshrrev_b32 v2, 4, v0
v_lshrrev_b32 v3, 2, v0
v_and_b32 v3, 1, v3
v_lshlrev_b32 v3, 2, v3
v_add_u32 v2, v2, v3
v_lshlrev_b32 v2, 4, v2
v_lshrrev_b32 v3, 3, v0
v_and_b32 v3, 1, v3
v_lshlrev_b32 v3, 1, v3
v_lshrrev_b32 v4, 1, v0
v_and_b32 v4, 1, v4
v_add_u32 v3, v3, v4
v_lshlrev_b32 v3, 7, v3
v_and_b32 v4, 1, v0
v_lshlrev_b32 v4, 3, v4
v_add3_u32 v2, v2, v3, v4
s_lshl_b32 s22, s29, 9
v_add_u32 v117, s22, v2
s_lshl_b32 s22, s29, 15
s_lshl_b32 s23, s17, 13
s_add_u32 s35, s22, s23
s_add_u32 s35, s35, 16515072
s_lshl_b32 s22, s29, 13
s_lshl_b32 s23, s17, 11
s_add_u32 s38, s22, s23
s_add_u32 s38, s38, 46403584
s_mov_b32 s18, 0
s_mov_b32 s19, 20000
s_mov_b32 s30, 45944832
s_mov_b32 s34, 45952000
s_mov_b32 s57, 68157440
v_min_u32 v125, 55, v0
v_lshlrev_b32 v125, 2, v125
v_and_b32 v124, 31, v0
v_lshlrev_b32 v124, 2, v124
v_add_u32 v124, 256, v124
s_lshl_b32 s22, s29, 2
s_add_u32 s22, s22, s17
s_lshl_b32 s22, s22, 2
v_mov_b32 v2, s22
v_mov_b32 v3, 0x10000000
v_cmp_eq_u32 vcc, 0, v0
v_mov_b32 v122, 1
s_nop 0
v_cndmask_b32 v126, v3, v2, vcc
v_mov_b32 v121, 0
v_mov_b32 v122, 1
s_lshl_b32 s22, s29, 4
s_lshl_b32 s23, s17, 2
s_add_u32 s39, s22, s23
s_add_u32 s39, s39, 68124672
s_lshl_b32 s22, s29, 2
s_add_u32 s56, s22, 68141056
s_lshl_b32 s22, s17, 6
v_add_u32 v2, s22, v0
v_mov_b32 v3, 64
v_cmp_eq_u32 vcc, v2, v3
v_mov_b32 v3, 0x10000000
s_nop 0
v_cndmask_b32 v123, v3, 0, vcc
s_mov_b32 s28, s19
.Ldfp_179:
buffer_load_dword v120, v121, s[8:11], s39 offen sc1
s_waitcnt vmcnt(0)
v_readfirstlane_b32 s21, v120
s_nop 3
s_cmp_lg_u32 s21, 0
s_cbranch_scc1 .Ldfo_180
s_sub_u32 s28, s28, 1
s_cbranch_scc0 .Ldfp_179
s_mov_b32 s19, 0
.Ldfo_180:
.p2align 6
.Lvloop_181:
v_mov_b64 v[72:73], 0
v_mov_b64 v[88:89], 0
v_mov_b64 v[74:75], 0
v_mov_b64 v[90:91], 0
s_add_u32 s59, s18, 1
s_mov_b32 s28, s19
.Lvpoll_182:
buffer_load_dwordx4 v[32:35], v109, s[8:11], s30 offen sc1
buffer_load_dwordx4 v[36:39], v111, s[8:11], s30 offen sc1
s_waitcnt vmcnt(1)
ds_write_b128 v109, v[32:35]
v_max3_u32 v2, v32, v33, v34
v_max_u32 v2, v2, v35
s_waitcnt vmcnt(0)
ds_write_b128 v109, v[36:39] offset:4096
v_max3_u32 v2, v2, v36, v37
v_max3_u32 v2, v2, v38, v39
v_cmp_eq_u32 vcc, -1, v2
s_cbranch_vccnz .Lmfail_184
.Lvpok_183:
s_waitcnt lgkmcnt(0)
s_barrier
ds_read_b128 v[4:7], v108 offset:0
ds_read_b128 v[8:11], v108 offset:1024
ds_read_b128 v[12:15], v108 offset:2048
ds_read_b128 v[16:19], v108 offset:3072
ds_read_b128 v[20:23], v108 offset:4096
ds_read_b128 v[24:27], v108 offset:5120
ds_read_b128 v[28:31], v108 offset:6144
s_cmp_gt_u32 s18, 12
s_cbranch_scc1 .Ldq_185
v_readfirstlane_b32 s21, v120
s_nop 3
s_cmp_lg_u32 s21, 0
s_cbranch_scc1 .Ldok_188
s_mov_b32 s28, s19
.Ldfp_189:
buffer_load_dword v120, v121, s[8:11], s39 offen sc1
s_waitcnt vmcnt(0)
v_readfirstlane_b32 s21, v120
s_nop 3
s_cmp_lg_u32 s21, 0
s_cbranch_scc1 .Ldfo_190
s_sub_u32 s28, s28, 1
s_cbranch_scc0 .Ldfp_189
s_mov_b32 s19, 0
.Ldfo_190:
.Ldok_188:
s_cmp_lg_u32 s18, 12
s_cbranch_scc1 .Ldq_185
v_cmp_eq_u32 vcc, 0, v125
s_cbranch_vccz .Ldq_185
s_lshl_b32 s22, s29, 4
s_lshl_b32 s23, s17, 2
s_add_u32 s22, s22, s23
s_add_u32 s22, s22, 68138112
v_and_b32 v2, 3, v0
v_mul_u32_u24 v2, 224, v2
s_mov_b32 s28, s19
.Ldr_186:
buffer_load_dword v120, v2, s[8:11], s22 offen sc1
s_waitcnt vmcnt(0)
v_cmp_eq_u32 vcc, 0, v120
s_cbranch_vccz .Ldo_187
s_sub_u32 s28, s28, 1
s_cbranch_scc0 .Ldr_186
s_mov_b32 s19, 0
.Ldo_187:
.Ldq_185:
s_add_u32 s60, s35, 4096
s_cmp_eq_u32 s18, 0
s_cselect_b32 s62, 68255744, s38
s_cselect_b32 s21, 0, 114688
s_add_u32 s38, s38, s21
buffer_load_dwordx4 v[32:35], v108, s[8:11], s35 offen offset:0 sc1
buffer_load_dwordx4 v[36:39], v108, s[8:11], s35 offen offset:1024 sc1
buffer_load_dwordx4 v[40:43], v108, s[8:11], s35 offen offset:2048 sc1
s_cmp_ge_u32 s18, 12
s_cbranch_scc1 .Lfle_191
s_add_u32 s39, s39, 224
buffer_load_dword v120, v121, s[8:11], s39 offen sc1
s_cmp_lg_u32 s18, 11
s_cbranch_scc1 .Lfle_191
s_lshl_b32 s22, s29, 4
s_lshl_b32 s23, s17, 2
s_add_u32 s22, s22, s23
s_add_u32 s22, s22, 68138112
v_and_b32 v124, 3, v0
v_mul_u32_u24 v124, 224, v124
buffer_load_dword v125, v124, s[8:11], s22 offen sc1
.Lfle_191:
s_add_u32 s21, s18, 1
s_and_b32 s21, s21, 3
s_mul_i32 s21, s21, 7168
s_add_u32 s32, s21, 45875200
s_add_u32 s21, s18, 3
s_and_b32 s21, s21, 3
s_mul_i32 s21, s21, 7168
s_add_u32 s33, s21, 45875200
s_and_b32 s21, s18, 3
s_mul_i32 s21, s21, 10240
s_add_u32 s31, s21, 45903872
s_mov_b32 s30, s32
buffer_store_dwordx4 v[64:67], v108, s[8:11], s62 offen sc1
buffer_store_dwordx4 v[68:71], v108, s[8:11], s62 offen offset:1024 sc1
s_waitcnt lgkmcnt(6)
v_smfmac_f32_16x16x64_bf16 v[72:75], v[4:7], a[0:7], v1
v_mov_b64 v[76:77], 0
ds_read_b128 v[92:95], v112 offset:2048
ds_read_b128 v[96:99], v112 offset:3072
s_waitcnt lgkmcnt(7)
v_smfmac_f32_16x16x64_bf16 v[72:75], v[8:11], a[8:15], v1
v_mov_b64 v[78:79], 0
buffer_load_dwordx4 v[44:47], v108, s[8:11], s35 offen offset:3072 sc1
s_waitcnt lgkmcnt(6)
v_smfmac_f32_16x16x64_bf16 v[72:75], v[12:15], a[16:23], v1
s_waitcnt lgkmcnt(5)
v_smfmac_f32_16x16x64_bf16 v[72:75], v[16:19], a[24:31], v1
buffer_load_dwordx4 v[48:51], v108, s[8:11], s60 offen offset:0 sc1
s_waitcnt lgkmcnt(4)
v_smfmac_f32_16x16x64_bf16 v[72:75], v[20:23], a[32:39], v1
s_waitcnt lgkmcnt(3)
v_smfmac_f32_16x16x64_bf16 v[72:75], v[24:27], a[40:47], v1
buffer_load_dwordx4 v[52:55], v108, s[8:11], s60 offen offset:1024 sc1
s_waitcnt lgkmcnt(2)
v_smfmac_f32_16x16x64_bf16 v[72:75], v[28:31], a[48:55], v1
s_waitcnt lgkmcnt(0)
v_smfmac_f32_16x16x64_bf16 v[88:91], v[4:7], v[92:99], v1
v_smfmac_f32_16x16x64_bf16 v[76:79], v[4:7], a[112:119], v1
v_mov_b64 v[80:81], 0
ds_read_b128 v[92:95], v112 offset:4096
ds_read_b128 v[96:99], v112 offset:5120
buffer_load_dwordx4 v[56:59], v108, s[8:11], s60 offen offset:2048 sc1
v_smfmac_f32_16x16x64_bf16 v[76:79], v[8:11], a[120:127], v1
v_mov_b64 v[82:83], 0
v_smfmac_f32_16x16x64_bf16 v[76:79], v[12:15], a[128:135], v1
buffer_load_dwordx4 v[60:63], v108, s[8:11], s60 offen offset:3072 sc1
v_smfmac_f32_16x16x64_bf16 v[76:79], v[16:19], a[136:143], v1
v_smfmac_f32_16x16x64_bf16 v[76:79], v[20:23], a[144:151], v1
v_smfmac_f32_16x16x64_bf16 v[76:79], v[24:27], a[152:159], v1
v_smfmac_f32_16x16x64_bf16 v[76:79], v[28:31], a[160:167], v1
s_waitcnt lgkmcnt(0)
v_smfmac_f32_16x16x64_bf16 v[88:91], v[8:11], v[92:99], v1
v_smfmac_f32_16x16x64_bf16 v[80:83], v[4:7], a[224:231], v1
v_mov_b64 v[84:85], 0
ds_read_b128 v[92:95], v112 offset:6144
ds_read_b128 v[96:99], v112 offset:7168
v_smfmac_f32_16x16x64_bf16 v[80:83], v[8:11], a[232:239], v1
v_mov_b64 v[86:87], 0
v_smfmac_f32_16x16x64_bf16 v[80:83], v[12:15], a[240:247], v1
v_permlane32_swap_b32 v72, v76
v_smfmac_f32_16x16x64_bf16 v[80:83], v[16:19], a[248:255], v1
v_permlane32_swap_b32 v73, v77
v_smfmac_f32_16x16x64_bf16 v[80:83], v[20:23], v[128:135], v1
v_permlane32_swap_b32 v74, v78
v_smfmac_f32_16x16x64_bf16 v[80:83], v[24:27], v[136:143], v1
v_permlane32_swap_b32 v75, v79
v_smfmac_f32_16x16x64_bf16 v[80:83], v[28:31], v[144:151], v1
v_add_f32 v72, v72, v76
s_waitcnt lgkmcnt(0)
v_smfmac_f32_16x16x64_bf16 v[88:91], v[12:15], v[92:99], v1
v_add_f32 v73, v73, v77
v_smfmac_f32_16x16x64_bf16 v[84:87], v[4:7], v[208:215], v1
v_add_f32 v74, v74, v78
ds_read_b128 v[92:95], v112 offset:8192
ds_read_b128 v[96:99], v112 offset:9216
v_smfmac_f32_16x16x64_bf16 v[84:87], v[8:11], v[216:223], v1
v_add_f32 v75, v75, v79
ds_read_b128 v[100:103], v112 offset:0
ds_read_b128 v[104:107], v112 offset:1024
v_smfmac_f32_16x16x64_bf16 v[84:87], v[12:15], v[224:231], v1
v_cvt_pk_bf16_f32 v64, v72, v73
v_smfmac_f32_16x16x64_bf16 v[84:87], v[16:19], v[232:239], v1
v_cvt_pk_bf16_f32 v65, v74, v75
v_smfmac_f32_16x16x64_bf16 v[84:87], v[20:23], v[240:247], v1
v_mov_b64 v[72:73], 0
v_smfmac_f32_16x16x64_bf16 v[84:87], v[24:27], v[248:255], v1
v_mov_b64 v[74:75], 0
s_waitcnt lgkmcnt(0)
v_smfmac_f32_16x16x64_bf16 v[84:87], v[28:31], v[100:107], v1
v_smfmac_f32_16x16x64_bf16 v[88:91], v[16:19], v[92:99], v1
v_smfmac_f32_16x16x64_bf16 v[72:75], v[4:7], a[56:63], v1
v_mov_b64 v[76:77], 0
ds_read_b128 v[92:95], v112 offset:10240
ds_read_b128 v[96:99], v112 offset:11264
v_smfmac_f32_16x16x64_bf16 v[72:75], v[8:11], a[64:71], v1
v_mov_b64 v[78:79], 0
v_smfmac_f32_16x16x64_bf16 v[72:75], v[12:15], a[72:79], v1
v_permlane32_swap_b32 v80, v84
v_smfmac_f32_16x16x64_bf16 v[72:75], v[16:19], a[80:87], v1
v_permlane32_swap_b32 v81, v85
v_smfmac_f32_16x16x64_bf16 v[72:75], v[20:23], a[88:95], v1
v_permlane32_swap_b32 v82, v86
v_smfmac_f32_16x16x64_bf16 v[72:75], v[24:27], a[96:103], v1
v_permlane32_swap_b32 v83, v87
v_smfmac_f32_16x16x64_bf16 v[72:75], v[28:31], a[104:111], v1
v_add_f32 v80, v80, v84
s_waitcnt lgkmcnt(0)
v_smfmac_f32_16x16x64_bf16 v[88:91], v[20:23], v[92:99], v1
v_add_f32 v81, v81, v85
v_smfmac_f32_16x16x64_bf16 v[76:79], v[4:7], a[168:175], v1
v_add_f32 v82, v82, v86
ds_read_b128 v[92:95], v112 offset:12288
ds_read_b128 v[96:99], v112 offset:13312
v_smfmac_f32_16x16x64_bf16 v[76:79], v[8:11], a[176:183], v1
v_add_f32 v83, v83, v87
v_smfmac_f32_16x16x64_bf16 v[76:79], v[12:15], a[184:191], v1
v_cvt_pk_bf16_f32 v66, v80, v81
v_smfmac_f32_16x16x64_bf16 v[76:79], v[16:19], a[192:199], v1
v_cvt_pk_bf16_f32 v67, v82, v83
v_smfmac_f32_16x16x64_bf16 v[76:79], v[20:23], a[200:207], v1
v_mov_b64 v[80:81], 0
v_smfmac_f32_16x16x64_bf16 v[76:79], v[24:27], a[208:215], v1
v_mov_b64 v[82:83], 0
v_smfmac_f32_16x16x64_bf16 v[76:79], v[28:31], a[216:223], v1
s_waitcnt lgkmcnt(0)
v_smfmac_f32_16x16x64_bf16 v[88:91], v[24:27], v[92:99], v1
v_smfmac_f32_16x16x64_bf16 v[80:83], v[4:7], v[152:159], v1
ds_read_b128 v[92:95], v112 offset:14336
ds_read_b128 v[96:99], v112 offset:15360
v_smfmac_f32_16x16x64_bf16 v[80:83], v[8:11], v[160:167], v1
v_smfmac_f32_16x16x64_bf16 v[80:83], v[12:15], v[168:175], v1
v_permlane32_swap_b32 v72, v76
v_smfmac_f32_16x16x64_bf16 v[80:83], v[16:19], v[176:183], v1
v_permlane32_swap_b32 v73, v77
v_smfmac_f32_16x16x64_bf16 v[80:83], v[20:23], v[184:191], v1
v_permlane32_swap_b32 v74, v78
v_smfmac_f32_16x16x64_bf16 v[80:83], v[24:27], v[192:199], v1
v_permlane32_swap_b32 v75, v79
v_smfmac_f32_16x16x64_bf16 v[80:83], v[28:31], v[200:207], v1
v_add_f32 v72, v72, v76
s_waitcnt lgkmcnt(0)
v_smfmac_f32_16x16x64_bf16 v[88:91], v[28:31], v[92:99], v1
v_add_f32 v73, v73, v77
s_add_u32 s35, s35, 458752
v_add_f32 v74, v74, v78
v_add_f32 v75, v75, v79
v_cvt_pk_bf16_f32 v68, v72, v73
v_cvt_pk_bf16_f32 v69, v74, v75
s_nop 3
v_permlane32_swap_b32 v80, v88
v_permlane32_swap_b32 v81, v89
v_permlane32_swap_b32 v82, v90
v_permlane32_swap_b32 v83, v91
v_add_f32 v80, v80, v88
v_add_f32 v81, v81, v89
v_add_f32 v82, v82, v90
v_add_f32 v83, v83, v91
v_cvt_pk_bf16_f32 v70, v80, v81
v_cvt_pk_bf16_f32 v71, v82, v83
s_cmp_ge_u32 s18, 63
s_cbranch_scc1 .Lvfin_192
s_sleep 1
s_mov_b32 s28, s19
buffer_load_dwordx4 v[12:15], v114, s[8:11], s31 offen sc1
buffer_load_dwordx4 v[4:7], v113, s[8:11], s31 offen sc1
buffer_load_dwordx4 v[8:11], v113, s[8:11], s31 offen offset:1024 sc1
s_sleep 2
buffer_load_dwordx4 v[24:27], v114, s[8:11], s31 offen sc1
buffer_load_dwordx4 v[16:19], v113, s[8:11], s31 offen sc1
buffer_load_dwordx4 v[20:23], v113, s[8:11], s31 offen offset:1024 sc1
.Lppoll_193:
s_waitcnt vmcnt(5)
v_mfma_f32_16x16x32_bf16 v[72:75], v[12:15], v[64:67], 0
v_max3_u32 v2, v12, v13, v14
v_mfma_f32_16x16x32_bf16 v[76:79], v[12:15], v[68:71], 0
s_waitcnt vmcnt(4)
v_smfmac_f32_16x16x64_bf16 v[72:75], v[4:7], v[32:39], v1
v_max3_u32 v2, v2, v15, v4
v_max3_u32 v2, v2, v5, v6
v_smfmac_f32_16x16x64_bf16 v[76:79], v[4:7], v[48:55], v1
s_waitcnt vmcnt(3)
v_smfmac_f32_16x16x64_bf16 v[72:75], v[8:11], v[40:47], v1
v_max3_u32 v2, v2, v7, v8
v_max3_u32 v2, v2, v9, v10
v_smfmac_f32_16x16x64_bf16 v[76:79], v[8:11], v[56:63], v1
v_max_u32 v2, v2, v11
v_cmp_eq_u32 vcc, -1, v2
s_cbranch_vccnz .Lpfail_195
.Lppok_194:
s_nop 4
v_permlane32_swap_b32 v72, v76
v_permlane32_swap_b32 v73, v77
v_permlane32_swap_b32 v74, v78
v_permlane32_swap_b32 v75, v79
v_add_f32 v72, v72, v76
v_add_f32 v73, v73, v77
v_add_f32 v74, v74, v78
v_add_f32 v75, v75, v79
ds_write2st64_b32 v115, v72, v73 offset0:0 offset1:1
ds_write2st64_b32 v115, v74, v75 offset0:2 offset1:3
s_cmp_lg_u32 s17, 0
s_cbranch_scc1 .Lvoth_197
s_waitcnt lgkmcnt(0)
s_barrier
ds_read_b128 v[32:35], v116 offset:0
ds_read_b128 v[36:39], v116 offset:1024
ds_read_b128 v[40:43], v116 offset:2048
ds_read_b128 v[44:47], v116 offset:3072
s_waitcnt lgkmcnt(2)
v_pk_add_f32 v[32:33], v[32:33], v[36:37]
v_pk_add_f32 v[34:35], v[34:35], v[38:39]
s_waitcnt lgkmcnt(0)
v_pk_add_f32 v[40:41], v[40:41], v[44:45]
v_pk_add_f32 v[42:43], v[42:43], v[46:47]
v_pk_add_f32 v[32:33], v[32:33], v[40:41]
v_pk_add_f32 v[34:35], v[34:35], v[42:43]
v_cvt_pk_bf16_f32 v32, v32, v33
v_cvt_pk_bf16_f32 v33, v34, v35
buffer_store_dwordx2 v[32:33], v117, s[8:11], s32 offen sc1
buffer_store_dwordx2 v[118:119], v117, s[8:11], s33 offen sc1
buffer_store_dwordx2 v[32:33], v117, s[8:11], s34 offen sc1
.Lvnext_196:
s_barrier
s_add_u32 s34, s34, 7168
s_add_u32 s18, s18, 1
s_branch .Lvloop_181
.Lmfail_184:
s_sub_u32 s28, s28, 1
s_cbranch_scc0 .Lvpoll_182
s_mov_b32 s19, 0
s_branch .Lvpok_183
.Lpfail_195:
buffer_load_dwordx4 v[12:15], v114, s[8:11], s31 offen sc1
buffer_load_dwordx4 v[4:7], v113, s[8:11], s31 offen sc1
buffer_load_dwordx4 v[8:11], v113, s[8:11], s31 offen offset:1024 sc1
s_waitcnt vmcnt(5)
v_mfma_f32_16x16x32_bf16 v[72:75], v[24:27], v[64:67], 0
v_max3_u32 v2, v24, v25, v26
v_mfma_f32_16x16x32_bf16 v[76:79], v[24:27], v[68:71], 0
s_waitcnt vmcnt(4)
v_smfmac_f32_16x16x64_bf16 v[72:75], v[16:19], v[32:39], v1
v_max3_u32 v2, v2, v27, v16
v_max3_u32 v2, v2, v17, v18
v_smfmac_f32_16x16x64_bf16 v[76:79], v[16:19], v[48:55], v1
s_waitcnt vmcnt(3)
v_smfmac_f32_16x16x64_bf16 v[72:75], v[20:23], v[40:47], v1
v_max3_u32 v2, v2, v19, v20
v_max3_u32 v2, v2, v21, v22
v_smfmac_f32_16x16x64_bf16 v[76:79], v[20:23], v[56:63], v1
v_max_u32 v2, v2, v23
v_cmp_eq_u32 vcc, -1, v2
s_cbranch_vccz .Lppok_194
buffer_load_dwordx4 v[24:27], v114, s[8:11], s31 offen sc1
buffer_load_dwordx4 v[16:19], v113, s[8:11], s31 offen sc1
buffer_load_dwordx4 v[20:23], v113, s[8:11], s31 offen offset:1024 sc1
s_sub_u32 s28, s28, 1
s_cbranch_scc0 .Lppoll_193
s_mov_b32 s19, 0
s_branch .Lppok_194
.Lvoth_197:
s_waitcnt lgkmcnt(0)
s_barrier
s_branch .Lvnext_196
.Lvfin_192:
buffer_store_dwordx4 v[64:67], v108, s[8:11], s38 offen sc1
buffer_store_dwordx4 v[68:71], v108, s[8:11], s38 offen offset:1024 sc1
s_add_u32 s38, s38, 114688
s_waitcnt vmcnt(0)
s_mov_b32 s21, 68175424
buffer_store_dword v122, v126, s[8:11], s21 offen sc1
buffer_store_dword v122, v126, s[8:11], s21 offen offset:224 sc1
s_waitcnt vmcnt(0)
s_barrier
s_sub_u32 s29, s16, 16
v_lshlrev_b32 v108, 4, v0
s_lshl_b32 s21, s29, 2
s_add_u32 s21, s21, s17
s_mul_i32 s21, s21, 114688
s_add_u32 s21, s21, 6422528
s_lshl_b32 s22, s17, 14
s_add_u32 s22, s22, 8192
v_add_u32 v112, s22, v108
v_and_b32 v2, 8, v0
v_mov_b32 v1, 0x44444444
v_mov_b32 v3, 0xeeeeeeee
v_cmp_ne_u32 vcc, 0, v2
v_mov_b32 v118, -1
v_mov_b32 v119, -1
v_cndmask_b32 v1, v1, v3, vcc
s_lshl_b32 s22, s17, 10
v_add_u32 v109, s22, v108
s_movk_i32 s23, 4096
s_cmp_eq_u32 s17, 3
s_cselect_b32 s23, 0x10000000, s23
v_add_u32 v111, s23, v109
s_lshl_b32 s22, s17, 11
v_add_u32 v113, s22, v108
s_lshl_b32 s22, s17, 9
s_add_u32 s22, s22, 8192
v_lshrrev_b32 v2, 4, v0
v_and_b32 v3, 15, v0
v_lshlrev_b32 v4, 7, v2
v_lshlrev_b32 v5, 4, v3
v_add3_u32 v4, v4, v5, s22
v_mov_b32 v5, 0x10000000
v_cmp_gt_u32 vcc, 8, v3
s_nop 1
v_cndmask_b32 v114, v5, v4, vcc
s_lshl_b32 s22, s17, 10
s_add_u32 s22, s22, 73728
v_lshlrev_b32 v4, 2, v0
v_add_u32 v115, s22, v4
v_add_u32 v116, 73728, v108
v_lshrrev_b32 v2, 4, v0
v_lshrrev_b32 v3, 2, v0
v_and_b32 v3, 1, v3
v_lshlrev_b32 v3, 2, v3
v_add_u32 v2, v2, v3
v_lshlrev_b32 v2, 4, v2
v_lshrrev_b32 v3, 3, v0
v_and_b32 v3, 1, v3
v_lshlrev_b32 v3, 1, v3
v_lshrrev_b32 v4, 1, v0
v_and_b32 v4, 1, v4
v_add_u32 v3, v3, v4
v_lshlrev_b32 v3, 7, v3
v_and_b32 v4, 1, v0
v_lshlrev_b32 v4, 3, v4
v_add3_u32 v2, v2, v3, v4
s_lshl_b32 s22, s29, 9
v_add_u32 v117, s22, v2
s_lshl_b32 s22, s29, 15
s_lshl_b32 s23, s17, 13
s_add_u32 s35, s22, s23
s_add_u32 s35, s35, 72056832
s_lshl_b32 s22, s29, 13
s_lshl_b32 s23, s17, 11
s_add_u32 s38, s22, s23
s_add_u32 s38, s38, 101945344
s_mov_b32 s18, 0
s_mov_b32 s19, 20000
s_mov_b32 s30, 101486592
s_mov_b32 s34, 101493760
s_mov_b32 s57, 118124544
v_min_u32 v125, 55, v0
v_lshlrev_b32 v125, 2, v125
v_and_b32 v124, 31, v0
v_lshlrev_b32 v124, 2, v124
v_add_u32 v124, 256, v124
s_lshl_b32 s22, s29, 2
s_add_u32 s22, s22, s17
s_lshl_b32 s22, s22, 2
v_mov_b32 v2, s22
v_mov_b32 v3, 0x10000000
v_cmp_eq_u32 vcc, 0, v0
v_mov_b32 v122, 1
s_nop 0
v_cndmask_b32 v126, v3, v2, vcc
v_mov_b32 v121, 0
v_mov_b32 v122, 1
s_lshl_b32 s22, s29, 4
s_lshl_b32 s23, s17, 2
s_add_u32 s39, s22, s23
s_add_u32 s39, s39, 118091776
s_lshl_b32 s22, s29, 2
s_add_u32 s56, s22, 118108160
s_lshl_b32 s22, s17, 6
v_add_u32 v2, s22, v0
v_mov_b32 v3, 64
v_cmp_eq_u32 vcc, v2, v3
v_mov_b32 v3, 0x10000000
s_nop 0
v_cndmask_b32 v123, v3, 0, vcc
v_mov_b32 v120, 1
.p2align 6
.Lvloop_198:
v_mov_b64 v[72:73], 0
v_mov_b64 v[88:89], 0
v_mov_b64 v[74:75], 0
v_mov_b64 v[90:91], 0
s_add_u32 s59, s18, 1
s_mov_b32 s28, s19
.Lvpoll_199:
buffer_load_dwordx4 v[32:35], v109, s[8:11], s30 offen sc1
buffer_load_dwordx4 v[36:39], v111, s[8:11], s30 offen sc1
s_waitcnt vmcnt(1)
ds_write_b128 v109, v[32:35]
v_max3_u32 v2, v32, v33, v34
v_max_u32 v2, v2, v35
s_waitcnt vmcnt(0)
ds_write_b128 v109, v[36:39] offset:4096
v_max3_u32 v2, v2, v36, v37
v_max3_u32 v2, v2, v38, v39
v_cmp_eq_u32 vcc, -1, v2
s_cbranch_vccnz .Lmfail_201
.Lvpok_200:
s_waitcnt lgkmcnt(0)
s_barrier
ds_read_b128 v[4:7], v108 offset:0
ds_read_b128 v[8:11], v108 offset:1024
ds_read_b128 v[12:15], v108 offset:2048
ds_read_b128 v[16:19], v108 offset:3072
ds_read_b128 v[20:23], v108 offset:4096
ds_read_b128 v[24:27], v108 offset:5120
ds_read_b128 v[28:31], v108 offset:6144
s_cmp_gt_u32 s18, 12
s_cbranch_scc1 .Ldq_202
v_readfirstlane_b32 s21, v120
s_nop 3
s_cmp_lg_u32 s21, 0
s_cbranch_scc1 .Ldok_205
s_mov_b32 s28, s19
.Ldfp_206:
buffer_load_dword v120, v121, s[8:11], s39 offen sc1
s_waitcnt vmcnt(0)
v_readfirstlane_b32 s21, v120
s_nop 3
s_cmp_lg_u32 s21, 0
s_cbranch_scc1 .Ldfo_207
s_sub_u32 s28, s28, 1
s_cbranch_scc0 .Ldfp_206
s_mov_b32 s19, 0
.Ldfo_207:
.Ldok_205:
s_cmp_lg_u32 s18, 12
s_cbranch_scc1 .Ldq_202
v_cmp_eq_u32 vcc, 0, v125
s_cbranch_vccz .Ldq_202
s_lshl_b32 s22, s29, 4
s_lshl_b32 s23, s17, 2
s_add_u32 s22, s22, s23
s_add_u32 s22, s22, 118105216
v_and_b32 v2, 3, v0
v_mul_u32_u24 v2, 224, v2
s_mov_b32 s28, s19
.Ldr_203:
buffer_load_dword v120, v2, s[8:11], s22 offen sc1
s_waitcnt vmcnt(0)
v_cmp_eq_u32 vcc, 0, v120
s_cbranch_vccz .Ldo_204
s_sub_u32 s28, s28, 1
s_cbranch_scc0 .Ldr_203
s_mov_b32 s19, 0
.Ldo_204:
.Ldq_202:
s_add_u32 s60, s35, 4096
s_cmp_eq_u32 s18, 0
s_cselect_b32 s62, 68255744, s38
s_cselect_b32 s21, 0, 114688
s_add_u32 s38, s38, s21
buffer_load_dwordx4 v[32:35], v108, s[8:11], s35 offen offset:0 sc1
buffer_load_dwordx4 v[36:39], v108, s[8:11], s35 offen offset:1024 sc1
buffer_load_dwordx4 v[40:43], v108, s[8:11], s35 offen offset:2048 sc1
s_cmp_ge_u32 s18, 12
s_cbranch_scc1 .Lfle_208
s_add_u32 s39, s39, 224
buffer_load_dword v120, v121, s[8:11], s39 offen sc1
s_cmp_lg_u32 s18, 11
s_cbranch_scc1 .Lfle_208
s_lshl_b32 s22, s29, 4
s_lshl_b32 s23, s17, 2
s_add_u32 s22, s22, s23
s_add_u32 s22, s22, 118105216
v_and_b32 v124, 3, v0
v_mul_u32_u24 v124, 224, v124
buffer_load_dword v125, v124, s[8:11], s22 offen sc1
.Lfle_208:
s_add_u32 s21, s18, 1
s_and_b32 s21, s21, 3
s_mul_i32 s21, s21, 7168
s_add_u32 s32, s21, 101416960
s_add_u32 s21, s18, 3
s_and_b32 s21, s21, 3
s_mul_i32 s21, s21, 7168
s_add_u32 s33, s21, 101416960
s_and_b32 s21, s18, 3
s_mul_i32 s21, s21, 10240
s_add_u32 s31, s21, 101445632
s_mov_b32 s30, s32
buffer_store_dwordx4 v[64:67], v108, s[8:11], s62 offen sc1
buffer_store_dwordx4 v[68:71], v108, s[8:11], s62 offen offset:1024 sc1
s_waitcnt lgkmcnt(6)
v_smfmac_f32_16x16x64_bf16 v[72:75], v[4:7], a[0:7], v1
v_mov_b64 v[76:77], 0
ds_read_b128 v[92:95], v112 offset:2048
ds_read_b128 v[96:99], v112 offset:3072
s_waitcnt lgkmcnt(7)
v_smfmac_f32_16x16x64_bf16 v[72:75], v[8:11], a[8:15], v1
v_mov_b64 v[78:79], 0
buffer_load_dwordx4 v[44:47], v108, s[8:11], s35 offen offset:3072 sc1
s_waitcnt lgkmcnt(6)
v_smfmac_f32_16x16x64_bf16 v[72:75], v[12:15], a[16:23], v1
s_waitcnt lgkmcnt(5)
v_smfmac_f32_16x16x64_bf16 v[72:75], v[16:19], a[24:31], v1
buffer_load_dwordx4 v[48:51], v108, s[8:11], s60 offen offset:0 sc1
s_waitcnt lgkmcnt(4)
v_smfmac_f32_16x16x64_bf16 v[72:75], v[20:23], a[32:39], v1
s_waitcnt lgkmcnt(3)
v_smfmac_f32_16x16x64_bf16 v[72:75], v[24:27], a[40:47], v1
buffer_load_dwordx4 v[52:55], v108, s[8:11], s60 offen offset:1024 sc1
s_waitcnt lgkmcnt(2)
v_smfmac_f32_16x16x64_bf16 v[72:75], v[28:31], a[48:55], v1
s_waitcnt lgkmcnt(0)
v_smfmac_f32_16x16x64_bf16 v[88:91], v[4:7], v[92:99], v1
v_smfmac_f32_16x16x64_bf16 v[76:79], v[4:7], a[112:119], v1
v_mov_b64 v[80:81], 0
ds_read_b128 v[92:95], v112 offset:4096
ds_read_b128 v[96:99], v112 offset:5120
buffer_load_dwordx4 v[56:59], v108, s[8:11], s60 offen offset:2048 sc1
v_smfmac_f32_16x16x64_bf16 v[76:79], v[8:11], a[120:127], v1
v_mov_b64 v[82:83], 0
v_smfmac_f32_16x16x64_bf16 v[76:79], v[12:15], a[128:135], v1
buffer_load_dwordx4 v[60:63], v108, s[8:11], s60 offen offset:3072 sc1
v_smfmac_f32_16x16x64_bf16 v[76:79], v[16:19], a[136:143], v1
v_smfmac_f32_16x16x64_bf16 v[76:79], v[20:23], a[144:151], v1
v_smfmac_f32_16x16x64_bf16 v[76:79], v[24:27], a[152:159], v1
v_smfmac_f32_16x16x64_bf16 v[76:79], v[28:31], a[160:167], v1
s_waitcnt lgkmcnt(0)
v_smfmac_f32_16x16x64_bf16 v[88:91], v[8:11], v[92:99], v1
v_smfmac_f32_16x16x64_bf16 v[80:83], v[4:7], a[224:231], v1
v_mov_b64 v[84:85], 0
ds_read_b128 v[92:95], v112 offset:6144
ds_read_b128 v[96:99], v112 offset:7168
v_smfmac_f32_16x16x64_bf16 v[80:83], v[8:11], a[232:239], v1
v_mov_b64 v[86:87], 0
v_smfmac_f32_16x16x64_bf16 v[80:83], v[12:15], a[240:247], v1
v_permlane32_swap_b32 v72, v76
v_smfmac_f32_16x16x64_bf16 v[80:83], v[16:19], a[248:255], v1
v_permlane32_swap_b32 v73, v77
v_smfmac_f32_16x16x64_bf16 v[80:83], v[20:23], v[128:135], v1
v_permlane32_swap_b32 v74, v78
v_smfmac_f32_16x16x64_bf16 v[80:83], v[24:27], v[136:143], v1
v_permlane32_swap_b32 v75, v79
v_smfmac_f32_16x16x64_bf16 v[80:83], v[28:31], v[144:151], v1
v_add_f32 v72, v72, v76
s_waitcnt lgkmcnt(0)
v_smfmac_f32_16x16x64_bf16 v[88:91], v[12:15], v[92:99], v1
v_add_f32 v73, v73, v77
v_smfmac_f32_16x16x64_bf16 v[84:87], v[4:7], v[208:215], v1
v_add_f32 v74, v74, v78
ds_read_b128 v[92:95], v112 offset:8192
ds_read_b128 v[96:99], v112 offset:9216
v_smfmac_f32_16x16x64_bf16 v[84:87], v[8:11], v[216:223], v1
v_add_f32 v75, v75, v79
ds_read_b128 v[100:103], v112 offset:0
ds_read_b128 v[104:107], v112 offset:1024
v_smfmac_f32_16x16x64_bf16 v[84:87], v[12:15], v[224:231], v1
v_cvt_pk_bf16_f32 v64, v72, v73
v_smfmac_f32_16x16x64_bf16 v[84:87], v[16:19], v[232:239], v1
v_cvt_pk_bf16_f32 v65, v74, v75
v_smfmac_f32_16x16x64_bf16 v[84:87], v[20:23], v[240:247], v1
v_mov_b64 v[72:73], 0
v_smfmac_f32_16x16x64_bf16 v[84:87], v[24:27], v[248:255], v1
v_mov_b64 v[74:75], 0
s_waitcnt lgkmcnt(0)
v_smfmac_f32_16x16x64_bf16 v[84:87], v[28:31], v[100:107], v1
v_smfmac_f32_16x16x64_bf16 v[88:91], v[16:19], v[92:99], v1
v_smfmac_f32_16x16x64_bf16 v[72:75], v[4:7], a[56:63], v1
v_mov_b64 v[76:77], 0
ds_read_b128 v[92:95], v112 offset:10240
ds_read_b128 v[96:99], v112 offset:11264
v_smfmac_f32_16x16x64_bf16 v[72:75], v[8:11], a[64:71], v1
v_mov_b64 v[78:79], 0
v_smfmac_f32_16x16x64_bf16 v[72:75], v[12:15], a[72:79], v1
v_permlane32_swap_b32 v80, v84
v_smfmac_f32_16x16x64_bf16 v[72:75], v[16:19], a[80:87], v1
v_permlane32_swap_b32 v81, v85
v_smfmac_f32_16x16x64_bf16 v[72:75], v[20:23], a[88:95], v1
v_permlane32_swap_b32 v82, v86
v_smfmac_f32_16x16x64_bf16 v[72:75], v[24:27], a[96:103], v1
v_permlane32_swap_b32 v83, v87
v_smfmac_f32_16x16x64_bf16 v[72:75], v[28:31], a[104:111], v1
v_add_f32 v80, v80, v84
s_waitcnt lgkmcnt(0)
v_smfmac_f32_16x16x64_bf16 v[88:91], v[20:23], v[92:99], v1
v_add_f32 v81, v81, v85
v_smfmac_f32_16x16x64_bf16 v[76:79], v[4:7], a[168:175], v1
v_add_f32 v82, v82, v86
ds_read_b128 v[92:95], v112 offset:12288
ds_read_b128 v[96:99], v112 offset:13312
v_smfmac_f32_16x16x64_bf16 v[76:79], v[8:11], a[176:183], v1
v_add_f32 v83, v83, v87
v_smfmac_f32_16x16x64_bf16 v[76:79], v[12:15], a[184:191], v1
v_cvt_pk_bf16_f32 v66, v80, v81
v_smfmac_f32_16x16x64_bf16 v[76:79], v[16:19], a[192:199], v1
v_cvt_pk_bf16_f32 v67, v82, v83
v_smfmac_f32_16x16x64_bf16 v[76:79], v[20:23], a[200:207], v1
v_mov_b64 v[80:81], 0
v_smfmac_f32_16x16x64_bf16 v[76:79], v[24:27], a[208:215], v1
v_mov_b64 v[82:83], 0
v_smfmac_f32_16x16x64_bf16 v[76:79], v[28:31], a[216:223], v1
s_waitcnt lgkmcnt(0)
v_smfmac_f32_16x16x64_bf16 v[88:91], v[24:27], v[92:99], v1
v_smfmac_f32_16x16x64_bf16 v[80:83], v[4:7], v[152:159], v1
ds_read_b128 v[92:95], v112 offset:14336
ds_read_b128 v[96:99], v112 offset:15360
v_smfmac_f32_16x16x64_bf16 v[80:83], v[8:11], v[160:167], v1
v_smfmac_f32_16x16x64_bf16 v[80:83], v[12:15], v[168:175], v1
v_permlane32_swap_b32 v72, v76
v_smfmac_f32_16x16x64_bf16 v[80:83], v[16:19], v[176:183], v1
v_permlane32_swap_b32 v73, v77
v_smfmac_f32_16x16x64_bf16 v[80:83], v[20:23], v[184:191], v1
v_permlane32_swap_b32 v74, v78
v_smfmac_f32_16x16x64_bf16 v[80:83], v[24:27], v[192:199], v1
v_permlane32_swap_b32 v75, v79
v_smfmac_f32_16x16x64_bf16 v[80:83], v[28:31], v[200:207], v1
v_add_f32 v72, v72, v76
s_waitcnt lgkmcnt(0)
v_smfmac_f32_16x16x64_bf16 v[88:91], v[28:31], v[92:99], v1
v_add_f32 v73, v73, v77
s_add_u32 s35, s35, 458752
v_add_f32 v74, v74, v78
v_add_f32 v75, v75, v79
v_cvt_pk_bf16_f32 v68, v72, v73
v_cvt_pk_bf16_f32 v69, v74, v75
s_nop 3
v_permlane32_swap_b32 v80, v88
v_permlane32_swap_b32 v81, v89
v_permlane32_swap_b32 v82, v90
v_permlane32_swap_b32 v83, v91
v_add_f32 v80, v80, v88
v_add_f32 v81, v81, v89
v_add_f32 v82, v82, v90
v_add_f32 v83, v83, v91
v_cvt_pk_bf16_f32 v70, v80, v81
v_cvt_pk_bf16_f32 v71, v82, v83
s_cmp_ge_u32 s18, 63
s_cbranch_scc1 .Lvfin_209
s_cmp_lg_u32 s18, 0
s_cbranch_scc1 .Ld0_210
s_lshl_b32 s21, s29, 15
s_lshl_b32 s22, s17, 13
s_add_u32 s21, s21, s22
s_add_u32 s21, s21, 72056832
s_add_u32 s22, s21, 4096
s_mov_b32 s28, s19
.Ld0_211:
s_waitcnt vmcnt(0)
v_max3_u32 v2, v32, v33, v34
v_max3_u32 v2, v2, v35, v36
v_max3_u32 v2, v2, v37, v38
v_max3_u32 v2, v2, v39, v40
v_max3_u32 v2, v2, v41, v42
v_max3_u32 v2, v2, v43, v44
v_max3_u32 v2, v2, v45, v46
v_max3_u32 v2, v2, v47, v48
v_max3_u32 v2, v2, v49, v50
v_max3_u32 v2, v2, v51, v52
v_max3_u32 v2, v2, v53, v54
v_max3_u32 v2, v2, v55, v56
v_max3_u32 v2, v2, v57, v58
v_max3_u32 v2, v2, v59, v60
v_max3_u32 v2, v2, v61, v62
v_max_u32 v2, v2, v63
s_nop 0
v_cmp_eq_u32 vcc, -1, v2
s_cbranch_vccz .Ld0_210
buffer_load_dwordx4 v[32:35], v108, s[8:11], s21 offen offset:0 sc1
buffer_load_dwordx4 v[36:39], v108, s[8:11], s21 offen offset:1024 sc1
buffer_load_dwordx4 v[40:43], v108, s[8:11], s21 offen offset:2048 sc1
buffer_load_dwordx4 v[44:47], v108, s[8:11], s21 offen offset:3072 sc1
buffer_load_dwordx4 v[48:51], v108, s[8:11], s22 offen offset:0 sc1
buffer_load_dwordx4 v[52:55], v108, s[8:11], s22 offen offset:1024 sc1
buffer_load_dwordx4 v[56:59], v108, s[8:11], s22 offen offset:2048 sc1
buffer_load_dwordx4 v[60:63], v108, s[8:11], s22 offen offset:3072 sc1
s_sub_u32 s28, s28, 1
s_cbranch_scc0 .Ld0_211
s_mov_b32 s19, 0
s_waitcnt vmcnt(0)
.Ld0_210:
s_sleep 1
s_mov_b32 s28, s19
buffer_load_dwordx4 v[12:15], v114, s[8:11], s31 offen sc1
buffer_load_dwordx4 v[4:7], v113, s[8:11], s31 offen sc1
buffer_load_dwordx4 v[8:11], v113, s[8:11], s31 offen offset:1024 sc1
s_sleep 2
buffer_load_dwordx4 v[24:27], v114, s[8:11], s31 offen sc1
buffer_load_dwordx4 v[16:19], v113, s[8:11], s31 offen sc1
buffer_load_dwordx4 v[20:23], v113, s[8:11], s31 offen offset:1024 sc1
.Lppoll_213:
s_waitcnt vmcnt(5)
v_mfma_f32_16x16x32_bf16 v[72:75], v[12:15], v[64:67], 0
v_max3_u32 v2, v12, v13, v14
v_mfma_f32_16x16x32_bf16 v[76:79], v[12:15], v[68:71], 0
s_waitcnt vmcnt(4)
v_smfmac_f32_16x16x64_bf16 v[72:75], v[4:7], v[32:39], v1
v_max3_u32 v2, v2, v15, v4
v_max3_u32 v2, v2, v5, v6
v_smfmac_f32_16x16x64_bf16 v[76:79], v[4:7], v[48:55], v1
s_waitcnt vmcnt(3)
v_smfmac_f32_16x16x64_bf16 v[72:75], v[8:11], v[40:47], v1
v_max3_u32 v2, v2, v7, v8
v_max3_u32 v2, v2, v9, v10
v_smfmac_f32_16x16x64_bf16 v[76:79], v[8:11], v[56:63], v1
v_max_u32 v2, v2, v11
v_cmp_eq_u32 vcc, -1, v2
s_cbranch_vccnz .Lpfail_215
.Lppok_214:
s_nop 4
v_permlane32_swap_b32 v72, v76
v_permlane32_swap_b32 v73, v77
v_permlane32_swap_b32 v74, v78
v_permlane32_swap_b32 v75, v79
v_add_f32 v72, v72, v76
v_add_f32 v73, v73, v77
v_add_f32 v74, v74, v78
v_add_f32 v75, v75, v79
ds_write2st64_b32 v115, v72, v73 offset0:0 offset1:1
ds_write2st64_b32 v115, v74, v75 offset0:2 offset1:3
s_cmp_lg_u32 s17, 0
s_cbranch_scc1 .Lvoth_217
s_waitcnt lgkmcnt(0)
s_barrier
ds_read_b128 v[32:35], v116 offset:0
ds_read_b128 v[36:39], v116 offset:1024
ds_read_b128 v[40:43], v116 offset:2048
ds_read_b128 v[44:47], v116 offset:3072
s_waitcnt lgkmcnt(2)
v_pk_add_f32 v[32:33], v[32:33], v[36:37]
v_pk_add_f32 v[34:35], v[34:35], v[38:39]
s_waitcnt lgkmcnt(0)
v_pk_add_f32 v[40:41], v[40:41], v[44:45]
v_pk_add_f32 v[42:43], v[42:43], v[46:47]
v_pk_add_f32 v[32:33], v[32:33], v[40:41]
v_pk_add_f32 v[34:35], v[34:35], v[42:43]
v_cvt_pk_bf16_f32 v32, v32, v33
v_cvt_pk_bf16_f32 v33, v34, v35
buffer_store_dwordx2 v[32:33], v117, s[8:11], s32 offen sc1
buffer_store_dwordx2 v[118:119], v117, s[8:11], s33 offen sc1
buffer_store_dwordx2 v[32:33], v117, s[8:11], s34 offen sc1
.Lvnext_216:
s_barrier
s_add_u32 s34, s34, 7168
s_add_u32 s18, s18, 1
s_branch .Lvloop_198
.Lmfail_201:
s_sub_u32 s28, s28, 1
s_cbranch_scc0 .Lvpoll_199
s_mov_b32 s19, 0
s_branch .Lvpok_200
.Lpfail_215:
buffer_load_dwordx4 v[12:15], v114, s[8:11], s31 offen sc1
buffer_load_dwordx4 v[4:7], v113, s[8:11], s31 offen sc1
buffer_load_dwordx4 v[8:11], v113, s[8:11], s31 offen offset:1024 sc1
s_waitcnt vmcnt(5)
v_mfma_f32_16x16x32_bf16 v[72:75], v[24:27], v[64:67], 0
v_max3_u32 v2, v24, v25, v26
v_mfma_f32_16x16x32_bf16 v[76:79], v[24:27], v[68:71], 0
s_waitcnt vmcnt(4)
v_smfmac_f32_16x16x64_bf16 v[72:75], v[16:19], v[32:39], v1
v_max3_u32 v2, v2, v27, v16
v_max3_u32 v2, v2, v17, v18
v_smfmac_f32_16x16x64_bf16 v[76:79], v[16:19], v[48:55], v1
s_waitcnt vmcnt(3)
v_smfmac_f32_16x16x64_bf16 v[72:75], v[20:23], v[40:47], v1
v_max3_u32 v2, v2, v19, v20
v_max3_u32 v2, v2, v21, v22
v_smfmac_f32_16x16x64_bf16 v[76:79], v[20:23], v[56:63], v1
v_max_u32 v2, v2, v23
v_cmp_eq_u32 vcc, -1, v2
s_cbranch_vccz .Lppok_214
buffer_load_dwordx4 v[24:27], v114, s[8:11], s31 offen sc1
buffer_load_dwordx4 v[16:19], v113, s[8:11], s31 offen sc1
buffer_load_dwordx4 v[20:23], v113, s[8:11], s31 offen offset:1024 sc1
s_sub_u32 s28, s28, 1
s_cbranch_scc0 .Lppoll_213
s_mov_b32 s19, 0
s_branch .Lppok_214
.Lvoth_217:
s_waitcnt lgkmcnt(0)
s_barrier
s_branch .Lvnext_216
.Lvfin_209:
buffer_store_dwordx4 v[64:67], v108, s[8:11], s38 offen sc1
buffer_store_dwordx4 v[68:71], v108, s[8:11], s38 offen offset:1024 sc1
s_add_u32 s38, s38, 114688
s_waitcnt vmcnt(0)
s_mov_b32 s21, 118142528
buffer_store_dword v122, v126, s[8:11], s21 offen sc1
buffer_store_dword v122, v126, s[8:11], s21 offen offset:224 sc1
s_waitcnt vmcnt(0)
s_endpgm
mega_kernel_wk:
s_sub_u32 s58, s16, 32
s_cmp_ge_u32 s58, 224
s_cbranch_scc1 mega_kernel_exit
s_and_b32 s18, s58, 3
s_lshr_b32 s21, s58, 2
s_cmp_ge_u32 s58, 64
s_cbranch_scc1 .Ldq_218
s_and_b32 s21, s58, 31
s_lshr_b32 s21, s21, 1
s_and_b32 s18, s58, 1
s_cmp_lt_u32 s58, 32
s_cselect_b32 s16, 2, 0
s_add_u32 s18, s18, s16
.Ldq_218:
s_lshr_b32 s16, s21, 2
s_and_b32 s19, s21, 3
s_lshl_b32 s21, s58, 2
s_add_u32 s21, s21, s17
s_lshl_b32 s21, s21, 6
v_add_u32 v2, s21, v0
v_lshlrev_b32 v3, 4, v2
v_mov_b32 v11, 0x10000000
v_mov_b32 v4, -1
v_mov_b32 v5, -1
v_mov_b32 v6, -1
v_mov_b32 v7, -1
v_lshrrev_b32 v9, 5, v2
v_mul_u32_u24 v9, 4096, v9
v_and_b32 v10, 31, v2
v_lshlrev_b32 v10, 4, v10
v_add_u32 v9, v9, v10
s_mov_b32 s22, 14400
v_cmp_gt_u32 vcc, s22, v2
s_nop 1
v_cndmask_b32 v9, v11, v9, vcc
s_lshl_b32 s21, s17, 6
v_add_u32 v10, s21, v0
s_movk_i32 s22, 256
v_cmp_gt_u32 vcc, s22, v10
v_lshrrev_b32 v8, 7, v10
v_mul_u32_u24 v8, 458752, v8
v_and_b32 v10, 127, v10
v_lshlrev_b32 v10, 4, v10
v_add_u32 v10, v10, v8
s_add_u32 s21, s18, 56
s_mul_i32 s21, s21, 14
s_add_u32 s21, s21, s16
s_lshl_b32 s21, s21, 13
s_lshl_b32 s22, s19, 11
s_add_u32 s24, s21, s22
v_cndmask_b32 v10, v11, v10, vcc
s_add_u32 s23, s24, 46403584
buffer_store_dwordx4 v[4:7], v10, s[8:11], s23 offen sc1
s_load_dwordx2 s[48:49], s[0:1], 0
s_load_dwordx4 s[36:39], s[0:1], 16
s_load_dwordx4 s[40:43], s[0:1], 32
s_lshr_b32 s21, s58, 5
s_and_b32 s22, s58, 31
s_lshl_b32 s21, s21, 2
s_cmp_ge_u32 s22, 28
s_cbranch_scc1 .Lf28_219
s_mul_i32 s23, s22, 37
s_lshr_b32 s23, s23, 8
s_mul_i32 s24, s23, 7
s_sub_u32 s20, s22, s24
s_add_u32 s23, s23, s21
s_branch .Lf29_220
.Lf28_219:
s_sub_u32 s22, s22, 28
s_add_u32 s22, s22, s21
s_mul_i32 s23, s22, 37
s_lshr_b32 s23, s23, 8
s_mul_i32 s24, s23, 7
s_sub_u32 s20, s22, s24
s_add_u32 s23, s23, 28
.Lf29_220:
s_lshr_b32 s18, s23, 4
s_and_b32 s19, s23, 15
s_waitcnt lgkmcnt(0)
s_cmp_eq_u32 s18, 0
s_cselect_b32 s12, s36, s40
s_cselect_b32 s13, s37, s41
s_mov_b32 s14, 3670016
s_mov_b32 s15, 0x00020000
s_cselect_b32 s44, s38, s42
s_cselect_b32 s45, s39, s43
s_mov_b32 s46, 3670016
s_mov_b32 s47, 0x00020000
v_lshrrev_b32 v10, 5, v0
v_and_b32 v11, 31, v0
v_lshlrev_b32 v12, 13, v10
v_add_u32 v13, 0, v10
v_xor_b32 v13, v13, v11
v_lshlrev_b32 v13, 4, v13
v_add_u32 v2, v13, v12
v_add_u32 v13, 2, v10
v_xor_b32 v13, v13, v11
v_lshlrev_b32 v13, 4, v13
v_add_u32 v3, v13, v12
v_add_u32 v13, 4, v10
v_xor_b32 v13, v13, v11
v_lshlrev_b32 v13, 4, v13
v_add_u32 v4, v13, v12
v_add_u32 v13, 6, v10
v_xor_b32 v13, v13, v11
v_lshlrev_b32 v13, 4, v13
v_add_u32 v5, v13, v12
v_add_u32 v13, 8, v10
v_xor_b32 v13, v13, v11
v_lshlrev_b32 v13, 4, v13
v_add_u32 v6, v13, v12
v_add_u32 v13, 10, v10
v_xor_b32 v13, v13, v11
v_lshlrev_b32 v13, 4, v13
v_add_u32 v7, v13, v12
v_add_u32 v13, 12, v10
v_xor_b32 v13, v13, v11
v_lshlrev_b32 v13, 4, v13
v_add_u32 v8, v13, v12
v_add_u32 v13, 14, v10
v_xor_b32 v13, v13, v11
v_lshlrev_b32 v13, 4, v13
v_add_u32 v9, v13, v12
s_mov_b32 s50, 1835008
s_mov_b32 s51, 0x00020000
s_lshr_b32 s60, s58, 5
s_mul_i32 s60, s60, 19
s_and_b32 s61, s58, 31
s_add_u32 s55, s60, s61
s_cmp_ge_u32 s61, 19
s_cselect_b32 s55, 128, s55
s_sub_u32 s55, s58, 96
s_min_u32 s55, s55, 128
s_lshr_b32 s52, s55, 1
s_and_b32 s53, s55, 1
s_mov_b32 s54, 0xffff0000
v_and_b32 v168, 31, v0
v_cmp_gt_u32 s[56:57], 28, v168
s_lshl_b32 s60, s55, 4
s_lshl_b32 s61, s17, 2
s_add_u32 s60, s60, s61
v_lshrrev_b32 v169, 5, v0
v_add_u32 v160, s60, v169
v_mul_u32_u24 v160, 896, v160
v_lshlrev_b32 v170, 4, v168
v_add_u32 v160, v160, v170
v_mov_b32 v171, 0x10000000
v_cndmask_b32 v160, v171, v160, s[56:57]
v_add_u32 v161, s61, v169
v_mul_u32_u24 v161, 912, v161
v_add_u32 v161, v161, v170
v_add_u32 v161, 131072, v161
s_cmp_lt_u32 s55, 128
s_cselect_b32 s60, 0, 1
s_or_b32 s60, s60, s17
s_cmp_eq_u32 s60, 0
s_cselect_b32 s60, 1, 0
v_cmp_gt_u32 vcc, s60, v0
s_lshl_b32 s61, s55, 2
s_add_u32 s61, s61, 68183040
v_mov_b32 v42, s61
v_cndmask_b32 v42, v171, v42, vcc
buffer_load_dwordx4 v[168:171], v160, s[48:51], 0 offen offset:0
buffer_load_dwordx4 v[172:175], v160, s[48:51], 0 offen offset:448
buffer_load_dwordx4 v[176:179], v160, s[48:51], 0 offen offset:1792
buffer_load_dwordx4 v[180:183], v160, s[48:51], 0 offen offset:2240
s_lshl_b32 s21, s20, 6
s_lshl_b32 s22, s17, 4
s_add_u32 s21, s21, s22
s_lshl_b32 s21, s21, 13
s_lshl_b32 s22, s19, 9
s_add_u32 s21, s21, s22
s_lshl_b32 s23, s17, 13
s_add_u32 m0, s23, 0
s_add_u32 s22, s21, 0
buffer_load_dwordx4 v2, s[12:15], s22 offen lds
s_add_u32 m0, s23, 1024
s_add_u32 s22, s21, 16384
buffer_load_dwordx4 v3, s[12:15], s22 offen lds
s_add_u32 m0, s23, 2048
s_add_u32 s22, s21, 32768
buffer_load_dwordx4 v4, s[12:15], s22 offen lds
s_add_u32 m0, s23, 3072
s_add_u32 s22, s21, 49152
buffer_load_dwordx4 v5, s[12:15], s22 offen lds
s_add_u32 m0, s23, 4096
s_add_u32 s22, s21, 65536
buffer_load_dwordx4 v6, s[12:15], s22 offen lds
s_add_u32 m0, s23, 5120
s_add_u32 s22, s21, 81920
buffer_load_dwordx4 v7, s[12:15], s22 offen lds
s_add_u32 m0, s23, 6144
s_add_u32 s22, s21, 98304
buffer_load_dwordx4 v8, s[12:15], s22 offen lds
s_add_u32 m0, s23, 7168
s_add_u32 s22, s21, 114688
buffer_load_dwordx4 v9, s[12:15], s22 offen lds
s_lshl_b32 s26, s17, 14
s_add_u32 s26, s26, 32768
s_mov_b32 s12, s6
s_mov_b32 s13, s7
s_mov_b32 s14, 256
s_mov_b32 s15, 0x00020000
s_lshl_b32 s21, s18, 4
s_add_u32 s21, s21, s19
s_mul_i32 s21, s21, 112
s_add_u32 s21, s21, s20
s_lshl_b32 s21, s21, 2
s_add_u32 s32, s21, 118222848
v_lshlrev_b32 v22, 2, v0
v_mov_b32 v40, 0x10000000
v_cmp_gt_u32 vcc, 32, v0
v_mov_b32 v41, 1
s_nop 0
v_cndmask_b32 v22, v40, v22, vcc
v_cmp_eq_u32 vcc, 0, v0
s_nop 1
v_cndmask_b32 v40, v40, 0, vcc
v_and_b32 v13, 15, v0
v_xor_b32 v13, v13, v10
v_lshlrev_b32 v13, 4, v13
v_lshlrev_b32 v14, 9, v11
v_add_u32 v14, v14, v13
v_add_u32 v15, s26, v14
v_lshrrev_b32 v13, 5, v0
v_lshlrev_b32 v13, 9, v13
v_lshrrev_b32 v17, 2, v0
v_and_b32 v17, 3, v17
v_lshlrev_b32 v17, 6, v17
v_add_u32 v13, v13, v17
v_lshrrev_b32 v17, 4, v0
v_and_b32 v17, 1, v17
v_lshlrev_b32 v17, 5, v17
v_add_u32 v13, v13, v17
v_and_b32 v17, 3, v0
v_lshlrev_b32 v17, 3, v17
v_add3_u32 v16, v13, v17, s26
v_lshrrev_b32 v13, 2, v0
v_mul_u32_u24 v13, 896, v13
v_and_b32 v17, 3, v0
v_lshlrev_b32 v17, 4, v17
v_add_u32 v17, v17, v13
v_and_b32 v13, 15, v0
v_lshlrev_b32 v18, 4, v10
v_add_u32 v13, v13, v18
v_lshlrev_b32 v13, 4, v13
v_lshrrev_b32 v18, 4, v11
v_mul_u32_u24 v19, 0x18800, v18
v_mul_u32_u24 v18, 0x3800, v18
v_add_u32 v18, v18, v13
v_add_u32 v19, v19, v13
s_mov_b32 s25, s17
s_cmp_lg_u32 s18, 0
s_cbranch_scc1 .LfC_221
s_cmp_ge_u32 s25, 12
s_cbranch_scc1 .LfO_222
s_and_b32 s21, s25, 3
s_lshr_b32 s22, s25, 2
s_mul_i32 s23, s21, 112
s_lshl_b32 s24, s22, 5
s_add_u32 s23, s23, s24
s_lshl_b32 s23, s23, 13
s_lshl_b32 s24, s19, 9
s_add_u32 s27, s23, s24
s_add_u32 m0, s26, 0
s_add_u32 s22, s27, 0
buffer_load_dwordx4 v2, s[44:47], s22 offen lds
s_add_u32 m0, s26, 1024
s_add_u32 s22, s27, 16384
buffer_load_dwordx4 v3, s[44:47], s22 offen lds
s_add_u32 m0, s26, 2048
s_add_u32 s22, s27, 65536
buffer_load_dwordx4 v4, s[44:47], s22 offen lds
s_add_u32 m0, s26, 3072
s_add_u32 s22, s27, 81920
buffer_load_dwordx4 v5, s[44:47], s22 offen lds
s_add_u32 m0, s26, 4096
s_add_u32 s22, s27, 131072
buffer_load_dwordx4 v6, s[44:47], s22 offen lds
s_add_u32 m0, s26, 5120
s_add_u32 s22, s27, 147456
buffer_load_dwordx4 v7, s[44:47], s22 offen lds
s_add_u32 m0, s26, 6144
s_add_u32 s22, s27, 196608
buffer_load_dwordx4 v8, s[44:47], s22 offen lds
s_add_u32 m0, s26, 7168
s_add_u32 s22, s27, 212992
buffer_load_dwordx4 v9, s[44:47], s22 offen lds
s_add_u32 m0, s26, 8192
s_add_u32 s22, s27, 32768
buffer_load_dwordx4 v2, s[44:47], s22 offen lds
s_add_u32 m0, s26, 9216
s_add_u32 s22, s27, 49152
buffer_load_dwordx4 v3, s[44:47], s22 offen lds
s_add_u32 m0, s26, 10240
s_add_u32 s22, s27, 98304
buffer_load_dwordx4 v4, s[44:47], s22 offen lds
s_add_u32 m0, s26, 11264
s_add_u32 s22, s27, 114688
buffer_load_dwordx4 v5, s[44:47], s22 offen lds
s_add_u32 m0, s26, 12288
s_add_u32 s22, s27, 163840
buffer_load_dwordx4 v6, s[44:47], s22 offen lds
s_add_u32 m0, s26, 13312
s_add_u32 s22, s27, 180224
buffer_load_dwordx4 v7, s[44:47], s22 offen lds
s_add_u32 m0, s26, 14336
s_add_u32 s22, s27, 229376
buffer_load_dwordx4 v8, s[44:47], s22 offen lds
s_add_u32 m0, s26, 15360
s_add_u32 s22, s27, 245760
buffer_load_dwordx4 v9, s[44:47], s22 offen lds
s_branch .LfE_223
.LfO_222:
s_sub_u32 s21, s25, 12
s_mul_i32 s23, s21, 224
s_add_u32 s23, s23, 96
s_lshl_b32 s23, s23, 13
s_lshl_b32 s24, s19, 9
s_add_u32 s27, s23, s24
s_add_u32 m0, s26, 0
s_add_u32 s22, s27, 0
buffer_load_dwordx4 v2, s[44:47], s22 offen lds
s_add_u32 m0, s26, 1024
s_add_u32 s22, s27, 16384
buffer_load_dwordx4 v3, s[44:47], s22 offen lds
s_add_u32 m0, s26, 2048
s_add_u32 s22, s27, 32768
buffer_load_dwordx4 v4, s[44:47], s22 offen lds
s_add_u32 m0, s26, 3072
s_add_u32 s22, s27, 49152
buffer_load_dwordx4 v5, s[44:47], s22 offen lds
s_add_u32 m0, s26, 4096
s_add_u32 s22, s27, 65536
buffer_load_dwordx4 v6, s[44:47], s22 offen lds
s_add_u32 m0, s26, 5120
s_add_u32 s22, s27, 81920
buffer_load_dwordx4 v7, s[44:47], s22 offen lds
s_add_u32 m0, s26, 6144
s_add_u32 s22, s27, 98304
buffer_load_dwordx4 v8, s[44:47], s22 offen lds
s_add_u32 m0, s26, 7168
s_add_u32 s22, s27, 114688
buffer_load_dwordx4 v9, s[44:47], s22 offen lds
s_add_u32 m0, s26, 8192
s_add_u32 s22, s27, 917504
buffer_load_dwordx4 v2, s[44:47], s22 offen lds
s_add_u32 m0, s26, 9216
s_add_u32 s22, s27, 933888
buffer_load_dwordx4 v3, s[44:47], s22 offen lds
s_add_u32 m0, s26, 10240
s_add_u32 s22, s27, 950272
buffer_load_dwordx4 v4, s[44:47], s22 offen lds
s_add_u32 m0, s26, 11264
s_add_u32 s22, s27, 966656
buffer_load_dwordx4 v5, s[44:47], s22 offen lds
s_add_u32 m0, s26, 12288
s_add_u32 s22, s27, 983040
buffer_load_dwordx4 v6, s[44:47], s22 offen lds
s_add_u32 m0, s26, 13312
s_add_u32 s22, s27, 999424
buffer_load_dwordx4 v7, s[44:47], s22 offen lds
s_add_u32 m0, s26, 14336
s_add_u32 s22, s27, 1015808
buffer_load_dwordx4 v8, s[44:47], s22 offen lds
s_add_u32 m0, s26, 15360
s_add_u32 s22, s27, 1032192
buffer_load_dwordx4 v9, s[44:47], s22 offen lds
s_branch .LfE_223
.LfC_221:
s_mul_i32 s23, s19, 229376
s_lshl_b32 s24, s25, 6
s_add_u32 s27, s23, s24
s_add_u32 m0, s26, 0
s_add_u32 s22, s27, 0
buffer_load_dwordx4 v17, s[44:47], s22 offen lds
s_add_u32 m0, s26, 1024
s_add_u32 s22, s27, 14336
buffer_load_dwordx4 v17, s[44:47], s22 offen lds
s_add_u32 m0, s26, 2048
s_add_u32 s22, s27, 28672
buffer_load_dwordx4 v17, s[44:47], s22 offen lds
s_add_u32 m0, s26, 3072
s_add_u32 s22, s27, 43008
buffer_load_dwordx4 v17, s[44:47], s22 offen lds
s_add_u32 m0, s26, 4096
s_add_u32 s22, s27, 57344
buffer_load_dwordx4 v17, s[44:47], s22 offen lds
s_add_u32 m0, s26, 5120
s_add_u32 s22, s27, 71680
buffer_load_dwordx4 v17, s[44:47], s22 offen lds
s_add_u32 m0, s26, 6144
s_add_u32 s22, s27, 86016
buffer_load_dwordx4 v17, s[44:47], s22 offen lds
s_add_u32 m0, s26, 7168
s_add_u32 s22, s27, 100352
buffer_load_dwordx4 v17, s[44:47], s22 offen lds
s_add_u32 m0, s26, 8192
s_add_u32 s22, s27, 114688
buffer_load_dwordx4 v17, s[44:47], s22 offen lds
s_add_u32 m0, s26, 9216
s_add_u32 s22, s27, 129024
buffer_load_dwordx4 v17, s[44:47], s22 offen lds
s_add_u32 m0, s26, 10240
s_add_u32 s22, s27, 143360
buffer_load_dwordx4 v17, s[44:47], s22 offen lds
s_add_u32 m0, s26, 11264
s_add_u32 s22, s27, 157696
buffer_load_dwordx4 v17, s[44:47], s22 offen lds
s_add_u32 m0, s26, 12288
s_add_u32 s22, s27, 172032
buffer_load_dwordx4 v17, s[44:47], s22 offen lds
s_add_u32 m0, s26, 13312
s_add_u32 s22, s27, 186368
buffer_load_dwordx4 v17, s[44:47], s22 offen lds
s_add_u32 m0, s26, 14336
s_add_u32 s22, s27, 200704
buffer_load_dwordx4 v17, s[44:47], s22 offen lds
s_add_u32 m0, s26, 15360
s_add_u32 s22, s27, 215040
buffer_load_dwordx4 v17, s[44:47], s22 offen lds
.LfE_223:
s_waitcnt vmcnt(16)
s_barrier
v_xor_b32 v13, 0, v14
ds_read_b128 a[0:3], v13
ds_read_b128 a[64:67], v13 offset:16384
v_xor_b32 v13, 32, v14
ds_read_b128 a[4:7], v13
ds_read_b128 a[68:71], v13 offset:16384
v_xor_b32 v13, 64, v14
ds_read_b128 a[8:11], v13
ds_read_b128 a[72:75], v13 offset:16384
v_xor_b32 v13, 96, v14
ds_read_b128 a[12:15], v13
ds_read_b128 a[76:79], v13 offset:16384
v_xor_b32 v13, 128, v14
ds_read_b128 a[16:19], v13
ds_read_b128 a[80:83], v13 offset:16384
v_xor_b32 v13, 160, v14
ds_read_b128 a[20:23], v13
ds_read_b128 a[84:87], v13 offset:16384
v_xor_b32 v13, 192, v14
ds_read_b128 a[24:27], v13
ds_read_b128 a[88:91], v13 offset:16384
v_xor_b32 v13, 224, v14
ds_read_b128 a[28:31], v13
ds_read_b128 a[92:95], v13 offset:16384
v_xor_b32 v13, 256, v14
ds_read_b128 a[32:35], v13
ds_read_b128 a[96:99], v13 offset:16384
v_xor_b32 v13, 288, v14
ds_read_b128 a[36:39], v13
ds_read_b128 a[100:103], v13 offset:16384
v_xor_b32 v13, 320, v14
ds_read_b128 a[40:43], v13
ds_read_b128 a[104:107], v13 offset:16384
v_xor_b32 v13, 352, v14
ds_read_b128 a[44:47], v13
ds_read_b128 a[108:111], v13 offset:16384
v_xor_b32 v13, 384, v14
ds_read_b128 a[48:51], v13
ds_read_b128 a[112:115], v13 offset:16384
v_xor_b32 v13, 416, v14
ds_read_b128 a[52:55], v13
ds_read_b128 a[116:119], v13 offset:16384
v_xor_b32 v13, 448, v14
ds_read_b128 a[56:59], v13
ds_read_b128 a[120:123], v13 offset:16384
v_xor_b32 v13, 480, v14
ds_read_b128 a[60:63], v13
ds_read_b128 a[124:127], v13 offset:16384
s_cmp_eq_u32 s18, 0
s_cselect_b32 s31, 0x3db8aa3b, 1.0
s_cmp_ge_u32 s17, 2
s_cselect_b32 s34, 0x8000, 0
s_cselect_b32 s21, 0, 0x8000
s_sub_u32 s34, s34, s21
s_waitcnt lgkmcnt(0)
s_barrier
s_add_u32 s26, s26, s34
s_add_u32 s25, s25, 4
s_cmp_lg_u32 s18, 0
s_cbranch_scc1 .LfC_224
s_cmp_ge_u32 s25, 12
s_cbranch_scc1 .LfO_225
s_and_b32 s21, s25, 3
s_lshr_b32 s22, s25, 2
s_mul_i32 s23, s21, 112
s_lshl_b32 s24, s22, 5
s_add_u32 s23, s23, s24
s_lshl_b32 s23, s23, 13
s_lshl_b32 s24, s19, 9
s_add_u32 s27, s23, s24
s_add_u32 m0, s26, 0
s_add_u32 s22, s27, 0
buffer_load_dwordx4 v2, s[44:47], s22 offen lds
s_add_u32 m0, s26, 1024
s_add_u32 s22, s27, 16384
buffer_load_dwordx4 v3, s[44:47], s22 offen lds
s_add_u32 m0, s26, 2048
s_add_u32 s22, s27, 65536
buffer_load_dwordx4 v4, s[44:47], s22 offen lds
s_add_u32 m0, s26, 3072
s_add_u32 s22, s27, 81920
buffer_load_dwordx4 v5, s[44:47], s22 offen lds
s_add_u32 m0, s26, 4096
s_add_u32 s22, s27, 131072
buffer_load_dwordx4 v6, s[44:47], s22 offen lds
s_add_u32 m0, s26, 5120
s_add_u32 s22, s27, 147456
buffer_load_dwordx4 v7, s[44:47], s22 offen lds
s_add_u32 m0, s26, 6144
s_add_u32 s22, s27, 196608
buffer_load_dwordx4 v8, s[44:47], s22 offen lds
s_add_u32 m0, s26, 7168
s_add_u32 s22, s27, 212992
buffer_load_dwordx4 v9, s[44:47], s22 offen lds
s_add_u32 m0, s26, 8192
s_add_u32 s22, s27, 32768
buffer_load_dwordx4 v2, s[44:47], s22 offen lds
s_add_u32 m0, s26, 9216
s_add_u32 s22, s27, 49152
buffer_load_dwordx4 v3, s[44:47], s22 offen lds
s_add_u32 m0, s26, 10240
s_add_u32 s22, s27, 98304
buffer_load_dwordx4 v4, s[44:47], s22 offen lds
s_add_u32 m0, s26, 11264
s_add_u32 s22, s27, 114688
buffer_load_dwordx4 v5, s[44:47], s22 offen lds
s_add_u32 m0, s26, 12288
s_add_u32 s22, s27, 163840
buffer_load_dwordx4 v6, s[44:47], s22 offen lds
s_add_u32 m0, s26, 13312
s_add_u32 s22, s27, 180224
buffer_load_dwordx4 v7, s[44:47], s22 offen lds
s_add_u32 m0, s26, 14336
s_add_u32 s22, s27, 229376
buffer_load_dwordx4 v8, s[44:47], s22 offen lds
s_add_u32 m0, s26, 15360
s_add_u32 s22, s27, 245760
buffer_load_dwordx4 v9, s[44:47], s22 offen lds
s_branch .LfE_226
.LfO_225:
s_sub_u32 s21, s25, 12
s_mul_i32 s23, s21, 224
s_add_u32 s23, s23, 96
s_lshl_b32 s23, s23, 13
s_lshl_b32 s24, s19, 9
s_add_u32 s27, s23, s24
s_add_u32 m0, s26, 0
s_add_u32 s22, s27, 0
buffer_load_dwordx4 v2, s[44:47], s22 offen lds
s_add_u32 m0, s26, 1024
s_add_u32 s22, s27, 16384
buffer_load_dwordx4 v3, s[44:47], s22 offen lds
s_add_u32 m0, s26, 2048
s_add_u32 s22, s27, 32768
buffer_load_dwordx4 v4, s[44:47], s22 offen lds
s_add_u32 m0, s26, 3072
s_add_u32 s22, s27, 49152
buffer_load_dwordx4 v5, s[44:47], s22 offen lds
s_add_u32 m0, s26, 4096
s_add_u32 s22, s27, 65536
buffer_load_dwordx4 v6, s[44:47], s22 offen lds
s_add_u32 m0, s26, 5120
s_add_u32 s22, s27, 81920
buffer_load_dwordx4 v7, s[44:47], s22 offen lds
s_add_u32 m0, s26, 6144
s_add_u32 s22, s27, 98304
buffer_load_dwordx4 v8, s[44:47], s22 offen lds
s_add_u32 m0, s26, 7168
s_add_u32 s22, s27, 114688
buffer_load_dwordx4 v9, s[44:47], s22 offen lds
s_add_u32 m0, s26, 8192
s_add_u32 s22, s27, 917504
buffer_load_dwordx4 v2, s[44:47], s22 offen lds
s_add_u32 m0, s26, 9216
s_add_u32 s22, s27, 933888
buffer_load_dwordx4 v3, s[44:47], s22 offen lds
s_add_u32 m0, s26, 10240
s_add_u32 s22, s27, 950272
buffer_load_dwordx4 v4, s[44:47], s22 offen lds
s_add_u32 m0, s26, 11264
s_add_u32 s22, s27, 966656
buffer_load_dwordx4 v5, s[44:47], s22 offen lds
s_add_u32 m0, s26, 12288
s_add_u32 s22, s27, 983040
buffer_load_dwordx4 v6, s[44:47], s22 offen lds
s_add_u32 m0, s26, 13312
s_add_u32 s22, s27, 999424
buffer_load_dwordx4 v7, s[44:47], s22 offen lds
s_add_u32 m0, s26, 14336
s_add_u32 s22, s27, 1015808
buffer_load_dwordx4 v8, s[44:47], s22 offen lds
s_add_u32 m0, s26, 15360
s_add_u32 s22, s27, 1032192
buffer_load_dwordx4 v9, s[44:47], s22 offen lds
s_branch .LfE_226
.LfC_224:
s_mul_i32 s23, s19, 229376
s_lshl_b32 s24, s25, 6
s_add_u32 s27, s23, s24
s_add_u32 m0, s26, 0
s_add_u32 s22, s27, 0
buffer_load_dwordx4 v17, s[44:47], s22 offen lds
s_add_u32 m0, s26, 1024
s_add_u32 s22, s27, 14336
buffer_load_dwordx4 v17, s[44:47], s22 offen lds
s_add_u32 m0, s26, 2048
s_add_u32 s22, s27, 28672
buffer_load_dwordx4 v17, s[44:47], s22 offen lds
s_add_u32 m0, s26, 3072
s_add_u32 s22, s27, 43008
buffer_load_dwordx4 v17, s[44:47], s22 offen lds
s_add_u32 m0, s26, 4096
s_add_u32 s22, s27, 57344
buffer_load_dwordx4 v17, s[44:47], s22 offen lds
s_add_u32 m0, s26, 5120
s_add_u32 s22, s27, 71680
buffer_load_dwordx4 v17, s[44:47], s22 offen lds
s_add_u32 m0, s26, 6144
s_add_u32 s22, s27, 86016
buffer_load_dwordx4 v17, s[44:47], s22 offen lds
s_add_u32 m0, s26, 7168
s_add_u32 s22, s27, 100352
buffer_load_dwordx4 v17, s[44:47], s22 offen lds
s_add_u32 m0, s26, 8192
s_add_u32 s22, s27, 114688
buffer_load_dwordx4 v17, s[44:47], s22 offen lds
s_add_u32 m0, s26, 9216
s_add_u32 s22, s27, 129024
buffer_load_dwordx4 v17, s[44:47], s22 offen lds
s_add_u32 m0, s26, 10240
s_add_u32 s22, s27, 143360
buffer_load_dwordx4 v17, s[44:47], s22 offen lds
s_add_u32 m0, s26, 11264
s_add_u32 s22, s27, 157696
buffer_load_dwordx4 v17, s[44:47], s22 offen lds
s_add_u32 m0, s26, 12288
s_add_u32 s22, s27, 172032
buffer_load_dwordx4 v17, s[44:47], s22 offen lds
s_add_u32 m0, s26, 13312
s_add_u32 s22, s27, 186368
buffer_load_dwordx4 v17, s[44:47], s22 offen lds
s_add_u32 m0, s26, 14336
s_add_u32 s22, s27, 200704
buffer_load_dwordx4 v17, s[44:47], s22 offen lds
s_add_u32 m0, s26, 15360
s_add_u32 s22, s27, 215040
buffer_load_dwordx4 v17, s[44:47], s22 offen lds
.LfE_226:
s_sub_u32 s25, s25, 4
s_sub_u32 s26, s26, s34
s_waitcnt vmcnt(16)
.Lfloop_227:
s_cmp_lg_u32 s18, 0
s_cbranch_scc1 .Lfr_229
v_xor_b32 v13, 0, v15
ds_read_b128 v[64:67], v13
v_xor_b32 v13, 32, v15
ds_read_b128 v[68:71], v13
v_xor_b32 v13, 64, v15
ds_read_b128 v[72:75], v13
v_xor_b32 v13, 96, v15
ds_read_b128 v[76:79], v13
v_xor_b32 v13, 128, v15
ds_read_b128 v[80:83], v13
v_xor_b32 v13, 160, v15
ds_read_b128 v[84:87], v13
v_xor_b32 v13, 192, v15
ds_read_b128 v[88:91], v13
v_xor_b32 v13, 224, v15
ds_read_b128 v[92:95], v13
v_xor_b32 v13, 256, v15
ds_read_b128 v[96:99], v13
v_xor_b32 v13, 288, v15
ds_read_b128 v[100:103], v13
v_xor_b32 v13, 320, v15
ds_read_b128 v[104:107], v13
v_xor_b32 v13, 352, v15
ds_read_b128 v[108:111], v13
v_xor_b32 v13, 384, v15
ds_read_b128 v[112:115], v13
v_xor_b32 v13, 416, v15
ds_read_b128 v[116:119], v13
v_xor_b32 v13, 448, v15
ds_read_b128 v[120:123], v13
v_xor_b32 v13, 480, v15
ds_read_b128 v[124:127], v13
s_branch .Lfr_230
.Lfr_229:
ds_read_b64_tr_b16 v[64:65], v16 offset:0
ds_read_b64_tr_b16 v[66:67], v16 offset:256
ds_read_b64_tr_b16 v[68:69], v16 offset:1024
ds_read_b64_tr_b16 v[70:71], v16 offset:1280
ds_read_b64_tr_b16 v[72:73], v16 offset:2048
ds_read_b64_tr_b16 v[74:75], v16 offset:2304
ds_read_b64_tr_b16 v[76:77], v16 offset:3072
ds_read_b64_tr_b16 v[78:79], v16 offset:3328
ds_read_b64_tr_b16 v[80:81], v16 offset:4096
ds_read_b64_tr_b16 v[82:83], v16 offset:4352
ds_read_b64_tr_b16 v[84:85], v16 offset:5120
ds_read_b64_tr_b16 v[86:87], v16 offset:5376
ds_read_b64_tr_b16 v[88:89], v16 offset:6144
ds_read_b64_tr_b16 v[90:91], v16 offset:6400
ds_read_b64_tr_b16 v[92:93], v16 offset:7168
ds_read_b64_tr_b16 v[94:95], v16 offset:7424
ds_read_b64_tr_b16 v[96:97], v16 offset:8192
ds_read_b64_tr_b16 v[98:99], v16 offset:8448
ds_read_b64_tr_b16 v[100:101], v16 offset:9216
ds_read_b64_tr_b16 v[102:103], v16 offset:9472
ds_read_b64_tr_b16 v[104:105], v16 offset:10240
ds_read_b64_tr_b16 v[106:107], v16 offset:10496
ds_read_b64_tr_b16 v[108:109], v16 offset:11264
ds_read_b64_tr_b16 v[110:111], v16 offset:11520
ds_read_b64_tr_b16 v[112:113], v16 offset:12288
ds_read_b64_tr_b16 v[114:115], v16 offset:12544
ds_read_b64_tr_b16 v[116:117], v16 offset:13312
ds_read_b64_tr_b16 v[118:119], v16 offset:13568
ds_read_b64_tr_b16 v[120:121], v16 offset:14336
ds_read_b64_tr_b16 v[122:123], v16 offset:14592
ds_read_b64_tr_b16 v[124:125], v16 offset:15360
ds_read_b64_tr_b16 v[126:127], v16 offset:15616
.Lfr_230:
s_cmp_lg_u32 s18, 0
s_cbranch_scc1 .LoC_231
s_cmp_ge_u32 s25, 12
s_cbranch_scc1 .LoO_232
s_and_b32 s21, s25, 3
s_lshr_b32 s22, s25, 2
s_lshl_b32 s23, s19, 2
s_add_u32 s23, s23, s21
s_mul_i32 s23, s23, 49
s_mul_i32 s22, s22, 14
s_add_u32 s23, s23, s22
s_add_u32 s23, s23, s20
s_lshl_b32 s23, s23, 11
s_add_u32 s28, s23, 0
v_mov_b32 v20, v18
s_branch .LoE_233
.LoO_232:
s_sub_u32 s21, s25, 12
s_lshl_b32 s21, s21, 1
s_lshl_b32 s23, s19, 2
s_add_u32 s23, s23, s21
s_mul_i32 s23, s23, 49
s_add_u32 s23, s23, 42
s_add_u32 s23, s23, s20
s_lshl_b32 s23, s23, 11
s_add_u32 s28, s23, 0
v_mov_b32 v20, v19
s_branch .LoE_233
.LoC_231:
s_lshl_b32 s23, s25, 4
s_add_u32 s23, s23, s19
s_mul_i32 s23, s23, 14
s_add_u32 s23, s23, s20
s_lshl_b32 s23, s23, 11
s_add_u32 s28, s23, 6422528
v_mov_b32 v20, v18
.LoE_233:
s_waitcnt lgkmcnt(0)
s_lshr_b32 s21, s25, 2
s_cmp_lg_u32 s21, 1
s_cbranch_scc1 .Lfh_234
buffer_load_dword v21, v22, s[12:15], 0 offen sc0 sc1
.Lfh_234:
s_add_u32 s25, s25, 8
s_cmp_ge_u32 s25, 14
s_cbranch_scc1 .Lflast_228
s_cmp_lg_u32 s18, 0
s_cbranch_scc1 .LfC_235
s_cmp_ge_u32 s25, 12
s_cbranch_scc1 .LfO_236
s_and_b32 s21, s25, 3
s_lshr_b32 s22, s25, 2
s_mul_i32 s23, s21, 112
s_lshl_b32 s24, s22, 5
s_add_u32 s23, s23, s24
s_lshl_b32 s23, s23, 13
s_lshl_b32 s24, s19, 9
s_add_u32 s27, s23, s24
s_add_u32 m0, s26, 0
s_add_u32 s22, s27, 0
buffer_load_dwordx4 v2, s[44:47], s22 offen lds
s_add_u32 m0, s26, 1024
s_add_u32 s22, s27, 16384
buffer_load_dwordx4 v3, s[44:47], s22 offen lds
s_add_u32 m0, s26, 2048
s_add_u32 s22, s27, 65536
buffer_load_dwordx4 v4, s[44:47], s22 offen lds
s_add_u32 m0, s26, 3072
s_add_u32 s22, s27, 81920
buffer_load_dwordx4 v5, s[44:47], s22 offen lds
s_add_u32 m0, s26, 4096
s_add_u32 s22, s27, 131072
buffer_load_dwordx4 v6, s[44:47], s22 offen lds
s_add_u32 m0, s26, 5120
s_add_u32 s22, s27, 147456
buffer_load_dwordx4 v7, s[44:47], s22 offen lds
s_add_u32 m0, s26, 6144
s_add_u32 s22, s27, 196608
buffer_load_dwordx4 v8, s[44:47], s22 offen lds
s_add_u32 m0, s26, 7168
s_add_u32 s22, s27, 212992
buffer_load_dwordx4 v9, s[44:47], s22 offen lds
s_add_u32 m0, s26, 8192
s_add_u32 s22, s27, 32768
buffer_load_dwordx4 v2, s[44:47], s22 offen lds
s_add_u32 m0, s26, 9216
s_add_u32 s22, s27, 49152
buffer_load_dwordx4 v3, s[44:47], s22 offen lds
s_add_u32 m0, s26, 10240
s_add_u32 s22, s27, 98304
buffer_load_dwordx4 v4, s[44:47], s22 offen lds
s_add_u32 m0, s26, 11264
s_add_u32 s22, s27, 114688
buffer_load_dwordx4 v5, s[44:47], s22 offen lds
s_add_u32 m0, s26, 12288
s_add_u32 s22, s27, 163840
buffer_load_dwordx4 v6, s[44:47], s22 offen lds
s_add_u32 m0, s26, 13312
s_add_u32 s22, s27, 180224
buffer_load_dwordx4 v7, s[44:47], s22 offen lds
s_add_u32 m0, s26, 14336
s_add_u32 s22, s27, 229376
buffer_load_dwordx4 v8, s[44:47], s22 offen lds
s_add_u32 m0, s26, 15360
s_add_u32 s22, s27, 245760
buffer_load_dwordx4 v9, s[44:47], s22 offen lds
s_branch .LfE_237
.LfO_236:
s_sub_u32 s21, s25, 12
s_mul_i32 s23, s21, 224
s_add_u32 s23, s23, 96
s_lshl_b32 s23, s23, 13
s_lshl_b32 s24, s19, 9
s_add_u32 s27, s23, s24
s_add_u32 m0, s26, 0
s_add_u32 s22, s27, 0
buffer_load_dwordx4 v2, s[44:47], s22 offen lds
s_add_u32 m0, s26, 1024
s_add_u32 s22, s27, 16384
buffer_load_dwordx4 v3, s[44:47], s22 offen lds
s_add_u32 m0, s26, 2048
s_add_u32 s22, s27, 32768
buffer_load_dwordx4 v4, s[44:47], s22 offen lds
s_add_u32 m0, s26, 3072
s_add_u32 s22, s27, 49152
buffer_load_dwordx4 v5, s[44:47], s22 offen lds
s_add_u32 m0, s26, 4096
s_add_u32 s22, s27, 65536
buffer_load_dwordx4 v6, s[44:47], s22 offen lds
s_add_u32 m0, s26, 5120
s_add_u32 s22, s27, 81920
buffer_load_dwordx4 v7, s[44:47], s22 offen lds
s_add_u32 m0, s26, 6144
s_add_u32 s22, s27, 98304
buffer_load_dwordx4 v8, s[44:47], s22 offen lds
s_add_u32 m0, s26, 7168
s_add_u32 s22, s27, 114688
buffer_load_dwordx4 v9, s[44:47], s22 offen lds
s_add_u32 m0, s26, 8192
s_add_u32 s22, s27, 917504
buffer_load_dwordx4 v2, s[44:47], s22 offen lds
s_add_u32 m0, s26, 9216
s_add_u32 s22, s27, 933888
buffer_load_dwordx4 v3, s[44:47], s22 offen lds
s_add_u32 m0, s26, 10240
s_add_u32 s22, s27, 950272
buffer_load_dwordx4 v4, s[44:47], s22 offen lds
s_add_u32 m0, s26, 11264
s_add_u32 s22, s27, 966656
buffer_load_dwordx4 v5, s[44:47], s22 offen lds
s_add_u32 m0, s26, 12288
s_add_u32 s22, s27, 983040
buffer_load_dwordx4 v6, s[44:47], s22 offen lds
s_add_u32 m0, s26, 13312
s_add_u32 s22, s27, 999424
buffer_load_dwordx4 v7, s[44:47], s22 offen lds
s_add_u32 m0, s26, 14336
s_add_u32 s22, s27, 1015808
buffer_load_dwordx4 v8, s[44:47], s22 offen lds
s_add_u32 m0, s26, 15360
s_add_u32 s22, s27, 1032192
buffer_load_dwordx4 v9, s[44:47], s22 offen lds
s_branch .LfE_237
.LfC_235:
s_mul_i32 s23, s19, 229376
s_lshl_b32 s24, s25, 6
s_add_u32 s27, s23, s24
s_add_u32 m0, s26, 0
s_add_u32 s22, s27, 0
buffer_load_dwordx4 v17, s[44:47], s22 offen lds
s_add_u32 m0, s26, 1024
s_add_u32 s22, s27, 14336
buffer_load_dwordx4 v17, s[44:47], s22 offen lds
s_add_u32 m0, s26, 2048
s_add_u32 s22, s27, 28672
buffer_load_dwordx4 v17, s[44:47], s22 offen lds
s_add_u32 m0, s26, 3072
s_add_u32 s22, s27, 43008
buffer_load_dwordx4 v17, s[44:47], s22 offen lds
s_add_u32 m0, s26, 4096
s_add_u32 s22, s27, 57344
buffer_load_dwordx4 v17, s[44:47], s22 offen lds
s_add_u32 m0, s26, 5120
s_add_u32 s22, s27, 71680
buffer_load_dwordx4 v17, s[44:47], s22 offen lds
s_add_u32 m0, s26, 6144
s_add_u32 s22, s27, 86016
buffer_load_dwordx4 v17, s[44:47], s22 offen lds
s_add_u32 m0, s26, 7168
s_add_u32 s22, s27, 100352
buffer_load_dwordx4 v17, s[44:47], s22 offen lds
s_add_u32 m0, s26, 8192
s_add_u32 s22, s27, 114688
buffer_load_dwordx4 v17, s[44:47], s22 offen lds
s_add_u32 m0, s26, 9216
s_add_u32 s22, s27, 129024
buffer_load_dwordx4 v17, s[44:47], s22 offen lds
s_add_u32 m0, s26, 10240
s_add_u32 s22, s27, 143360
buffer_load_dwordx4 v17, s[44:47], s22 offen lds
s_add_u32 m0, s26, 11264
s_add_u32 s22, s27, 157696
buffer_load_dwordx4 v17, s[44:47], s22 offen lds
s_add_u32 m0, s26, 12288
s_add_u32 s22, s27, 172032
buffer_load_dwordx4 v17, s[44:47], s22 offen lds
s_add_u32 m0, s26, 13312
s_add_u32 s22, s27, 186368
buffer_load_dwordx4 v17, s[44:47], s22 offen lds
s_add_u32 m0, s26, 14336
s_add_u32 s22, s27, 200704
buffer_load_dwordx4 v17, s[44:47], s22 offen lds
s_add_u32 m0, s26, 15360
s_add_u32 s22, s27, 215040
buffer_load_dwordx4 v17, s[44:47], s22 offen lds
.LfE_237:
.Lflast_228:
s_sub_u32 s25, s25, 8
v_mfma_f32_32x32x16_bf16 v[128:143], a[0:3], v[64:67], 0
v_mfma_f32_32x32x16_bf16 v[144:159], a[64:67], v[64:67], 0
v_mfma_f32_32x32x16_bf16 v[128:143], a[4:7], v[68:71], v[128:143]
v_mfma_f32_32x32x16_bf16 v[144:159], a[68:71], v[68:71], v[144:159]
v_mfma_f32_32x32x16_bf16 v[128:143], a[8:11], v[72:75], v[128:143]
v_mfma_f32_32x32x16_bf16 v[144:159], a[72:75], v[72:75], v[144:159]
v_mfma_f32_32x32x16_bf16 v[128:143], a[12:15], v[76:79], v[128:143]
v_mfma_f32_32x32x16_bf16 v[144:159], a[76:79], v[76:79], v[144:159]
v_mfma_f32_32x32x16_bf16 v[128:143], a[16:19], v[80:83], v[128:143]
v_mfma_f32_32x32x16_bf16 v[144:159], a[80:83], v[80:83], v[144:159]
v_mfma_f32_32x32x16_bf16 v[128:143], a[20:23], v[84:87], v[128:143]
v_mfma_f32_32x32x16_bf16 v[144:159], a[84:87], v[84:87], v[144:159]
v_mfma_f32_32x32x16_bf16 v[128:143], a[24:27], v[88:91], v[128:143]
v_mfma_f32_32x32x16_bf16 v[144:159], a[88:91], v[88:91], v[144:159]
v_mfma_f32_32x32x16_bf16 v[128:143], a[28:31], v[92:95], v[128:143]
v_mfma_f32_32x32x16_bf16 v[144:159], a[92:95], v[92:95], v[144:159]
v_mfma_f32_32x32x16_bf16 v[128:143], a[32:35], v[96:99], v[128:143]
v_mfma_f32_32x32x16_bf16 v[144:159], a[96:99], v[96:99], v[144:159]
v_mfma_f32_32x32x16_bf16 v[128:143], a[36:39], v[100:103], v[128:143]
v_mfma_f32_32x32x16_bf16 v[144:159], a[100:103], v[100:103], v[144:159]
v_mfma_f32_32x32x16_bf16 v[128:143], a[40:43], v[104:107], v[128:143]
v_mfma_f32_32x32x16_bf16 v[144:159], a[104:107], v[104:107], v[144:159]
v_mfma_f32_32x32x16_bf16 v[128:143], a[44:47], v[108:111], v[128:143]
v_mfma_f32_32x32x16_bf16 v[144:159], a[108:111], v[108:111], v[144:159]
v_mfma_f32_32x32x16_bf16 v[128:143], a[48:51], v[112:115], v[128:143]
v_mfma_f32_32x32x16_bf16 v[144:159], a[112:115], v[112:115], v[144:159]
v_mfma_f32_32x32x16_bf16 v[128:143], a[52:55], v[116:119], v[128:143]
v_mfma_f32_32x32x16_bf16 v[144:159], a[116:119], v[116:119], v[144:159]
v_mfma_f32_32x32x16_bf16 v[128:143], a[56:59], v[120:123], v[128:143]
v_mfma_f32_32x32x16_bf16 v[144:159], a[120:123], v[120:123], v[144:159]
v_mfma_f32_32x32x16_bf16 v[128:143], a[60:63], v[124:127], v[128:143]
v_mfma_f32_32x32x16_bf16 v[144:159], a[124:127], v[124:127], v[144:159]
v_add_u32 v15, s34, v15
v_add_u32 v16, s34, v16
s_add_u32 s26, s26, s34
s_sub_u32 s34, 0, s34
s_cmp_ge_u32 s25, 4
s_cbranch_scc1 .Lfln_238
s_cmp_ge_u32 s55, 128
s_cbranch_scc1 .Lfln_238
v_lshlrev_b32 v184, 16, v168
v_lshlrev_b32 v200, 16, v176
v_and_b32 v185, s54, v168
v_and_b32 v201, s54, v176
v_lshlrev_b32 v186, 16, v169
v_lshlrev_b32 v202, 16, v177
v_and_b32 v187, s54, v169
v_and_b32 v203, s54, v177
v_lshlrev_b32 v188, 16, v170
v_lshlrev_b32 v204, 16, v178
v_and_b32 v189, s54, v170
v_and_b32 v205, s54, v178
v_lshlrev_b32 v190, 16, v171
v_lshlrev_b32 v206, 16, v179
v_and_b32 v191, s54, v171
v_and_b32 v207, s54, v179
v_lshlrev_b32 v192, 16, v172
v_lshlrev_b32 v208, 16, v180
v_and_b32 v193, s54, v172
v_and_b32 v209, s54, v180
v_lshlrev_b32 v194, 16, v173
v_lshlrev_b32 v210, 16, v181
v_and_b32 v195, s54, v173
v_and_b32 v211, s54, v181
v_lshlrev_b32 v196, 16, v174
v_lshlrev_b32 v212, 16, v182
v_and_b32 v197, s54, v174
v_and_b32 v213, s54, v182
v_lshlrev_b32 v198, 16, v175
v_lshlrev_b32 v214, 16, v183
v_and_b32 v199, s54, v175
v_and_b32 v215, s54, v183
v_pk_add_f32 v[216:217], v[184:185], v[186:187]
v_pk_add_f32 v[224:225], v[200:201], v[202:203]
v_pk_add_f32 v[218:219], v[188:189], v[190:191]
v_pk_add_f32 v[226:227], v[204:205], v[206:207]
v_pk_add_f32 v[220:221], v[192:193], v[194:195]
v_pk_add_f32 v[228:229], v[208:209], v[210:211]
v_pk_add_f32 v[222:223], v[196:197], v[198:199]
v_pk_add_f32 v[230:231], v[212:213], v[214:215]
v_pk_add_f32 v[216:217], v[216:217], v[218:219]
v_pk_add_f32 v[224:225], v[224:225], v[226:227]
v_pk_add_f32 v[220:221], v[220:221], v[222:223]
v_pk_add_f32 v[228:229], v[228:229], v[230:231]
v_pk_add_f32 v[216:217], v[216:217], v[220:221]
v_pk_add_f32 v[224:225], v[224:225], v[228:229]
v_add_f32 v216, v216, v217
v_add_f32 v224, v224, v225
s_nop 1
s_nop 1
v_add_f32_dpp v216, v216, v216 row_ror:8 row_mask:0xf bank_mask:0xf
v_add_f32_dpp v224, v224, v224 row_ror:8 row_mask:0xf bank_mask:0xf
s_nop 1
s_nop 1
v_add_f32_dpp v216, v216, v216 row_ror:4 row_mask:0xf bank_mask:0xf
v_add_f32_dpp v224, v224, v224 row_ror:4 row_mask:0xf bank_mask:0xf
s_nop 1
s_nop 1
v_add_f32_dpp v216, v216, v216 row_ror:2 row_mask:0xf bank_mask:0xf
v_add_f32_dpp v224, v224, v224 row_ror:2 row_mask:0xf bank_mask:0xf
s_nop 1
s_nop 1
v_add_f32_dpp v216, v216, v216 row_ror:1 row_mask:0xf bank_mask:0xf
v_add_f32_dpp v224, v224, v224 row_ror:1 row_mask:0xf bank_mask:0xf
s_nop 1
s_nop 1
v_mov_b32 v217, v216
v_mov_b32 v225, v224
s_nop 1
s_nop 1
v_permlane16_swap_b32 v216, v217
v_permlane16_swap_b32 v224, v225
v_add_f32 v216, v216, v217
v_add_f32 v224, v224, v225
v_mul_f32 v216, 0x3b124925, v216
v_mul_f32 v224, 0x3b124925, v224
v_cndmask_b32 v218, 0, v216, s[56:57]
v_cndmask_b32 v226, 0, v224, s[56:57]
v_pk_add_f32 v[168:169], v[184:185], v[218:219] op_sel_hi:[1,0] neg_lo:[0,1] neg_hi:[0,1]
v_pk_add_f32 v[176:177], v[200:201], v[226:227] op_sel_hi:[1,0] neg_lo:[0,1] neg_hi:[0,1]
v_pk_mul_f32 v[220:221], v[168:169], v[168:169]
v_pk_mul_f32 v[228:229], v[176:177], v[176:177]
v_pk_add_f32 v[170:171], v[186:187], v[218:219] op_sel_hi:[1,0] neg_lo:[0,1] neg_hi:[0,1]
v_pk_add_f32 v[178:179], v[202:203], v[226:227] op_sel_hi:[1,0] neg_lo:[0,1] neg_hi:[0,1]
v_pk_mul_f32 v[222:223], v[170:171], v[170:171]
v_pk_mul_f32 v[230:231], v[178:179], v[178:179]
v_pk_add_f32 v[172:173], v[188:189], v[218:219] op_sel_hi:[1,0] neg_lo:[0,1] neg_hi:[0,1]
v_pk_add_f32 v[180:181], v[204:205], v[226:227] op_sel_hi:[1,0] neg_lo:[0,1] neg_hi:[0,1]
v_pk_fma_f32 v[220:221], v[172:173], v[172:173], v[220:221]
v_pk_fma_f32 v[228:229], v[180:181], v[180:181], v[228:229]
v_pk_add_f32 v[174:175], v[190:191], v[218:219] op_sel_hi:[1,0] neg_lo:[0,1] neg_hi:[0,1]
v_pk_add_f32 v[182:183], v[206:207], v[226:227] op_sel_hi:[1,0] neg_lo:[0,1] neg_hi:[0,1]
v_pk_fma_f32 v[222:223], v[174:175], v[174:175], v[222:223]
v_pk_fma_f32 v[230:231], v[182:183], v[182:183], v[230:231]
v_pk_add_f32 v[168:169], v[192:193], v[218:219] op_sel_hi:[1,0] neg_lo:[0,1] neg_hi:[0,1]
v_pk_add_f32 v[176:177], v[208:209], v[226:227] op_sel_hi:[1,0] neg_lo:[0,1] neg_hi:[0,1]
v_pk_fma_f32 v[220:221], v[168:169], v[168:169], v[220:221]
v_pk_fma_f32 v[228:229], v[176:177], v[176:177], v[228:229]
v_pk_add_f32 v[170:171], v[194:195], v[218:219] op_sel_hi:[1,0] neg_lo:[0,1] neg_hi:[0,1]
v_pk_add_f32 v[178:179], v[210:211], v[226:227] op_sel_hi:[1,0] neg_lo:[0,1] neg_hi:[0,1]
v_pk_fma_f32 v[222:223], v[170:171], v[170:171], v[222:223]
v_pk_fma_f32 v[230:231], v[178:179], v[178:179], v[230:231]
v_pk_add_f32 v[172:173], v[196:197], v[218:219] op_sel_hi:[1,0] neg_lo:[0,1] neg_hi:[0,1]
v_pk_add_f32 v[180:181], v[212:213], v[226:227] op_sel_hi:[1,0] neg_lo:[0,1] neg_hi:[0,1]
v_pk_fma_f32 v[220:221], v[172:173], v[172:173], v[220:221]
v_pk_fma_f32 v[228:229], v[180:181], v[180:181], v[228:229]
v_pk_add_f32 v[174:175], v[198:199], v[218:219] op_sel_hi:[1,0] neg_lo:[0,1] neg_hi:[0,1]
v_pk_add_f32 v[182:183], v[214:215], v[226:227] op_sel_hi:[1,0] neg_lo:[0,1] neg_hi:[0,1]
v_pk_fma_f32 v[222:223], v[174:175], v[174:175], v[222:223]
v_pk_fma_f32 v[230:231], v[182:183], v[182:183], v[230:231]
v_pk_add_f32 v[220:221], v[220:221], v[222:223]
v_pk_add_f32 v[228:229], v[228:229], v[230:231]
v_add_f32 v220, v220, v221
v_add_f32 v228, v228, v229
s_nop 1
s_nop 1
v_add_f32_dpp v220, v220, v220 row_ror:8 row_mask:0xf bank_mask:0xf
v_add_f32_dpp v228, v228, v228 row_ror:8 row_mask:0xf bank_mask:0xf
s_nop 1
s_nop 1
v_add_f32_dpp v220, v220, v220 row_ror:4 row_mask:0xf bank_mask:0xf
v_add_f32_dpp v228, v228, v228 row_ror:4 row_mask:0xf bank_mask:0xf
s_nop 1
s_nop 1
v_add_f32_dpp v220, v220, v220 row_ror:2 row_mask:0xf bank_mask:0xf
v_add_f32_dpp v228, v228, v228 row_ror:2 row_mask:0xf bank_mask:0xf
s_nop 1
s_nop 1
v_add_f32_dpp v220, v220, v220 row_ror:1 row_mask:0xf bank_mask:0xf
v_add_f32_dpp v228, v228, v228 row_ror:1 row_mask:0xf bank_mask:0xf
s_nop 1
s_nop 1
v_mov_b32 v221, v220
v_mov_b32 v229, v228
s_nop 1
s_nop 1
v_permlane16_swap_b32 v220, v221
v_permlane16_swap_b32 v228, v229
v_add_f32 v220, v220, v221
v_add_f32 v228, v228, v229
v_mul_f32 v220, 0x3b124925, v220
v_mul_f32 v228, 0x3b124925, v228
v_cvt_pk_bf16_f32 v216, v216, v216
v_cvt_pk_bf16_f32 v224, v224, v224
v_cvt_pk_bf16_f32 v220, v220, v220
v_cvt_pk_bf16_f32 v228, v228, v228
v_and_b32 v216, s54, v216
v_and_b32 v224, s54, v224
v_and_b32 v220, s54, v220
v_and_b32 v228, s54, v228
v_add_f32 v220, 0x3727c5ac, v220
v_add_f32 v228, 0x3727c5ac, v228
v_cvt_pk_bf16_f32 v220, v220, v220
v_cvt_pk_bf16_f32 v228, v228, v228
v_and_b32 v220, s54, v220
v_and_b32 v228, s54, v228
v_sqrt_f32 v220, v220
v_sqrt_f32 v228, v228
s_nop 0
s_nop 0
v_cvt_pk_bf16_f32 v220, v220, v220
v_cvt_pk_bf16_f32 v228, v228, v228
v_and_b32 v220, s54, v220
v_and_b32 v228, s54, v228
v_rcp_f32 v220, v220
v_rcp_f32 v228, v228
s_nop 0
s_nop 0
v_pk_add_f32 v[184:185], v[184:185], v[216:217] op_sel_hi:[1,0] neg_lo:[0,1] neg_hi:[0,1]
v_pk_add_f32 v[200:201], v[200:201], v[224:225] op_sel_hi:[1,0] neg_lo:[0,1] neg_hi:[0,1]
v_cvt_pk_bf16_f32 v168, v184, v185
v_cvt_pk_bf16_f32 v176, v200, v201
v_pk_add_f32 v[186:187], v[186:187], v[216:217] op_sel_hi:[1,0] neg_lo:[0,1] neg_hi:[0,1]
v_pk_add_f32 v[202:203], v[202:203], v[224:225] op_sel_hi:[1,0] neg_lo:[0,1] neg_hi:[0,1]
v_cvt_pk_bf16_f32 v169, v186, v187
v_cvt_pk_bf16_f32 v177, v202, v203
v_pk_add_f32 v[188:189], v[188:189], v[216:217] op_sel_hi:[1,0] neg_lo:[0,1] neg_hi:[0,1]
v_pk_add_f32 v[204:205], v[204:205], v[224:225] op_sel_hi:[1,0] neg_lo:[0,1] neg_hi:[0,1]
v_cvt_pk_bf16_f32 v170, v188, v189
v_cvt_pk_bf16_f32 v178, v204, v205
v_pk_add_f32 v[190:191], v[190:191], v[216:217] op_sel_hi:[1,0] neg_lo:[0,1] neg_hi:[0,1]
v_pk_add_f32 v[206:207], v[206:207], v[224:225] op_sel_hi:[1,0] neg_lo:[0,1] neg_hi:[0,1]
v_cvt_pk_bf16_f32 v171, v190, v191
v_cvt_pk_bf16_f32 v179, v206, v207
v_pk_add_f32 v[192:193], v[192:193], v[216:217] op_sel_hi:[1,0] neg_lo:[0,1] neg_hi:[0,1]
v_pk_add_f32 v[208:209], v[208:209], v[224:225] op_sel_hi:[1,0] neg_lo:[0,1] neg_hi:[0,1]
v_cvt_pk_bf16_f32 v172, v192, v193
v_cvt_pk_bf16_f32 v180, v208, v209
v_pk_add_f32 v[194:195], v[194:195], v[216:217] op_sel_hi:[1,0] neg_lo:[0,1] neg_hi:[0,1]
v_pk_add_f32 v[210:211], v[210:211], v[224:225] op_sel_hi:[1,0] neg_lo:[0,1] neg_hi:[0,1]
v_cvt_pk_bf16_f32 v173, v194, v195
v_cvt_pk_bf16_f32 v181, v210, v211
v_pk_add_f32 v[196:197], v[196:197], v[216:217] op_sel_hi:[1,0] neg_lo:[0,1] neg_hi:[0,1]
v_pk_add_f32 v[212:213], v[212:213], v[224:225] op_sel_hi:[1,0] neg_lo:[0,1] neg_hi:[0,1]
v_cvt_pk_bf16_f32 v174, v196, v197
v_cvt_pk_bf16_f32 v182, v212, v213
v_pk_add_f32 v[198:199], v[198:199], v[216:217] op_sel_hi:[1,0] neg_lo:[0,1] neg_hi:[0,1]
v_pk_add_f32 v[214:215], v[214:215], v[224:225] op_sel_hi:[1,0] neg_lo:[0,1] neg_hi:[0,1]
v_cvt_pk_bf16_f32 v175, v198, v199
v_cvt_pk_bf16_f32 v183, v214, v215
v_lshlrev_b32 v184, 16, v168
v_lshlrev_b32 v200, 16, v176
v_and_b32 v185, s54, v168
v_and_b32 v201, s54, v176
v_pk_mul_f32 v[184:185], v[184:185], v[220:221] op_sel_hi:[1,0]
v_pk_mul_f32 v[200:201], v[200:201], v[228:229] op_sel_hi:[1,0]
v_lshlrev_b32 v186, 16, v169
v_lshlrev_b32 v202, 16, v177
v_and_b32 v187, s54, v169
v_and_b32 v203, s54, v177
v_pk_mul_f32 v[186:187], v[186:187], v[220:221] op_sel_hi:[1,0]
v_pk_mul_f32 v[202:203], v[202:203], v[228:229] op_sel_hi:[1,0]
v_lshlrev_b32 v188, 16, v170
v_lshlrev_b32 v204, 16, v178
v_and_b32 v189, s54, v170
v_and_b32 v205, s54, v178
v_pk_mul_f32 v[188:189], v[188:189], v[220:221] op_sel_hi:[1,0]
v_pk_mul_f32 v[204:205], v[204:205], v[228:229] op_sel_hi:[1,0]
v_lshlrev_b32 v190, 16, v171
v_lshlrev_b32 v206, 16, v179
v_and_b32 v191, s54, v171
v_and_b32 v207, s54, v179
v_pk_mul_f32 v[190:191], v[190:191], v[220:221] op_sel_hi:[1,0]
v_pk_mul_f32 v[206:207], v[206:207], v[228:229] op_sel_hi:[1,0]
v_lshlrev_b32 v192, 16, v172
v_lshlrev_b32 v208, 16, v180
v_and_b32 v193, s54, v172
v_and_b32 v209, s54, v180
v_pk_mul_f32 v[192:193], v[192:193], v[220:221] op_sel_hi:[1,0]
v_pk_mul_f32 v[208:209], v[208:209], v[228:229] op_sel_hi:[1,0]
v_lshlrev_b32 v194, 16, v173
v_lshlrev_b32 v210, 16, v181
v_and_b32 v195, s54, v173
v_and_b32 v211, s54, v181
v_pk_mul_f32 v[194:195], v[194:195], v[220:221] op_sel_hi:[1,0]
v_pk_mul_f32 v[210:211], v[210:211], v[228:229] op_sel_hi:[1,0]
v_lshlrev_b32 v196, 16, v174
v_lshlrev_b32 v212, 16, v182
v_and_b32 v197, s54, v174
v_and_b32 v213, s54, v182
v_pk_mul_f32 v[196:197], v[196:197], v[220:221] op_sel_hi:[1,0]
v_pk_mul_f32 v[212:213], v[212:213], v[228:229] op_sel_hi:[1,0]
v_lshlrev_b32 v198, 16, v175
v_lshlrev_b32 v214, 16, v183
v_and_b32 v199, s54, v175
v_and_b32 v215, s54, v183
v_pk_mul_f32 v[198:199], v[198:199], v[220:221] op_sel_hi:[1,0]
v_pk_mul_f32 v[214:215], v[214:215], v[228:229] op_sel_hi:[1,0]
v_cvt_pk_bf16_f32 v168, v184, v185
v_cvt_pk_bf16_f32 v176, v200, v201
v_cvt_pk_bf16_f32 v169, v186, v187
v_cvt_pk_bf16_f32 v177, v202, v203
v_cvt_pk_bf16_f32 v170, v188, v189
v_cvt_pk_bf16_f32 v178, v204, v205
v_cvt_pk_bf16_f32 v171, v190, v191
v_cvt_pk_bf16_f32 v179, v206, v207
v_cvt_pk_bf16_f32 v172, v192, v193
v_cvt_pk_bf16_f32 v180, v208, v209
v_cvt_pk_bf16_f32 v173, v194, v195
v_cvt_pk_bf16_f32 v181, v210, v211
v_cvt_pk_bf16_f32 v174, v196, v197
v_cvt_pk_bf16_f32 v182, v212, v213
v_cvt_pk_bf16_f32 v175, v198, v199
v_cvt_pk_bf16_f32 v183, v214, v215
s_mov_b64 s[60:61], exec
s_mov_b64 exec, s[56:57]
ds_write_b128 v161, v[168:171] offset:0
ds_write_b128 v161, v[172:175] offset:448
ds_write_b128 v161, v[176:179] offset:1824
ds_write_b128 v161, v[180:183] offset:2272
s_mov_b64 exec, s[60:61]
s_waitcnt lgkmcnt(0)
s_barrier
v_and_b32 v168, 1, v0
v_lshrrev_b32 v169, 1, v0
v_and_b32 v169, 1, v169
v_lshlrev_b32 v169, 3, v169
v_add_u32 v168, v168, v169
v_lshrrev_b32 v169, 2, v0
v_and_b32 v169, 1, v169
v_lshlrev_b32 v169, 2, v169
v_add_u32 v168, v168, v169
v_lshrrev_b32 v169, 3, v0
v_and_b32 v169, 1, v169
v_lshlrev_b32 v169, 1, v169
v_add_u32 v168, v168, v169
v_mul_u32_u24 v168, 912, v168
s_mul_i32 s60, s17, 224
s_add_u32 s60, s60, 131072
v_lshrrev_b32 v169, 4, v0
v_lshlrev_b32 v170, 4, v169
v_add3_u32 v170, v168, v170, s60
v_lshlrev_b32 v171, 3, v169
v_add3_u32 v171, v168, v171, s60
ds_read_b128 v[176:179], v170 offset:0
ds_read_b128 v[180:183], v170 offset:64
ds_read_b128 v[184:187], v170 offset:128
ds_read_b64 v[188:189], v171 offset:192
s_mul_i32 s60, s52, 28672
s_mul_i32 s61, s17, 7168
s_add_u32 s60, s60, s61
s_add_u32 s60, s60, 14680064
s_mul_i32 s61, s53, 3072
s_add_u32 s61, s61, s60
s_lshl_b32 s62, s53, 9
s_add_u32 s62, s62, s60
s_add_u32 s62, s62, 6144
v_lshlrev_b32 v172, 4, v0
v_lshlrev_b32 v173, 3, v0
s_waitcnt lgkmcnt(3)
buffer_store_dwordx4 v[176:179], v172, s[8:11], s61 offen offset:0 sc1
s_waitcnt lgkmcnt(2)
buffer_store_dwordx4 v[180:183], v172, s[8:11], s61 offen offset:1024 sc1
s_waitcnt lgkmcnt(1)
buffer_store_dwordx4 v[184:187], v172, s[8:11], s61 offen offset:2048 sc1
s_waitcnt lgkmcnt(0)
buffer_store_dwordx2 v[188:189], v173, s[8:11], s62 offen sc1
v_and_b32 v168, 7, v0
v_lshrrev_b32 v169, 2, v168
v_lshlrev_b32 v169, 2, v169
v_and_b32 v170, 3, v0
v_add_u32 v169, v169, v170
v_mul_u32_u24 v169, 912, v169
v_lshrrev_b32 v170, 5, v0
v_lshlrev_b32 v171, 6, v170
v_add_u32 v169, v169, v171
v_lshrrev_b32 v171, 4, v0
v_and_b32 v171, 1, v171
v_lshlrev_b32 v171, 5, v171
v_add_u32 v169, v169, v171
v_lshrrev_b32 v171, 3, v0
v_and_b32 v171, 1, v171
v_lshlrev_b32 v171, 3, v171
v_add_u32 v169, v169, v171
v_add_u32 v169, 131072, v169
v_lshlrev_b32 v170, 10, v170
v_lshrrev_b32 v171, 3, v0
v_and_b32 v171, 3, v171
v_lshlrev_b32 v171, 8, v171
v_lshlrev_b32 v168, 4, v168
v_add3_u32 v170, v170, v171, v168
s_lshl_b32 s61, s53, 7
v_add_u32 v170, s61, v170
s_mul_i32 s60, s52, 28672
s_add_u32 s60, s60, 12845056
s_add_u32 s61, s17, 0
s_cmp_ge_u32 s61, 7
s_cselect_b32 s62, 6400, 0
s_lshl_b32 s63, s61, 7
s_add_u32 s62, s62, s63
v_add_u32 v171, s62, v169
s_lshl_b32 s61, s61, 11
s_add_u32 s61, s61, s60
ds_read2_b32 v[192:193], v171 offset0:0 offset1:4
ds_read2_b32 v[194:195], v171 offset0:1 offset1:5
s_waitcnt lgkmcnt(0)
buffer_store_dwordx4 v[192:195], v170, s[8:11], s61 offen sc1
s_nop 1
.Lxt_244:
s_add_u32 s61, s17, 4
s_cmp_ge_u32 s61, 7
s_cselect_b32 s62, 6400, 0
s_lshl_b32 s63, s61, 7
s_add_u32 s62, s62, s63
v_add_u32 v171, s62, v169
s_lshl_b32 s61, s61, 11
s_add_u32 s61, s61, s60
ds_read2_b32 v[192:193], v171 offset0:0 offset1:4
ds_read2_b32 v[194:195], v171 offset0:1 offset1:5
s_waitcnt lgkmcnt(0)
buffer_store_dwordx4 v[192:195], v170, s[8:11], s61 offen sc1
s_nop 1
.Lxt_245:
s_add_u32 s61, s17, 8
s_cmp_ge_u32 s61, 7
s_cselect_b32 s62, 6400, 0
s_lshl_b32 s63, s61, 7
s_add_u32 s62, s62, s63
v_add_u32 v171, s62, v169
s_lshl_b32 s61, s61, 11
s_add_u32 s61, s61, s60
ds_read2_b32 v[192:193], v171 offset0:0 offset1:4
ds_read2_b32 v[194:195], v171 offset0:1 offset1:5
s_waitcnt lgkmcnt(0)
buffer_store_dwordx4 v[192:195], v170, s[8:11], s61 offen sc1
s_nop 1
.Lxt_246:
s_add_u32 s61, s17, 12
s_cmp_ge_u32 s61, 14
s_cbranch_scc1 .Lxt_247
s_cmp_ge_u32 s61, 7
s_cselect_b32 s62, 6400, 0
s_lshl_b32 s63, s61, 7
s_add_u32 s62, s62, s63
v_add_u32 v171, s62, v169
s_lshl_b32 s61, s61, 11
s_add_u32 s61, s61, s60
ds_read2_b32 v[192:193], v171 offset0:0 offset1:4
ds_read2_b32 v[194:195], v171 offset0:1 offset1:5
s_waitcnt lgkmcnt(0)
buffer_store_dwordx4 v[192:195], v170, s[8:11], s61 offen sc1
s_nop 1
.Lxt_247:
s_waitcnt vmcnt(23)
s_branch .Lfln_239
.Lfln_238:
s_cmp_ge_u32 s25, 6
s_cbranch_scc1 .Lfw_248
s_waitcnt vmcnt(16)
s_branch .Lfw_249
.Lfw_248:
s_waitcnt vmcnt(0)
.Lfw_249:
s_cmp_lt_u32 s25, 4
s_cbranch_scc1 .Lffl_250
s_cmp_ge_u32 s25, 8
s_cbranch_scc1 .Lffk_253
s_mov_b32 s21, 4000
.Lffr_252:
v_cmp_ne_u32 vcc, 0, v21
s_nop 1
s_cmp_eq_u32 vcc_lo, -1
s_cbranch_scc1 .Lffk_251
buffer_load_dword v21, v22, s[12:15], 0 offen sc0 sc1
s_waitcnt vmcnt(0)
s_sub_u32 s21, s21, 1
s_cbranch_scc0 .Lffr_252
.Lffk_251:
s_cmp_ge_u32 s55, 128
s_cbranch_scc1 .Ll0f_254
s_barrier
buffer_store_dword v41, v42, s[8:11], 0 offen sc1
.Ll0f_254:
.Lffk_253:
s_lshl_b32 s33, s25, 5
s_add_u32 s33, s33, s32
s_sub_u32 s33, s33, 128
buffer_store_dword v41, v40, s[8:11], s33 offen sc1
.Lffl_250:
.Lfln_239:
s_nop 7
s_nop 3
v_mul_f32 v128, s31, v128
v_mul_f32 v129, s31, v129
v_mul_f32 v130, s31, v130
v_mul_f32 v131, s31, v131
v_mul_f32 v132, s31, v132
v_mul_f32 v133, s31, v133
v_mul_f32 v134, s31, v134
v_mul_f32 v135, s31, v135
v_mul_f32 v136, s31, v136
v_mul_f32 v137, s31, v137
v_mul_f32 v138, s31, v138
v_mul_f32 v139, s31, v139
v_mul_f32 v140, s31, v140
v_mul_f32 v141, s31, v141
v_mul_f32 v142, s31, v142
v_mul_f32 v143, s31, v143
v_cvt_pk_bf16_f32 v24, v128, v129
v_cvt_pk_bf16_f32 v25, v132, v133
v_cvt_pk_bf16_f32 v26, v130, v131
v_cvt_pk_bf16_f32 v27, v134, v135
buffer_store_dwordx4 v[24:27], v20, s[8:11], s28 offen offset:0 sc1
v_cvt_pk_bf16_f32 v28, v136, v137
v_cvt_pk_bf16_f32 v29, v140, v141
v_cvt_pk_bf16_f32 v30, v138, v139
v_cvt_pk_bf16_f32 v31, v142, v143
buffer_store_dwordx4 v[28:31], v20, s[8:11], s28 offen offset:512 sc1
s_nop 0
v_mul_f32 v144, s31, v144
v_mul_f32 v145, s31, v145
v_mul_f32 v146, s31, v146
v_mul_f32 v147, s31, v147
v_mul_f32 v148, s31, v148
v_mul_f32 v149, s31, v149
v_mul_f32 v150, s31, v150
v_mul_f32 v151, s31, v151
v_mul_f32 v152, s31, v152
v_mul_f32 v153, s31, v153
v_mul_f32 v154, s31, v154
v_mul_f32 v155, s31, v155
v_mul_f32 v156, s31, v156
v_mul_f32 v157, s31, v157
v_mul_f32 v158, s31, v158
v_mul_f32 v159, s31, v159
v_cvt_pk_bf16_f32 v32, v144, v145
v_cvt_pk_bf16_f32 v33, v148, v149
v_cvt_pk_bf16_f32 v34, v146, v147
v_cvt_pk_bf16_f32 v35, v150, v151
buffer_store_dwordx4 v[32:35], v20, s[8:11], s28 offen offset:1024 sc1
v_cvt_pk_bf16_f32 v36, v152, v153
v_cvt_pk_bf16_f32 v37, v156, v157
v_cvt_pk_bf16_f32 v38, v154, v155
v_cvt_pk_bf16_f32 v39, v158, v159
buffer_store_dwordx4 v[36:39], v20, s[8:11], s28 offen offset:1536 sc1
s_add_u32 s25, s25, 4
s_cmp_lt_u32 s25, 14
s_cbranch_scc1 .Lfloop_227
s_waitcnt vmcnt(0)
s_lshl_b32 s33, s25, 5
s_add_u32 s33, s33, s32
s_sub_u32 s33, s33, 128
buffer_store_dword v41, v40, s[8:11], s33 offen sc1
s_barrier
s_mul_i32 s60, s58, 293
s_lshr_b32 s60, s60, 11
s_mul_i32 s24, s60, 7
s_sub_u32 s61, s58, s24
s_lshl_b32 s24, s61, 2
s_add_u32 s24, s24, s17
s_cmp_ge_u32 s24, 14
s_cselect_b32 s25, 1, 0
s_cselect_b32 s26, 14, 0
s_sub_u32 s63, s24, s26
s_lshl_b32 s62, s60, 1
s_add_u32 s62, s62, s25
s_and_b32 s18, s58, 3
s_lshr_b32 s21, s58, 2
s_cmp_ge_u32 s58, 64
s_cbranch_scc1 .Ldq_259
s_and_b32 s21, s58, 31
s_lshr_b32 s21, s21, 1
s_and_b32 s18, s58, 1
s_cmp_lt_u32 s58, 32
s_cselect_b32 s16, 2, 0
s_add_u32 s18, s18, s16
.Ldq_259:
s_lshr_b32 s16, s21, 2
s_and_b32 s19, s21, 3
s_mov_b32 s39, 8000
s_cmp_lg_u32 s17, 0
s_cbranch_scc1 .Lww_260
s_mov_b32 s24, 68183040
v_lshlrev_b32 v248, 4, v0
v_mov_b32 v252, 0x10000000
v_cmp_gt_u32 vcc, 32, v0
s_mov_b32 s25, s39
s_nop 0
v_cndmask_b32 v248, v252, v248, vcc
.Lwr_261:
buffer_load_dwordx4 v[252:255], v248, s[8:11], s24 offen sc1
s_waitcnt vmcnt(0)
s_mov_b32 s26, 0
v_cmp_eq_u32 vcc, 1, v252
s_nop 1
s_and_b32 vcc_lo, vcc_lo, 0xffffffff
s_and_b32 vcc_hi, vcc_hi, 0x0
s_bcnt1_i32_b64 s27, vcc
s_add_u32 s26, s26, s27
v_cmp_eq_u32 vcc, 1, v253
s_nop 1
s_and_b32 vcc_lo, vcc_lo, 0xffffffff
s_and_b32 vcc_hi, vcc_hi, 0x0
s_bcnt1_i32_b64 s27, vcc
s_add_u32 s26, s26, s27
v_cmp_eq_u32 vcc, 1, v254
s_nop 1
s_and_b32 vcc_lo, vcc_lo, 0xffffffff
s_and_b32 vcc_hi, vcc_hi, 0x0
s_bcnt1_i32_b64 s27, vcc
s_add_u32 s26, s26, s27
v_cmp_eq_u32 vcc, 1, v255
s_nop 1
s_and_b32 vcc_lo, vcc_lo, 0xffffffff
s_and_b32 vcc_hi, vcc_hi, 0x0
s_bcnt1_i32_b64 s27, vcc
s_add_u32 s26, s26, s27
s_cmp_eq_u32 s26, 128
s_cbranch_scc1 .Lwo_262
s_sleep 2
s_sub_u32 s25, s25, 1
s_cbranch_scc0 .Lwr_261
s_mov_b32 s39, 0
.Lwo_262:
.Lww_260:
s_barrier
s_lshl_b32 s30, s19, 2
s_add_u32 s30, s30, s17
s_add_u32 s30, s30, 16
s_mul_i32 s30, s30, 14
s_add_u32 s30, s30, s16
s_lshl_b32 s30, s30, 5
s_add_u32 s30, s30, 118222848
s_mov_b32 s24, s30
v_lshlrev_b32 v248, 2, v0
v_mov_b32 v252, 0x10000000
v_cmp_gt_u32 vcc, 8, v0
s_mov_b32 s25, s39
s_nop 0
v_cndmask_b32 v248, v252, v248, vcc
.Lwr_264:
buffer_load_dword v252, v248, s[8:11], s24 offen sc1
s_waitcnt vmcnt(0)
v_cmp_eq_u32 vcc, 1, v252
s_nop 1
s_bcnt1_i32_b64 s26, vcc
s_cmp_eq_u32 s26, 8
s_cbranch_scc1 .Lwo_265
s_sleep 2
s_sub_u32 s25, s25, 1
s_cbranch_scc0 .Lwr_264
s_mov_b32 s39, 0
.Lwo_265:
v_lshlrev_b32 v1, 4, v0
s_lshl_b32 s24, s16, 2
s_add_u32 s24, s24, s19
s_lshl_b32 s25, s24, 2
s_add_u32 s25, s25, s17
s_mul_i32 s32, s25, 28672
s_add_u32 s32, s32, 6422528
s_mul_i32 s33, s18, 28672
s_mul_i32 s26, s17, 7168
s_add_u32 s33, s33, s26
s_add_u32 s33, s33, 12845056
s_mov_b32 s38, s26
s_mov_b32 s36, s38
s_add_u32 m0, s36, 0
s_add_u32 s27, s33, 0
buffer_load_dwordx4 v1, s[8:11], s27 offen lds
s_add_u32 m0, s36, 1024
s_add_u32 s27, s33, 1024
buffer_load_dwordx4 v1, s[8:11], s27 offen lds
s_add_u32 m0, s36, 2048
s_add_u32 s27, s33, 2048
buffer_load_dwordx4 v1, s[8:11], s27 offen lds
s_add_u32 m0, s36, 3072
s_add_u32 s27, s33, 3072
buffer_load_dwordx4 v1, s[8:11], s27 offen lds
s_add_u32 m0, s36, 4096
s_add_u32 s27, s33, 4096
buffer_load_dwordx4 v1, s[8:11], s27 offen lds
s_add_u32 m0, s36, 5120
s_add_u32 s27, s33, 5120
buffer_load_dwordx4 v1, s[8:11], s27 offen lds
s_add_u32 m0, s36, 6144
s_add_u32 s27, s33, 6144
buffer_load_dwordx4 v1, s[8:11], s27 offen lds
s_add_u32 s33, s33, 114688
s_add_u32 s36, s38, 28672
buffer_load_dwordx4 a[0:3], v1, s[8:11], s32 offen offset:0
buffer_load_dwordx4 a[4:7], v1, s[8:11], s32 offen offset:1024
buffer_load_dwordx4 a[8:11], v1, s[8:11], s32 offen offset:2048
buffer_load_dwordx4 a[12:15], v1, s[8:11], s32 offen offset:3072
s_add_u32 s32, s32, 4096
buffer_load_dwordx4 a[16:19], v1, s[8:11], s32 offen offset:0
buffer_load_dwordx4 a[20:23], v1, s[8:11], s32 offen offset:1024
buffer_load_dwordx4 a[24:27], v1, s[8:11], s32 offen offset:2048
buffer_load_dwordx4 a[28:31], v1, s[8:11], s32 offen offset:3072
s_add_u32 s32, s32, 4096
buffer_load_dwordx4 a[32:35], v1, s[8:11], s32 offen offset:0
buffer_load_dwordx4 a[36:39], v1, s[8:11], s32 offen offset:1024
buffer_load_dwordx4 a[40:43], v1, s[8:11], s32 offen offset:2048
buffer_load_dwordx4 a[44:47], v1, s[8:11], s32 offen offset:3072
s_add_u32 s32, s32, 4096
buffer_load_dwordx4 a[48:51], v1, s[8:11], s32 offen offset:0
buffer_load_dwordx4 a[52:55], v1, s[8:11], s32 offen offset:1024
buffer_load_dwordx4 a[56:59], v1, s[8:11], s32 offen offset:2048
buffer_load_dwordx4 a[60:63], v1, s[8:11], s32 offen offset:3072
s_add_u32 s32, s32, 4096
buffer_load_dwordx4 a[64:67], v1, s[8:11], s32 offen offset:0
buffer_load_dwordx4 a[68:71], v1, s[8:11], s32 offen offset:1024
buffer_load_dwordx4 a[72:75], v1, s[8:11], s32 offen offset:2048
buffer_load_dwordx4 a[76:79], v1, s[8:11], s32 offen offset:3072
s_add_u32 s32, s32, 4096
buffer_load_dwordx4 a[80:83], v1, s[8:11], s32 offen offset:0
buffer_load_dwordx4 a[84:87], v1, s[8:11], s32 offen offset:1024
buffer_load_dwordx4 a[88:91], v1, s[8:11], s32 offen offset:2048
buffer_load_dwordx4 a[92:95], v1, s[8:11], s32 offen offset:3072
s_add_u32 s32, s32, 4096
buffer_load_dwordx4 a[96:99], v1, s[8:11], s32 offen offset:0
buffer_load_dwordx4 a[100:103], v1, s[8:11], s32 offen offset:1024
buffer_load_dwordx4 a[104:107], v1, s[8:11], s32 offen offset:2048
buffer_load_dwordx4 a[108:111], v1, s[8:11], s32 offen offset:3072
s_add_u32 s32, s32, 4096
s_add_u32 m0, s36, 0
s_add_u32 s27, s33, 0
buffer_load_dwordx4 v1, s[8:11], s27 offen lds
s_add_u32 m0, s36, 1024
s_add_u32 s27, s33, 1024
buffer_load_dwordx4 v1, s[8:11], s27 offen lds
s_add_u32 m0, s36, 2048
s_add_u32 s27, s33, 2048
buffer_load_dwordx4 v1, s[8:11], s27 offen lds
s_add_u32 m0, s36, 3072
s_add_u32 s27, s33, 3072
buffer_load_dwordx4 v1, s[8:11], s27 offen lds
s_add_u32 m0, s36, 4096
s_add_u32 s27, s33, 4096
buffer_load_dwordx4 v1, s[8:11], s27 offen lds
s_add_u32 m0, s36, 5120
s_add_u32 s27, s33, 5120
buffer_load_dwordx4 v1, s[8:11], s27 offen lds
s_add_u32 m0, s36, 6144
s_add_u32 s27, s33, 6144
buffer_load_dwordx4 v1, s[8:11], s27 offen lds
s_add_u32 s33, s33, 114688
s_add_u32 s36, s38, 57344
v_lshrrev_b32 v5, 5, v0
v_lshlrev_b32 v5, 11, v5
v_and_b32 v6, 15, v0
v_lshlrev_b32 v6, 4, v6
v_lshrrev_b32 v7, 4, v0
v_and_b32 v7, 1, v7
v_lshlrev_b32 v7, 8, v7
v_add3_u32 v5, v5, v6, v7
s_lshr_b32 s25, s17, 1
s_lshl_b32 s25, s25, 10
s_and_b32 s26, s17, 1
s_lshl_b32 s26, s26, 9
s_add_u32 s25, s25, s26
v_add_u32 v3, s25, v5
s_mul_i32 s34, s18, 458752
s_lshl_b32 s24, s24, 13
s_add_u32 s34, s34, s24
s_add_u32 s34, s34, 16515072
v_mov_b32 v2, v1
s_mul_i32 s40, s18, 224
s_lshl_b32 s25, s16, 4
s_add_u32 s40, s40, s25
s_lshl_b32 s25, s19, 2
s_add_u32 s40, s40, s25
s_add_u32 s40, s40, 68124672
s_lshl_b32 s25, s17, 6
v_add_u32 v6, s25, v0
v_mov_b32 v7, 0x10000000
v_cmp_eq_u32 vcc, 0, v6
v_mov_b32 v81, 1
s_nop 0
v_cndmask_b32 v80, v7, 0, vcc
v_add_u32 v4, 28672, v1
s_mov_b32 s35, 28672
s_mov_b32 s37, 0
s_waitcnt vmcnt(35)
s_barrier
ds_read_b128 v[8:11], v2 offset:0
ds_read_b128 v[12:15], v2 offset:14336
ds_read_b128 v[16:19], v2 offset:1024
ds_read_b128 v[20:23], v2 offset:15360
s_waitcnt vmcnt(0)
.Ldloop_266:
s_waitcnt lgkmcnt(2)
v_mfma_f32_16x16x32_bf16 v[40:43], v[8:11], a[0:3], 0
ds_read_b128 v[24:27], v2 offset:2048
v_mfma_f32_16x16x32_bf16 v[44:47], v[12:15], a[0:3], 0
ds_read_b128 v[28:31], v2 offset:16384
v_mfma_f32_16x16x32_bf16 v[48:51], v[8:11], a[56:59], 0
v_mfma_f32_16x16x32_bf16 v[52:55], v[12:15], a[56:59], 0
s_waitcnt lgkmcnt(2)
v_mfma_f32_16x16x32_bf16 v[40:43], v[16:19], a[4:7], v[40:43]
ds_read_b128 v[32:35], v2 offset:3072
ds_read_b128 v[36:39], v2 offset:17408
v_mfma_f32_16x16x32_bf16 v[44:47], v[20:23], a[4:7], v[44:47]
v_cvt_pk_bf16_f32 v72, v56, v57
v_cvt_pk_bf16_f32 v73, v58, v59
v_mfma_f32_16x16x32_bf16 v[48:51], v[16:19], a[60:63], v[48:51]
v_cvt_pk_bf16_f32 v74, v60, v61
v_mfma_f32_16x16x32_bf16 v[52:55], v[20:23], a[60:63], v[52:55]
v_cvt_pk_bf16_f32 v75, v62, v63
s_waitcnt lgkmcnt(2)
v_mfma_f32_16x16x32_bf16 v[40:43], v[24:27], a[8:11], v[40:43]
ds_read_b128 v[8:11], v2 offset:4096
ds_read_b128 v[12:15], v2 offset:18432
v_mfma_f32_16x16x32_bf16 v[44:47], v[28:31], a[8:11], v[44:47]
v_cvt_pk_bf16_f32 v76, v64, v65
v_cvt_pk_bf16_f32 v77, v66, v67
v_mfma_f32_16x16x32_bf16 v[48:51], v[24:27], a[64:67], v[48:51]
v_cvt_pk_bf16_f32 v78, v68, v69
v_mfma_f32_16x16x32_bf16 v[52:55], v[28:31], a[64:67], v[52:55]
v_cvt_pk_bf16_f32 v79, v70, v71
s_waitcnt lgkmcnt(2)
v_mfma_f32_16x16x32_bf16 v[40:43], v[32:35], a[12:15], v[40:43]
ds_read_b128 v[16:19], v2 offset:5120
ds_read_b128 v[20:23], v2 offset:19456
s_cmp_eq_u32 s37, 0
s_cbranch_scc1 .Ldns_267
buffer_store_dwordx4 v[72:75], v3, s[8:11], s34 offen sc1
s_add_u32 s39, s34, 4096
buffer_store_dwordx4 v[76:79], v3, s[8:11], s39 offen sc1
s_add_u32 s34, s34, 1835008
.Ldns_267:
v_mfma_f32_16x16x32_bf16 v[44:47], v[36:39], a[12:15], v[44:47]
v_mfma_f32_16x16x32_bf16 v[48:51], v[32:35], a[68:71], v[48:51]
v_mfma_f32_16x16x32_bf16 v[52:55], v[36:39], a[68:71], v[52:55]
s_waitcnt lgkmcnt(2)
v_mfma_f32_16x16x32_bf16 v[40:43], v[8:11], a[16:19], v[40:43]
ds_read_b128 v[24:27], v2 offset:6144
v_mfma_f32_16x16x32_bf16 v[44:47], v[12:15], a[16:19], v[44:47]
ds_read_b128 v[28:31], v2 offset:20480
v_mfma_f32_16x16x32_bf16 v[48:51], v[8:11], a[72:75], v[48:51]
v_mfma_f32_16x16x32_bf16 v[52:55], v[12:15], a[72:75], v[52:55]
s_waitcnt lgkmcnt(2)
v_mfma_f32_16x16x32_bf16 v[40:43], v[16:19], a[20:23], v[40:43]
ds_read_b128 v[32:35], v2 offset:7168
v_mfma_f32_16x16x32_bf16 v[44:47], v[20:23], a[20:23], v[44:47]
ds_read_b128 v[36:39], v2 offset:21504
v_mfma_f32_16x16x32_bf16 v[48:51], v[16:19], a[76:79], v[48:51]
v_mfma_f32_16x16x32_bf16 v[52:55], v[20:23], a[76:79], v[52:55]
s_waitcnt lgkmcnt(2)
v_mfma_f32_16x16x32_bf16 v[40:43], v[24:27], a[24:27], v[40:43]
ds_read_b128 v[8:11], v2 offset:8192
v_mfma_f32_16x16x32_bf16 v[44:47], v[28:31], a[24:27], v[44:47]
ds_read_b128 v[12:15], v2 offset:22528
v_mfma_f32_16x16x32_bf16 v[48:51], v[24:27], a[80:83], v[48:51]
v_mfma_f32_16x16x32_bf16 v[52:55], v[28:31], a[80:83], v[52:55]
s_waitcnt lgkmcnt(2)
v_mfma_f32_16x16x32_bf16 v[40:43], v[32:35], a[28:31], v[40:43]
ds_read_b128 v[16:19], v2 offset:9216
ds_read_b128 v[20:23], v2 offset:23552
s_waitcnt vmcnt(2)
s_barrier
s_cmp_eq_u32 s37, 0
s_cbranch_scc1 .Ldfl_268
buffer_store_dword v81, v80, s[8:11], s40 offen sc1
s_add_u32 s40, s40, 896
.Ldfl_268:
v_mfma_f32_16x16x32_bf16 v[44:47], v[36:39], a[28:31], v[44:47]
v_mfma_f32_16x16x32_bf16 v[48:51], v[32:35], a[84:87], v[48:51]
v_mfma_f32_16x16x32_bf16 v[52:55], v[36:39], a[84:87], v[52:55]
s_add_u32 s24, s37, 2
s_cmp_ge_u32 s24, 16
s_cselect_b32 s28, 0x10000000, 0
v_add_u32 v5, s28, v1
s_waitcnt lgkmcnt(2)
v_mfma_f32_16x16x32_bf16 v[40:43], v[8:11], a[32:35], v[40:43]
ds_read_b128 v[24:27], v2 offset:10240
ds_read_b128 v[28:31], v2 offset:24576
v_mfma_f32_16x16x32_bf16 v[44:47], v[12:15], a[32:35], v[44:47]
s_add_u32 m0, s36, 0
v_mfma_f32_16x16x32_bf16 v[48:51], v[8:11], a[88:91], v[48:51]
s_add_u32 s27, s33, 0
v_mfma_f32_16x16x32_bf16 v[52:55], v[12:15], a[88:91], v[52:55]
buffer_load_dwordx4 v5, s[8:11], s27 offen lds
s_waitcnt lgkmcnt(2)
v_mfma_f32_16x16x32_bf16 v[40:43], v[16:19], a[36:39], v[40:43]
ds_read_b128 v[32:35], v2 offset:11264
ds_read_b128 v[36:39], v2 offset:25600
v_mfma_f32_16x16x32_bf16 v[44:47], v[20:23], a[36:39], v[44:47]
s_add_u32 m0, s36, 1024
v_mfma_f32_16x16x32_bf16 v[48:51], v[16:19], a[92:95], v[48:51]
s_add_u32 s27, s33, 1024
v_mfma_f32_16x16x32_bf16 v[52:55], v[20:23], a[92:95], v[52:55]
buffer_load_dwordx4 v5, s[8:11], s27 offen lds
s_waitcnt lgkmcnt(2)
v_mfma_f32_16x16x32_bf16 v[40:43], v[24:27], a[40:43], v[40:43]
ds_read_b128 v[8:11], v2 offset:12288
ds_read_b128 v[12:15], v2 offset:26624
v_mfma_f32_16x16x32_bf16 v[44:47], v[28:31], a[40:43], v[44:47]
s_add_u32 m0, s36, 2048
v_mfma_f32_16x16x32_bf16 v[48:51], v[24:27], a[96:99], v[48:51]
s_add_u32 s27, s33, 2048
v_mfma_f32_16x16x32_bf16 v[52:55], v[28:31], a[96:99], v[52:55]
buffer_load_dwordx4 v5, s[8:11], s27 offen lds
s_waitcnt lgkmcnt(2)
v_mfma_f32_16x16x32_bf16 v[40:43], v[32:35], a[44:47], v[40:43]
ds_read_b128 v[16:19], v2 offset:13312
ds_read_b128 v[20:23], v2 offset:27648
v_mfma_f32_16x16x32_bf16 v[44:47], v[36:39], a[44:47], v[44:47]
s_add_u32 m0, s36, 3072
v_mfma_f32_16x16x32_bf16 v[48:51], v[32:35], a[100:103], v[48:51]
s_add_u32 s27, s33, 3072
v_mfma_f32_16x16x32_bf16 v[52:55], v[36:39], a[100:103], v[52:55]
buffer_load_dwordx4 v5, s[8:11], s27 offen lds
s_waitcnt lgkmcnt(2)
v_mfma_f32_16x16x32_bf16 v[40:43], v[8:11], a[48:51], v[40:43]
ds_read_b128 v[24:27], v4 offset:0
ds_read_b128 v[28:31], v4 offset:14336
v_mfma_f32_16x16x32_bf16 v[44:47], v[12:15], a[48:51], v[44:47]
s_add_u32 m0, s36, 4096
v_mfma_f32_16x16x32_bf16 v[48:51], v[8:11], a[104:107], v[48:51]
s_add_u32 s27, s33, 4096
v_mfma_f32_16x16x32_bf16 v[52:55], v[12:15], a[104:107], v[52:55]
buffer_load_dwordx4 v5, s[8:11], s27 offen lds
s_waitcnt lgkmcnt(2)
v_mfma_f32_16x16x32_bf16 v[40:43], v[16:19], a[52:55], v[40:43]
ds_read_b128 v[32:35], v4 offset:1024
ds_read_b128 v[36:39], v4 offset:15360
v_mfma_f32_16x16x32_bf16 v[44:47], v[20:23], a[52:55], v[44:47]
s_add_u32 m0, s36, 5120
s_add_u32 s27, s33, 5120
v_mfma_f32_16x16x32_bf16 v[48:51], v[16:19], a[108:111], v[48:51]
buffer_load_dwordx4 v5, s[8:11], s27 offen lds
s_add_u32 m0, s36, 6144
v_mfma_f32_16x16x32_bf16 v[52:55], v[20:23], a[108:111], v[52:55]
s_add_u32 s27, s33, 6144
buffer_load_dwordx4 v5, s[8:11], s27 offen lds
s_add_u32 s33, s33, 114688
v_mov_b32 v2, v4
s_add_u32 s35, s35, 28672
s_cmp_ge_u32 s35, 86016
s_cselect_b32 s35, 0, s35
v_add_u32 v4, s35, v1
s_add_u32 s24, s35, 28672
s_cmp_ge_u32 s24, 86016
s_cselect_b32 s24, 0, s24
s_add_u32 s36, s24, s38
s_waitcnt lgkmcnt(2)
v_mfma_f32_16x16x32_bf16 v[56:59], v[24:27], a[0:3], 0
ds_read_b128 v[8:11], v2 offset:2048
v_mfma_f32_16x16x32_bf16 v[60:63], v[28:31], a[0:3], 0
ds_read_b128 v[12:15], v2 offset:16384
v_mfma_f32_16x16x32_bf16 v[64:67], v[24:27], a[56:59], 0
v_mfma_f32_16x16x32_bf16 v[68:71], v[28:31], a[56:59], 0
s_waitcnt lgkmcnt(2)
v_mfma_f32_16x16x32_bf16 v[56:59], v[32:35], a[4:7], v[56:59]
ds_read_b128 v[16:19], v2 offset:3072
ds_read_b128 v[20:23], v2 offset:17408
v_mfma_f32_16x16x32_bf16 v[60:63], v[36:39], a[4:7], v[60:63]
v_cvt_pk_bf16_f32 v72, v40, v41
v_cvt_pk_bf16_f32 v73, v42, v43
v_mfma_f32_16x16x32_bf16 v[64:67], v[32:35], a[60:63], v[64:67]
v_cvt_pk_bf16_f32 v74, v44, v45
v_mfma_f32_16x16x32_bf16 v[68:71], v[36:39], a[60:63], v[68:71]
v_cvt_pk_bf16_f32 v75, v46, v47
s_waitcnt lgkmcnt(2)
v_mfma_f32_16x16x32_bf16 v[56:59], v[8:11], a[8:11], v[56:59]
ds_read_b128 v[24:27], v2 offset:4096
ds_read_b128 v[28:31], v2 offset:18432
v_mfma_f32_16x16x32_bf16 v[60:63], v[12:15], a[8:11], v[60:63]
v_cvt_pk_bf16_f32 v76, v48, v49
v_cvt_pk_bf16_f32 v77, v50, v51
v_mfma_f32_16x16x32_bf16 v[64:67], v[8:11], a[64:67], v[64:67]
v_cvt_pk_bf16_f32 v78, v52, v53
v_mfma_f32_16x16x32_bf16 v[68:71], v[12:15], a[64:67], v[68:71]
v_cvt_pk_bf16_f32 v79, v54, v55
s_waitcnt lgkmcnt(2)
v_mfma_f32_16x16x32_bf16 v[56:59], v[16:19], a[12:15], v[56:59]
ds_read_b128 v[32:35], v2 offset:5120
ds_read_b128 v[36:39], v2 offset:19456
buffer_store_dwordx4 v[72:75], v3, s[8:11], s34 offen sc1
s_add_u32 s39, s34, 4096
buffer_store_dwordx4 v[76:79], v3, s[8:11], s39 offen sc1
s_add_u32 s34, s34, 1835008
v_mfma_f32_16x16x32_bf16 v[60:63], v[20:23], a[12:15], v[60:63]
v_mfma_f32_16x16x32_bf16 v[64:67], v[16:19], a[68:71], v[64:67]
v_mfma_f32_16x16x32_bf16 v[68:71], v[20:23], a[68:71], v[68:71]
s_waitcnt lgkmcnt(2)
v_mfma_f32_16x16x32_bf16 v[56:59], v[24:27], a[16:19], v[56:59]
ds_read_b128 v[8:11], v2 offset:6144
v_mfma_f32_16x16x32_bf16 v[60:63], v[28:31], a[16:19], v[60:63]
ds_read_b128 v[12:15], v2 offset:20480
v_mfma_f32_16x16x32_bf16 v[64:67], v[24:27], a[72:75], v[64:67]
v_mfma_f32_16x16x32_bf16 v[68:71], v[28:31], a[72:75], v[68:71]
s_waitcnt lgkmcnt(2)
v_mfma_f32_16x16x32_bf16 v[56:59], v[32:35], a[20:23], v[56:59]
ds_read_b128 v[16:19], v2 offset:7168
v_mfma_f32_16x16x32_bf16 v[60:63], v[36:39], a[20:23], v[60:63]
ds_read_b128 v[20:23], v2 offset:21504
v_mfma_f32_16x16x32_bf16 v[64:67], v[32:35], a[76:79], v[64:67]
v_mfma_f32_16x16x32_bf16 v[68:71], v[36:39], a[76:79], v[68:71]
s_waitcnt lgkmcnt(2)
v_mfma_f32_16x16x32_bf16 v[56:59], v[8:11], a[24:27], v[56:59]
ds_read_b128 v[24:27], v2 offset:8192
v_mfma_f32_16x16x32_bf16 v[60:63], v[12:15], a[24:27], v[60:63]
ds_read_b128 v[28:31], v2 offset:22528
v_mfma_f32_16x16x32_bf16 v[64:67], v[8:11], a[80:83], v[64:67]
v_mfma_f32_16x16x32_bf16 v[68:71], v[12:15], a[80:83], v[68:71]
s_waitcnt lgkmcnt(2)
v_mfma_f32_16x16x32_bf16 v[56:59], v[16:19], a[28:31], v[56:59]
ds_read_b128 v[32:35], v2 offset:9216
ds_read_b128 v[36:39], v2 offset:23552
s_waitcnt vmcnt(2)
s_barrier
s_cmp_eq_u32 s37, 0
s_cbranch_scc1 .Ldfl_271
buffer_store_dword v81, v80, s[8:11], s40 offen sc1
s_add_u32 s40, s40, 896
.Ldfl_271:
v_mfma_f32_16x16x32_bf16 v[60:63], v[20:23], a[28:31], v[60:63]
v_mfma_f32_16x16x32_bf16 v[64:67], v[16:19], a[84:87], v[64:67]
v_mfma_f32_16x16x32_bf16 v[68:71], v[20:23], a[84:87], v[68:71]
s_add_u32 s24, s37, 3
s_cmp_ge_u32 s24, 16
s_cselect_b32 s28, 0x10000000, 0
v_add_u32 v5, s28, v1
s_waitcnt lgkmcnt(2)
v_mfma_f32_16x16x32_bf16 v[56:59], v[24:27], a[32:35], v[56:59]
ds_read_b128 v[8:11], v2 offset:10240
ds_read_b128 v[12:15], v2 offset:24576
v_mfma_f32_16x16x32_bf16 v[60:63], v[28:31], a[32:35], v[60:63]
s_add_u32 m0, s36, 0
v_mfma_f32_16x16x32_bf16 v[64:67], v[24:27], a[88:91], v[64:67]
s_add_u32 s27, s33, 0
v_mfma_f32_16x16x32_bf16 v[68:71], v[28:31], a[88:91], v[68:71]
buffer_load_dwordx4 v5, s[8:11], s27 offen lds
s_waitcnt lgkmcnt(2)
v_mfma_f32_16x16x32_bf16 v[56:59], v[32:35], a[36:39], v[56:59]
ds_read_b128 v[16:19], v2 offset:11264
ds_read_b128 v[20:23], v2 offset:25600
v_mfma_f32_16x16x32_bf16 v[60:63], v[36:39], a[36:39], v[60:63]
s_add_u32 m0, s36, 1024
v_mfma_f32_16x16x32_bf16 v[64:67], v[32:35], a[92:95], v[64:67]
s_add_u32 s27, s33, 1024
v_mfma_f32_16x16x32_bf16 v[68:71], v[36:39], a[92:95], v[68:71]
buffer_load_dwordx4 v5, s[8:11], s27 offen lds
s_waitcnt lgkmcnt(2)
v_mfma_f32_16x16x32_bf16 v[56:59], v[8:11], a[40:43], v[56:59]
ds_read_b128 v[24:27], v2 offset:12288
ds_read_b128 v[28:31], v2 offset:26624
v_mfma_f32_16x16x32_bf16 v[60:63], v[12:15], a[40:43], v[60:63]
s_add_u32 m0, s36, 2048
v_mfma_f32_16x16x32_bf16 v[64:67], v[8:11], a[96:99], v[64:67]
s_add_u32 s27, s33, 2048
v_mfma_f32_16x16x32_bf16 v[68:71], v[12:15], a[96:99], v[68:71]
buffer_load_dwordx4 v5, s[8:11], s27 offen lds
s_waitcnt lgkmcnt(2)
v_mfma_f32_16x16x32_bf16 v[56:59], v[16:19], a[44:47], v[56:59]
ds_read_b128 v[32:35], v2 offset:13312
ds_read_b128 v[36:39], v2 offset:27648
v_mfma_f32_16x16x32_bf16 v[60:63], v[20:23], a[44:47], v[60:63]
s_add_u32 m0, s36, 3072
v_mfma_f32_16x16x32_bf16 v[64:67], v[16:19], a[100:103], v[64:67]
s_add_u32 s27, s33, 3072
v_mfma_f32_16x16x32_bf16 v[68:71], v[20:23], a[100:103], v[68:71]
buffer_load_dwordx4 v5, s[8:11], s27 offen lds
s_waitcnt lgkmcnt(2)
v_mfma_f32_16x16x32_bf16 v[56:59], v[24:27], a[48:51], v[56:59]
ds_read_b128 v[8:11], v4 offset:0
ds_read_b128 v[12:15], v4 offset:14336
v_mfma_f32_16x16x32_bf16 v[60:63], v[28:31], a[48:51], v[60:63]
s_add_u32 m0, s36, 4096
v_mfma_f32_16x16x32_bf16 v[64:67], v[24:27], a[104:107], v[64:67]
s_add_u32 s27, s33, 4096
v_mfma_f32_16x16x32_bf16 v[68:71], v[28:31], a[104:107], v[68:71]
buffer_load_dwordx4 v5, s[8:11], s27 offen lds
s_waitcnt lgkmcnt(2)
v_mfma_f32_16x16x32_bf16 v[56:59], v[32:35], a[52:55], v[56:59]
ds_read_b128 v[16:19], v4 offset:1024
ds_read_b128 v[20:23], v4 offset:15360
v_mfma_f32_16x16x32_bf16 v[60:63], v[36:39], a[52:55], v[60:63]
s_add_u32 m0, s36, 5120
s_add_u32 s27, s33, 5120
v_mfma_f32_16x16x32_bf16 v[64:67], v[32:35], a[108:111], v[64:67]
buffer_load_dwordx4 v5, s[8:11], s27 offen lds
s_add_u32 m0, s36, 6144
v_mfma_f32_16x16x32_bf16 v[68:71], v[36:39], a[108:111], v[68:71]
s_add_u32 s27, s33, 6144
buffer_load_dwordx4 v5, s[8:11], s27 offen lds
s_add_u32 s33, s33, 114688
v_mov_b32 v2, v4
s_add_u32 s35, s35, 28672
s_cmp_ge_u32 s35, 86016
s_cselect_b32 s35, 0, s35
v_add_u32 v4, s35, v1
s_add_u32 s24, s35, 28672
s_cmp_ge_u32 s24, 86016
s_cselect_b32 s24, 0, s24
s_add_u32 s36, s24, s38
s_add_u32 s37, s37, 2
s_cmp_lt_u32 s37, 16
s_cbranch_scc1 .Ldloop_266
s_nop 7
v_cvt_pk_bf16_f32 v72, v56, v57
v_cvt_pk_bf16_f32 v73, v58, v59
v_cvt_pk_bf16_f32 v74, v60, v61
v_cvt_pk_bf16_f32 v75, v62, v63
v_cvt_pk_bf16_f32 v76, v64, v65
v_cvt_pk_bf16_f32 v77, v66, v67
v_cvt_pk_bf16_f32 v78, v68, v69
v_cvt_pk_bf16_f32 v79, v70, v71
buffer_store_dwordx4 v[72:75], v3, s[8:11], s34 offen sc1
s_add_u32 s39, s34, 4096
buffer_store_dwordx4 v[76:79], v3, s[8:11], s39 offen sc1
s_waitcnt vmcnt(0) lgkmcnt(0)
s_barrier
buffer_store_dword v81, v80, s[8:11], s40 offen sc1
s_add_u32 s40, s40, 896
buffer_store_dword v81, v80, s[8:11], s40 offen sc1
s_barrier
s_mov_b32 s39, 8000
s_and_b32 s18, s58, 3
s_lshr_b32 s21, s58, 2
s_cmp_ge_u32 s58, 64
s_cbranch_scc1 .Ldq_273
s_and_b32 s21, s58, 31
s_lshr_b32 s21, s21, 1
s_and_b32 s18, s58, 1
s_cmp_lt_u32 s58, 32
s_cselect_b32 s16, 2, 0
s_add_u32 s18, s18, s16
.Ldq_273:
s_lshr_b32 s16, s21, 2
s_and_b32 s19, s21, 3
s_lshl_b32 s21, s58, 2
s_add_u32 s21, s21, s17
s_lshl_b32 s21, s21, 6
v_add_u32 v2, s21, v0
v_lshlrev_b32 v3, 4, v2
v_mov_b32 v11, 0x10000000
v_mov_b32 v4, -1
v_mov_b32 v5, -1
v_mov_b32 v6, -1
v_mov_b32 v7, -1
v_lshrrev_b32 v9, 5, v2
v_mul_u32_u24 v9, 4096, v9
v_and_b32 v10, 31, v2
v_lshlrev_b32 v10, 4, v10
v_add_u32 v9, v9, v10
s_mov_b32 s22, 14400
v_cmp_gt_u32 vcc, s22, v2
s_nop 1
v_cndmask_b32 v9, v11, v9, vcc
s_lshl_b32 s21, s17, 6
v_add_u32 v10, s21, v0
s_movk_i32 s22, 256
v_cmp_gt_u32 vcc, s22, v10
v_lshrrev_b32 v8, 7, v10
v_mul_u32_u24 v8, 458752, v8
v_and_b32 v10, 127, v10
v_lshlrev_b32 v10, 4, v10
v_add_u32 v10, v10, v8
s_add_u32 s21, s18, 56
s_mul_i32 s21, s21, 14
s_add_u32 s21, s21, s16
s_lshl_b32 s21, s21, 13
s_lshl_b32 s22, s19, 11
s_add_u32 s24, s21, s22
v_cndmask_b32 v10, v11, v10, vcc
s_mov_b32 s22, 327680
v_cmp_gt_u32 vcc, s22, v3
s_nop 1
v_cndmask_b32 v8, v11, v3, vcc
s_mov_b32 s23, 67796992
buffer_store_dwordx4 v[4:7], v8, s[8:11], s23 offen sc1
s_mov_b32 s22, 229376
v_cmp_gt_u32 vcc, s22, v3
s_nop 1
v_cndmask_b32 v8, v11, v3, vcc
s_mov_b32 s23, 56397824
buffer_store_dwordx4 v[4:7], v8, s[8:11], s23 offen sc1
s_mov_b32 s23, 60674048
buffer_store_dwordx4 v[4:7], v3, s[8:11], s23 offen sc1
s_mov_b32 s23, 61591552
buffer_store_dwordx4 v[4:7], v3, s[8:11], s23 offen sc1
s_mov_b32 s22, 8192
v_cmp_gt_u32 vcc, s22, v3
s_nop 1
v_cndmask_b32 v8, v11, v3, vcc
s_mov_b32 s23, 62509056
buffer_store_dwordx4 v[4:7], v8, s[8:11], s23 offen sc1
s_mov_b32 s23, 58465792
buffer_store_dwordx4 v[4:7], v9, s[8:11], s23 offen sc1
s_add_u32 s23, s24, 101945344
buffer_store_dwordx4 v[4:7], v10, s[8:11], s23 offen sc1
s_mov_b32 s22, 327680
v_cmp_gt_u32 vcc, s22, v3
s_nop 1
v_cndmask_b32 v8, v11, v3, vcc
s_mov_b32 s23, 117764096
buffer_store_dwordx4 v[4:7], v8, s[8:11], s23 offen sc1
s_mov_b32 s22, 229376
v_cmp_gt_u32 vcc, s22, v3
s_nop 1
v_cndmask_b32 v8, v11, v3, vcc
s_mov_b32 s23, 110891008
buffer_store_dwordx4 v[4:7], v8, s[8:11], s23 offen sc1
s_mov_b32 s23, 113332224
buffer_store_dwordx4 v[4:7], v3, s[8:11], s23 offen sc1
s_mov_b32 s23, 114249728
buffer_store_dwordx4 v[4:7], v3, s[8:11], s23 offen sc1
s_mov_b32 s22, 8192
v_cmp_gt_u32 vcc, s22, v3
s_nop 1
v_cndmask_b32 v8, v11, v3, vcc
s_mov_b32 s23, 115167232
buffer_store_dwordx4 v[4:7], v8, s[8:11], s23 offen sc1
s_mov_b32 s22, 458752
v_cmp_gt_u32 vcc, s22, v3
s_nop 1
v_cndmask_b32 v8, v11, v3, vcc
s_mov_b32 s23, 72056832
buffer_store_dwordx4 v[4:7], v8, s[8:11], s23 offen sc1
s_mov_b32 s23, 111123968
buffer_store_dwordx4 v[4:7], v9, s[8:11], s23 offen sc1
s_mov_b32 s23, 56627200
buffer_store_dwordx4 v[4:7], v3, s[8:11], s23 offen sc1
s_mov_b32 s23, 57544704
buffer_store_dwordx4 v[4:7], v3, s[8:11], s23 offen sc1
s_lshl_b32 s24, s58, 2
s_add_u32 s24, s24, 68222976
s_lshl_b32 s25, s17, 6
v_add_u32 v4, s25, v0
v_cmp_eq_u32 vcc, 0, v4
v_mov_b32 v4, 0x10000000
v_mov_b32 v5, 1
v_cndmask_b32 v4, v4, 0, vcc
s_waitcnt vmcnt(0) lgkmcnt(0)
s_barrier
buffer_store_dword v5, v4, s[8:11], s24 offen sc1
s_cmp_lg_u32 s17, 0
s_cbranch_scc1 .Lww_274
s_mov_b32 s24, 68222976
v_lshlrev_b32 v248, 4, v0
v_mov_b32 v252, 0x10000000
v_cmp_gt_u32 vcc, 56, v0
s_mov_b32 s25, s39
s_nop 0
v_cndmask_b32 v248, v252, v248, vcc
.Lwr_275:
buffer_load_dwordx4 v[252:255], v248, s[8:11], s24 offen sc1
s_waitcnt vmcnt(0)
s_mov_b32 s26, 0
v_cmp_eq_u32 vcc, 1, v252
s_nop 1
s_and_b32 vcc_lo, vcc_lo, 0xffffffff
s_and_b32 vcc_hi, vcc_hi, 0xffffff
s_bcnt1_i32_b64 s27, vcc
s_add_u32 s26, s26, s27
v_cmp_eq_u32 vcc, 1, v253
s_nop 1
s_and_b32 vcc_lo, vcc_lo, 0xffffffff
s_and_b32 vcc_hi, vcc_hi, 0xffffff
s_bcnt1_i32_b64 s27, vcc
s_add_u32 s26, s26, s27
v_cmp_eq_u32 vcc, 1, v254
s_nop 1
s_and_b32 vcc_lo, vcc_lo, 0xffffffff
s_and_b32 vcc_hi, vcc_hi, 0xffffff
s_bcnt1_i32_b64 s27, vcc
s_add_u32 s26, s26, s27
v_cmp_eq_u32 vcc, 1, v255
s_nop 1
s_and_b32 vcc_lo, vcc_lo, 0xffffffff
s_and_b32 vcc_hi, vcc_hi, 0xffffff
s_bcnt1_i32_b64 s27, vcc
s_add_u32 s26, s26, s27
s_cmp_eq_u32 s26, 224
s_cbranch_scc1 .Lwo_276
s_sleep 8
s_sub_u32 s25, s25, 1
s_cbranch_scc0 .Lwr_275
s_mov_b32 s39, 0
.Lwo_276:
.Lww_274:
s_barrier
s_mov_b32 s39, 8000
s_cmp_ge_u32 s58, 112
s_cbranch_scc1 .Lj2_255
s_mul_i32 s16, s58, 147
s_lshr_b32 s16, s16, 10
s_mul_i32 s18, s16, 7
s_sub_u32 s18, s58, s18
s_cmp_eq_u32 s18, 0
s_cselect_b32 s19, 10, 9
s_mul_i32 s30, s16, 448
s_add_u32 s30, s30, 118222848
s_cmp_lg_u32 s17, 0
s_cbranch_scc1 .Lww_277
s_mov_b32 s24, s30
v_lshlrev_b32 v248, 4, v0
v_mov_b32 v252, 0x10000000
v_cmp_gt_u32 vcc, 28, v0
s_mov_b32 s25, s39
s_nop 0
v_cndmask_b32 v248, v252, v248, vcc
.Lwr_278:
buffer_load_dwordx4 v[252:255], v248, s[8:11], s24 offen sc1
s_waitcnt vmcnt(0)
s_mov_b32 s26, 0
v_cmp_eq_u32 vcc, 1, v252
s_nop 1
s_and_b32 vcc_lo, vcc_lo, 0xfffffff
s_and_b32 vcc_hi, vcc_hi, 0x0
s_bcnt1_i32_b64 s27, vcc
s_add_u32 s26, s26, s27
v_cmp_eq_u32 vcc, 1, v253
s_nop 1
s_and_b32 vcc_lo, vcc_lo, 0xfffffff
s_and_b32 vcc_hi, vcc_hi, 0x0
s_bcnt1_i32_b64 s27, vcc
s_add_u32 s26, s26, s27
v_cmp_eq_u32 vcc, 1, v254
s_nop 1
s_and_b32 vcc_lo, vcc_lo, 0xfffffff
s_and_b32 vcc_hi, vcc_hi, 0x0
s_bcnt1_i32_b64 s27, vcc
s_add_u32 s26, s26, s27
v_cmp_eq_u32 vcc, 1, v255
s_nop 1
s_and_b32 vcc_lo, vcc_lo, 0xfffffff
s_and_b32 vcc_hi, vcc_hi, 0x0
s_bcnt1_i32_b64 s27, vcc
s_add_u32 s26, s26, s27
s_cmp_eq_u32 s26, 112
s_cbranch_scc1 .Lwo_279
s_sleep 2
s_sub_u32 s25, s25, 1
s_cbranch_scc0 .Lwr_278
s_mov_b32 s39, 0
.Lwo_279:
.Lww_277:
s_barrier
v_lshlrev_b32 v1, 4, v0
s_lshl_b32 s24, s16, 2
s_add_u32 s24, s24, s17
s_mul_i32 s32, s24, 100352
s_add_u32 s32, s32, 0
s_mov_b32 s33, s18
s_mov_b32 s37, s33
s_mov_b32 s38, 0
v_mov_b32 v15, v1
s_cmp_eq_u32 s17, 3
s_cselect_b32 s24, 0x10000000, 0
v_add_u32 v14, s24, v1
s_mul_i32 s24, s37, 28672
s_mul_i32 s25, s17, 7168
s_add_u32 s24, s24, s25
s_mul_i32 s26, s38, 28672
s_add_u32 s26, s26, s25
s_mul_i32 s27, s37, 7168
s_lshl_b32 s29, s17, 10
s_add_u32 s27, s27, s29
s_lshl_b32 s28, s38, 13
s_add_u32 s28, s28, s29
s_add_u32 m0, s26, 0
s_add_u32 s30, s24, 12845056
buffer_load_dwordx4 v15, s[8:11], s30 offen lds
s_add_u32 m0, s26, 1024
s_add_u32 s30, s24, 12846080
buffer_load_dwordx4 v15, s[8:11], s30 offen lds
s_add_u32 m0, s26, 2048
s_add_u32 s30, s24, 12847104
buffer_load_dwordx4 v15, s[8:11], s30 offen lds
s_add_u32 m0, s26, 3072
s_add_u32 s30, s24, 12848128
buffer_load_dwordx4 v15, s[8:11], s30 offen lds
s_add_u32 m0, s26, 4096
s_add_u32 s30, s24, 12849152
buffer_load_dwordx4 v15, s[8:11], s30 offen lds
s_add_u32 m0, s26, 5120
s_add_u32 s30, s24, 12850176
buffer_load_dwordx4 v15, s[8:11], s30 offen lds
s_add_u32 m0, s26, 6144
s_add_u32 s30, s24, 12851200
buffer_load_dwordx4 v15, s[8:11], s30 offen lds
s_add_u32 m0, s26, 57344
s_add_u32 s30, s24, 14680064
buffer_load_dwordx4 v15, s[8:11], s30 offen lds
s_add_u32 m0, s26, 58368
s_add_u32 s30, s24, 14681088
buffer_load_dwordx4 v15, s[8:11], s30 offen lds
s_add_u32 m0, s26, 59392
s_add_u32 s30, s24, 14682112
buffer_load_dwordx4 v15, s[8:11], s30 offen lds
s_add_u32 m0, s26, 60416
s_add_u32 s30, s24, 14683136
buffer_load_dwordx4 v15, s[8:11], s30 offen lds
s_add_u32 m0, s26, 61440
s_add_u32 s30, s24, 14684160
buffer_load_dwordx4 v15, s[8:11], s30 offen lds
s_add_u32 m0, s26, 62464
s_add_u32 s30, s24, 14685184
buffer_load_dwordx4 v15, s[8:11], s30 offen lds
s_add_u32 m0, s26, 63488
s_add_u32 s30, s24, 14686208
buffer_load_dwordx4 v15, s[8:11], s30 offen lds
buffer_load_dwordx4 a[0:3], v1, s[8:11], s32 offen offset:0
buffer_load_dwordx4 a[4:7], v1, s[8:11], s32 offen offset:1024
buffer_load_dwordx4 a[8:11], v1, s[8:11], s32 offen offset:2048
buffer_load_dwordx4 a[12:15], v1, s[8:11], s32 offen offset:3072
s_add_u32 s32, s32, 4096
buffer_load_dwordx4 a[16:19], v1, s[8:11], s32 offen offset:0
buffer_load_dwordx4 a[20:23], v1, s[8:11], s32 offen offset:1024
buffer_load_dwordx4 a[24:27], v1, s[8:11], s32 offen offset:2048
buffer_load_dwordx4 a[28:31], v1, s[8:11], s32 offen offset:3072
s_add_u32 s32, s32, 4096
buffer_load_dwordx4 a[32:35], v1, s[8:11], s32 offen offset:0
buffer_load_dwordx4 a[36:39], v1, s[8:11], s32 offen offset:1024
buffer_load_dwordx4 a[40:43], v1, s[8:11], s32 offen offset:2048
buffer_load_dwordx4 a[44:47], v1, s[8:11], s32 offen offset:3072
s_add_u32 s32, s32, 4096
buffer_load_dwordx4 a[48:51], v1, s[8:11], s32 offen offset:0
buffer_load_dwordx4 a[52:55], v1, s[8:11], s32 offen offset:1024
buffer_load_dwordx4 a[56:59], v1, s[8:11], s32 offen offset:2048
buffer_load_dwordx4 a[60:63], v1, s[8:11], s32 offen offset:3072
s_add_u32 s32, s32, 4096
buffer_load_dwordx4 a[64:67], v1, s[8:11], s32 offen offset:0
buffer_load_dwordx4 a[68:71], v1, s[8:11], s32 offen offset:1024
buffer_load_dwordx4 a[72:75], v1, s[8:11], s32 offen offset:2048
buffer_load_dwordx4 a[76:79], v1, s[8:11], s32 offen offset:3072
s_add_u32 s32, s32, 4096
buffer_load_dwordx4 a[80:83], v1, s[8:11], s32 offen offset:0
buffer_load_dwordx4 a[84:87], v1, s[8:11], s32 offen offset:1024
buffer_load_dwordx4 a[88:91], v1, s[8:11], s32 offen offset:2048
buffer_load_dwordx4 a[92:95], v1, s[8:11], s32 offen offset:3072
s_add_u32 s32, s32, 4096
buffer_load_dwordx4 a[96:99], v1, s[8:11], s32 offen offset:0
buffer_load_dwordx4 a[100:103], v1, s[8:11], s32 offen offset:1024
buffer_load_dwordx4 a[104:107], v1, s[8:11], s32 offen offset:2048
buffer_load_dwordx4 a[108:111], v1, s[8:11], s32 offen offset:3072
s_add_u32 s32, s32, 4096
buffer_load_dwordx4 a[112:115], v1, s[8:11], s32 offen offset:0
buffer_load_dwordx4 a[116:119], v1, s[8:11], s32 offen offset:1024
buffer_load_dwordx4 a[120:123], v1, s[8:11], s32 offen offset:2048
buffer_load_dwordx4 a[124:127], v1, s[8:11], s32 offen offset:3072
s_add_u32 s32, s32, 4096
buffer_load_dwordx4 a[128:131], v1, s[8:11], s32 offen offset:0
buffer_load_dwordx4 a[132:135], v1, s[8:11], s32 offen offset:1024
buffer_load_dwordx4 a[136:139], v1, s[8:11], s32 offen offset:2048
buffer_load_dwordx4 a[140:143], v1, s[8:11], s32 offen offset:3072
s_add_u32 s32, s32, 4096
buffer_load_dwordx4 a[144:147], v1, s[8:11], s32 offen offset:0
buffer_load_dwordx4 a[148:151], v1, s[8:11], s32 offen offset:1024
buffer_load_dwordx4 a[152:155], v1, s[8:11], s32 offen offset:2048
buffer_load_dwordx4 a[156:159], v1, s[8:11], s32 offen offset:3072
s_add_u32 s32, s32, 4096
buffer_load_dwordx4 a[160:163], v1, s[8:11], s32 offen offset:0
s_waitcnt vmcnt(20)
buffer_load_dwordx4 a[164:167], v1, s[8:11], s32 offen offset:1024
buffer_load_dwordx4 a[168:171], v1, s[8:11], s32 offen offset:2048
buffer_load_dwordx4 a[172:175], v1, s[8:11], s32 offen offset:3072
s_add_u32 s32, s32, 4096
buffer_load_dwordx4 a[176:179], v1, s[8:11], s32 offen offset:0
buffer_load_dwordx4 a[180:183], v1, s[8:11], s32 offen offset:1024
buffer_load_dwordx4 a[184:187], v1, s[8:11], s32 offen offset:2048
buffer_load_dwordx4 a[188:191], v1, s[8:11], s32 offen offset:3072
s_add_u32 s32, s32, 4096
buffer_load_dwordx4 a[192:195], v1, s[8:11], s32 offen offset:0
buffer_load_dwordx4 a[196:199], v1, s[8:11], s32 offen offset:1024
buffer_load_dwordx4 a[200:203], v1, s[8:11], s32 offen offset:2048
buffer_load_dwordx4 a[204:207], v1, s[8:11], s32 offen offset:3072
s_add_u32 s32, s32, 4096
buffer_load_dwordx4 a[208:211], v1, s[8:11], s32 offen offset:0
buffer_load_dwordx4 a[212:215], v1, s[8:11], s32 offen offset:1024
buffer_load_dwordx4 a[216:219], v1, s[8:11], s32 offen offset:2048
buffer_load_dwordx4 a[220:223], v1, s[8:11], s32 offen offset:3072
s_add_u32 s32, s32, 4096
buffer_load_dwordx4 a[224:227], v1, s[8:11], s32 offen offset:0
buffer_load_dwordx4 a[228:231], v1, s[8:11], s32 offen offset:1024
buffer_load_dwordx4 a[232:235], v1, s[8:11], s32 offen offset:2048
buffer_load_dwordx4 a[236:239], v1, s[8:11], s32 offen offset:3072
s_add_u32 s32, s32, 4096
buffer_load_dwordx4 a[240:243], v1, s[8:11], s32 offen offset:0
buffer_load_dwordx4 a[244:247], v1, s[8:11], s32 offen offset:1024
buffer_load_dwordx4 a[248:251], v1, s[8:11], s32 offen offset:2048
buffer_load_dwordx4 a[252:255], v1, s[8:11], s32 offen offset:3072
s_add_u32 s32, s32, 4096
buffer_load_dwordx4 v[120:123], v1, s[8:11], s32 offen offset:0
buffer_load_dwordx4 v[124:127], v1, s[8:11], s32 offen offset:1024
buffer_load_dwordx4 v[128:131], v1, s[8:11], s32 offen offset:2048
buffer_load_dwordx4 v[132:135], v1, s[8:11], s32 offen offset:3072
s_add_u32 s32, s32, 4096
buffer_load_dwordx4 v[136:139], v1, s[8:11], s32 offen offset:0
buffer_load_dwordx4 v[140:143], v1, s[8:11], s32 offen offset:1024
buffer_load_dwordx4 v[144:147], v1, s[8:11], s32 offen offset:2048
buffer_load_dwordx4 v[148:151], v1, s[8:11], s32 offen offset:3072
s_add_u32 s32, s32, 4096
buffer_load_dwordx4 v[152:155], v1, s[8:11], s32 offen offset:0
buffer_load_dwordx4 v[156:159], v1, s[8:11], s32 offen offset:1024
buffer_load_dwordx4 v[160:163], v1, s[8:11], s32 offen offset:2048
buffer_load_dwordx4 v[164:167], v1, s[8:11], s32 offen offset:3072
s_add_u32 s32, s32, 4096
buffer_load_dwordx4 v[168:171], v1, s[8:11], s32 offen offset:0
buffer_load_dwordx4 v[172:175], v1, s[8:11], s32 offen offset:1024
buffer_load_dwordx4 v[176:179], v1, s[8:11], s32 offen offset:2048
buffer_load_dwordx4 v[180:183], v1, s[8:11], s32 offen offset:3072
s_add_u32 s32, s32, 4096
buffer_load_dwordx4 v[184:187], v1, s[8:11], s32 offen offset:0
s_waitcnt vmcnt(20)
buffer_load_dwordx4 v[188:191], v1, s[8:11], s32 offen offset:1024
buffer_load_dwordx4 v[192:195], v1, s[8:11], s32 offen offset:2048
buffer_load_dwordx4 v[196:199], v1, s[8:11], s32 offen offset:3072
s_add_u32 s32, s32, 4096
buffer_load_dwordx4 v[200:203], v1, s[8:11], s32 offen offset:0
buffer_load_dwordx4 v[204:207], v1, s[8:11], s32 offen offset:1024
buffer_load_dwordx4 v[208:211], v1, s[8:11], s32 offen offset:2048
buffer_load_dwordx4 v[212:215], v1, s[8:11], s32 offen offset:3072
s_add_u32 s32, s32, 4096
buffer_load_dwordx4 v[216:219], v1, s[8:11], s32 offen offset:0
buffer_load_dwordx4 v[220:223], v1, s[8:11], s32 offen offset:1024
buffer_load_dwordx4 v[224:227], v1, s[8:11], s32 offen offset:2048
buffer_load_dwordx4 v[228:231], v1, s[8:11], s32 offen offset:3072
s_add_u32 s32, s32, 4096
buffer_load_dwordx4 v[232:235], v1, s[8:11], s32 offen offset:0
buffer_load_dwordx4 v[236:239], v1, s[8:11], s32 offen offset:1024
buffer_load_dwordx4 v[240:243], v1, s[8:11], s32 offen offset:2048
buffer_load_dwordx4 v[244:247], v1, s[8:11], s32 offen offset:3072
s_add_u32 s32, s32, 4096
buffer_load_dwordx4 v[248:251], v1, s[8:11], s32 offen offset:0
buffer_load_dwordx4 v[252:255], v1, s[8:11], s32 offen offset:1024
v_and_b32 v11, 15, v0
v_lshrrev_b32 v12, 4, v0
v_and_b32 v13, 7, v0
v_lshlrev_b32 v13, 4, v13
s_mul_i32 s24, s17, 1792
s_add_u32 s24, s24, 0
v_lshlrev_b32 v3, 7, v12
v_add3_u32 v3, v3, v13, s24
v_lshrrev_b32 v4, 1, v12
v_lshlrev_b32 v4, 7, v4
v_and_b32 v2, 1, v12
v_lshlrev_b32 v2, 3, v2
s_add_u32 s24, s24, 1536
v_add3_u32 v4, v4, v13, s24
v_add_u32 v4, v4, v2
s_mul_i32 s24, s17, 7168
s_add_u32 s24, s24, 57344
v_add_u32 v5, s24, v1
s_add_u32 s24, s24, 6144
v_lshlrev_b32 v6, 3, v0
v_add_u32 v6, s24, v6
s_mul_i32 s24, s17, 6144
s_add_u32 s24, s24, 131072
v_add_u32 v7, s24, v1
s_and_b32 s25, s17, 1
s_lshl_b32 s24, s25, 10
s_add_u32 s24, s24, 131072
v_add_u32 v8, s24, v1
v_lshrrev_b32 v88, 3, v11
v_lshlrev_b32 v88, 4, v88
v_lshrrev_b32 v89, 2, v11
v_and_b32 v89, 1, v89
v_lshlrev_b32 v89, 2, v89
v_and_b32 v90, 3, v11
v_add3_u32 v88, v88, v89, v90
s_lshl_b32 s24, s25, 3
v_add_u32 v88, s24, v88
v_lshrrev_b32 v89, 1, v12
v_lshlrev_b32 v89, 1, v89
v_and_b32 v90, 1, v12
v_lshlrev_b32 v90, 2, v90
v_add_u32 v89, v89, v90
v_add_u32 v90, 0, v89
v_cmp_le_u32 s[40:41], v90, v88
v_add_u32 v90, 1, v89
v_cmp_le_u32 s[42:43], v90, v88
v_add_u32 v90, 8, v89
v_cmp_le_u32 s[44:45], v90, v88
v_add_u32 v90, 9, v89
v_cmp_le_u32 s[46:47], v90, v88
v_add_u32 v90, 16, v89
v_cmp_le_u32 s[48:49], v90, v88
v_add_u32 v90, 17, v89
v_cmp_le_u32 s[50:51], v90, v88
v_add_u32 v90, 24, v89
v_cmp_le_u32 s[52:53], v90, v88
v_add_u32 v90, 25, v89
v_cmp_le_u32 s[54:55], v90, v88
v_cmp_gt_u32 s[56:57], 2, v12
s_lshr_b32 s24, s16, 2
s_lshr_b32 s26, s16, 1
s_and_b32 s26, s26, 1
s_and_b32 s27, s16, 1
s_lshl_b32 s28, s24, 13
s_lshl_b32 s29, s26, 12
s_add_u32 s28, s28, s29
s_lshl_b32 s29, s25, 10
s_add_u32 s28, s28, s29
s_lshl_b32 s29, s27, 9
s_add_u32 s28, s28, s29
v_lshrrev_b32 v88, 5, v0
v_lshlrev_b32 v88, 11, v88
v_and_b32 v89, 31, v0
v_lshlrev_b32 v89, 4, v89
v_add3_u32 v9, v88, v89, s28
s_lshl_b32 s28, s24, 11
s_lshl_b32 s30, s25, 10
s_add_u32 s28, s28, s30
s_add_u32 s28, s28, s29
s_lshl_b32 s30, s26, 3
s_add_u32 s28, s28, s30
s_add_u32 s28, s28, 32768
v_add_u32 v89, s28, v89
v_mov_b32 v88, 0x10000000
v_cndmask_b32 v10, v88, v89, s[56:57]
s_mov_b32 s34, 0
s_mov_b32 s39, 4000
s_waitcnt vmcnt(0)
.Lj1loop_280:
s_barrier
s_mul_i32 s24, s38, 28672
v_add_u32 v2, s24, v1
s_xor_b32 s38, s38, 1
s_add_u32 s37, s33, 7
s_add_u32 s24, s34, 1
s_cmp_ge_u32 s24, s19
s_cselect_b32 s24, 0x10000000, 0
v_add_u32 v15, s24, v1
s_cmp_eq_u32 s17, 3
s_cselect_b32 s24, 0x10000000, s24
v_add_u32 v14, s24, v1
ds_read_b128 v[16:19], v2 offset:0
ds_read_b128 v[20:23], v2 offset:14336
s_waitcnt lgkmcnt(0)
v_mfma_f32_16x16x32_bf16 v[32:35], a[0:3], v[16:19], 0
ds_read_b128 v[24:27], v2 offset:1024
v_mfma_f32_16x16x32_bf16 v[36:39], a[0:3], v[20:23], 0
ds_read_b128 v[28:31], v2 offset:15360
v_mfma_f32_16x16x32_bf16 v[40:43], a[56:59], v[16:19], 0
s_mul_i32 s24, s37, 28672
v_mfma_f32_16x16x32_bf16 v[44:47], a[56:59], v[20:23], 0
s_mul_i32 s25, s17, 7168
v_mfma_f32_16x16x32_bf16 v[48:51], a[112:115], v[16:19], 0
s_add_u32 s24, s24, s25
v_mfma_f32_16x16x32_bf16 v[52:55], a[112:115], v[20:23], 0
s_mul_i32 s26, s38, 28672
v_mfma_f32_16x16x32_bf16 v[56:59], a[168:171], v[16:19], 0
s_add_u32 s26, s26, s25
v_mfma_f32_16x16x32_bf16 v[60:63], a[168:171], v[20:23], 0
s_mul_i32 s27, s37, 7168
v_mfma_f32_16x16x32_bf16 v[64:67], a[224:227], v[16:19], 0
s_lshl_b32 s29, s17, 10
v_mfma_f32_16x16x32_bf16 v[68:71], a[224:227], v[20:23], 0
s_add_u32 s27, s27, s29
v_mfma_f32_16x16x32_bf16 v[72:75], v[144:147], v[16:19], 0
v_mfma_f32_16x16x32_bf16 v[76:79], v[144:147], v[20:23], 0
v_mfma_f32_16x16x32_bf16 v[80:83], v[200:203], v[16:19], 0
v_mfma_f32_16x16x32_bf16 v[84:87], v[200:203], v[20:23], 0
s_waitcnt lgkmcnt(0)
v_mfma_f32_16x16x32_bf16 v[32:35], a[4:7], v[24:27], v[32:35]
ds_read_b128 v[16:19], v2 offset:2048
v_mfma_f32_16x16x32_bf16 v[36:39], a[4:7], v[28:31], v[36:39]
ds_read_b128 v[20:23], v2 offset:16384
v_mfma_f32_16x16x32_bf16 v[40:43], a[60:63], v[24:27], v[40:43]
s_lshl_b32 s28, s38, 13
v_mfma_f32_16x16x32_bf16 v[44:47], a[60:63], v[28:31], v[44:47]
s_add_u32 s28, s28, s29
v_mfma_f32_16x16x32_bf16 v[48:51], a[116:119], v[24:27], v[48:51]
s_add_u32 m0, s26, 0
v_mfma_f32_16x16x32_bf16 v[52:55], a[116:119], v[28:31], v[52:55]
s_add_u32 s30, s24, 12845056
v_mfma_f32_16x16x32_bf16 v[56:59], a[172:175], v[24:27], v[56:59]
buffer_load_dwordx4 v15, s[8:11], s30 offen lds
v_mfma_f32_16x16x32_bf16 v[60:63], a[172:175], v[28:31], v[60:63]
s_add_u32 m0, s26, 1024
v_mfma_f32_16x16x32_bf16 v[64:67], a[228:231], v[24:27], v[64:67]
s_add_u32 s30, s24, 12846080
v_mfma_f32_16x16x32_bf16 v[68:71], a[228:231], v[28:31], v[68:71]
buffer_load_dwordx4 v15, s[8:11], s30 offen lds
v_mfma_f32_16x16x32_bf16 v[72:75], v[148:151], v[24:27], v[72:75]
v_mfma_f32_16x16x32_bf16 v[76:79], v[148:151], v[28:31], v[76:79]
v_mfma_f32_16x16x32_bf16 v[80:83], v[204:207], v[24:27], v[80:83]
v_mfma_f32_16x16x32_bf16 v[84:87], v[204:207], v[28:31], v[84:87]
s_waitcnt lgkmcnt(0)
v_mfma_f32_16x16x32_bf16 v[32:35], a[8:11], v[16:19], v[32:35]
ds_read_b128 v[24:27], v2 offset:3072
v_mfma_f32_16x16x32_bf16 v[36:39], a[8:11], v[20:23], v[36:39]
ds_read_b128 v[28:31], v2 offset:17408
v_mfma_f32_16x16x32_bf16 v[40:43], a[64:67], v[16:19], v[40:43]
s_add_u32 m0, s26, 2048
v_mfma_f32_16x16x32_bf16 v[44:47], a[64:67], v[20:23], v[44:47]
s_add_u32 s30, s24, 12847104
v_mfma_f32_16x16x32_bf16 v[48:51], a[120:123], v[16:19], v[48:51]
buffer_load_dwordx4 v15, s[8:11], s30 offen lds
v_mfma_f32_16x16x32_bf16 v[52:55], a[120:123], v[20:23], v[52:55]
s_add_u32 m0, s26, 3072
v_mfma_f32_16x16x32_bf16 v[56:59], a[176:179], v[16:19], v[56:59]
s_add_u32 s30, s24, 12848128
v_mfma_f32_16x16x32_bf16 v[60:63], a[176:179], v[20:23], v[60:63]
buffer_load_dwordx4 v15, s[8:11], s30 offen lds
v_mfma_f32_16x16x32_bf16 v[64:67], a[232:235], v[16:19], v[64:67]
s_add_u32 m0, s26, 4096
v_mfma_f32_16x16x32_bf16 v[68:71], a[232:235], v[20:23], v[68:71]
s_add_u32 s30, s24, 12849152
v_mfma_f32_16x16x32_bf16 v[72:75], v[152:155], v[16:19], v[72:75]
v_mfma_f32_16x16x32_bf16 v[76:79], v[152:155], v[20:23], v[76:79]
v_mfma_f32_16x16x32_bf16 v[80:83], v[208:211], v[16:19], v[80:83]
v_mfma_f32_16x16x32_bf16 v[84:87], v[208:211], v[20:23], v[84:87]
s_waitcnt lgkmcnt(0)
v_mfma_f32_16x16x32_bf16 v[32:35], a[12:15], v[24:27], v[32:35]
ds_read_b128 v[16:19], v2 offset:4096
v_mfma_f32_16x16x32_bf16 v[36:39], a[12:15], v[28:31], v[36:39]
ds_read_b128 v[20:23], v2 offset:18432
v_mfma_f32_16x16x32_bf16 v[40:43], a[68:71], v[24:27], v[40:43]
buffer_load_dwordx4 v15, s[8:11], s30 offen lds
v_mfma_f32_16x16x32_bf16 v[44:47], a[68:71], v[28:31], v[44:47]
s_add_u32 m0, s26, 5120
v_mfma_f32_16x16x32_bf16 v[48:51], a[124:127], v[24:27], v[48:51]
s_add_u32 s30, s24, 12850176
v_mfma_f32_16x16x32_bf16 v[52:55], a[124:127], v[28:31], v[52:55]
buffer_load_dwordx4 v15, s[8:11], s30 offen lds
v_mfma_f32_16x16x32_bf16 v[56:59], a[180:183], v[24:27], v[56:59]
s_add_u32 m0, s26, 6144
v_mfma_f32_16x16x32_bf16 v[60:63], a[180:183], v[28:31], v[60:63]
s_add_u32 s30, s24, 12851200
v_mfma_f32_16x16x32_bf16 v[64:67], a[236:239], v[24:27], v[64:67]
buffer_load_dwordx4 v15, s[8:11], s30 offen lds
v_mfma_f32_16x16x32_bf16 v[68:71], a[236:239], v[28:31], v[68:71]
s_add_u32 m0, s26, 57344
v_mfma_f32_16x16x32_bf16 v[72:75], v[156:159], v[24:27], v[72:75]
v_mfma_f32_16x16x32_bf16 v[76:79], v[156:159], v[28:31], v[76:79]
v_mfma_f32_16x16x32_bf16 v[80:83], v[212:215], v[24:27], v[80:83]
v_mfma_f32_16x16x32_bf16 v[84:87], v[212:215], v[28:31], v[84:87]
s_waitcnt lgkmcnt(0)
v_mfma_f32_16x16x32_bf16 v[32:35], a[16:19], v[16:19], v[32:35]
ds_read_b128 v[24:27], v2 offset:5120
v_mfma_f32_16x16x32_bf16 v[36:39], a[16:19], v[20:23], v[36:39]
ds_read_b128 v[28:31], v2 offset:19456
v_mfma_f32_16x16x32_bf16 v[40:43], a[72:75], v[16:19], v[40:43]
s_add_u32 s30, s24, 14680064
v_mfma_f32_16x16x32_bf16 v[44:47], a[72:75], v[20:23], v[44:47]
buffer_load_dwordx4 v15, s[8:11], s30 offen lds
v_mfma_f32_16x16x32_bf16 v[48:51], a[128:131], v[16:19], v[48:51]
s_add_u32 m0, s26, 58368
v_mfma_f32_16x16x32_bf16 v[52:55], a[128:131], v[20:23], v[52:55]
s_add_u32 s30, s24, 14681088
v_mfma_f32_16x16x32_bf16 v[56:59], a[184:187], v[16:19], v[56:59]
buffer_load_dwordx4 v15, s[8:11], s30 offen lds
v_mfma_f32_16x16x32_bf16 v[60:63], a[184:187], v[20:23], v[60:63]
s_add_u32 m0, s26, 59392
v_mfma_f32_16x16x32_bf16 v[64:67], a[240:243], v[16:19], v[64:67]
s_add_u32 s30, s24, 14682112
v_mfma_f32_16x16x32_bf16 v[68:71], a[240:243], v[20:23], v[68:71]
buffer_load_dwordx4 v15, s[8:11], s30 offen lds
v_mfma_f32_16x16x32_bf16 v[72:75], v[160:163], v[16:19], v[72:75]
v_mfma_f32_16x16x32_bf16 v[76:79], v[160:163], v[20:23], v[76:79]
v_mfma_f32_16x16x32_bf16 v[80:83], v[216:219], v[16:19], v[80:83]
v_mfma_f32_16x16x32_bf16 v[84:87], v[216:219], v[20:23], v[84:87]
s_waitcnt lgkmcnt(0)
v_mfma_f32_16x16x32_bf16 v[32:35], a[20:23], v[24:27], v[32:35]
ds_read_b128 v[16:19], v2 offset:6144
v_mfma_f32_16x16x32_bf16 v[36:39], a[20:23], v[28:31], v[36:39]
ds_read_b128 v[20:23], v2 offset:20480
v_mfma_f32_16x16x32_bf16 v[40:43], a[76:79], v[24:27], v[40:43]
s_add_u32 m0, s26, 60416
v_mfma_f32_16x16x32_bf16 v[44:47], a[76:79], v[28:31], v[44:47]
s_add_u32 s30, s24, 14683136
v_mfma_f32_16x16x32_bf16 v[48:51], a[132:135], v[24:27], v[48:51]
buffer_load_dwordx4 v15, s[8:11], s30 offen lds
v_mfma_f32_16x16x32_bf16 v[52:55], a[132:135], v[28:31], v[52:55]
s_add_u32 m0, s26, 61440
v_mfma_f32_16x16x32_bf16 v[56:59], a[188:191], v[24:27], v[56:59]
s_add_u32 s30, s24, 14684160
v_mfma_f32_16x16x32_bf16 v[60:63], a[188:191], v[28:31], v[60:63]
buffer_load_dwordx4 v15, s[8:11], s30 offen lds
v_mfma_f32_16x16x32_bf16 v[64:67], a[244:247], v[24:27], v[64:67]
s_add_u32 m0, s26, 62464
v_mfma_f32_16x16x32_bf16 v[68:71], a[244:247], v[28:31], v[68:71]
s_add_u32 s30, s24, 14685184
v_mfma_f32_16x16x32_bf16 v[72:75], v[164:167], v[24:27], v[72:75]
v_mfma_f32_16x16x32_bf16 v[76:79], v[164:167], v[28:31], v[76:79]
v_mfma_f32_16x16x32_bf16 v[80:83], v[220:223], v[24:27], v[80:83]
v_mfma_f32_16x16x32_bf16 v[84:87], v[220:223], v[28:31], v[84:87]
s_waitcnt lgkmcnt(0)
v_mfma_f32_16x16x32_bf16 v[32:35], a[24:27], v[16:19], v[32:35]
ds_read_b128 v[24:27], v2 offset:7168
v_mfma_f32_16x16x32_bf16 v[36:39], a[24:27], v[20:23], v[36:39]
ds_read_b128 v[28:31], v2 offset:21504
v_mfma_f32_16x16x32_bf16 v[40:43], a[80:83], v[16:19], v[40:43]
buffer_load_dwordx4 v15, s[8:11], s30 offen lds
v_mfma_f32_16x16x32_bf16 v[44:47], a[80:83], v[20:23], v[44:47]
s_add_u32 m0, s26, 63488
v_mfma_f32_16x16x32_bf16 v[48:51], a[136:139], v[16:19], v[48:51]
s_add_u32 s30, s24, 14686208
v_mfma_f32_16x16x32_bf16 v[52:55], a[136:139], v[20:23], v[52:55]
buffer_load_dwordx4 v15, s[8:11], s30 offen lds
v_mfma_f32_16x16x32_bf16 v[56:59], a[192:195], v[16:19], v[56:59]
v_mfma_f32_16x16x32_bf16 v[60:63], a[192:195], v[20:23], v[60:63]
v_mfma_f32_16x16x32_bf16 v[64:67], a[248:251], v[16:19], v[64:67]
v_mfma_f32_16x16x32_bf16 v[68:71], a[248:251], v[20:23], v[68:71]
v_mfma_f32_16x16x32_bf16 v[72:75], v[168:171], v[16:19], v[72:75]
v_mfma_f32_16x16x32_bf16 v[76:79], v[168:171], v[20:23], v[76:79]
v_mfma_f32_16x16x32_bf16 v[80:83], v[224:227], v[16:19], v[80:83]
v_mfma_f32_16x16x32_bf16 v[84:87], v[224:227], v[20:23], v[84:87]
s_waitcnt lgkmcnt(0)
v_mfma_f32_16x16x32_bf16 v[32:35], a[28:31], v[24:27], v[32:35]
ds_read_b128 v[16:19], v2 offset:8192
v_mfma_f32_16x16x32_bf16 v[36:39], a[28:31], v[28:31], v[36:39]
ds_read_b128 v[20:23], v2 offset:22528
v_mfma_f32_16x16x32_bf16 v[40:43], a[84:87], v[24:27], v[40:43]
v_mfma_f32_16x16x32_bf16 v[44:47], a[84:87], v[28:31], v[44:47]
v_mfma_f32_16x16x32_bf16 v[48:51], a[140:143], v[24:27], v[48:51]
v_mfma_f32_16x16x32_bf16 v[52:55], a[140:143], v[28:31], v[52:55]
v_mfma_f32_16x16x32_bf16 v[56:59], a[196:199], v[24:27], v[56:59]
v_mfma_f32_16x16x32_bf16 v[60:63], a[196:199], v[28:31], v[60:63]
v_mfma_f32_16x16x32_bf16 v[64:67], a[252:255], v[24:27], v[64:67]
v_mfma_f32_16x16x32_bf16 v[68:71], a[252:255], v[28:31], v[68:71]
v_mfma_f32_16x16x32_bf16 v[72:75], v[172:175], v[24:27], v[72:75]
v_mfma_f32_16x16x32_bf16 v[76:79], v[172:175], v[28:31], v[76:79]
v_mfma_f32_16x16x32_bf16 v[80:83], v[228:231], v[24:27], v[80:83]
v_mfma_f32_16x16x32_bf16 v[84:87], v[228:231], v[28:31], v[84:87]
s_waitcnt lgkmcnt(0)
v_mfma_f32_16x16x32_bf16 v[32:35], a[32:35], v[16:19], v[32:35]
ds_read_b128 v[24:27], v2 offset:9216
v_mfma_f32_16x16x32_bf16 v[36:39], a[32:35], v[20:23], v[36:39]
ds_read_b128 v[28:31], v2 offset:23552
v_mfma_f32_16x16x32_bf16 v[40:43], a[88:91], v[16:19], v[40:43]
v_mfma_f32_16x16x32_bf16 v[44:47], a[88:91], v[20:23], v[44:47]
v_mfma_f32_16x16x32_bf16 v[48:51], a[144:147], v[16:19], v[48:51]
v_mfma_f32_16x16x32_bf16 v[52:55], a[144:147], v[20:23], v[52:55]
v_mfma_f32_16x16x32_bf16 v[56:59], a[200:203], v[16:19], v[56:59]
v_mfma_f32_16x16x32_bf16 v[60:63], a[200:203], v[20:23], v[60:63]
v_mfma_f32_16x16x32_bf16 v[64:67], v[120:123], v[16:19], v[64:67]
v_mfma_f32_16x16x32_bf16 v[68:71], v[120:123], v[20:23], v[68:71]
v_mfma_f32_16x16x32_bf16 v[72:75], v[176:179], v[16:19], v[72:75]
v_mfma_f32_16x16x32_bf16 v[76:79], v[176:179], v[20:23], v[76:79]
v_mfma_f32_16x16x32_bf16 v[80:83], v[232:235], v[16:19], v[80:83]
v_mfma_f32_16x16x32_bf16 v[84:87], v[232:235], v[20:23], v[84:87]
s_waitcnt lgkmcnt(0)
v_mfma_f32_16x16x32_bf16 v[32:35], a[36:39], v[24:27], v[32:35]
ds_read_b128 v[16:19], v2 offset:10240
v_mfma_f32_16x16x32_bf16 v[36:39], a[36:39], v[28:31], v[36:39]
ds_read_b128 v[20:23], v2 offset:24576
v_mfma_f32_16x16x32_bf16 v[40:43], a[92:95], v[24:27], v[40:43]
v_mfma_f32_16x16x32_bf16 v[44:47], a[92:95], v[28:31], v[44:47]
v_mfma_f32_16x16x32_bf16 v[48:51], a[148:151], v[24:27], v[48:51]
v_mfma_f32_16x16x32_bf16 v[52:55], a[148:151], v[28:31], v[52:55]
v_mfma_f32_16x16x32_bf16 v[56:59], a[204:207], v[24:27], v[56:59]
v_mfma_f32_16x16x32_bf16 v[60:63], a[204:207], v[28:31], v[60:63]
v_mfma_f32_16x16x32_bf16 v[64:67], v[124:127], v[24:27], v[64:67]
v_mfma_f32_16x16x32_bf16 v[68:71], v[124:127], v[28:31], v[68:71]
v_mfma_f32_16x16x32_bf16 v[72:75], v[180:183], v[24:27], v[72:75]
v_mfma_f32_16x16x32_bf16 v[76:79], v[180:183], v[28:31], v[76:79]
v_mfma_f32_16x16x32_bf16 v[80:83], v[236:239], v[24:27], v[80:83]
v_mfma_f32_16x16x32_bf16 v[84:87], v[236:239], v[28:31], v[84:87]
s_waitcnt lgkmcnt(0)
v_mfma_f32_16x16x32_bf16 v[32:35], a[40:43], v[16:19], v[32:35]
ds_read_b128 v[24:27], v2 offset:11264
v_mfma_f32_16x16x32_bf16 v[36:39], a[40:43], v[20:23], v[36:39]
ds_read_b128 v[28:31], v2 offset:25600
v_mfma_f32_16x16x32_bf16 v[40:43], a[96:99], v[16:19], v[40:43]
v_mfma_f32_16x16x32_bf16 v[44:47], a[96:99], v[20:23], v[44:47]
v_mfma_f32_16x16x32_bf16 v[48:51], a[152:155], v[16:19], v[48:51]
v_mfma_f32_16x16x32_bf16 v[52:55], a[152:155], v[20:23], v[52:55]
v_mfma_f32_16x16x32_bf16 v[56:59], a[208:211], v[16:19], v[56:59]
v_mfma_f32_16x16x32_bf16 v[60:63], a[208:211], v[20:23], v[60:63]
v_mfma_f32_16x16x32_bf16 v[64:67], v[128:131], v[16:19], v[64:67]
v_mfma_f32_16x16x32_bf16 v[68:71], v[128:131], v[20:23], v[68:71]
v_mfma_f32_16x16x32_bf16 v[72:75], v[184:187], v[16:19], v[72:75]
v_mfma_f32_16x16x32_bf16 v[76:79], v[184:187], v[20:23], v[76:79]
v_mfma_f32_16x16x32_bf16 v[80:83], v[240:243], v[16:19], v[80:83]
v_mfma_f32_16x16x32_bf16 v[84:87], v[240:243], v[20:23], v[84:87]
s_waitcnt lgkmcnt(0)
v_mfma_f32_16x16x32_bf16 v[32:35], a[44:47], v[24:27], v[32:35]
ds_read_b128 v[16:19], v2 offset:12288
v_mfma_f32_16x16x32_bf16 v[36:39], a[44:47], v[28:31], v[36:39]
ds_read_b128 v[20:23], v2 offset:26624
v_mfma_f32_16x16x32_bf16 v[40:43], a[100:103], v[24:27], v[40:43]
v_mfma_f32_16x16x32_bf16 v[44:47], a[100:103], v[28:31], v[44:47]
v_mfma_f32_16x16x32_bf16 v[48:51], a[156:159], v[24:27], v[48:51]
v_mfma_f32_16x16x32_bf16 v[52:55], a[156:159], v[28:31], v[52:55]
v_mfma_f32_16x16x32_bf16 v[56:59], a[212:215], v[24:27], v[56:59]
v_mfma_f32_16x16x32_bf16 v[60:63], a[212:215], v[28:31], v[60:63]
v_mfma_f32_16x16x32_bf16 v[64:67], v[132:135], v[24:27], v[64:67]
v_mfma_f32_16x16x32_bf16 v[68:71], v[132:135], v[28:31], v[68:71]
v_mfma_f32_16x16x32_bf16 v[72:75], v[188:191], v[24:27], v[72:75]
v_mfma_f32_16x16x32_bf16 v[76:79], v[188:191], v[28:31], v[76:79]
v_mfma_f32_16x16x32_bf16 v[80:83], v[244:247], v[24:27], v[80:83]
v_mfma_f32_16x16x32_bf16 v[84:87], v[244:247], v[28:31], v[84:87]
s_waitcnt lgkmcnt(0)
v_mfma_f32_16x16x32_bf16 v[32:35], a[48:51], v[16:19], v[32:35]
ds_read_b128 v[24:27], v2 offset:13312
v_mfma_f32_16x16x32_bf16 v[36:39], a[48:51], v[20:23], v[36:39]
ds_read_b128 v[28:31], v2 offset:27648
v_mfma_f32_16x16x32_bf16 v[40:43], a[104:107], v[16:19], v[40:43]
v_mfma_f32_16x16x32_bf16 v[44:47], a[104:107], v[20:23], v[44:47]
v_mfma_f32_16x16x32_bf16 v[48:51], a[160:163], v[16:19], v[48:51]
v_mfma_f32_16x16x32_bf16 v[52:55], a[160:163], v[20:23], v[52:55]
v_mfma_f32_16x16x32_bf16 v[56:59], a[216:219], v[16:19], v[56:59]
v_mfma_f32_16x16x32_bf16 v[60:63], a[216:219], v[20:23], v[60:63]
v_mfma_f32_16x16x32_bf16 v[64:67], v[136:139], v[16:19], v[64:67]
v_mfma_f32_16x16x32_bf16 v[68:71], v[136:139], v[20:23], v[68:71]
v_mfma_f32_16x16x32_bf16 v[72:75], v[192:195], v[16:19], v[72:75]
v_mfma_f32_16x16x32_bf16 v[76:79], v[192:195], v[20:23], v[76:79]
v_mfma_f32_16x16x32_bf16 v[80:83], v[248:251], v[16:19], v[80:83]
v_mfma_f32_16x16x32_bf16 v[84:87], v[248:251], v[20:23], v[84:87]
s_waitcnt lgkmcnt(0)
v_mfma_f32_16x16x32_bf16 v[32:35], a[52:55], v[24:27], v[32:35]
v_mfma_f32_16x16x32_bf16 v[36:39], a[52:55], v[28:31], v[36:39]
v_mfma_f32_16x16x32_bf16 v[40:43], a[108:111], v[24:27], v[40:43]
v_mfma_f32_16x16x32_bf16 v[44:47], a[108:111], v[28:31], v[44:47]
v_mfma_f32_16x16x32_bf16 v[48:51], a[164:167], v[24:27], v[48:51]
v_mfma_f32_16x16x32_bf16 v[52:55], a[164:167], v[28:31], v[52:55]
v_mfma_f32_16x16x32_bf16 v[56:59], a[220:223], v[24:27], v[56:59]
v_mfma_f32_16x16x32_bf16 v[60:63], a[220:223], v[28:31], v[60:63]
v_mfma_f32_16x16x32_bf16 v[64:67], v[140:143], v[24:27], v[64:67]
v_mfma_f32_16x16x32_bf16 v[68:71], v[140:143], v[28:31], v[68:71]
v_mfma_f32_16x16x32_bf16 v[72:75], v[196:199], v[24:27], v[72:75]
v_mfma_f32_16x16x32_bf16 v[76:79], v[196:199], v[28:31], v[76:79]
v_mfma_f32_16x16x32_bf16 v[80:83], v[252:255], v[24:27], v[80:83]
v_mfma_f32_16x16x32_bf16 v[84:87], v[252:255], v[28:31], v[84:87]
s_xor_b32 s24, s38, 1
s_lshl_b32 s25, s24, 13
s_mul_i32 s24, s24, 28672
v_add_u32 v11, s25, v3
v_add_u32 v12, s25, v4
v_add_u32 v13, s24, v5
v_add_u32 v2, s24, v6
ds_read_b128 v[100:103], v13 offset:0
ds_read_b128 v[104:107], v13 offset:1024
ds_read_b128 v[108:111], v13 offset:2048
ds_read_b128 v[112:115], v13 offset:3072
ds_read_b128 v[116:119], v13 offset:4096
ds_read_b128 v[16:19], v13 offset:5120
ds_read_b64 v[22:23], v2 offset:0
ds_read_b64 v[24:25], v2 offset:512
v_cvt_pk_bf16_f32 v32, v32, v33
v_cvt_pk_bf16_f32 v33, v34, v35
v_cvt_pk_bf16_f32 v34, v40, v41
v_cvt_pk_bf16_f32 v35, v42, v43
v_cvt_pk_bf16_f32 v36, v36, v37
v_cvt_pk_bf16_f32 v37, v38, v39
v_cvt_pk_bf16_f32 v38, v44, v45
v_cvt_pk_bf16_f32 v39, v46, v47
v_cvt_pk_bf16_f32 v48, v48, v49
v_cvt_pk_bf16_f32 v49, v50, v51
v_cvt_pk_bf16_f32 v50, v56, v57
v_cvt_pk_bf16_f32 v51, v58, v59
v_cvt_pk_bf16_f32 v52, v52, v53
v_cvt_pk_bf16_f32 v53, v54, v55
v_cvt_pk_bf16_f32 v54, v60, v61
v_cvt_pk_bf16_f32 v55, v62, v63
v_cvt_pk_bf16_f32 v64, v64, v65
v_cvt_pk_bf16_f32 v65, v66, v67
v_cvt_pk_bf16_f32 v66, v72, v73
v_cvt_pk_bf16_f32 v67, v74, v75
v_cvt_pk_bf16_f32 v68, v68, v69
v_cvt_pk_bf16_f32 v69, v70, v71
v_cvt_pk_bf16_f32 v70, v76, v77
v_cvt_pk_bf16_f32 v71, v78, v79
v_cvt_pk_bf16_f32 v80, v80, v81
v_cvt_pk_bf16_f32 v81, v82, v83
v_cvt_pk_bf16_f32 v84, v84, v85
v_cvt_pk_bf16_f32 v85, v86, v87
s_waitcnt lgkmcnt(0)
v_mfma_f32_16x16x32_bf16 v[56:59], v[100:103], v[32:35], 0
v_mfma_f32_16x16x32_bf16 v[60:63], v[100:103], v[36:39], 0
v_mfma_f32_16x16x32_bf16 v[72:75], v[112:115], v[32:35], 0
v_mfma_f32_16x16x32_bf16 v[76:79], v[112:115], v[36:39], 0
v_mfma_f32_16x16x32_bf16 v[56:59], v[104:107], v[48:51], v[56:59]
v_mfma_f32_16x16x32_bf16 v[60:63], v[104:107], v[52:55], v[60:63]
v_mfma_f32_16x16x32_bf16 v[72:75], v[116:119], v[48:51], v[72:75]
v_mfma_f32_16x16x32_bf16 v[76:79], v[116:119], v[52:55], v[76:79]
v_mfma_f32_16x16x32_bf16 v[56:59], v[108:111], v[64:67], v[56:59]
v_mfma_f32_16x16x32_bf16 v[60:63], v[108:111], v[68:71], v[60:63]
v_mfma_f32_16x16x32_bf16 v[72:75], v[16:19], v[64:67], v[72:75]
v_mfma_f32_16x16x32_bf16 v[76:79], v[16:19], v[68:71], v[76:79]
v_mfma_f32_16x16x16_bf16 v[56:59], v[22:23], v[80:81], v[56:59]
v_mfma_f32_16x16x16_bf16 v[60:63], v[22:23], v[84:85], v[60:63]
v_mfma_f32_16x16x16_bf16 v[72:75], v[24:25], v[80:81], v[72:75]
v_mfma_f32_16x16x16_bf16 v[76:79], v[24:25], v[84:85], v[76:79]
s_lshl_b32 s24, s33, 6
s_add_u32 s24, s24, 68141056
s_cmp_ge_u32 s33, 56
s_cselect_b32 s25, 64, 0
s_sub_u32 s24, s24, s25
s_mul_i32 s25, s33, 7168
s_add_u32 s25, s25, 45944832
v_lshlrev_b32 v11, 2, v0
s_mov_b32 s26, s39
.Lj1p_281:
buffer_load_dword v12, v11, s[8:11], s24 offen sc1
s_waitcnt vmcnt(0)
v_cmp_eq_u32 vcc, 1, v12
s_nop 1
s_and_b32 s27, vcc_lo, 0x3fff
s_cmp_eq_u32 s27, 0x3fff
s_cbranch_scc1 .Lj1o_282
s_sleep 2
s_sub_u32 s26, s26, 1
s_cbranch_scc0 .Lj1p_281
s_mov_b32 s39, 0
.Lj1o_282:
s_mov_b32 s26, s39
.Lj1r_283:
buffer_load_dwordx4 v[88:91], v3, s[8:11], s25 offen offset:0 sc1
buffer_load_dwordx4 v[92:95], v3, s[8:11], s25 offen offset:512 sc1
buffer_load_dwordx4 v[96:99], v3, s[8:11], s25 offen offset:1024 sc1
buffer_load_dwordx2 v[20:21], v4, s[8:11], s25 offen sc1
s_waitcnt vmcnt(0)
v_max_u32 v12, v88, v89
v_max3_u32 v12, v12, v90, v91
v_max3_u32 v12, v12, v92, v93
v_max3_u32 v12, v12, v94, v95
v_max3_u32 v12, v12, v96, v97
v_max3_u32 v12, v12, v98, v99
v_max3_u32 v12, v12, v20, v21
v_cmp_eq_u32 vcc, -1, v12
s_cbranch_vccz .Lj1q_284
s_sub_u32 s26, s26, 1
s_cbranch_scc0 .Lj1r_283
s_mov_b32 s39, 0
.Lj1q_284:
v_mfma_f32_16x16x32_bf16 v[40:43], v[88:91], v[32:35], 0
v_mfma_f32_16x16x32_bf16 v[44:47], v[88:91], v[36:39], 0
v_mfma_f32_16x16x32_bf16 v[40:43], v[92:95], v[48:51], v[40:43]
v_mfma_f32_16x16x32_bf16 v[44:47], v[92:95], v[52:55], v[44:47]
v_mfma_f32_16x16x32_bf16 v[40:43], v[96:99], v[64:67], v[40:43]
v_mfma_f32_16x16x32_bf16 v[44:47], v[96:99], v[68:71], v[44:47]
v_mfma_f32_16x16x16_bf16 v[40:43], v[20:21], v[80:81], v[40:43]
v_mfma_f32_16x16x16_bf16 v[44:47], v[20:21], v[84:85], v[44:47]
s_nop 4
s_nop 2
s_nop 0
ds_write_b128 v7, v[40:43] offset:0
ds_write_b128 v7, v[44:47] offset:1024
ds_write_b128 v7, v[56:59] offset:2048
ds_write_b128 v7, v[60:63] offset:3072
ds_write_b128 v7, v[72:75] offset:4096
ds_write_b128 v7, v[76:79] offset:5120
s_mul_i32 s35, s33, 40960
s_add_u32 s35, s35, 65503232
s_waitcnt lgkmcnt(0)
s_barrier
s_cmp_ge_u32 s17, 2
s_cbranch_scc1 .Lj1ns_285
ds_read_b128 v[88:91], v8 offset:0
ds_read_b128 v[92:95], v8 offset:2048
ds_read_b128 v[96:99], v8 offset:4096
ds_read_b128 v[100:103], v8 offset:6144
ds_read_b128 v[104:107], v8 offset:8192
ds_read_b128 v[108:111], v8 offset:10240
ds_read_b128 v[112:115], v8 offset:12288
ds_read_b128 v[116:119], v8 offset:14336
ds_read_b128 v[16:19], v8 offset:16384
ds_read_b128 v[20:23], v8 offset:18432
ds_read_b128 v[24:27], v8 offset:20480
ds_read_b128 v[28:31], v8 offset:22528
s_waitcnt lgkmcnt(6)
v_pk_add_f32 v[88:89], v[88:89], v[100:101]
v_pk_add_f32 v[90:91], v[90:91], v[102:103]
v_pk_add_f32 v[92:93], v[92:93], v[104:105]
v_pk_add_f32 v[94:95], v[94:95], v[106:107]
v_pk_add_f32 v[96:97], v[96:97], v[108:109]
v_pk_add_f32 v[98:99], v[98:99], v[110:111]
s_waitcnt lgkmcnt(0)
v_pk_add_f32 v[112:113], v[112:113], v[20:21]
v_pk_add_f32 v[114:115], v[114:115], v[22:23]
v_pk_add_f32 v[116:117], v[116:117], v[24:25]
v_pk_add_f32 v[118:119], v[118:119], v[26:27]
v_pk_add_f32 v[16:17], v[16:17], v[28:29]
v_pk_add_f32 v[18:19], v[18:19], v[30:31]
v_pk_add_f32 v[88:89], v[88:89], v[112:113]
v_pk_add_f32 v[90:91], v[90:91], v[114:115]
v_pk_add_f32 v[92:93], v[92:93], v[116:117]
v_pk_add_f32 v[94:95], v[94:95], v[118:119]
v_pk_add_f32 v[96:97], v[96:97], v[16:17]
v_pk_add_f32 v[98:99], v[98:99], v[18:19]
v_mov_b32 v101, 0xf149f2ca
v_cndmask_b32 v88, v101, v88, s[56:57]
v_cndmask_b32 v89, v101, v89, s[56:57]
v_cndmask_b32 v90, v101, v90, s[56:57]
v_cndmask_b32 v91, v101, v91, s[56:57]
v_cndmask_b32 v92, v101, v92, s[40:41]
v_cndmask_b32 v93, v101, v93, s[42:43]
v_cndmask_b32 v94, v101, v94, s[44:45]
v_cndmask_b32 v95, v101, v95, s[46:47]
v_cndmask_b32 v96, v101, v96, s[48:49]
v_cndmask_b32 v97, v101, v97, s[50:51]
v_cndmask_b32 v98, v101, v98, s[52:53]
v_cndmask_b32 v99, v101, v99, s[54:55]
v_max3_f32 v100, v88, v89, v90
v_max3_f32 v100, v100, v91, v92
v_max3_f32 v100, v100, v93, v94
v_max3_f32 v100, v100, v95, v96
v_max3_f32 v100, v100, v97, v98
v_max_f32 v100, v100, v99
v_mov_b32 v101, v100
s_nop 1
v_permlane16_swap_b32 v100, v101
v_max_f32 v100, v100, v101
v_mov_b32 v101, v100
s_nop 1
v_permlane32_swap_b32 v100, v101
v_max_f32 v100, v100, v101
v_pk_add_f32 v[88:89], v[88:89], v[100:101] op_sel_hi:[1,0] neg_lo:[0,1] neg_hi:[0,1]
v_pk_add_f32 v[90:91], v[90:91], v[100:101] op_sel_hi:[1,0] neg_lo:[0,1] neg_hi:[0,1]
v_pk_add_f32 v[92:93], v[92:93], v[100:101] op_sel_hi:[1,0] neg_lo:[0,1] neg_hi:[0,1]
v_pk_add_f32 v[94:95], v[94:95], v[100:101] op_sel_hi:[1,0] neg_lo:[0,1] neg_hi:[0,1]
v_pk_add_f32 v[96:97], v[96:97], v[100:101] op_sel_hi:[1,0] neg_lo:[0,1] neg_hi:[0,1]
v_pk_add_f32 v[98:99], v[98:99], v[100:101] op_sel_hi:[1,0] neg_lo:[0,1] neg_hi:[0,1]
v_exp_f32 v88, v88
v_exp_f32 v89, v89
v_exp_f32 v90, v90
v_exp_f32 v91, v91
v_exp_f32 v92, v92
v_exp_f32 v93, v93
v_exp_f32 v94, v94
v_exp_f32 v95, v95
v_exp_f32 v96, v96
v_exp_f32 v97, v97
v_exp_f32 v98, v98
v_exp_f32 v99, v99
v_pk_add_f32 v[102:103], v[88:89], v[90:91]
v_pk_add_f32 v[104:105], v[92:93], v[94:95]
v_pk_add_f32 v[106:107], v[96:97], v[98:99]
v_pk_add_f32 v[102:103], v[102:103], v[104:105]
v_pk_add_f32 v[102:103], v[102:103], v[106:107]
v_add_f32 v100, v102, v103
v_mov_b32 v101, v100
s_nop 1
v_permlane16_swap_b32 v100, v101
v_add_f32 v100, v100, v101
v_mov_b32 v101, v100
s_nop 1
v_permlane32_swap_b32 v100, v101
v_add_f32 v100, v100, v101
v_rcp_f32 v100, v100
s_nop 0
v_pk_mul_f32 v[88:89], v[88:89], v[100:101] op_sel_hi:[1,0]
v_pk_mul_f32 v[90:91], v[90:91], v[100:101] op_sel_hi:[1,0]
v_pk_mul_f32 v[92:93], v[92:93], v[100:101] op_sel_hi:[1,0]
v_pk_mul_f32 v[94:95], v[94:95], v[100:101] op_sel_hi:[1,0]
v_pk_mul_f32 v[96:97], v[96:97], v[100:101] op_sel_hi:[1,0]
v_pk_mul_f32 v[98:99], v[98:99], v[100:101] op_sel_hi:[1,0]
v_cvt_pk_bf16_f32 v102, v88, v89
v_cvt_pk_bf16_f32 v103, v90, v91
v_cvt_pk_bf16_f32 v108, v92, v93
v_cvt_pk_bf16_f32 v109, v96, v97
v_cvt_pk_bf16_f32 v110, v94, v95
v_cvt_pk_bf16_f32 v111, v98, v99
buffer_store_dwordx2 v[102:103], v10, s[8:11], s35 offen sc1
s_nop 0
v_permlane32_swap_b32 v108, v109
v_permlane32_swap_b32 v110, v111
buffer_store_dwordx4 v[108:111], v9, s[8:11], s35 offen sc1
s_lshl_b32 s24, s33, 7
s_lshl_b32 s25, s16, 3
s_add_u32 s24, s24, s25
s_lshl_b32 s25, s17, 2
s_add_u32 s24, s24, s25
s_add_u32 s24, s24, 68149248
v_mov_b32 v100, 0x10000000
v_cmp_eq_u32 vcc, 0, v0
v_mov_b32 v101, 1
s_nop 0
v_cndmask_b32 v100, v100, 0, vcc
s_waitcnt vmcnt(0)
buffer_store_dword v101, v100, s[8:11], s24 offen sc1
s_branch .Lj1j_286
.Lj1ns_285:
s_waitcnt vmcnt(0)
.Lj1j_286:
s_mov_b32 s33, s37
s_add_u32 s34, s34, 1
s_cmp_lt_u32 s34, s19
s_cbranch_scc1 .Lj1loop_280
s_waitcnt vmcnt(0)
s_branch .Ljoin_257
.Lj2_255:
s_cmp_ge_u32 s58, 208
s_cbranch_scc1 .Lb1_256
s_sub_u32 s59, s58, 112
.Lml_287:
s_cmp_ge_u32 s59, 136
s_cbranch_scc1 .Lmd_289
s_cmp_ge_u32 s59, 32
s_cbranch_scc1 .Lmtb_290
s_load_dwordx4 s[36:39], s[0:1], 64
s_lshr_b32 s24, s59, 3
s_lshl_b32 s24, s24, 4
s_and_b32 s25, s59, 7
s_lshl_b32 s25, s25, 2
s_add_u32 s25, s25, s17
s_lshl_b32 s25, s25, 6
s_add_u32 s24, s24, s25
s_mul_i32 s24, s24, 450
v_lshlrev_b32 v2, 4, v0
s_waitcnt lgkmcnt(0)
s_mov_b32 s12, s36
s_mov_b32 s13, s37
s_mov_b32 s14, 921600
s_mov_b32 s15, 0x00020000
s_mov_b32 s40, s38
s_mov_b32 s41, s39
s_mov_b32 s42, 921600
s_mov_b32 s43, 0x00020000
s_lshl_b32 s25, s17, 13
s_add_u32 m0, s25, 0
s_add_u32 s26, s24, 0
buffer_load_dwordx4 v2, s[12:15], s26 offen lds
s_lshl_b32 s25, s17, 13
s_add_u32 m0, s25, 1024
s_add_u32 s26, s24, 1024
buffer_load_dwordx4 v2, s[12:15], s26 offen lds
s_lshl_b32 s25, s17, 13
s_add_u32 m0, s25, 2048
s_add_u32 s26, s24, 2048
buffer_load_dwordx4 v2, s[12:15], s26 offen lds
s_lshl_b32 s25, s17, 13
s_add_u32 m0, s25, 3072
s_add_u32 s26, s24, 3072
buffer_load_dwordx4 v2, s[12:15], s26 offen lds
s_lshl_b32 s25, s17, 13
s_add_u32 m0, s25, 4096
s_add_u32 s26, s24, 4096
buffer_load_dwordx4 v2, s[12:15], s26 offen lds
s_lshl_b32 s25, s17, 13
s_add_u32 m0, s25, 5120
s_add_u32 s26, s24, 5120
buffer_load_dwordx4 v2, s[12:15], s26 offen lds
s_lshl_b32 s25, s17, 13
s_add_u32 m0, s25, 6144
s_add_u32 s26, s24, 6144
buffer_load_dwordx4 v2, s[12:15], s26 offen lds
s_lshl_b32 s25, s17, 13
s_add_u32 m0, s25, 7168
s_add_u32 s26, s24, 7168
buffer_load_dwordx4 v2, s[12:15], s26 offen lds
s_lshl_b32 s25, s17, 13
s_add_u32 m0, s25, 32768
s_add_u32 s26, s24, 0
buffer_load_dwordx4 v2, s[40:43], s26 offen lds
s_lshl_b32 s25, s17, 13
s_add_u32 m0, s25, 33792
s_add_u32 s26, s24, 1024
buffer_load_dwordx4 v2, s[40:43], s26 offen lds
s_lshl_b32 s25, s17, 13
s_add_u32 m0, s25, 34816
s_add_u32 s26, s24, 2048
buffer_load_dwordx4 v2, s[40:43], s26 offen lds
s_lshl_b32 s25, s17, 13
s_add_u32 m0, s25, 35840
s_add_u32 s26, s24, 3072
buffer_load_dwordx4 v2, s[40:43], s26 offen lds
s_lshl_b32 s25, s17, 13
s_add_u32 m0, s25, 36864
s_add_u32 s26, s24, 4096
buffer_load_dwordx4 v2, s[40:43], s26 offen lds
s_lshl_b32 s25, s17, 13
s_add_u32 m0, s25, 37888
s_add_u32 s26, s24, 5120
buffer_load_dwordx4 v2, s[40:43], s26 offen lds
s_lshl_b32 s25, s17, 13
s_add_u32 m0, s25, 38912
s_add_u32 s26, s24, 6144
buffer_load_dwordx4 v2, s[40:43], s26 offen lds
s_lshl_b32 s25, s17, 13
s_add_u32 m0, s25, 39936
s_add_u32 s26, s24, 7168
buffer_load_dwordx4 v2, s[40:43], s26 offen lds
s_lshl_b32 s25, s17, 2
v_and_b32 v3, 15, v0
v_lshrrev_b32 v4, 4, v0
v_add_u32 v4, s25, v4
v_mul_u32_u24 v5, 450, v3
v_lshlrev_b32 v6, 1, v4
v_add_u32 v5, v5, v6
v_lshlrev_b32 v6, 13, v4
v_lshlrev_b32 v7, 4, v3
v_add_u32 v6, v6, v7
s_lshr_b32 s24, s59, 2
s_lshl_b32 s24, s24, 10
s_and_b32 s25, s59, 3
s_lshl_b32 s25, s25, 8
s_add_u32 s24, s24, s25
s_add_u32 s24, s24, 63660032
s_waitcnt vmcnt(0)
s_barrier
ds_read_u16 v8, v5 offset:0
ds_read_u16 v9, v5 offset:8192
ds_read_u16 v10, v5 offset:16384
ds_read_u16 v11, v5 offset:24576
ds_read_u16 v28, v5 offset:32768
ds_read_u16 v29, v5 offset:40960
ds_read_u16 v30, v5 offset:49152
ds_read_u16 v31, v5 offset:57344
s_waitcnt lgkmcnt(0)
v_lshl_or_b32 v8, v28, 16, v8
v_lshl_or_b32 v9, v29, 16, v9
v_lshl_or_b32 v10, v30, 16, v10
v_lshl_or_b32 v11, v31, 16, v11
buffer_store_dwordx4 v[8:11], v6, s[8:11], s24 offen sc1
s_add_u32 s24, s24, 131072
ds_read_u16 v12, v5 offset:32
ds_read_u16 v13, v5 offset:8224
ds_read_u16 v14, v5 offset:16416
ds_read_u16 v15, v5 offset:24608
ds_read_u16 v28, v5 offset:32800
ds_read_u16 v29, v5 offset:40992
ds_read_u16 v30, v5 offset:49184
ds_read_u16 v31, v5 offset:57376
s_waitcnt lgkmcnt(0)
v_lshl_or_b32 v12, v28, 16, v12
v_lshl_or_b32 v13, v29, 16, v13
v_lshl_or_b32 v14, v30, 16, v14
v_lshl_or_b32 v15, v31, 16, v15
buffer_store_dwordx4 v[12:15], v6, s[8:11], s24 offen sc1
s_add_u32 s24, s24, 131072
ds_read_u16 v16, v5 offset:64
ds_read_u16 v17, v5 offset:8256
ds_read_u16 v18, v5 offset:16448
ds_read_u16 v19, v5 offset:24640
ds_read_u16 v28, v5 offset:32832
ds_read_u16 v29, v5 offset:41024
ds_read_u16 v30, v5 offset:49216
ds_read_u16 v31, v5 offset:57408
s_waitcnt lgkmcnt(0)
v_lshl_or_b32 v16, v28, 16, v16
v_lshl_or_b32 v17, v29, 16, v17
v_lshl_or_b32 v18, v30, 16, v18
v_lshl_or_b32 v19, v31, 16, v19
buffer_store_dwordx4 v[16:19], v6, s[8:11], s24 offen sc1
s_add_u32 s24, s24, 131072
ds_read_u16 v20, v5 offset:96
ds_read_u16 v21, v5 offset:8288
ds_read_u16 v22, v5 offset:16480
ds_read_u16 v23, v5 offset:24672
ds_read_u16 v28, v5 offset:32864
ds_read_u16 v29, v5 offset:41056
ds_read_u16 v30, v5 offset:49248
ds_read_u16 v31, v5 offset:57440
s_waitcnt lgkmcnt(0)
v_lshl_or_b32 v20, v28, 16, v20
v_lshl_or_b32 v21, v29, 16, v21
v_lshl_or_b32 v22, v30, 16, v22
v_lshl_or_b32 v23, v31, 16, v23
buffer_store_dwordx4 v[20:23], v6, s[8:11], s24 offen sc1
s_add_u32 s24, s24, 131072
s_waitcnt vmcnt(0)
ds_read_u16 v8, v5 offset:128
ds_read_u16 v9, v5 offset:8320
ds_read_u16 v10, v5 offset:16512
ds_read_u16 v11, v5 offset:24704
ds_read_u16 v28, v5 offset:32896
ds_read_u16 v29, v5 offset:41088
ds_read_u16 v30, v5 offset:49280
ds_read_u16 v31, v5 offset:57472
s_waitcnt lgkmcnt(0)
v_lshl_or_b32 v8, v28, 16, v8
v_lshl_or_b32 v9, v29, 16, v9
v_lshl_or_b32 v10, v30, 16, v10
v_lshl_or_b32 v11, v31, 16, v11
buffer_store_dwordx4 v[8:11], v6, s[8:11], s24 offen sc1
s_add_u32 s24, s24, 131072
ds_read_u16 v12, v5 offset:160
ds_read_u16 v13, v5 offset:8352
ds_read_u16 v14, v5 offset:16544
ds_read_u16 v15, v5 offset:24736
ds_read_u16 v28, v5 offset:32928
ds_read_u16 v29, v5 offset:41120
ds_read_u16 v30, v5 offset:49312
ds_read_u16 v31, v5 offset:57504
s_waitcnt lgkmcnt(0)
v_lshl_or_b32 v12, v28, 16, v12
v_lshl_or_b32 v13, v29, 16, v13
v_lshl_or_b32 v14, v30, 16, v14
v_lshl_or_b32 v15, v31, 16, v15
buffer_store_dwordx4 v[12:15], v6, s[8:11], s24 offen sc1
s_add_u32 s24, s24, 131072
ds_read_u16 v16, v5 offset:192
ds_read_u16 v17, v5 offset:8384
ds_read_u16 v18, v5 offset:16576
ds_read_u16 v19, v5 offset:24768
ds_read_u16 v28, v5 offset:32960
ds_read_u16 v29, v5 offset:41152
ds_read_u16 v30, v5 offset:49344
ds_read_u16 v31, v5 offset:57536
s_waitcnt lgkmcnt(0)
v_lshl_or_b32 v16, v28, 16, v16
v_lshl_or_b32 v17, v29, 16, v17
v_lshl_or_b32 v18, v30, 16, v18
v_lshl_or_b32 v19, v31, 16, v19
buffer_store_dwordx4 v[16:19], v6, s[8:11], s24 offen sc1
s_add_u32 s24, s24, 131072
ds_read_u16 v20, v5 offset:224
ds_read_u16 v21, v5 offset:8416
ds_read_u16 v22, v5 offset:16608
ds_read_u16 v23, v5 offset:24800
ds_read_u16 v28, v5 offset:32992
ds_read_u16 v29, v5 offset:41184
ds_read_u16 v30, v5 offset:49376
ds_read_u16 v31, v5 offset:57568
s_waitcnt lgkmcnt(0)
v_lshl_or_b32 v20, v28, 16, v20
v_lshl_or_b32 v21, v29, 16, v21
v_lshl_or_b32 v22, v30, 16, v22
v_lshl_or_b32 v23, v31, 16, v23
buffer_store_dwordx4 v[20:23], v6, s[8:11], s24 offen sc1
s_add_u32 s24, s24, 131072
s_waitcnt vmcnt(0)
ds_read_u16 v8, v5 offset:256
ds_read_u16 v9, v5 offset:8448
ds_read_u16 v10, v5 offset:16640
ds_read_u16 v11, v5 offset:24832
ds_read_u16 v28, v5 offset:33024
ds_read_u16 v29, v5 offset:41216
ds_read_u16 v30, v5 offset:49408
ds_read_u16 v31, v5 offset:57600
s_waitcnt lgkmcnt(0)
v_lshl_or_b32 v8, v28, 16, v8
v_lshl_or_b32 v9, v29, 16, v9
v_lshl_or_b32 v10, v30, 16, v10
v_lshl_or_b32 v11, v31, 16, v11
buffer_store_dwordx4 v[8:11], v6, s[8:11], s24 offen sc1
s_add_u32 s24, s24, 131072
ds_read_u16 v12, v5 offset:288
ds_read_u16 v13, v5 offset:8480
ds_read_u16 v14, v5 offset:16672
ds_read_u16 v15, v5 offset:24864
ds_read_u16 v28, v5 offset:33056
ds_read_u16 v29, v5 offset:41248
ds_read_u16 v30, v5 offset:49440
ds_read_u16 v31, v5 offset:57632
s_waitcnt lgkmcnt(0)
v_lshl_or_b32 v12, v28, 16, v12
v_lshl_or_b32 v13, v29, 16, v13
v_lshl_or_b32 v14, v30, 16, v14
v_lshl_or_b32 v15, v31, 16, v15
buffer_store_dwordx4 v[12:15], v6, s[8:11], s24 offen sc1
s_add_u32 s24, s24, 131072
ds_read_u16 v16, v5 offset:320
ds_read_u16 v17, v5 offset:8512
ds_read_u16 v18, v5 offset:16704
ds_read_u16 v19, v5 offset:24896
ds_read_u16 v28, v5 offset:33088
ds_read_u16 v29, v5 offset:41280
ds_read_u16 v30, v5 offset:49472
ds_read_u16 v31, v5 offset:57664
s_waitcnt lgkmcnt(0)
v_lshl_or_b32 v16, v28, 16, v16
v_lshl_or_b32 v17, v29, 16, v17
v_lshl_or_b32 v18, v30, 16, v18
v_lshl_or_b32 v19, v31, 16, v19
buffer_store_dwordx4 v[16:19], v6, s[8:11], s24 offen sc1
s_add_u32 s24, s24, 131072
ds_read_u16 v20, v5 offset:352
ds_read_u16 v21, v5 offset:8544
ds_read_u16 v22, v5 offset:16736
ds_read_u16 v23, v5 offset:24928
ds_read_u16 v28, v5 offset:33120
ds_read_u16 v29, v5 offset:41312
ds_read_u16 v30, v5 offset:49504
ds_read_u16 v31, v5 offset:57696
s_waitcnt lgkmcnt(0)
v_lshl_or_b32 v20, v28, 16, v20
v_lshl_or_b32 v21, v29, 16, v21
v_lshl_or_b32 v22, v30, 16, v22
v_lshl_or_b32 v23, v31, 16, v23
buffer_store_dwordx4 v[20:23], v6, s[8:11], s24 offen sc1
s_add_u32 s24, s24, 131072
s_waitcnt vmcnt(0)
ds_read_u16 v8, v5 offset:384
ds_read_u16 v9, v5 offset:8576
ds_read_u16 v10, v5 offset:16768
ds_read_u16 v11, v5 offset:24960
ds_read_u16 v28, v5 offset:33152
ds_read_u16 v29, v5 offset:41344
ds_read_u16 v30, v5 offset:49536
ds_read_u16 v31, v5 offset:57728
s_waitcnt lgkmcnt(0)
v_lshl_or_b32 v8, v28, 16, v8
v_lshl_or_b32 v9, v29, 16, v9
v_lshl_or_b32 v10, v30, 16, v10
v_lshl_or_b32 v11, v31, 16, v11
buffer_store_dwordx4 v[8:11], v6, s[8:11], s24 offen sc1
s_add_u32 s24, s24, 131072
ds_read_u16 v12, v5 offset:416
ds_read_u16 v13, v5 offset:8608
ds_read_u16 v14, v5 offset:16800
ds_read_u16 v15, v5 offset:24992
ds_read_u16 v28, v5 offset:33184
ds_read_u16 v29, v5 offset:41376
ds_read_u16 v30, v5 offset:49568
ds_read_u16 v31, v5 offset:57760
s_waitcnt lgkmcnt(0)
v_lshl_or_b32 v12, v28, 16, v12
v_lshl_or_b32 v13, v29, 16, v13
v_lshl_or_b32 v14, v30, 16, v14
v_lshl_or_b32 v15, v31, 16, v15
buffer_store_dwordx4 v[12:15], v6, s[8:11], s24 offen sc1
s_add_u32 s24, s24, 131072
v_cmp_gt_u32 vcc, 1, v4
s_and_saveexec_b64 s[44:45], vcc
ds_read_u16 v16, v5 offset:448
ds_read_u16 v17, v5 offset:8640
ds_read_u16 v18, v5 offset:16832
ds_read_u16 v19, v5 offset:25024
ds_read_u16 v28, v5 offset:33216
ds_read_u16 v29, v5 offset:41408
ds_read_u16 v30, v5 offset:49600
ds_read_u16 v31, v5 offset:57792
s_waitcnt lgkmcnt(0)
v_lshl_or_b32 v16, v28, 16, v16
v_lshl_or_b32 v17, v29, 16, v17
v_lshl_or_b32 v18, v30, 16, v18
v_lshl_or_b32 v19, v31, 16, v19
buffer_store_dwordx4 v[16:19], v6, s[8:11], s24 offen sc1
s_add_u32 s24, s24, 131072
s_mov_b64 exec, -1
s_branch .Lmn_288
.Lmtb_290:
s_sub_u32 s24, s59, 32
s_lshl_b32 s24, s24, 3
s_lshl_b32 s25, s17, 1
s_add_u32 s24, s24, s25
v_and_b32 v2, 31, v0
v_lshrrev_b32 v3, 5, v0
v_lshlrev_b32 v3, 3, v3
v_lshlrev_b32 v20, 4, v0
s_cmp_ge_u32 s24, 826
s_cbranch_scc1 .Lsk_294
s_cmp_ge_u32 s24, 420
s_cbranch_scc1 .Liv_292
s_mul_i32 s25, s24, 293
s_lshr_b32 s25, s25, 13
s_mul_i32 s26, s25, 28
s_sub_u32 s26, s24, s26
s_lshl_b32 s25, s25, 5
s_lshl_b32 s26, s26, 4
v_add_u32 v4, s25, v2
v_add_u32 v5, s26, v3
s_mov_b32 s27, 0
s_lshl_b32 s28, s24, 10
s_add_u32 s28, s28, 62812160
s_branch .Lgo_293
.Liv_292:
s_sub_u32 s29, s24, 420
s_mul_i32 s25, s29, 283
s_lshr_b32 s25, s25, 13
s_mul_i32 s26, s25, 29
s_sub_u32 s26, s29, s26
s_lshl_b32 s25, s25, 5
s_lshl_b32 s26, s26, 4
v_add_u32 v4, s26, v3
v_add_u32 v5, s25, v2
s_mov_b32 s27, 1
s_lshl_b32 s28, s29, 10
s_add_u32 s28, s28, 63242240
.Lgo_293:
s_xor_b32 s29, s27, 1
s_mov_b32 s30, 0x3b124925
s_mov_b32 s31, 0x3b924925
s_mul_i32 s32, s27, 0
s_mul_i32 s33, s29, 0
v_add_u32 v6, s32, v4
v_add_u32 v7, s33, v5
v_subrev_u32 v8, 225, v6
v_cmp_gt_u32 vcc, 225, v6
v_mov_b32 v10, 0.25
s_nop 0
v_cndmask_b32 v8, v8, v6, vcc
v_cndmask_b32 v10, v10, 0, vcc
v_mul_u32_u24 v9, v8, v7
v_cvt_f32_u32 v9, v9
v_mul_f32 v11, s30, v9
v_floor_f32 v11, v11
v_mul_f32 v11, 0xc3e00000, v11
v_add_f32 v9, v9, v11
v_fma_f32 v9, v9, s30, v10
v_cos_f32 v9, v9
v_mov_b32 v11, 1.0
s_cmp_eq_u32 s27, 0
s_cbranch_scc1 .Lm0_0_294
v_mov_b32 v11, s31
v_mov_b32 v12, s30
v_cmp_eq_u32 vcc, 0, v8
s_nop 1
v_cndmask_b32 v11, v11, v12, vcc
v_mov_b32 v13, 224
v_cmp_eq_u32 vcc, v13, v8
s_nop 1
v_cndmask_b32 v11, v11, v12, vcc
.Lm0_0_294:
v_mov_b32 v13, 450
v_cmp_gt_u32 vcc, v13, v6
s_nop 1
v_cndmask_b32 v11, 0, v11, vcc
v_mul_f32 v22, v9, v11
s_mul_i32 s32, s27, 1
s_mul_i32 s33, s29, 1
v_add_u32 v6, s32, v4
v_add_u32 v7, s33, v5
v_subrev_u32 v8, 225, v6
v_cmp_gt_u32 vcc, 225, v6
v_mov_b32 v10, 0.25
s_nop 0
v_cndmask_b32 v8, v8, v6, vcc
v_cndmask_b32 v10, v10, 0, vcc
v_mul_u32_u24 v9, v8, v7
v_cvt_f32_u32 v9, v9
v_mul_f32 v11, s30, v9
v_floor_f32 v11, v11
v_mul_f32 v11, 0xc3e00000, v11
v_add_f32 v9, v9, v11
v_fma_f32 v9, v9, s30, v10
v_cos_f32 v9, v9
v_mov_b32 v11, 1.0
s_cmp_eq_u32 s27, 0
s_cbranch_scc1 .Lm0_1_294
v_mov_b32 v11, s31
v_mov_b32 v12, s30
v_cmp_eq_u32 vcc, 0, v8
s_nop 1
v_cndmask_b32 v11, v11, v12, vcc
v_mov_b32 v13, 224
v_cmp_eq_u32 vcc, v13, v8
s_nop 1
v_cndmask_b32 v11, v11, v12, vcc
.Lm0_1_294:
v_mov_b32 v13, 450
v_cmp_gt_u32 vcc, v13, v6
s_nop 1
v_cndmask_b32 v11, 0, v11, vcc
v_mul_f32 v23, v9, v11
s_mul_i32 s32, s27, 2
s_mul_i32 s33, s29, 2
v_add_u32 v6, s32, v4
v_add_u32 v7, s33, v5
v_subrev_u32 v8, 225, v6
v_cmp_gt_u32 vcc, 225, v6
v_mov_b32 v10, 0.25
s_nop 0
v_cndmask_b32 v8, v8, v6, vcc
v_cndmask_b32 v10, v10, 0, vcc
v_mul_u32_u24 v9, v8, v7
v_cvt_f32_u32 v9, v9
v_mul_f32 v11, s30, v9
v_floor_f32 v11, v11
v_mul_f32 v11, 0xc3e00000, v11
v_add_f32 v9, v9, v11
v_fma_f32 v9, v9, s30, v10
v_cos_f32 v9, v9
v_mov_b32 v11, 1.0
s_cmp_eq_u32 s27, 0
s_cbranch_scc1 .Lm0_2_294
v_mov_b32 v11, s31
v_mov_b32 v12, s30
v_cmp_eq_u32 vcc, 0, v8
s_nop 1
v_cndmask_b32 v11, v11, v12, vcc
v_mov_b32 v13, 224
v_cmp_eq_u32 vcc, v13, v8
s_nop 1
v_cndmask_b32 v11, v11, v12, vcc
.Lm0_2_294:
v_mov_b32 v13, 450
v_cmp_gt_u32 vcc, v13, v6
s_nop 1
v_cndmask_b32 v11, 0, v11, vcc
v_mul_f32 v24, v9, v11
s_mul_i32 s32, s27, 3
s_mul_i32 s33, s29, 3
v_add_u32 v6, s32, v4
v_add_u32 v7, s33, v5
v_subrev_u32 v8, 225, v6
v_cmp_gt_u32 vcc, 225, v6
v_mov_b32 v10, 0.25
s_nop 0
v_cndmask_b32 v8, v8, v6, vcc
v_cndmask_b32 v10, v10, 0, vcc
v_mul_u32_u24 v9, v8, v7
v_cvt_f32_u32 v9, v9
v_mul_f32 v11, s30, v9
v_floor_f32 v11, v11
v_mul_f32 v11, 0xc3e00000, v11
v_add_f32 v9, v9, v11
v_fma_f32 v9, v9, s30, v10
v_cos_f32 v9, v9
v_mov_b32 v11, 1.0
s_cmp_eq_u32 s27, 0
s_cbranch_scc1 .Lm0_3_294
v_mov_b32 v11, s31
v_mov_b32 v12, s30
v_cmp_eq_u32 vcc, 0, v8
s_nop 1
v_cndmask_b32 v11, v11, v12, vcc
v_mov_b32 v13, 224
v_cmp_eq_u32 vcc, v13, v8
s_nop 1
v_cndmask_b32 v11, v11, v12, vcc
.Lm0_3_294:
v_mov_b32 v13, 450
v_cmp_gt_u32 vcc, v13, v6
s_nop 1
v_cndmask_b32 v11, 0, v11, vcc
v_mul_f32 v25, v9, v11
s_mul_i32 s32, s27, 4
s_mul_i32 s33, s29, 4
v_add_u32 v6, s32, v4
v_add_u32 v7, s33, v5
v_subrev_u32 v8, 225, v6
v_cmp_gt_u32 vcc, 225, v6
v_mov_b32 v10, 0.25
s_nop 0
v_cndmask_b32 v8, v8, v6, vcc
v_cndmask_b32 v10, v10, 0, vcc
v_mul_u32_u24 v9, v8, v7
v_cvt_f32_u32 v9, v9
v_mul_f32 v11, s30, v9
v_floor_f32 v11, v11
v_mul_f32 v11, 0xc3e00000, v11
v_add_f32 v9, v9, v11
v_fma_f32 v9, v9, s30, v10
v_cos_f32 v9, v9
v_mov_b32 v11, 1.0
s_cmp_eq_u32 s27, 0
s_cbranch_scc1 .Lm0_4_294
v_mov_b32 v11, s31
v_mov_b32 v12, s30
v_cmp_eq_u32 vcc, 0, v8
s_nop 1
v_cndmask_b32 v11, v11, v12, vcc
v_mov_b32 v13, 224
v_cmp_eq_u32 vcc, v13, v8
s_nop 1
v_cndmask_b32 v11, v11, v12, vcc
.Lm0_4_294:
v_mov_b32 v13, 450
v_cmp_gt_u32 vcc, v13, v6
s_nop 1
v_cndmask_b32 v11, 0, v11, vcc
v_mul_f32 v26, v9, v11
s_mul_i32 s32, s27, 5
s_mul_i32 s33, s29, 5
v_add_u32 v6, s32, v4
v_add_u32 v7, s33, v5
v_subrev_u32 v8, 225, v6
v_cmp_gt_u32 vcc, 225, v6
v_mov_b32 v10, 0.25
s_nop 0
v_cndmask_b32 v8, v8, v6, vcc
v_cndmask_b32 v10, v10, 0, vcc
v_mul_u32_u24 v9, v8, v7
v_cvt_f32_u32 v9, v9
v_mul_f32 v11, s30, v9
v_floor_f32 v11, v11
v_mul_f32 v11, 0xc3e00000, v11
v_add_f32 v9, v9, v11
v_fma_f32 v9, v9, s30, v10
v_cos_f32 v9, v9
v_mov_b32 v11, 1.0
s_cmp_eq_u32 s27, 0
s_cbranch_scc1 .Lm0_5_294
v_mov_b32 v11, s31
v_mov_b32 v12, s30
v_cmp_eq_u32 vcc, 0, v8
s_nop 1
v_cndmask_b32 v11, v11, v12, vcc
v_mov_b32 v13, 224
v_cmp_eq_u32 vcc, v13, v8
s_nop 1
v_cndmask_b32 v11, v11, v12, vcc
.Lm0_5_294:
v_mov_b32 v13, 450
v_cmp_gt_u32 vcc, v13, v6
s_nop 1
v_cndmask_b32 v11, 0, v11, vcc
v_mul_f32 v27, v9, v11
s_mul_i32 s32, s27, 6
s_mul_i32 s33, s29, 6
v_add_u32 v6, s32, v4
v_add_u32 v7, s33, v5
v_subrev_u32 v8, 225, v6
v_cmp_gt_u32 vcc, 225, v6
v_mov_b32 v10, 0.25
s_nop 0
v_cndmask_b32 v8, v8, v6, vcc
v_cndmask_b32 v10, v10, 0, vcc
v_mul_u32_u24 v9, v8, v7
v_cvt_f32_u32 v9, v9
v_mul_f32 v11, s30, v9
v_floor_f32 v11, v11
v_mul_f32 v11, 0xc3e00000, v11
v_add_f32 v9, v9, v11
v_fma_f32 v9, v9, s30, v10
v_cos_f32 v9, v9
v_mov_b32 v11, 1.0
s_cmp_eq_u32 s27, 0
s_cbranch_scc1 .Lm0_6_294
v_mov_b32 v11, s31
v_mov_b32 v12, s30
v_cmp_eq_u32 vcc, 0, v8
s_nop 1
v_cndmask_b32 v11, v11, v12, vcc
v_mov_b32 v13, 224
v_cmp_eq_u32 vcc, v13, v8
s_nop 1
v_cndmask_b32 v11, v11, v12, vcc
.Lm0_6_294:
v_mov_b32 v13, 450
v_cmp_gt_u32 vcc, v13, v6
s_nop 1
v_cndmask_b32 v11, 0, v11, vcc
v_mul_f32 v28, v9, v11
s_mul_i32 s32, s27, 7
s_mul_i32 s33, s29, 7
v_add_u32 v6, s32, v4
v_add_u32 v7, s33, v5
v_subrev_u32 v8, 225, v6
v_cmp_gt_u32 vcc, 225, v6
v_mov_b32 v10, 0.25
s_nop 0
v_cndmask_b32 v8, v8, v6, vcc
v_cndmask_b32 v10, v10, 0, vcc
v_mul_u32_u24 v9, v8, v7
v_cvt_f32_u32 v9, v9
v_mul_f32 v11, s30, v9
v_floor_f32 v11, v11
v_mul_f32 v11, 0xc3e00000, v11
v_add_f32 v9, v9, v11
v_fma_f32 v9, v9, s30, v10
v_cos_f32 v9, v9
v_mov_b32 v11, 1.0
s_cmp_eq_u32 s27, 0
s_cbranch_scc1 .Lm0_7_294
v_mov_b32 v11, s31
v_mov_b32 v12, s30
v_cmp_eq_u32 vcc, 0, v8
s_nop 1
v_cndmask_b32 v11, v11, v12, vcc
v_mov_b32 v13, 224
v_cmp_eq_u32 vcc, v13, v8
s_nop 1
v_cndmask_b32 v11, v11, v12, vcc
.Lm0_7_294:
v_mov_b32 v13, 450
v_cmp_gt_u32 vcc, v13, v6
s_nop 1
v_cndmask_b32 v11, 0, v11, vcc
v_mul_f32 v29, v9, v11
v_cvt_pk_bf16_f32 v32, v22, v23
v_cvt_pk_bf16_f32 v33, v24, v25
v_cvt_pk_bf16_f32 v34, v26, v27
v_cvt_pk_bf16_f32 v35, v28, v29
buffer_store_dwordx4 v[32:35], v20, s[8:11], s28 offen sc1
s_waitcnt vmcnt(0)
.Lsk_294:
s_add_u32 s24, s24, 1
s_cmp_ge_u32 s24, 826
s_cbranch_scc1 .Lsk_297
s_cmp_ge_u32 s24, 420
s_cbranch_scc1 .Liv_295
s_mul_i32 s25, s24, 293
s_lshr_b32 s25, s25, 13
s_mul_i32 s26, s25, 28
s_sub_u32 s26, s24, s26
s_lshl_b32 s25, s25, 5
s_lshl_b32 s26, s26, 4
v_add_u32 v4, s25, v2
v_add_u32 v5, s26, v3
s_mov_b32 s27, 0
s_lshl_b32 s28, s24, 10
s_add_u32 s28, s28, 62812160
s_branch .Lgo_296
.Liv_295:
s_sub_u32 s29, s24, 420
s_mul_i32 s25, s29, 283
s_lshr_b32 s25, s25, 13
s_mul_i32 s26, s25, 29
s_sub_u32 s26, s29, s26
s_lshl_b32 s25, s25, 5
s_lshl_b32 s26, s26, 4
v_add_u32 v4, s26, v3
v_add_u32 v5, s25, v2
s_mov_b32 s27, 1
s_lshl_b32 s28, s29, 10
s_add_u32 s28, s28, 63242240
.Lgo_296:
s_xor_b32 s29, s27, 1
s_mov_b32 s30, 0x3b124925
s_mov_b32 s31, 0x3b924925
s_mul_i32 s32, s27, 0
s_mul_i32 s33, s29, 0
v_add_u32 v6, s32, v4
v_add_u32 v7, s33, v5
v_subrev_u32 v8, 225, v6
v_cmp_gt_u32 vcc, 225, v6
v_mov_b32 v10, 0.25
s_nop 0
v_cndmask_b32 v8, v8, v6, vcc
v_cndmask_b32 v10, v10, 0, vcc
v_mul_u32_u24 v9, v8, v7
v_cvt_f32_u32 v9, v9
v_mul_f32 v11, s30, v9
v_floor_f32 v11, v11
v_mul_f32 v11, 0xc3e00000, v11
v_add_f32 v9, v9, v11
v_fma_f32 v9, v9, s30, v10
v_cos_f32 v9, v9
v_mov_b32 v11, 1.0
s_cmp_eq_u32 s27, 0
s_cbranch_scc1 .Lm1_0_297
v_mov_b32 v11, s31
v_mov_b32 v12, s30
v_cmp_eq_u32 vcc, 0, v8
s_nop 1
v_cndmask_b32 v11, v11, v12, vcc
v_mov_b32 v13, 224
v_cmp_eq_u32 vcc, v13, v8
s_nop 1
v_cndmask_b32 v11, v11, v12, vcc
.Lm1_0_297:
v_mov_b32 v13, 450
v_cmp_gt_u32 vcc, v13, v6
s_nop 1
v_cndmask_b32 v11, 0, v11, vcc
v_mul_f32 v22, v9, v11
s_mul_i32 s32, s27, 1
s_mul_i32 s33, s29, 1
v_add_u32 v6, s32, v4
v_add_u32 v7, s33, v5
v_subrev_u32 v8, 225, v6
v_cmp_gt_u32 vcc, 225, v6
v_mov_b32 v10, 0.25
s_nop 0
v_cndmask_b32 v8, v8, v6, vcc
v_cndmask_b32 v10, v10, 0, vcc
v_mul_u32_u24 v9, v8, v7
v_cvt_f32_u32 v9, v9
v_mul_f32 v11, s30, v9
v_floor_f32 v11, v11
v_mul_f32 v11, 0xc3e00000, v11
v_add_f32 v9, v9, v11
v_fma_f32 v9, v9, s30, v10
v_cos_f32 v9, v9
v_mov_b32 v11, 1.0
s_cmp_eq_u32 s27, 0
s_cbranch_scc1 .Lm1_1_297
v_mov_b32 v11, s31
v_mov_b32 v12, s30
v_cmp_eq_u32 vcc, 0, v8
s_nop 1
v_cndmask_b32 v11, v11, v12, vcc
v_mov_b32 v13, 224
v_cmp_eq_u32 vcc, v13, v8
s_nop 1
v_cndmask_b32 v11, v11, v12, vcc
.Lm1_1_297:
v_mov_b32 v13, 450
v_cmp_gt_u32 vcc, v13, v6
s_nop 1
v_cndmask_b32 v11, 0, v11, vcc
v_mul_f32 v23, v9, v11
s_mul_i32 s32, s27, 2
s_mul_i32 s33, s29, 2
v_add_u32 v6, s32, v4
v_add_u32 v7, s33, v5
v_subrev_u32 v8, 225, v6
v_cmp_gt_u32 vcc, 225, v6
v_mov_b32 v10, 0.25
s_nop 0
v_cndmask_b32 v8, v8, v6, vcc
v_cndmask_b32 v10, v10, 0, vcc
v_mul_u32_u24 v9, v8, v7
v_cvt_f32_u32 v9, v9
v_mul_f32 v11, s30, v9
v_floor_f32 v11, v11
v_mul_f32 v11, 0xc3e00000, v11
v_add_f32 v9, v9, v11
v_fma_f32 v9, v9, s30, v10
v_cos_f32 v9, v9
v_mov_b32 v11, 1.0
s_cmp_eq_u32 s27, 0
s_cbranch_scc1 .Lm1_2_297
v_mov_b32 v11, s31
v_mov_b32 v12, s30
v_cmp_eq_u32 vcc, 0, v8
s_nop 1
v_cndmask_b32 v11, v11, v12, vcc
v_mov_b32 v13, 224
v_cmp_eq_u32 vcc, v13, v8
s_nop 1
v_cndmask_b32 v11, v11, v12, vcc
.Lm1_2_297:
v_mov_b32 v13, 450
v_cmp_gt_u32 vcc, v13, v6
s_nop 1
v_cndmask_b32 v11, 0, v11, vcc
v_mul_f32 v24, v9, v11
s_mul_i32 s32, s27, 3
s_mul_i32 s33, s29, 3
v_add_u32 v6, s32, v4
v_add_u32 v7, s33, v5
v_subrev_u32 v8, 225, v6
v_cmp_gt_u32 vcc, 225, v6
v_mov_b32 v10, 0.25
s_nop 0
v_cndmask_b32 v8, v8, v6, vcc
v_cndmask_b32 v10, v10, 0, vcc
v_mul_u32_u24 v9, v8, v7
v_cvt_f32_u32 v9, v9
v_mul_f32 v11, s30, v9
v_floor_f32 v11, v11
v_mul_f32 v11, 0xc3e00000, v11
v_add_f32 v9, v9, v11
v_fma_f32 v9, v9, s30, v10
v_cos_f32 v9, v9
v_mov_b32 v11, 1.0
s_cmp_eq_u32 s27, 0
s_cbranch_scc1 .Lm1_3_297
v_mov_b32 v11, s31
v_mov_b32 v12, s30
v_cmp_eq_u32 vcc, 0, v8
s_nop 1
v_cndmask_b32 v11, v11, v12, vcc
v_mov_b32 v13, 224
v_cmp_eq_u32 vcc, v13, v8
s_nop 1
v_cndmask_b32 v11, v11, v12, vcc
.Lm1_3_297:
v_mov_b32 v13, 450
v_cmp_gt_u32 vcc, v13, v6
s_nop 1
v_cndmask_b32 v11, 0, v11, vcc
v_mul_f32 v25, v9, v11
s_mul_i32 s32, s27, 4
s_mul_i32 s33, s29, 4
v_add_u32 v6, s32, v4
v_add_u32 v7, s33, v5
v_subrev_u32 v8, 225, v6
v_cmp_gt_u32 vcc, 225, v6
v_mov_b32 v10, 0.25
s_nop 0
v_cndmask_b32 v8, v8, v6, vcc
v_cndmask_b32 v10, v10, 0, vcc
v_mul_u32_u24 v9, v8, v7
v_cvt_f32_u32 v9, v9
v_mul_f32 v11, s30, v9
v_floor_f32 v11, v11
v_mul_f32 v11, 0xc3e00000, v11
v_add_f32 v9, v9, v11
v_fma_f32 v9, v9, s30, v10
v_cos_f32 v9, v9
v_mov_b32 v11, 1.0
s_cmp_eq_u32 s27, 0
s_cbranch_scc1 .Lm1_4_297
v_mov_b32 v11, s31
v_mov_b32 v12, s30
v_cmp_eq_u32 vcc, 0, v8
s_nop 1
v_cndmask_b32 v11, v11, v12, vcc
v_mov_b32 v13, 224
v_cmp_eq_u32 vcc, v13, v8
s_nop 1
v_cndmask_b32 v11, v11, v12, vcc
.Lm1_4_297:
v_mov_b32 v13, 450
v_cmp_gt_u32 vcc, v13, v6
s_nop 1
v_cndmask_b32 v11, 0, v11, vcc
v_mul_f32 v26, v9, v11
s_mul_i32 s32, s27, 5
s_mul_i32 s33, s29, 5
v_add_u32 v6, s32, v4
v_add_u32 v7, s33, v5
v_subrev_u32 v8, 225, v6
v_cmp_gt_u32 vcc, 225, v6
v_mov_b32 v10, 0.25
s_nop 0
v_cndmask_b32 v8, v8, v6, vcc
v_cndmask_b32 v10, v10, 0, vcc
v_mul_u32_u24 v9, v8, v7
v_cvt_f32_u32 v9, v9
v_mul_f32 v11, s30, v9
v_floor_f32 v11, v11
v_mul_f32 v11, 0xc3e00000, v11
v_add_f32 v9, v9, v11
v_fma_f32 v9, v9, s30, v10
v_cos_f32 v9, v9
v_mov_b32 v11, 1.0
s_cmp_eq_u32 s27, 0
s_cbranch_scc1 .Lm1_5_297
v_mov_b32 v11, s31
v_mov_b32 v12, s30
v_cmp_eq_u32 vcc, 0, v8
s_nop 1
v_cndmask_b32 v11, v11, v12, vcc
v_mov_b32 v13, 224
v_cmp_eq_u32 vcc, v13, v8
s_nop 1
v_cndmask_b32 v11, v11, v12, vcc
.Lm1_5_297:
v_mov_b32 v13, 450
v_cmp_gt_u32 vcc, v13, v6
s_nop 1
v_cndmask_b32 v11, 0, v11, vcc
v_mul_f32 v27, v9, v11
s_mul_i32 s32, s27, 6
s_mul_i32 s33, s29, 6
v_add_u32 v6, s32, v4
v_add_u32 v7, s33, v5
v_subrev_u32 v8, 225, v6
v_cmp_gt_u32 vcc, 225, v6
v_mov_b32 v10, 0.25
s_nop 0
v_cndmask_b32 v8, v8, v6, vcc
v_cndmask_b32 v10, v10, 0, vcc
v_mul_u32_u24 v9, v8, v7
v_cvt_f32_u32 v9, v9
v_mul_f32 v11, s30, v9
v_floor_f32 v11, v11
v_mul_f32 v11, 0xc3e00000, v11
v_add_f32 v9, v9, v11
v_fma_f32 v9, v9, s30, v10
v_cos_f32 v9, v9
v_mov_b32 v11, 1.0
s_cmp_eq_u32 s27, 0
s_cbranch_scc1 .Lm1_6_297
v_mov_b32 v11, s31
v_mov_b32 v12, s30
v_cmp_eq_u32 vcc, 0, v8
s_nop 1
v_cndmask_b32 v11, v11, v12, vcc
v_mov_b32 v13, 224
v_cmp_eq_u32 vcc, v13, v8
s_nop 1
v_cndmask_b32 v11, v11, v12, vcc
.Lm1_6_297:
v_mov_b32 v13, 450
v_cmp_gt_u32 vcc, v13, v6
s_nop 1
v_cndmask_b32 v11, 0, v11, vcc
v_mul_f32 v28, v9, v11
s_mul_i32 s32, s27, 7
s_mul_i32 s33, s29, 7
v_add_u32 v6, s32, v4
v_add_u32 v7, s33, v5
v_subrev_u32 v8, 225, v6
v_cmp_gt_u32 vcc, 225, v6
v_mov_b32 v10, 0.25
s_nop 0
v_cndmask_b32 v8, v8, v6, vcc
v_cndmask_b32 v10, v10, 0, vcc
v_mul_u32_u24 v9, v8, v7
v_cvt_f32_u32 v9, v9
v_mul_f32 v11, s30, v9
v_floor_f32 v11, v11
v_mul_f32 v11, 0xc3e00000, v11
v_add_f32 v9, v9, v11
v_fma_f32 v9, v9, s30, v10
v_cos_f32 v9, v9
v_mov_b32 v11, 1.0
s_cmp_eq_u32 s27, 0
s_cbranch_scc1 .Lm1_7_297
v_mov_b32 v11, s31
v_mov_b32 v12, s30
v_cmp_eq_u32 vcc, 0, v8
s_nop 1
v_cndmask_b32 v11, v11, v12, vcc
v_mov_b32 v13, 224
v_cmp_eq_u32 vcc, v13, v8
s_nop 1
v_cndmask_b32 v11, v11, v12, vcc
.Lm1_7_297:
v_mov_b32 v13, 450
v_cmp_gt_u32 vcc, v13, v6
s_nop 1
v_cndmask_b32 v11, 0, v11, vcc
v_mul_f32 v29, v9, v11
v_cvt_pk_bf16_f32 v32, v22, v23
v_cvt_pk_bf16_f32 v33, v24, v25
v_cvt_pk_bf16_f32 v34, v26, v27
v_cvt_pk_bf16_f32 v35, v28, v29
buffer_store_dwordx4 v[32:35], v20, s[8:11], s28 offen sc1
s_waitcnt vmcnt(0)
.Lsk_297:
s_add_u32 s24, s24, 1
s_branch .Lmn_288
.Lmn_288:
s_lshl_b32 s24, s59, 2
s_add_u32 s24, s24, 68184064
s_lshl_b32 s25, s17, 6
v_add_u32 v2, s25, v0
v_cmp_eq_u32 vcc, 0, v2
v_mov_b32 v2, 0x10000000
v_mov_b32 v3, 1
v_cndmask_b32 v2, v2, 0, vcc
s_waitcnt vmcnt(0) lgkmcnt(0)
s_barrier
buffer_store_dword v3, v2, s[8:11], s24 offen sc1
s_add_u32 s59, s59, 96
s_branch .Lml_287
.Lmd_289:
s_sub_u32 s16, s58, 112
s_load_dwordx2 s[6:7], s[0:1], 0
s_waitcnt lgkmcnt(0)
s_mov_b32 s12, s6
s_mov_b32 s13, s7
s_mov_b32 s14, 1835008
s_mov_b32 s15, 0x00020000
s_mov_b32 s19, 54792192
s_mov_b32 s32, s16
s_mov_b32 s39, 4000
v_lshlrev_b32 v1, 4, v0
v_lshlrev_b32 v4, 2, v0
.Lj2loop_298:
s_lshr_b32 s33, s32, 2
s_and_b32 s34, s32, 3
s_lshl_b32 s34, s34, 2
s_add_u32 s34, s34, s17
s_cmp_ge_u32 s34, 14
s_cbranch_scc1 .Lj2idle_299
s_mul_i32 s24, s33, 14
s_add_u32 s24, s24, s34
s_lshl_b32 s25, s24, 4
s_add_u32 s25, s25, 68124672
s_mov_b32 s30, s39
.Lj2p_302:
buffer_load_dword v5, v4, s[8:11], s25 offen sc1
s_waitcnt vmcnt(0)
v_cmp_eq_u32 vcc, 1, v5
s_nop 1
s_and_b32 s31, vcc_lo, 0xf
s_cmp_eq_u32 s31, 0xf
s_cbranch_scc1 .Lj2o_303
s_sleep 2
s_sub_u32 s30, s30, 1
s_cbranch_scc0 .Lj2p_302
s_mov_b32 s39, 0
.Lj2o_303:
s_lshl_b32 s35, s24, 4
s_add_u32 s35, s35, 68161536
s_lshl_b32 s25, s24, 13
s_add_u32 s25, s25, 46403584
s_lshl_b32 s24, s24, 15
s_add_u32 s24, s24, 16515072
buffer_load_dwordx4 a[0:3], v1, s[8:11], s24 offen offset:0 sc1
buffer_load_dwordx4 a[4:7], v1, s[8:11], s24 offen offset:1024 sc1
buffer_load_dwordx4 a[8:11], v1, s[8:11], s24 offen offset:2048 sc1
buffer_load_dwordx4 a[12:15], v1, s[8:11], s24 offen offset:3072 sc1
s_add_u32 s24, s24, 4096
buffer_load_dwordx4 a[16:19], v1, s[8:11], s24 offen offset:0 sc1
buffer_load_dwordx4 a[20:23], v1, s[8:11], s24 offen offset:1024 sc1
buffer_load_dwordx4 a[24:27], v1, s[8:11], s24 offen offset:2048 sc1
buffer_load_dwordx4 a[28:31], v1, s[8:11], s24 offen offset:3072 sc1
s_add_u32 s24, s24, 4096
buffer_load_dwordx4 a[32:35], v1, s[8:11], s24 offen offset:0 sc1
buffer_load_dwordx4 a[36:39], v1, s[8:11], s24 offen offset:1024 sc1
buffer_load_dwordx4 a[40:43], v1, s[8:11], s24 offen offset:2048 sc1
buffer_load_dwordx4 a[44:47], v1, s[8:11], s24 offen offset:3072 sc1
s_add_u32 s24, s24, 4096
buffer_load_dwordx4 a[48:51], v1, s[8:11], s24 offen offset:0 sc1
buffer_load_dwordx4 a[52:55], v1, s[8:11], s24 offen offset:1024 sc1
buffer_load_dwordx4 a[56:59], v1, s[8:11], s24 offen offset:2048 sc1
buffer_load_dwordx4 a[60:63], v1, s[8:11], s24 offen offset:3072 sc1
s_add_u32 s24, s24, 4096
buffer_load_dwordx4 a[64:67], v1, s[8:11], s24 offen offset:0 sc1
buffer_load_dwordx4 a[68:71], v1, s[8:11], s24 offen offset:1024 sc1
buffer_load_dwordx4 a[72:75], v1, s[8:11], s24 offen offset:2048 sc1
buffer_load_dwordx4 a[76:79], v1, s[8:11], s24 offen offset:3072 sc1
s_add_u32 s24, s24, 4096
buffer_load_dwordx4 a[80:83], v1, s[8:11], s24 offen offset:0 sc1
buffer_load_dwordx4 a[84:87], v1, s[8:11], s24 offen offset:1024 sc1
buffer_load_dwordx4 a[88:91], v1, s[8:11], s24 offen offset:2048 sc1
buffer_load_dwordx4 a[92:95], v1, s[8:11], s24 offen offset:3072 sc1
s_add_u32 s24, s24, 4096
buffer_load_dwordx4 a[96:99], v1, s[8:11], s24 offen offset:0 sc1
buffer_load_dwordx4 a[100:103], v1, s[8:11], s24 offen offset:1024 sc1
buffer_load_dwordx4 a[104:107], v1, s[8:11], s24 offen offset:2048 sc1
buffer_load_dwordx4 a[108:111], v1, s[8:11], s24 offen offset:3072 sc1
s_add_u32 s24, s24, 4096
buffer_load_dwordx4 a[112:115], v1, s[8:11], s24 offen offset:0 sc1
buffer_load_dwordx4 a[116:119], v1, s[8:11], s24 offen offset:1024 sc1
buffer_load_dwordx4 a[120:123], v1, s[8:11], s24 offen offset:2048 sc1
buffer_load_dwordx4 a[124:127], v1, s[8:11], s24 offen offset:3072 sc1
s_add_u32 s24, s24, 4096
v_and_b32 v6, 15, v0
v_lshrrev_b32 v5, 3, v6
v_lshlrev_b32 v5, 4, v5
v_lshrrev_b32 v7, 2, v6
v_and_b32 v7, 1, v7
v_lshlrev_b32 v7, 2, v7
v_and_b32 v6, 3, v6
v_add3_u32 v5, v5, v7, v6
s_lshl_b32 s24, s33, 5
v_add_u32 v5, s24, v5
v_mul_u32_u24 v5, 896, v5
v_lshrrev_b32 v6, 4, v0
v_and_b32 v7, 1, v6
v_lshlrev_b32 v7, 5, v7
v_lshrrev_b32 v6, 1, v6
v_lshlrev_b32 v6, 4, v6
v_add3_u32 v5, v5, v6, v7
s_lshl_b32 s24, s34, 6
v_add_u32 v3, s24, v5
v_add_u32 v2, 7168, v3
buffer_load_dwordx4 v[8:11], v3, s[12:15], 0 offen
buffer_load_dwordx4 v[12:15], v2, s[12:15], 0 offen
.Lj2idle_299:
s_add_u32 s26, s33, 1
s_lshl_b32 s26, s26, 6
s_add_u32 s26, s26, 68141056
s_lshl_b32 s27, s33, 7
s_add_u32 s27, s27, 68149248
s_cmp_ge_u32 s33, 56
s_cbranch_scc1 .Lj2f_304
s_mov_b32 s30, s39
.Lj2p_306:
buffer_load_dword v5, v4, s[8:11], s27 offen sc1
s_waitcnt vmcnt(0)
v_cmp_eq_u32 vcc, 1, v5
s_nop 1
s_and_b32 s31, vcc_lo, 0xffffffff
s_cmp_eq_u32 s31, 0xffffffff
s_cbranch_scc1 .Lj2o_307
s_sleep 2
s_sub_u32 s30, s30, 1
s_cbranch_scc0 .Lj2p_306
s_mov_b32 s39, 0
.Lj2o_307:
s_branch .Lj2j_305
.Lj2f_304:
s_lshl_b32 s27, s33, 6
s_add_u32 s27, s27, 68140992
s_mov_b32 s30, s39
.Lj2p_308:
buffer_load_dword v5, v4, s[8:11], s27 offen sc1
s_waitcnt vmcnt(0)
v_cmp_eq_u32 vcc, 1, v5
s_nop 1
s_and_b32 s31, vcc_lo, 0x3fff
s_cmp_eq_u32 s31, 0x3fff
s_cbranch_scc1 .Lj2o_309
s_sleep 2
s_sub_u32 s30, s30, 1
s_cbranch_scc0 .Lj2p_308
s_mov_b32 s39, 0
.Lj2o_309:
.Lj2j_305:
s_mul_i32 s24, s33, 40960
s_mul_i32 s28, s17, 10240
s_add_u32 s24, s24, s28
s_add_u32 s24, s24, 65503232
v_add_u32 v6, s28, v1
s_add_u32 s26, s24, 4096
s_add_u32 s27, s24, 8192
s_mov_b32 s30, s39
.Lj2r_310:
buffer_load_dwordx4 v[72:75], v1, s[8:11], s24 offen offset:0 sc1
buffer_load_dwordx4 v[76:79], v1, s[8:11], s24 offen offset:1024 sc1
buffer_load_dwordx4 v[80:83], v1, s[8:11], s24 offen offset:2048 sc1
buffer_load_dwordx4 v[84:87], v1, s[8:11], s24 offen offset:3072 sc1
buffer_load_dwordx4 v[88:91], v1, s[8:11], s26 offen offset:0 sc1
buffer_load_dwordx4 v[92:95], v1, s[8:11], s26 offen offset:1024 sc1
buffer_load_dwordx4 v[96:99], v1, s[8:11], s26 offen offset:2048 sc1
buffer_load_dwordx4 v[100:103], v1, s[8:11], s26 offen offset:3072 sc1
buffer_load_dwordx4 v[104:107], v1, s[8:11], s27 offen offset:0 sc1
buffer_load_dwordx4 v[108:111], v1, s[8:11], s27 offen offset:1024 sc1
s_waitcnt vmcnt(0)
v_max_u32 v5, v72, v73
v_max3_u32 v5, v5, v74, v75
v_max3_u32 v5, v5, v76, v77
v_max3_u32 v5, v5, v78, v79
v_max3_u32 v5, v5, v80, v81
v_max3_u32 v5, v5, v82, v83
v_max3_u32 v5, v5, v84, v85
v_max3_u32 v5, v5, v86, v87
v_max3_u32 v5, v5, v88, v89
v_max3_u32 v5, v5, v90, v91
v_max3_u32 v5, v5, v92, v93
v_max3_u32 v5, v5, v94, v95
v_max3_u32 v5, v5, v96, v97
v_max3_u32 v5, v5, v98, v99
v_max3_u32 v5, v5, v100, v101
v_max3_u32 v5, v5, v102, v103
v_max3_u32 v5, v5, v104, v105
v_max3_u32 v5, v5, v106, v107
v_max3_u32 v5, v5, v108, v109
v_max3_u32 v5, v5, v110, v111
v_cmp_eq_u32 vcc, -1, v5
s_cbranch_vccz .Lj2q_311
s_sub_u32 s30, s30, 1
s_cbranch_scc0 .Lj2r_310
s_mov_b32 s39, 0
.Lj2q_311:
s_barrier
ds_write_b128 v6, v[72:75] offset:0
ds_write_b128 v6, v[76:79] offset:1024
ds_write_b128 v6, v[80:83] offset:2048
ds_write_b128 v6, v[84:87] offset:3072
ds_write_b128 v6, v[88:91] offset:4096
ds_write_b128 v6, v[92:95] offset:5120
ds_write_b128 v6, v[96:99] offset:6144
ds_write_b128 v6, v[100:103] offset:7168
ds_write_b128 v6, v[104:107] offset:8192
ds_write_b128 v6, v[108:111] offset:9216
s_cmp_ge_u32 s34, 14
s_cbranch_scc1 .Lj2w_312
s_cmp_ge_u32 s33, 56
s_cbranch_scc1 .Lj2nw_313
s_mov_b32 s30, s39
.Lj2p_314:
buffer_load_dword v5, v4, s[8:11], s35 offen sc1
s_waitcnt vmcnt(0)
v_cmp_eq_u32 vcc, 1, v5
s_nop 1
s_and_b32 s31, vcc_lo, 0xf
s_cmp_eq_u32 s31, 0xf
s_cbranch_scc1 .Lj2o_315
s_sleep 2
s_sub_u32 s30, s30, 1
s_cbranch_scc0 .Lj2p_314
s_mov_b32 s39, 0
.Lj2o_315:
.Lj2nw_313:
s_add_u32 s29, s25, 4096
buffer_load_dwordx4 v[112:115], v1, s[8:11], s25 offen offset:0 sc1
buffer_load_dwordx4 v[116:119], v1, s[8:11], s25 offen offset:1024 sc1
buffer_load_dwordx4 v[120:123], v1, s[8:11], s25 offen offset:2048 sc1
buffer_load_dwordx4 v[124:127], v1, s[8:11], s25 offen offset:3072 sc1
buffer_load_dwordx4 v[128:131], v1, s[8:11], s29 offen offset:0 sc1
buffer_load_dwordx4 v[132:135], v1, s[8:11], s29 offen offset:1024 sc1
buffer_load_dwordx4 v[136:139], v1, s[8:11], s29 offen offset:2048 sc1
buffer_load_dwordx4 v[140:143], v1, s[8:11], s29 offen offset:3072 sc1
.Lj2w_312:
s_waitcnt lgkmcnt(0)
s_barrier
s_cmp_ge_u32 s34, 14
s_cbranch_scc1 .Lj2next_300
ds_read_b128 v[16:19], v1 offset:0
ds_read_b128 v[20:23], v1 offset:1024
ds_read_b128 v[24:27], v1 offset:2048
ds_read_b128 v[28:31], v1 offset:3072
s_waitcnt lgkmcnt(2)
v_mfma_f32_16x16x32_bf16 v[48:51], a[0:3], v[16:19], 0
ds_read_b128 v[32:35], v1 offset:4096
v_mfma_f32_16x16x32_bf16 v[52:55], a[0:3], v[20:23], 0
ds_read_b128 v[36:39], v1 offset:5120
v_mfma_f32_16x16x32_bf16 v[56:59], a[16:19], v[16:19], 0
v_mfma_f32_16x16x32_bf16 v[60:63], a[16:19], v[20:23], 0
s_waitcnt lgkmcnt(2)
v_mfma_f32_16x16x32_bf16 v[48:51], a[8:11], v[24:27], v[48:51]
ds_read_b128 v[40:43], v1 offset:6144
v_mfma_f32_16x16x32_bf16 v[52:55], a[8:11], v[28:31], v[52:55]
ds_read_b128 v[44:47], v1 offset:7168
v_mfma_f32_16x16x32_bf16 v[56:59], a[24:27], v[24:27], v[56:59]
v_mfma_f32_16x16x32_bf16 v[60:63], a[24:27], v[28:31], v[60:63]
s_waitcnt lgkmcnt(2)
v_mfma_f32_16x16x32_bf16 v[48:51], a[4:7], v[32:35], v[48:51]
ds_read_b128 v[16:19], v1 offset:8192
v_mfma_f32_16x16x32_bf16 v[52:55], a[4:7], v[36:39], v[52:55]
ds_read_b128 v[20:23], v1 offset:9216
v_mfma_f32_16x16x32_bf16 v[56:59], a[20:23], v[32:35], v[56:59]
v_mfma_f32_16x16x32_bf16 v[60:63], a[20:23], v[36:39], v[60:63]
s_waitcnt lgkmcnt(2)
v_mfma_f32_16x16x32_bf16 v[48:51], a[12:15], v[40:43], v[48:51]
ds_read_b128 v[24:27], v1 offset:10240
v_mfma_f32_16x16x32_bf16 v[52:55], a[12:15], v[44:47], v[52:55]
ds_read_b128 v[28:31], v1 offset:11264
v_mfma_f32_16x16x32_bf16 v[56:59], a[28:31], v[40:43], v[56:59]
v_mfma_f32_16x16x32_bf16 v[60:63], a[28:31], v[44:47], v[60:63]
s_waitcnt lgkmcnt(2)
v_mfma_f32_16x16x32_bf16 v[48:51], a[32:35], v[16:19], v[48:51]
ds_read_b128 v[32:35], v1 offset:12288
v_mfma_f32_16x16x32_bf16 v[52:55], a[32:35], v[20:23], v[52:55]
ds_read_b128 v[36:39], v1 offset:13312
v_mfma_f32_16x16x32_bf16 v[56:59], a[48:51], v[16:19], v[56:59]
v_mfma_f32_16x16x32_bf16 v[60:63], a[48:51], v[20:23], v[60:63]
s_waitcnt lgkmcnt(2)
v_mfma_f32_16x16x32_bf16 v[48:51], a[40:43], v[24:27], v[48:51]
ds_read_b128 v[40:43], v1 offset:14336
v_mfma_f32_16x16x32_bf16 v[52:55], a[40:43], v[28:31], v[52:55]
ds_read_b128 v[44:47], v1 offset:15360
v_mfma_f32_16x16x32_bf16 v[56:59], a[56:59], v[24:27], v[56:59]
v_mfma_f32_16x16x32_bf16 v[60:63], a[56:59], v[28:31], v[60:63]
s_waitcnt lgkmcnt(2)
v_mfma_f32_16x16x32_bf16 v[48:51], a[36:39], v[32:35], v[48:51]
ds_read_b128 v[16:19], v1 offset:16384
v_mfma_f32_16x16x32_bf16 v[52:55], a[36:39], v[36:39], v[52:55]
ds_read_b128 v[20:23], v1 offset:17408
v_mfma_f32_16x16x32_bf16 v[56:59], a[52:55], v[32:35], v[56:59]
v_mfma_f32_16x16x32_bf16 v[60:63], a[52:55], v[36:39], v[60:63]
s_waitcnt lgkmcnt(2)
v_mfma_f32_16x16x32_bf16 v[48:51], a[44:47], v[40:43], v[48:51]
ds_read_b128 v[24:27], v1 offset:18432
v_mfma_f32_16x16x32_bf16 v[52:55], a[44:47], v[44:47], v[52:55]
ds_read_b128 v[28:31], v1 offset:19456
v_mfma_f32_16x16x32_bf16 v[56:59], a[60:63], v[40:43], v[56:59]
v_mfma_f32_16x16x32_bf16 v[60:63], a[60:63], v[44:47], v[60:63]
s_waitcnt lgkmcnt(2)
v_mfma_f32_16x16x32_bf16 v[48:51], a[64:67], v[16:19], v[48:51]
ds_read_b128 v[32:35], v1 offset:20480
v_mfma_f32_16x16x32_bf16 v[52:55], a[64:67], v[20:23], v[52:55]
ds_read_b128 v[36:39], v1 offset:21504
v_mfma_f32_16x16x32_bf16 v[56:59], a[80:83], v[16:19], v[56:59]
v_mfma_f32_16x16x32_bf16 v[60:63], a[80:83], v[20:23], v[60:63]
s_waitcnt lgkmcnt(2)
v_mfma_f32_16x16x32_bf16 v[48:51], a[72:75], v[24:27], v[48:51]
ds_read_b128 v[40:43], v1 offset:22528
v_mfma_f32_16x16x32_bf16 v[52:55], a[72:75], v[28:31], v[52:55]
ds_read_b128 v[44:47], v1 offset:23552
v_mfma_f32_16x16x32_bf16 v[56:59], a[88:91], v[24:27], v[56:59]
v_mfma_f32_16x16x32_bf16 v[60:63], a[88:91], v[28:31], v[60:63]
s_waitcnt lgkmcnt(2)
v_mfma_f32_16x16x32_bf16 v[48:51], a[68:71], v[32:35], v[48:51]
ds_read_b128 v[16:19], v1 offset:24576
v_mfma_f32_16x16x32_bf16 v[52:55], a[68:71], v[36:39], v[52:55]
ds_read_b128 v[20:23], v1 offset:25600
v_mfma_f32_16x16x32_bf16 v[56:59], a[84:87], v[32:35], v[56:59]
v_mfma_f32_16x16x32_bf16 v[60:63], a[84:87], v[36:39], v[60:63]
s_waitcnt lgkmcnt(2)
v_mfma_f32_16x16x32_bf16 v[48:51], a[76:79], v[40:43], v[48:51]
ds_read_b128 v[24:27], v1 offset:26624
v_mfma_f32_16x16x32_bf16 v[52:55], a[76:79], v[44:47], v[52:55]
ds_read_b128 v[28:31], v1 offset:27648
v_mfma_f32_16x16x32_bf16 v[56:59], a[92:95], v[40:43], v[56:59]
v_mfma_f32_16x16x32_bf16 v[60:63], a[92:95], v[44:47], v[60:63]
s_waitcnt lgkmcnt(2)
v_mfma_f32_16x16x32_bf16 v[48:51], a[96:99], v[16:19], v[48:51]
ds_read_b128 v[32:35], v1 offset:28672
v_mfma_f32_16x16x32_bf16 v[52:55], a[96:99], v[20:23], v[52:55]
ds_read_b128 v[36:39], v1 offset:29696
v_mfma_f32_16x16x32_bf16 v[56:59], a[112:115], v[16:19], v[56:59]
v_mfma_f32_16x16x32_bf16 v[60:63], a[112:115], v[20:23], v[60:63]
s_waitcnt lgkmcnt(2)
v_mfma_f32_16x16x32_bf16 v[48:51], a[104:107], v[24:27], v[48:51]
ds_read_b128 v[40:43], v1 offset:30720
v_mfma_f32_16x16x32_bf16 v[52:55], a[104:107], v[28:31], v[52:55]
ds_read_b128 v[44:47], v1 offset:31744
v_mfma_f32_16x16x32_bf16 v[56:59], a[120:123], v[24:27], v[56:59]
v_mfma_f32_16x16x32_bf16 v[60:63], a[120:123], v[28:31], v[60:63]
s_waitcnt lgkmcnt(2)
v_mfma_f32_16x16x32_bf16 v[48:51], a[100:103], v[32:35], v[48:51]
ds_read_b128 v[16:19], v1 offset:32768
v_mfma_f32_16x16x32_bf16 v[52:55], a[100:103], v[36:39], v[52:55]
ds_read_b128 v[20:23], v1 offset:33792
v_mfma_f32_16x16x32_bf16 v[56:59], a[116:119], v[32:35], v[56:59]
v_mfma_f32_16x16x32_bf16 v[60:63], a[116:119], v[36:39], v[60:63]
s_waitcnt lgkmcnt(2)
v_mfma_f32_16x16x32_bf16 v[48:51], a[108:111], v[40:43], v[48:51]
ds_read_b128 v[24:27], v1 offset:34816
v_mfma_f32_16x16x32_bf16 v[52:55], a[108:111], v[44:47], v[52:55]
ds_read_b128 v[28:31], v1 offset:35840
v_mfma_f32_16x16x32_bf16 v[56:59], a[124:127], v[40:43], v[56:59]
v_mfma_f32_16x16x32_bf16 v[60:63], a[124:127], v[44:47], v[60:63]
s_waitcnt vmcnt(0)
s_mov_b32 s30, s39
.Lj2c_316:
v_max_u32 v5, v112, v113
v_max3_u32 v5, v5, v114, v115
v_max3_u32 v5, v5, v116, v117
v_max3_u32 v5, v5, v118, v119
v_max3_u32 v5, v5, v120, v121
v_max3_u32 v5, v5, v122, v123
v_max3_u32 v5, v5, v124, v125
v_max3_u32 v5, v5, v126, v127
v_max3_u32 v5, v5, v128, v129
v_max3_u32 v5, v5, v130, v131
v_max3_u32 v5, v5, v132, v133
v_max3_u32 v5, v5, v134, v135
v_max3_u32 v5, v5, v136, v137
v_max3_u32 v5, v5, v138, v139
v_max3_u32 v5, v5, v140, v141
v_max3_u32 v5, v5, v142, v143
v_cmp_eq_u32 vcc, -1, v5
s_cbranch_vccz .Lj2k_317
s_sub_u32 s30, s30, 1
s_cbranch_scc1 .Lj2t_318
buffer_load_dwordx4 v[112:115], v1, s[8:11], s25 offen offset:0 sc1
buffer_load_dwordx4 v[116:119], v1, s[8:11], s25 offen offset:1024 sc1
buffer_load_dwordx4 v[120:123], v1, s[8:11], s25 offen offset:2048 sc1
buffer_load_dwordx4 v[124:127], v1, s[8:11], s25 offen offset:3072 sc1
buffer_load_dwordx4 v[128:131], v1, s[8:11], s29 offen offset:0 sc1
buffer_load_dwordx4 v[132:135], v1, s[8:11], s29 offen offset:1024 sc1
buffer_load_dwordx4 v[136:139], v1, s[8:11], s29 offen offset:2048 sc1
buffer_load_dwordx4 v[140:143], v1, s[8:11], s29 offen offset:3072 sc1
s_waitcnt vmcnt(0)
s_branch .Lj2c_316
.Lj2t_318:
s_mov_b32 s39, 0
.Lj2k_317:
s_waitcnt lgkmcnt(2)
v_mfma_f32_16x16x32_bf16 v[48:51], v[112:115], v[16:19], v[48:51]
ds_read_b128 v[32:35], v1 offset:36864
v_mfma_f32_16x16x32_bf16 v[52:55], v[112:115], v[20:23], v[52:55]
ds_read_b128 v[36:39], v1 offset:37888
v_mfma_f32_16x16x32_bf16 v[56:59], v[116:119], v[16:19], v[56:59]
v_mfma_f32_16x16x32_bf16 v[60:63], v[116:119], v[20:23], v[60:63]
s_waitcnt lgkmcnt(2)
v_mfma_f32_16x16x32_bf16 v[48:51], v[120:123], v[24:27], v[48:51]
ds_read_b128 v[40:43], v1 offset:38912
v_mfma_f32_16x16x32_bf16 v[52:55], v[120:123], v[28:31], v[52:55]
ds_read_b128 v[44:47], v1 offset:39936
v_mfma_f32_16x16x32_bf16 v[56:59], v[124:127], v[24:27], v[56:59]
v_mfma_f32_16x16x32_bf16 v[60:63], v[124:127], v[28:31], v[60:63]
s_waitcnt lgkmcnt(2)
v_mfma_f32_16x16x32_bf16 v[48:51], v[128:131], v[32:35], v[48:51]
v_mfma_f32_16x16x32_bf16 v[52:55], v[128:131], v[36:39], v[52:55]
v_mfma_f32_16x16x32_bf16 v[56:59], v[132:135], v[32:35], v[56:59]
v_mfma_f32_16x16x32_bf16 v[60:63], v[132:135], v[36:39], v[60:63]
s_waitcnt lgkmcnt(0)
v_mfma_f32_16x16x32_bf16 v[48:51], v[136:139], v[40:43], v[48:51]
v_mfma_f32_16x16x32_bf16 v[52:55], v[136:139], v[44:47], v[52:55]
v_mfma_f32_16x16x32_bf16 v[56:59], v[140:143], v[40:43], v[56:59]
v_mfma_f32_16x16x32_bf16 v[60:63], v[140:143], v[44:47], v[60:63]
s_nop 7
v_cvt_pk_bf16_f32 v64, v48, v49
v_cvt_pk_bf16_f32 v65, v50, v51
v_cvt_pk_bf16_f32 v66, v56, v57
v_cvt_pk_bf16_f32 v67, v58, v59
s_nop 1
v_permlane16_swap_b32 v64, v66
v_permlane16_swap_b32 v65, v67
v_lshlrev_b32 v16, 16, v64
v_and_b32 v17, 0xffff0000, v64
v_lshlrev_b32 v18, 16, v8
v_and_b32 v19, 0xffff0000, v8
v_pk_add_f32 v[16:17], v[16:17], v[18:19]
v_cvt_pk_bf16_f32 v64, v16, v17
v_lshlrev_b32 v16, 16, v65
v_and_b32 v17, 0xffff0000, v65
v_lshlrev_b32 v18, 16, v9
v_and_b32 v19, 0xffff0000, v9
v_pk_add_f32 v[16:17], v[16:17], v[18:19]
v_cvt_pk_bf16_f32 v65, v16, v17
v_lshlrev_b32 v16, 16, v66
v_and_b32 v17, 0xffff0000, v66
v_lshlrev_b32 v18, 16, v10
v_and_b32 v19, 0xffff0000, v10
v_pk_add_f32 v[16:17], v[16:17], v[18:19]
v_cvt_pk_bf16_f32 v66, v16, v17
v_lshlrev_b32 v16, 16, v67
v_and_b32 v17, 0xffff0000, v67
v_lshlrev_b32 v18, 16, v11
v_and_b32 v19, 0xffff0000, v11
v_pk_add_f32 v[16:17], v[16:17], v[18:19]
v_cvt_pk_bf16_f32 v67, v16, v17
buffer_store_dwordx4 v[64:67], v3, s[8:11], s19 offen sc1
v_cvt_pk_bf16_f32 v68, v52, v53
v_cvt_pk_bf16_f32 v69, v54, v55
v_cvt_pk_bf16_f32 v70, v60, v61
v_cvt_pk_bf16_f32 v71, v62, v63
s_nop 1
v_permlane16_swap_b32 v68, v70
v_permlane16_swap_b32 v69, v71
v_lshlrev_b32 v16, 16, v68
v_and_b32 v17, 0xffff0000, v68
v_lshlrev_b32 v18, 16, v12
v_and_b32 v19, 0xffff0000, v12
v_pk_add_f32 v[16:17], v[16:17], v[18:19]
v_cvt_pk_bf16_f32 v68, v16, v17
v_lshlrev_b32 v16, 16, v69
v_and_b32 v17, 0xffff0000, v69
v_lshlrev_b32 v18, 16, v13
v_and_b32 v19, 0xffff0000, v13
v_pk_add_f32 v[16:17], v[16:17], v[18:19]
v_cvt_pk_bf16_f32 v69, v16, v17
v_lshlrev_b32 v16, 16, v70
v_and_b32 v17, 0xffff0000, v70
v_lshlrev_b32 v18, 16, v14
v_and_b32 v19, 0xffff0000, v14
v_pk_add_f32 v[16:17], v[16:17], v[18:19]
v_cvt_pk_bf16_f32 v70, v16, v17
v_lshlrev_b32 v16, 16, v71
v_and_b32 v17, 0xffff0000, v71
v_lshlrev_b32 v18, 16, v15
v_and_b32 v19, 0xffff0000, v15
v_pk_add_f32 v[16:17], v[16:17], v[18:19]
v_cvt_pk_bf16_f32 v71, v16, v17
buffer_store_dwordx4 v[68:71], v2, s[8:11], s19 offen sc1
s_lshl_b32 s24, s33, 6
s_lshl_b32 s25, s34, 2
s_add_u32 s24, s24, s25
s_add_u32 s24, s24, 68175872
v_mov_b32 v5, 0x10000000
v_cmp_eq_u32 vcc, 0, v0
v_mov_b32 v6, 1
s_nop 0
v_cndmask_b32 v5, v5, 0, vcc
s_waitcnt vmcnt(0)
buffer_store_dword v6, v5, s[8:11], s24 offen sc1
.Lj2next_300:
s_add_u32 s32, s32, 96
s_cmp_lt_u32 s32, 256
s_cbranch_scc1 .Lj2loop_298
s_waitcnt vmcnt(0)
s_branch .Ljoin_257
.Lb1_256:
s_mov_b32 s39, 8000
s_cmp_lg_u32 s17, 0
s_cbranch_scc1 .Lww_319
s_mov_b32 s24, 68184064
v_lshlrev_b32 v248, 4, v0
v_mov_b32 v252, 0x10000000
v_cmp_gt_u32 vcc, 34, v0
s_mov_b32 s25, s39
s_nop 0
v_cndmask_b32 v248, v252, v248, vcc
.Lwr_320:
buffer_load_dwordx4 v[252:255], v248, s[8:11], s24 offen sc1
s_waitcnt vmcnt(0)
s_mov_b32 s26, 0
v_cmp_eq_u32 vcc, 1, v252
s_nop 1
s_and_b32 vcc_lo, vcc_lo, 0xffffffff
s_and_b32 vcc_hi, vcc_hi, 0x3
s_bcnt1_i32_b64 s27, vcc
s_add_u32 s26, s26, s27
v_cmp_eq_u32 vcc, 1, v253
s_nop 1
s_and_b32 vcc_lo, vcc_lo, 0xffffffff
s_and_b32 vcc_hi, vcc_hi, 0x3
s_bcnt1_i32_b64 s27, vcc
s_add_u32 s26, s26, s27
v_cmp_eq_u32 vcc, 1, v254
s_nop 1
s_and_b32 vcc_lo, vcc_lo, 0xffffffff
s_and_b32 vcc_hi, vcc_hi, 0x3
s_bcnt1_i32_b64 s27, vcc
s_add_u32 s26, s26, s27
v_cmp_eq_u32 vcc, 1, v255
s_nop 1
s_and_b32 vcc_lo, vcc_lo, 0xffffffff
s_and_b32 vcc_hi, vcc_hi, 0x3
s_bcnt1_i32_b64 s27, vcc
s_add_u32 s26, s26, s27
s_cmp_eq_u32 s26, 136
s_cbranch_scc1 .Lwo_321
s_sleep 8
s_sub_u32 s25, s25, 1
s_cbranch_scc0 .Lwr_320
s_mov_b32 s39, 0
.Lwo_321:
.Lww_319:
s_barrier
v_lshlrev_b32 v1, 4, v0
s_mul_i32 s24, s63, 29696
s_add_u32 s24, s24, 63242240
buffer_load_dwordx4 a[128:131], v1, s[8:11], s24 offen offset:0
buffer_load_dwordx4 a[132:135], v1, s[8:11], s24 offen offset:1024
buffer_load_dwordx4 a[136:139], v1, s[8:11], s24 offen offset:2048
buffer_load_dwordx4 a[140:143], v1, s[8:11], s24 offen offset:3072
s_add_u32 s24, s24, 4096
buffer_load_dwordx4 a[144:147], v1, s[8:11], s24 offen offset:0
buffer_load_dwordx4 a[148:151], v1, s[8:11], s24 offen offset:1024
buffer_load_dwordx4 a[152:155], v1, s[8:11], s24 offen offset:2048
buffer_load_dwordx4 a[156:159], v1, s[8:11], s24 offen offset:3072
s_add_u32 s24, s24, 4096
buffer_load_dwordx4 a[160:163], v1, s[8:11], s24 offen offset:0
buffer_load_dwordx4 a[164:167], v1, s[8:11], s24 offen offset:1024
buffer_load_dwordx4 a[168:171], v1, s[8:11], s24 offen offset:2048
buffer_load_dwordx4 a[172:175], v1, s[8:11], s24 offen offset:3072
s_add_u32 s24, s24, 4096
buffer_load_dwordx4 a[176:179], v1, s[8:11], s24 offen offset:0
buffer_load_dwordx4 a[180:183], v1, s[8:11], s24 offen offset:1024
buffer_load_dwordx4 a[184:187], v1, s[8:11], s24 offen offset:2048
buffer_load_dwordx4 a[188:191], v1, s[8:11], s24 offen offset:3072
s_add_u32 s24, s24, 4096
buffer_load_dwordx4 a[192:195], v1, s[8:11], s24 offen offset:0
buffer_load_dwordx4 a[196:199], v1, s[8:11], s24 offen offset:1024
buffer_load_dwordx4 a[200:203], v1, s[8:11], s24 offen offset:2048
buffer_load_dwordx4 a[204:207], v1, s[8:11], s24 offen offset:3072
s_add_u32 s24, s24, 4096
buffer_load_dwordx4 a[208:211], v1, s[8:11], s24 offen offset:0
buffer_load_dwordx4 a[212:215], v1, s[8:11], s24 offen offset:1024
buffer_load_dwordx4 a[216:219], v1, s[8:11], s24 offen offset:2048
buffer_load_dwordx4 a[220:223], v1, s[8:11], s24 offen offset:3072
s_add_u32 s24, s24, 4096
buffer_load_dwordx4 a[224:227], v1, s[8:11], s24 offen offset:0
buffer_load_dwordx4 a[228:231], v1, s[8:11], s24 offen offset:1024
buffer_load_dwordx4 a[232:235], v1, s[8:11], s24 offen offset:2048
buffer_load_dwordx4 a[236:239], v1, s[8:11], s24 offen offset:3072
s_add_u32 s24, s24, 4096
buffer_load_dwordx4 a[240:243], v1, s[8:11], s24 offen offset:0
s_lshl_b32 s28, s58, 13
s_lshl_b32 s29, s17, 11
s_add_u32 s28, s28, s29
s_add_u32 s28, s28, 63660032
buffer_load_dwordx4 v[228:231], v1, s[8:11], s28 offen
buffer_load_dwordx4 v[232:235], v1, s[8:11], s28 offen offset:1024
v_and_b32 v5, 15, v0
v_lshrrev_b32 v6, 4, v0
s_lshl_b32 s29, s17, 4
v_add_u32 v7, s29, v5
v_cvt_f32_u32 v8, v7
v_cvt_f32_u32 v9, v6
v_cvt_f32_u32 v10, v5
v_mul_f32 v11, 0x3c800000, v8
v_mul_f32 v162, 0x41000000, v9
v_add_f32 v156, 0x0, v162
v_mul_f32 v156, v156, v11
v_fract_f32 v156, v156
v_add_f32 v157, 0x3f800000, v162
v_mul_f32 v157, v157, v11
v_fract_f32 v157, v157
v_cos_f32 v158, v156
v_cos_f32 v159, v157
v_sin_f32 v160, v156
v_sin_f32 v161, v157
s_nop 0
v_cvt_pk_bf16_f32 v164, v158, v159
v_cvt_pk_bf16_f32 v172, v160, v161
v_add_f32 v156, 0x40000000, v162
v_mul_f32 v156, v156, v11
v_fract_f32 v156, v156
v_add_f32 v157, 0x40400000, v162
v_mul_f32 v157, v157, v11
v_fract_f32 v157, v157
v_cos_f32 v158, v156
v_cos_f32 v159, v157
v_sin_f32 v160, v156
v_sin_f32 v161, v157
s_nop 0
v_cvt_pk_bf16_f32 v165, v158, v159
v_cvt_pk_bf16_f32 v173, v160, v161
v_add_f32 v156, 0x40800000, v162
v_mul_f32 v156, v156, v11
v_fract_f32 v156, v156
v_add_f32 v157, 0x40a00000, v162
v_mul_f32 v157, v157, v11
v_fract_f32 v157, v157
v_cos_f32 v158, v156
v_cos_f32 v159, v157
v_sin_f32 v160, v156
v_sin_f32 v161, v157
s_nop 0
v_cvt_pk_bf16_f32 v166, v158, v159
v_cvt_pk_bf16_f32 v174, v160, v161
v_add_f32 v156, 0x40c00000, v162
v_mul_f32 v156, v156, v11
v_fract_f32 v156, v156
v_add_f32 v157, 0x40e00000, v162
v_mul_f32 v157, v157, v11
v_fract_f32 v157, v157
v_cos_f32 v158, v156
v_cos_f32 v159, v157
v_sin_f32 v160, v156
v_sin_f32 v161, v157
s_nop 0
v_cvt_pk_bf16_f32 v167, v158, v159
v_cvt_pk_bf16_f32 v175, v160, v161
v_add_f32 v156, 0x42000000, v162
v_mul_f32 v156, v156, v11
v_fract_f32 v156, v156
v_add_f32 v157, 0x42040000, v162
v_mul_f32 v157, v157, v11
v_fract_f32 v157, v157
v_cos_f32 v158, v156
v_cos_f32 v159, v157
v_sin_f32 v160, v156
v_sin_f32 v161, v157
s_nop 0
v_cvt_pk_bf16_f32 v168, v158, v159
v_cvt_pk_bf16_f32 v176, v160, v161
v_add_f32 v156, 0x42080000, v162
v_mul_f32 v156, v156, v11
v_fract_f32 v156, v156
v_add_f32 v157, 0x420c0000, v162
v_mul_f32 v157, v157, v11
v_fract_f32 v157, v157
v_cos_f32 v158, v156
v_cos_f32 v159, v157
v_sin_f32 v160, v156
v_sin_f32 v161, v157
s_nop 0
v_cvt_pk_bf16_f32 v169, v158, v159
v_cvt_pk_bf16_f32 v177, v160, v161
v_add_f32 v156, 0x42100000, v162
v_mul_f32 v156, v156, v11
v_fract_f32 v156, v156
v_add_f32 v157, 0x42140000, v162
v_mul_f32 v157, v157, v11
v_fract_f32 v157, v157
v_cos_f32 v158, v156
v_cos_f32 v159, v157
v_sin_f32 v160, v156
v_sin_f32 v161, v157
s_nop 0
v_cvt_pk_bf16_f32 v170, v158, v159
v_cvt_pk_bf16_f32 v178, v160, v161
v_add_f32 v156, 0x42180000, v162
v_mul_f32 v156, v156, v11
v_fract_f32 v156, v156
v_add_f32 v157, 0x421c0000, v162
v_mul_f32 v157, v157, v11
v_fract_f32 v157, v157
v_cos_f32 v158, v156
v_cos_f32 v159, v157
v_sin_f32 v160, v156
v_sin_f32 v161, v157
s_nop 0
v_cvt_pk_bf16_f32 v171, v158, v159
v_cvt_pk_bf16_f32 v179, v160, v161
v_xor_b32 v180, 0x80008000, v172
v_xor_b32 v181, 0x80008000, v173
v_xor_b32 v182, 0x80008000, v174
v_xor_b32 v183, 0x80008000, v175
v_xor_b32 v184, 0x80008000, v176
v_xor_b32 v185, 0x80008000, v177
v_xor_b32 v186, 0x80008000, v178
v_xor_b32 v187, 0x80008000, v179
v_mul_f32 v162, 4.0, v9
v_add_f32 v156, 0x0, v162
v_add_f32 v163, 0x0, v10
v_mul_f32 v156, v156, v163
v_mul_f32 v156, 0x3d000000, v156
v_fract_f32 v156, v156
v_add_f32 v157, 0x3f800000, v162
v_add_f32 v163, 0x0, v10
v_mul_f32 v157, v157, v163
v_mul_f32 v157, 0x3d000000, v157
v_fract_f32 v157, v157
v_cos_f32 v158, v156
v_cos_f32 v159, v157
v_sin_f32 v160, v156
v_sin_f32 v161, v157
s_nop 0
v_cvt_pk_bf16_f32 v188, v158, v159
v_cvt_pk_bf16_f32 v196, v160, v161
v_add_f32 v156, 0x40000000, v162
v_add_f32 v163, 0x0, v10
v_mul_f32 v156, v156, v163
v_mul_f32 v156, 0x3d000000, v156
v_fract_f32 v156, v156
v_add_f32 v157, 0x40400000, v162
v_add_f32 v163, 0x0, v10
v_mul_f32 v157, v157, v163
v_mul_f32 v157, 0x3d000000, v157
v_fract_f32 v157, v157
v_cos_f32 v158, v156
v_cos_f32 v159, v157
v_sin_f32 v160, v156
v_sin_f32 v161, v157
s_nop 0
v_cvt_pk_bf16_f32 v189, v158, v159
v_cvt_pk_bf16_f32 v197, v160, v161
v_add_f32 v156, 0x41800000, v162
v_add_f32 v163, 0x0, v10
v_mul_f32 v156, v156, v163
v_mul_f32 v156, 0x3d000000, v156
v_fract_f32 v156, v156
v_add_f32 v157, 0x41880000, v162
v_add_f32 v163, 0x0, v10
v_mul_f32 v157, v157, v163
v_mul_f32 v157, 0x3d000000, v157
v_fract_f32 v157, v157
v_cos_f32 v158, v156
v_cos_f32 v159, v157
v_sin_f32 v160, v156
v_sin_f32 v161, v157
s_nop 0
v_cvt_pk_bf16_f32 v190, v158, v159
v_cvt_pk_bf16_f32 v198, v160, v161
v_add_f32 v156, 0x41900000, v162
v_add_f32 v163, 0x0, v10
v_mul_f32 v156, v156, v163
v_mul_f32 v156, 0x3d000000, v156
v_fract_f32 v156, v156
v_add_f32 v157, 0x41980000, v162
v_add_f32 v163, 0x0, v10
v_mul_f32 v157, v157, v163
v_mul_f32 v157, 0x3d000000, v157
v_fract_f32 v157, v157
v_cos_f32 v158, v156
v_cos_f32 v159, v157
v_sin_f32 v160, v156
v_sin_f32 v161, v157
s_nop 0
v_cvt_pk_bf16_f32 v191, v158, v159
v_cvt_pk_bf16_f32 v199, v160, v161
v_add_f32 v156, 0x0, v162
v_add_f32 v163, 0x41800000, v10
v_mul_f32 v156, v156, v163
v_mul_f32 v156, 0x3d000000, v156
v_fract_f32 v156, v156
v_add_f32 v157, 0x3f800000, v162
v_add_f32 v163, 0x41800000, v10
v_mul_f32 v157, v157, v163
v_mul_f32 v157, 0x3d000000, v157
v_fract_f32 v157, v157
v_cos_f32 v158, v156
v_cos_f32 v159, v157
v_sin_f32 v160, v156
v_sin_f32 v161, v157
s_nop 0
v_cvt_pk_bf16_f32 v192, v158, v159
v_cvt_pk_bf16_f32 v200, v160, v161
v_add_f32 v156, 0x40000000, v162
v_add_f32 v163, 0x41800000, v10
v_mul_f32 v156, v156, v163
v_mul_f32 v156, 0x3d000000, v156
v_fract_f32 v156, v156
v_add_f32 v157, 0x40400000, v162
v_add_f32 v163, 0x41800000, v10
v_mul_f32 v157, v157, v163
v_mul_f32 v157, 0x3d000000, v157
v_fract_f32 v157, v157
v_cos_f32 v158, v156
v_cos_f32 v159, v157
v_sin_f32 v160, v156
v_sin_f32 v161, v157
s_nop 0
v_cvt_pk_bf16_f32 v193, v158, v159
v_cvt_pk_bf16_f32 v201, v160, v161
v_add_f32 v156, 0x41800000, v162
v_add_f32 v163, 0x41800000, v10
v_mul_f32 v156, v156, v163
v_mul_f32 v156, 0x3d000000, v156
v_fract_f32 v156, v156
v_add_f32 v157, 0x41880000, v162
v_add_f32 v163, 0x41800000, v10
v_mul_f32 v157, v157, v163
v_mul_f32 v157, 0x3d000000, v157
v_fract_f32 v157, v157
v_cos_f32 v158, v156
v_cos_f32 v159, v157
v_sin_f32 v160, v156
v_sin_f32 v161, v157
s_nop 0
v_cvt_pk_bf16_f32 v194, v158, v159
v_cvt_pk_bf16_f32 v202, v160, v161
v_add_f32 v156, 0x41900000, v162
v_add_f32 v163, 0x41800000, v10
v_mul_f32 v156, v156, v163
v_mul_f32 v156, 0x3d000000, v156
v_fract_f32 v156, v156
v_add_f32 v157, 0x41980000, v162
v_add_f32 v163, 0x41800000, v10
v_mul_f32 v157, v157, v163
v_mul_f32 v157, 0x3d000000, v157
v_fract_f32 v157, v157
v_cos_f32 v158, v156
v_cos_f32 v159, v157
v_sin_f32 v160, v156
v_sin_f32 v161, v157
s_nop 0
v_cvt_pk_bf16_f32 v195, v158, v159
v_cvt_pk_bf16_f32 v203, v160, v161
v_xor_b32 v204, 0x80008000, v196
v_xor_b32 v205, 0x80008000, v197
v_xor_b32 v206, 0x80008000, v198
v_xor_b32 v207, 0x80008000, v199
v_xor_b32 v208, 0x80008000, v200
v_xor_b32 v209, 0x80008000, v201
v_xor_b32 v210, 0x80008000, v202
v_xor_b32 v211, 0x80008000, v203
v_mul_f32 v11, 0x3a000000, v8
v_add_f32 v156, 0x0, v162
v_mul_f32 v156, v156, v11
v_cos_f32 v212, v156
v_sin_f32 v220, v156
v_add_f32 v156, 0x3f800000, v162
v_mul_f32 v156, v156, v11
v_cos_f32 v213, v156
v_sin_f32 v221, v156
v_add_f32 v156, 0x40000000, v162
v_mul_f32 v156, v156, v11
v_cos_f32 v214, v156
v_sin_f32 v222, v156
v_add_f32 v156, 0x40400000, v162
v_mul_f32 v156, v156, v11
v_cos_f32 v215, v156
v_sin_f32 v223, v156
v_add_f32 v156, 0x41800000, v162
v_mul_f32 v156, v156, v11
v_cos_f32 v216, v156
v_sin_f32 v224, v156
v_add_f32 v156, 0x41880000, v162
v_mul_f32 v156, v156, v11
v_cos_f32 v217, v156
v_sin_f32 v225, v156
v_add_f32 v156, 0x41900000, v162
v_mul_f32 v156, v156, v11
v_cos_f32 v218, v156
v_sin_f32 v226, v156
v_add_f32 v156, 0x41980000, v162
v_mul_f32 v156, v156, v11
v_cos_f32 v219, v156
v_sin_f32 v227, v156
s_sub_u32 s16, s58, 208
s_and_b32 s34, s16, 3
s_lshr_b32 s18, s16, 2
s_lshl_b32 s19, s34, 2
s_add_u32 s19, s19, s17
s_mov_b32 s20, 0xffff0000
s_mov_b32 s39, 4000
v_and_b32 v2, 31, v0
v_cmp_gt_u32 s[22:23], 28, v2
v_lshlrev_b32 v155, 2, v0
s_mov_b32 s37, 68184192
s_mov_b32 s35, s39
.Lpf_324:
buffer_load_dword v156, v155, s[8:11], s37 offen sc1
s_waitcnt vmcnt(0)
v_cmp_eq_u32 vcc, 1, v156
s_nop 1
s_and_b32 s36, vcc_lo, vcc_hi
s_cmp_eq_u32 s36, -1
s_cbranch_scc1 .Lpo_325
s_sleep 8
s_sub_u32 s35, s35, 1
s_cbranch_scc0 .Lpf_324
s_mov_b32 s39, 0
.Lpo_325:
v_lshlrev_b32 v1, 4, v0
s_mul_i32 s28, s19, 28672
s_add_u32 s28, s28, 62812160
s_cmp_ge_u32 s19, 15
s_cselect_b32 s29, 0x10000000, 0
v_add_u32 v1, s29, v1
buffer_load_dwordx4 a[0:3], v1, s[8:11], s28 offen offset:0
buffer_load_dwordx4 a[4:7], v1, s[8:11], s28 offen offset:1024
buffer_load_dwordx4 a[8:11], v1, s[8:11], s28 offen offset:2048
buffer_load_dwordx4 a[12:15], v1, s[8:11], s28 offen offset:3072
s_add_u32 s28, s28, 4096
buffer_load_dwordx4 a[16:19], v1, s[8:11], s28 offen offset:0
buffer_load_dwordx4 a[20:23], v1, s[8:11], s28 offen offset:1024
buffer_load_dwordx4 a[24:27], v1, s[8:11], s28 offen offset:2048
buffer_load_dwordx4 a[28:31], v1, s[8:11], s28 offen offset:3072
s_add_u32 s28, s28, 4096
buffer_load_dwordx4 a[32:35], v1, s[8:11], s28 offen offset:0
buffer_load_dwordx4 a[36:39], v1, s[8:11], s28 offen offset:1024
buffer_load_dwordx4 a[40:43], v1, s[8:11], s28 offen offset:2048
buffer_load_dwordx4 a[44:47], v1, s[8:11], s28 offen offset:3072
s_add_u32 s28, s28, 4096
buffer_load_dwordx4 a[48:51], v1, s[8:11], s28 offen offset:0
buffer_load_dwordx4 a[52:55], v1, s[8:11], s28 offen offset:1024
buffer_load_dwordx4 a[56:59], v1, s[8:11], s28 offen offset:2048
buffer_load_dwordx4 a[60:63], v1, s[8:11], s28 offen offset:3072
s_add_u32 s28, s28, 4096
buffer_load_dwordx4 a[64:67], v1, s[8:11], s28 offen offset:0
buffer_load_dwordx4 a[68:71], v1, s[8:11], s28 offen offset:1024
buffer_load_dwordx4 a[72:75], v1, s[8:11], s28 offen offset:2048
buffer_load_dwordx4 a[76:79], v1, s[8:11], s28 offen offset:3072
s_add_u32 s28, s28, 4096
buffer_load_dwordx4 a[80:83], v1, s[8:11], s28 offen offset:0
buffer_load_dwordx4 a[84:87], v1, s[8:11], s28 offen offset:1024
buffer_load_dwordx4 a[88:91], v1, s[8:11], s28 offen offset:2048
buffer_load_dwordx4 a[92:95], v1, s[8:11], s28 offen offset:3072
s_add_u32 s28, s28, 4096
buffer_load_dwordx4 a[96:99], v1, s[8:11], s28 offen offset:0
buffer_load_dwordx4 a[100:103], v1, s[8:11], s28 offen offset:1024
buffer_load_dwordx4 a[104:107], v1, s[8:11], s28 offen offset:2048
buffer_load_dwordx4 a[108:111], v1, s[8:11], s28 offen offset:3072
s_add_u32 s28, s28, 4096
s_lshl_b32 s25, s17, 3
v_lshrrev_b32 v3, 5, v0
v_add_u32 v4, s25, v3
v_mul_u32_u24 v7, 912, v4
v_mul_u32_u24 v4, 896, v4
v_lshlrev_b32 v6, 4, v2
v_add_u32 v4, v4, v6
v_add_u32 v7, v7, v6
v_mov_b32 v6, 0x10000000
v_cndmask_b32 v4, v6, v4, s[22:23]
v_mul_u32_u24 v5, 912, v2
v_lshlrev_b32 v6, 4, v3
v_add_u32 v5, v5, v6
s_lshl_b32 s24, s19, 5
v_add_u32 v152, s24, v2
v_mul_u32_u24 v152, 4096, v152
v_add_u32 v152, v152, v6
v_and_b32 v152, 15, v0
v_add_u32 v152, s24, v152
v_mul_u32_u24 v152, 4096, v152
v_add_u32 v152, v152, v6
v_lshrrev_b32 v6, 4, v0
v_and_b32 v6, 1, v6
v_lshlrev_b32 v6, 5, v6
v_add_u32 v152, v152, v6
s_lshl_b32 s24, s17, 6
v_add_u32 v6, s24, v0
v_cmp_eq_u32 vcc, 0, v6
v_mov_b32 v6, 0x10000000
v_mov_b32 v154, 1
v_cndmask_b32 v153, v6, 0, vcc
.Lb1l_322:
s_lshl_b32 s37, s18, 6
s_cmp_ge_u32 s18, 56
s_cselect_b32 s36, 34816, 0
s_sub_u32 s37, s37, s36
s_add_u32 s37, s37, 68175872
s_mov_b32 s35, s39
.Lpf_326:
buffer_load_dword v156, v155, s[8:11], s37 offen sc1
s_waitcnt vmcnt(0)
v_cmp_eq_u32 vcc, 1, v156
s_nop 1
s_and_b32 s36, vcc_lo, 0x3fff
s_cmp_eq_u32 s36, 0x3fff
s_cbranch_scc1 .Lpo_327
s_sleep 2
s_sub_u32 s35, s35, 1
s_cbranch_scc0 .Lpf_326
s_mov_b32 s39, 0
.Lpo_327:
s_cmp_lt_u32 s18, 60
s_cbranch_scc1 .Lb1b_328
s_mov_b32 s37, 68180800
s_mov_b32 s35, s39
.Lpf_329:
buffer_load_dword v156, v155, s[8:11], s37 offen sc1
s_waitcnt vmcnt(0)
v_cmp_eq_u32 vcc, 1, v156
s_nop 1
s_and_b32 s36, vcc_lo, 0xffff
s_cmp_eq_u32 s36, 0xffff
s_cbranch_scc1 .Lpo_330
s_sleep 2
s_sub_u32 s35, s35, 1
s_cbranch_scc0 .Lpf_329
s_mov_b32 s39, 0
.Lpo_330:
.Lb1b_328:
s_mul_i32 s26, s18, 28672
s_add_u32 s26, s26, 54792192
s_add_u32 s27, s26, 3584
s_mov_b32 s35, s39
.Lb1r_331:
buffer_load_dwordx4 v[8:11], v4, s[8:11], s26 offen offset:0 sc1
buffer_load_dwordx4 v[12:15], v4, s[8:11], s26 offen offset:448 sc1
buffer_load_dwordx4 v[16:19], v4, s[8:11], s26 offen offset:1792 sc1
buffer_load_dwordx4 v[20:23], v4, s[8:11], s26 offen offset:2240 sc1
buffer_load_dwordx4 v[24:27], v4, s[8:11], s27 offen offset:0 sc1
buffer_load_dwordx4 v[28:31], v4, s[8:11], s27 offen offset:448 sc1
buffer_load_dwordx4 v[32:35], v4, s[8:11], s27 offen offset:1792 sc1
buffer_load_dwordx4 v[36:39], v4, s[8:11], s27 offen offset:2240 sc1
s_lshl_b32 s38, s18, 6
s_add_u32 s38, s38, 58462208
s_waitcnt vmcnt(0)
v_max_u32 v156, v8, v9
v_max3_u32 v156, v156, v10, v11
v_max3_u32 v156, v156, v12, v13
v_max3_u32 v156, v156, v14, v15
v_max3_u32 v156, v156, v16, v17
v_max3_u32 v156, v156, v18, v19
v_max3_u32 v156, v156, v20, v21
v_max3_u32 v156, v156, v22, v23
v_max3_u32 v156, v156, v24, v25
v_max3_u32 v156, v156, v26, v27
v_max3_u32 v156, v156, v28, v29
v_max3_u32 v156, v156, v30, v31
v_max3_u32 v156, v156, v32, v33
v_max3_u32 v156, v156, v34, v35
v_max3_u32 v156, v156, v36, v37
v_max3_u32 v156, v156, v38, v39
v_cmp_eq_u32 vcc, -1, v156
s_cbranch_vccz .Lb1o_332
s_sub_u32 s35, s35, 1
s_cbranch_scc0 .Lb1r_331
s_mov_b32 s39, 0
.Lb1o_332:
v_lshlrev_b32 v40, 16, v8
v_lshlrev_b32 v56, 16, v16
v_lshlrev_b32 v72, 16, v24
v_lshlrev_b32 v88, 16, v32
v_and_b32 v41, s20, v8
v_and_b32 v57, s20, v16
v_and_b32 v73, s20, v24
v_and_b32 v89, s20, v32
v_lshlrev_b32 v42, 16, v9
v_lshlrev_b32 v58, 16, v17
v_lshlrev_b32 v74, 16, v25
v_lshlrev_b32 v90, 16, v33
v_and_b32 v43, s20, v9
v_and_b32 v59, s20, v17
v_and_b32 v75, s20, v25
v_and_b32 v91, s20, v33
v_lshlrev_b32 v44, 16, v10
v_lshlrev_b32 v60, 16, v18
v_lshlrev_b32 v76, 16, v26
v_lshlrev_b32 v92, 16, v34
v_and_b32 v45, s20, v10
v_and_b32 v61, s20, v18
v_and_b32 v77, s20, v26
v_and_b32 v93, s20, v34
v_lshlrev_b32 v46, 16, v11
v_lshlrev_b32 v62, 16, v19
v_lshlrev_b32 v78, 16, v27
v_lshlrev_b32 v94, 16, v35
v_and_b32 v47, s20, v11
v_and_b32 v63, s20, v19
v_and_b32 v79, s20, v27
v_and_b32 v95, s20, v35
v_lshlrev_b32 v48, 16, v12
v_lshlrev_b32 v64, 16, v20
v_lshlrev_b32 v80, 16, v28
v_lshlrev_b32 v96, 16, v36
v_and_b32 v49, s20, v12
v_and_b32 v65, s20, v20
v_and_b32 v81, s20, v28
v_and_b32 v97, s20, v36
v_lshlrev_b32 v50, 16, v13
v_lshlrev_b32 v66, 16, v21
v_lshlrev_b32 v82, 16, v29
v_lshlrev_b32 v98, 16, v37
v_and_b32 v51, s20, v13
v_and_b32 v67, s20, v21
v_and_b32 v83, s20, v29
v_and_b32 v99, s20, v37
v_lshlrev_b32 v52, 16, v14
v_lshlrev_b32 v68, 16, v22
v_lshlrev_b32 v84, 16, v30
v_lshlrev_b32 v100, 16, v38
v_and_b32 v53, s20, v14
v_and_b32 v69, s20, v22
v_and_b32 v85, s20, v30
v_and_b32 v101, s20, v38
v_lshlrev_b32 v54, 16, v15
v_lshlrev_b32 v70, 16, v23
v_lshlrev_b32 v86, 16, v31
v_lshlrev_b32 v102, 16, v39
v_and_b32 v55, s20, v15
v_and_b32 v71, s20, v23
v_and_b32 v87, s20, v31
v_and_b32 v103, s20, v39
v_pk_add_f32 v[104:105], v[40:41], v[42:43]
v_pk_add_f32 v[112:113], v[56:57], v[58:59]
v_pk_add_f32 v[120:121], v[72:73], v[74:75]
v_pk_add_f32 v[128:129], v[88:89], v[90:91]
v_pk_add_f32 v[106:107], v[44:45], v[46:47]
v_pk_add_f32 v[114:115], v[60:61], v[62:63]
v_pk_add_f32 v[122:123], v[76:77], v[78:79]
v_pk_add_f32 v[130:131], v[92:93], v[94:95]
v_pk_add_f32 v[108:109], v[48:49], v[50:51]
v_pk_add_f32 v[116:117], v[64:65], v[66:67]
v_pk_add_f32 v[124:125], v[80:81], v[82:83]
v_pk_add_f32 v[132:133], v[96:97], v[98:99]
v_pk_add_f32 v[110:111], v[52:53], v[54:55]
v_pk_add_f32 v[118:119], v[68:69], v[70:71]
v_pk_add_f32 v[126:127], v[84:85], v[86:87]
v_pk_add_f32 v[134:135], v[100:101], v[102:103]
v_pk_add_f32 v[104:105], v[104:105], v[106:107]
v_pk_add_f32 v[112:113], v[112:113], v[114:115]
v_pk_add_f32 v[120:121], v[120:121], v[122:123]
v_pk_add_f32 v[128:129], v[128:129], v[130:131]
v_pk_add_f32 v[108:109], v[108:109], v[110:111]
v_pk_add_f32 v[116:117], v[116:117], v[118:119]
v_pk_add_f32 v[124:125], v[124:125], v[126:127]
v_pk_add_f32 v[132:133], v[132:133], v[134:135]
v_pk_add_f32 v[104:105], v[104:105], v[108:109]
v_pk_add_f32 v[112:113], v[112:113], v[116:117]
v_pk_add_f32 v[120:121], v[120:121], v[124:125]
v_pk_add_f32 v[128:129], v[128:129], v[132:133]
v_add_f32 v104, v104, v105
v_add_f32 v112, v112, v113
v_add_f32 v120, v120, v121
v_add_f32 v128, v128, v129
v_add_f32_dpp v104, v104, v104 row_ror:8 row_mask:0xf bank_mask:0xf
v_add_f32_dpp v112, v112, v112 row_ror:8 row_mask:0xf bank_mask:0xf
v_add_f32_dpp v120, v120, v120 row_ror:8 row_mask:0xf bank_mask:0xf
v_add_f32_dpp v128, v128, v128 row_ror:8 row_mask:0xf bank_mask:0xf
v_add_f32_dpp v104, v104, v104 row_ror:4 row_mask:0xf bank_mask:0xf
v_add_f32_dpp v112, v112, v112 row_ror:4 row_mask:0xf bank_mask:0xf
v_add_f32_dpp v120, v120, v120 row_ror:4 row_mask:0xf bank_mask:0xf
v_add_f32_dpp v128, v128, v128 row_ror:4 row_mask:0xf bank_mask:0xf
v_add_f32_dpp v104, v104, v104 row_ror:2 row_mask:0xf bank_mask:0xf
v_add_f32_dpp v112, v112, v112 row_ror:2 row_mask:0xf bank_mask:0xf
v_add_f32_dpp v120, v120, v120 row_ror:2 row_mask:0xf bank_mask:0xf
v_add_f32_dpp v128, v128, v128 row_ror:2 row_mask:0xf bank_mask:0xf
v_add_f32_dpp v104, v104, v104 row_ror:1 row_mask:0xf bank_mask:0xf
v_add_f32_dpp v112, v112, v112 row_ror:1 row_mask:0xf bank_mask:0xf
v_add_f32_dpp v120, v120, v120 row_ror:1 row_mask:0xf bank_mask:0xf
v_add_f32_dpp v128, v128, v128 row_ror:1 row_mask:0xf bank_mask:0xf
v_mov_b32 v105, v104
v_mov_b32 v113, v112
v_mov_b32 v121, v120
v_mov_b32 v129, v128
v_permlane16_swap_b32 v104, v105
v_permlane16_swap_b32 v112, v113
v_permlane16_swap_b32 v120, v121
v_permlane16_swap_b32 v128, v129
v_add_f32 v104, v104, v105
v_add_f32 v112, v112, v113
v_add_f32 v120, v120, v121
v_add_f32 v128, v128, v129
v_mul_f32 v104, 0x3b124925, v104
v_mul_f32 v112, 0x3b124925, v112
v_mul_f32 v120, 0x3b124925, v120
v_mul_f32 v128, 0x3b124925, v128
v_cndmask_b32 v106, 0, v104, s[22:23]
v_cndmask_b32 v114, 0, v112, s[22:23]
v_cndmask_b32 v122, 0, v120, s[22:23]
v_cndmask_b32 v130, 0, v128, s[22:23]
v_pk_add_f32 v[8:9], v[40:41], v[106:107] op_sel_hi:[1,0] neg_lo:[0,1] neg_hi:[0,1]
v_pk_add_f32 v[16:17], v[56:57], v[114:115] op_sel_hi:[1,0] neg_lo:[0,1] neg_hi:[0,1]
v_pk_add_f32 v[24:25], v[72:73], v[122:123] op_sel_hi:[1,0] neg_lo:[0,1] neg_hi:[0,1]
v_pk_add_f32 v[32:33], v[88:89], v[130:131] op_sel_hi:[1,0] neg_lo:[0,1] neg_hi:[0,1]
v_pk_mul_f32 v[108:109], v[8:9], v[8:9]
v_pk_mul_f32 v[116:117], v[16:17], v[16:17]
v_pk_mul_f32 v[124:125], v[24:25], v[24:25]
v_pk_mul_f32 v[132:133], v[32:33], v[32:33]
v_pk_add_f32 v[10:11], v[42:43], v[106:107] op_sel_hi:[1,0] neg_lo:[0,1] neg_hi:[0,1]
v_pk_add_f32 v[18:19], v[58:59], v[114:115] op_sel_hi:[1,0] neg_lo:[0,1] neg_hi:[0,1]
v_pk_add_f32 v[26:27], v[74:75], v[122:123] op_sel_hi:[1,0] neg_lo:[0,1] neg_hi:[0,1]
v_pk_add_f32 v[34:35], v[90:91], v[130:131] op_sel_hi:[1,0] neg_lo:[0,1] neg_hi:[0,1]
v_pk_mul_f32 v[110:111], v[10:11], v[10:11]
v_pk_mul_f32 v[118:119], v[18:19], v[18:19]
v_pk_mul_f32 v[126:127], v[26:27], v[26:27]
v_pk_mul_f32 v[134:135], v[34:35], v[34:35]
v_pk_add_f32 v[12:13], v[44:45], v[106:107] op_sel_hi:[1,0] neg_lo:[0,1] neg_hi:[0,1]
v_pk_add_f32 v[20:21], v[60:61], v[114:115] op_sel_hi:[1,0] neg_lo:[0,1] neg_hi:[0,1]
v_pk_add_f32 v[28:29], v[76:77], v[122:123] op_sel_hi:[1,0] neg_lo:[0,1] neg_hi:[0,1]
v_pk_add_f32 v[36:37], v[92:93], v[130:131] op_sel_hi:[1,0] neg_lo:[0,1] neg_hi:[0,1]
v_pk_fma_f32 v[108:109], v[12:13], v[12:13], v[108:109]
v_pk_fma_f32 v[116:117], v[20:21], v[20:21], v[116:117]
v_pk_fma_f32 v[124:125], v[28:29], v[28:29], v[124:125]
v_pk_fma_f32 v[132:133], v[36:37], v[36:37], v[132:133]
v_pk_add_f32 v[14:15], v[46:47], v[106:107] op_sel_hi:[1,0] neg_lo:[0,1] neg_hi:[0,1]
v_pk_add_f32 v[22:23], v[62:63], v[114:115] op_sel_hi:[1,0] neg_lo:[0,1] neg_hi:[0,1]
v_pk_add_f32 v[30:31], v[78:79], v[122:123] op_sel_hi:[1,0] neg_lo:[0,1] neg_hi:[0,1]
v_pk_add_f32 v[38:39], v[94:95], v[130:131] op_sel_hi:[1,0] neg_lo:[0,1] neg_hi:[0,1]
v_pk_fma_f32 v[110:111], v[14:15], v[14:15], v[110:111]
v_pk_fma_f32 v[118:119], v[22:23], v[22:23], v[118:119]
v_pk_fma_f32 v[126:127], v[30:31], v[30:31], v[126:127]
v_pk_fma_f32 v[134:135], v[38:39], v[38:39], v[134:135]
v_pk_add_f32 v[8:9], v[48:49], v[106:107] op_sel_hi:[1,0] neg_lo:[0,1] neg_hi:[0,1]
v_pk_add_f32 v[16:17], v[64:65], v[114:115] op_sel_hi:[1,0] neg_lo:[0,1] neg_hi:[0,1]
v_pk_add_f32 v[24:25], v[80:81], v[122:123] op_sel_hi:[1,0] neg_lo:[0,1] neg_hi:[0,1]
v_pk_add_f32 v[32:33], v[96:97], v[130:131] op_sel_hi:[1,0] neg_lo:[0,1] neg_hi:[0,1]
v_pk_fma_f32 v[108:109], v[8:9], v[8:9], v[108:109]
v_pk_fma_f32 v[116:117], v[16:17], v[16:17], v[116:117]
v_pk_fma_f32 v[124:125], v[24:25], v[24:25], v[124:125]
v_pk_fma_f32 v[132:133], v[32:33], v[32:33], v[132:133]
v_pk_add_f32 v[10:11], v[50:51], v[106:107] op_sel_hi:[1,0] neg_lo:[0,1] neg_hi:[0,1]
v_pk_add_f32 v[18:19], v[66:67], v[114:115] op_sel_hi:[1,0] neg_lo:[0,1] neg_hi:[0,1]
v_pk_add_f32 v[26:27], v[82:83], v[122:123] op_sel_hi:[1,0] neg_lo:[0,1] neg_hi:[0,1]
v_pk_add_f32 v[34:35], v[98:99], v[130:131] op_sel_hi:[1,0] neg_lo:[0,1] neg_hi:[0,1]
v_pk_fma_f32 v[110:111], v[10:11], v[10:11], v[110:111]
v_pk_fma_f32 v[118:119], v[18:19], v[18:19], v[118:119]
v_pk_fma_f32 v[126:127], v[26:27], v[26:27], v[126:127]
v_pk_fma_f32 v[134:135], v[34:35], v[34:35], v[134:135]
v_pk_add_f32 v[12:13], v[52:53], v[106:107] op_sel_hi:[1,0] neg_lo:[0,1] neg_hi:[0,1]
v_pk_add_f32 v[20:21], v[68:69], v[114:115] op_sel_hi:[1,0] neg_lo:[0,1] neg_hi:[0,1]
v_pk_add_f32 v[28:29], v[84:85], v[122:123] op_sel_hi:[1,0] neg_lo:[0,1] neg_hi:[0,1]
v_pk_add_f32 v[36:37], v[100:101], v[130:131] op_sel_hi:[1,0] neg_lo:[0,1] neg_hi:[0,1]
v_pk_fma_f32 v[108:109], v[12:13], v[12:13], v[108:109]
v_pk_fma_f32 v[116:117], v[20:21], v[20:21], v[116:117]
v_pk_fma_f32 v[124:125], v[28:29], v[28:29], v[124:125]
v_pk_fma_f32 v[132:133], v[36:37], v[36:37], v[132:133]
v_pk_add_f32 v[14:15], v[54:55], v[106:107] op_sel_hi:[1,0] neg_lo:[0,1] neg_hi:[0,1]
v_pk_add_f32 v[22:23], v[70:71], v[114:115] op_sel_hi:[1,0] neg_lo:[0,1] neg_hi:[0,1]
v_pk_add_f32 v[30:31], v[86:87], v[122:123] op_sel_hi:[1,0] neg_lo:[0,1] neg_hi:[0,1]
v_pk_add_f32 v[38:39], v[102:103], v[130:131] op_sel_hi:[1,0] neg_lo:[0,1] neg_hi:[0,1]
v_pk_fma_f32 v[110:111], v[14:15], v[14:15], v[110:111]
v_pk_fma_f32 v[118:119], v[22:23], v[22:23], v[118:119]
v_pk_fma_f32 v[126:127], v[30:31], v[30:31], v[126:127]
v_pk_fma_f32 v[134:135], v[38:39], v[38:39], v[134:135]
v_pk_add_f32 v[108:109], v[108:109], v[110:111]
v_pk_add_f32 v[116:117], v[116:117], v[118:119]
v_pk_add_f32 v[124:125], v[124:125], v[126:127]
v_pk_add_f32 v[132:133], v[132:133], v[134:135]
v_add_f32 v108, v108, v109
v_add_f32 v116, v116, v117
v_add_f32 v124, v124, v125
v_add_f32 v132, v132, v133
v_add_f32_dpp v108, v108, v108 row_ror:8 row_mask:0xf bank_mask:0xf
v_add_f32_dpp v116, v116, v116 row_ror:8 row_mask:0xf bank_mask:0xf
v_add_f32_dpp v124, v124, v124 row_ror:8 row_mask:0xf bank_mask:0xf
v_add_f32_dpp v132, v132, v132 row_ror:8 row_mask:0xf bank_mask:0xf
v_add_f32_dpp v108, v108, v108 row_ror:4 row_mask:0xf bank_mask:0xf
v_add_f32_dpp v116, v116, v116 row_ror:4 row_mask:0xf bank_mask:0xf
v_add_f32_dpp v124, v124, v124 row_ror:4 row_mask:0xf bank_mask:0xf
v_add_f32_dpp v132, v132, v132 row_ror:4 row_mask:0xf bank_mask:0xf
v_add_f32_dpp v108, v108, v108 row_ror:2 row_mask:0xf bank_mask:0xf
v_add_f32_dpp v116, v116, v116 row_ror:2 row_mask:0xf bank_mask:0xf
v_add_f32_dpp v124, v124, v124 row_ror:2 row_mask:0xf bank_mask:0xf
v_add_f32_dpp v132, v132, v132 row_ror:2 row_mask:0xf bank_mask:0xf
v_add_f32_dpp v108, v108, v108 row_ror:1 row_mask:0xf bank_mask:0xf
v_add_f32_dpp v116, v116, v116 row_ror:1 row_mask:0xf bank_mask:0xf
v_add_f32_dpp v124, v124, v124 row_ror:1 row_mask:0xf bank_mask:0xf
v_add_f32_dpp v132, v132, v132 row_ror:1 row_mask:0xf bank_mask:0xf
v_mov_b32 v109, v108
v_mov_b32 v117, v116
v_mov_b32 v125, v124
v_mov_b32 v133, v132
v_permlane16_swap_b32 v108, v109
v_permlane16_swap_b32 v116, v117
v_permlane16_swap_b32 v124, v125
v_permlane16_swap_b32 v132, v133
v_add_f32 v108, v108, v109
v_add_f32 v116, v116, v117
v_add_f32 v124, v124, v125
v_add_f32 v132, v132, v133
v_mul_f32 v108, 0x3b124925, v108
v_mul_f32 v116, 0x3b124925, v116
v_mul_f32 v124, 0x3b124925, v124
v_mul_f32 v132, 0x3b124925, v132
v_cvt_pk_bf16_f32 v104, v104, v104
v_cvt_pk_bf16_f32 v112, v112, v112
v_cvt_pk_bf16_f32 v120, v120, v120
v_cvt_pk_bf16_f32 v128, v128, v128
v_cvt_pk_bf16_f32 v108, v108, v108
v_cvt_pk_bf16_f32 v116, v116, v116
v_cvt_pk_bf16_f32 v124, v124, v124
v_cvt_pk_bf16_f32 v132, v132, v132
v_and_b32 v104, s20, v104
v_and_b32 v112, s20, v112
v_and_b32 v120, s20, v120
v_and_b32 v128, s20, v128
v_and_b32 v108, s20, v108
v_and_b32 v116, s20, v116
v_and_b32 v124, s20, v124
v_and_b32 v132, s20, v132
v_add_f32 v108, 0x3727c5ac, v108
v_add_f32 v116, 0x3727c5ac, v116
v_add_f32 v124, 0x3727c5ac, v124
v_add_f32 v132, 0x3727c5ac, v132
v_cvt_pk_bf16_f32 v108, v108, v108
v_cvt_pk_bf16_f32 v116, v116, v116
v_cvt_pk_bf16_f32 v124, v124, v124
v_cvt_pk_bf16_f32 v132, v132, v132
v_and_b32 v108, s20, v108
v_and_b32 v116, s20, v116
v_and_b32 v124, s20, v124
v_and_b32 v132, s20, v132
v_sqrt_f32 v108, v108
v_sqrt_f32 v116, v116
v_sqrt_f32 v124, v124
v_sqrt_f32 v132, v132
v_cvt_pk_bf16_f32 v108, v108, v108
v_cvt_pk_bf16_f32 v116, v116, v116
v_cvt_pk_bf16_f32 v124, v124, v124
v_cvt_pk_bf16_f32 v132, v132, v132
v_and_b32 v108, s20, v108
v_and_b32 v116, s20, v116
v_and_b32 v124, s20, v124
v_and_b32 v132, s20, v132
v_rcp_f32 v108, v108
v_rcp_f32 v116, v116
v_rcp_f32 v124, v124
v_rcp_f32 v132, v132
v_pk_add_f32 v[40:41], v[40:41], v[104:105] op_sel_hi:[1,0] neg_lo:[0,1] neg_hi:[0,1]
v_pk_add_f32 v[56:57], v[56:57], v[112:113] op_sel_hi:[1,0] neg_lo:[0,1] neg_hi:[0,1]
v_pk_add_f32 v[72:73], v[72:73], v[120:121] op_sel_hi:[1,0] neg_lo:[0,1] neg_hi:[0,1]
v_pk_add_f32 v[88:89], v[88:89], v[128:129] op_sel_hi:[1,0] neg_lo:[0,1] neg_hi:[0,1]
v_cvt_pk_bf16_f32 v8, v40, v41
v_cvt_pk_bf16_f32 v16, v56, v57
v_cvt_pk_bf16_f32 v24, v72, v73
v_cvt_pk_bf16_f32 v32, v88, v89
v_pk_add_f32 v[42:43], v[42:43], v[104:105] op_sel_hi:[1,0] neg_lo:[0,1] neg_hi:[0,1]
v_pk_add_f32 v[58:59], v[58:59], v[112:113] op_sel_hi:[1,0] neg_lo:[0,1] neg_hi:[0,1]
v_pk_add_f32 v[74:75], v[74:75], v[120:121] op_sel_hi:[1,0] neg_lo:[0,1] neg_hi:[0,1]
v_pk_add_f32 v[90:91], v[90:91], v[128:129] op_sel_hi:[1,0] neg_lo:[0,1] neg_hi:[0,1]
v_cvt_pk_bf16_f32 v9, v42, v43
v_cvt_pk_bf16_f32 v17, v58, v59
v_cvt_pk_bf16_f32 v25, v74, v75
v_cvt_pk_bf16_f32 v33, v90, v91
v_pk_add_f32 v[44:45], v[44:45], v[104:105] op_sel_hi:[1,0] neg_lo:[0,1] neg_hi:[0,1]
v_pk_add_f32 v[60:61], v[60:61], v[112:113] op_sel_hi:[1,0] neg_lo:[0,1] neg_hi:[0,1]
v_pk_add_f32 v[76:77], v[76:77], v[120:121] op_sel_hi:[1,0] neg_lo:[0,1] neg_hi:[0,1]
v_pk_add_f32 v[92:93], v[92:93], v[128:129] op_sel_hi:[1,0] neg_lo:[0,1] neg_hi:[0,1]
v_cvt_pk_bf16_f32 v10, v44, v45
v_cvt_pk_bf16_f32 v18, v60, v61
v_cvt_pk_bf16_f32 v26, v76, v77
v_cvt_pk_bf16_f32 v34, v92, v93
v_pk_add_f32 v[46:47], v[46:47], v[104:105] op_sel_hi:[1,0] neg_lo:[0,1] neg_hi:[0,1]
v_pk_add_f32 v[62:63], v[62:63], v[112:113] op_sel_hi:[1,0] neg_lo:[0,1] neg_hi:[0,1]
v_pk_add_f32 v[78:79], v[78:79], v[120:121] op_sel_hi:[1,0] neg_lo:[0,1] neg_hi:[0,1]
v_pk_add_f32 v[94:95], v[94:95], v[128:129] op_sel_hi:[1,0] neg_lo:[0,1] neg_hi:[0,1]
v_cvt_pk_bf16_f32 v11, v46, v47
v_cvt_pk_bf16_f32 v19, v62, v63
v_cvt_pk_bf16_f32 v27, v78, v79
v_cvt_pk_bf16_f32 v35, v94, v95
v_pk_add_f32 v[48:49], v[48:49], v[104:105] op_sel_hi:[1,0] neg_lo:[0,1] neg_hi:[0,1]
v_pk_add_f32 v[64:65], v[64:65], v[112:113] op_sel_hi:[1,0] neg_lo:[0,1] neg_hi:[0,1]
v_pk_add_f32 v[80:81], v[80:81], v[120:121] op_sel_hi:[1,0] neg_lo:[0,1] neg_hi:[0,1]
v_pk_add_f32 v[96:97], v[96:97], v[128:129] op_sel_hi:[1,0] neg_lo:[0,1] neg_hi:[0,1]
v_cvt_pk_bf16_f32 v12, v48, v49
v_cvt_pk_bf16_f32 v20, v64, v65
v_cvt_pk_bf16_f32 v28, v80, v81
v_cvt_pk_bf16_f32 v36, v96, v97
v_pk_add_f32 v[50:51], v[50:51], v[104:105] op_sel_hi:[1,0] neg_lo:[0,1] neg_hi:[0,1]
v_pk_add_f32 v[66:67], v[66:67], v[112:113] op_sel_hi:[1,0] neg_lo:[0,1] neg_hi:[0,1]
v_pk_add_f32 v[82:83], v[82:83], v[120:121] op_sel_hi:[1,0] neg_lo:[0,1] neg_hi:[0,1]
v_pk_add_f32 v[98:99], v[98:99], v[128:129] op_sel_hi:[1,0] neg_lo:[0,1] neg_hi:[0,1]
v_cvt_pk_bf16_f32 v13, v50, v51
v_cvt_pk_bf16_f32 v21, v66, v67
v_cvt_pk_bf16_f32 v29, v82, v83
v_cvt_pk_bf16_f32 v37, v98, v99
v_pk_add_f32 v[52:53], v[52:53], v[104:105] op_sel_hi:[1,0] neg_lo:[0,1] neg_hi:[0,1]
v_pk_add_f32 v[68:69], v[68:69], v[112:113] op_sel_hi:[1,0] neg_lo:[0,1] neg_hi:[0,1]
v_pk_add_f32 v[84:85], v[84:85], v[120:121] op_sel_hi:[1,0] neg_lo:[0,1] neg_hi:[0,1]
v_pk_add_f32 v[100:101], v[100:101], v[128:129] op_sel_hi:[1,0] neg_lo:[0,1] neg_hi:[0,1]
v_cvt_pk_bf16_f32 v14, v52, v53
v_cvt_pk_bf16_f32 v22, v68, v69
v_cvt_pk_bf16_f32 v30, v84, v85
v_cvt_pk_bf16_f32 v38, v100, v101
v_pk_add_f32 v[54:55], v[54:55], v[104:105] op_sel_hi:[1,0] neg_lo:[0,1] neg_hi:[0,1]
v_pk_add_f32 v[70:71], v[70:71], v[112:113] op_sel_hi:[1,0] neg_lo:[0,1] neg_hi:[0,1]
v_pk_add_f32 v[86:87], v[86:87], v[120:121] op_sel_hi:[1,0] neg_lo:[0,1] neg_hi:[0,1]
v_pk_add_f32 v[102:103], v[102:103], v[128:129] op_sel_hi:[1,0] neg_lo:[0,1] neg_hi:[0,1]
v_cvt_pk_bf16_f32 v15, v54, v55
v_cvt_pk_bf16_f32 v23, v70, v71
v_cvt_pk_bf16_f32 v31, v86, v87
v_cvt_pk_bf16_f32 v39, v102, v103
v_lshlrev_b32 v40, 16, v8
v_lshlrev_b32 v56, 16, v16
v_lshlrev_b32 v72, 16, v24
v_lshlrev_b32 v88, 16, v32
v_and_b32 v41, s20, v8
v_and_b32 v57, s20, v16
v_and_b32 v73, s20, v24
v_and_b32 v89, s20, v32
v_pk_mul_f32 v[40:41], v[40:41], v[108:109] op_sel_hi:[1,0]
v_pk_mul_f32 v[56:57], v[56:57], v[116:117] op_sel_hi:[1,0]
v_pk_mul_f32 v[72:73], v[72:73], v[124:125] op_sel_hi:[1,0]
v_pk_mul_f32 v[88:89], v[88:89], v[132:133] op_sel_hi:[1,0]
v_lshlrev_b32 v42, 16, v9
v_lshlrev_b32 v58, 16, v17
v_lshlrev_b32 v74, 16, v25
v_lshlrev_b32 v90, 16, v33
v_and_b32 v43, s20, v9
v_and_b32 v59, s20, v17
v_and_b32 v75, s20, v25
v_and_b32 v91, s20, v33
v_pk_mul_f32 v[42:43], v[42:43], v[108:109] op_sel_hi:[1,0]
v_pk_mul_f32 v[58:59], v[58:59], v[116:117] op_sel_hi:[1,0]
v_pk_mul_f32 v[74:75], v[74:75], v[124:125] op_sel_hi:[1,0]
v_pk_mul_f32 v[90:91], v[90:91], v[132:133] op_sel_hi:[1,0]
v_lshlrev_b32 v44, 16, v10
v_lshlrev_b32 v60, 16, v18
v_lshlrev_b32 v76, 16, v26
v_lshlrev_b32 v92, 16, v34
v_and_b32 v45, s20, v10
v_and_b32 v61, s20, v18
v_and_b32 v77, s20, v26
v_and_b32 v93, s20, v34
v_pk_mul_f32 v[44:45], v[44:45], v[108:109] op_sel_hi:[1,0]
v_pk_mul_f32 v[60:61], v[60:61], v[116:117] op_sel_hi:[1,0]
v_pk_mul_f32 v[76:77], v[76:77], v[124:125] op_sel_hi:[1,0]
v_pk_mul_f32 v[92:93], v[92:93], v[132:133] op_sel_hi:[1,0]
v_lshlrev_b32 v46, 16, v11
v_lshlrev_b32 v62, 16, v19
v_lshlrev_b32 v78, 16, v27
v_lshlrev_b32 v94, 16, v35
v_and_b32 v47, s20, v11
v_and_b32 v63, s20, v19
v_and_b32 v79, s20, v27
v_and_b32 v95, s20, v35
v_pk_mul_f32 v[46:47], v[46:47], v[108:109] op_sel_hi:[1,0]
v_pk_mul_f32 v[62:63], v[62:63], v[116:117] op_sel_hi:[1,0]
v_pk_mul_f32 v[78:79], v[78:79], v[124:125] op_sel_hi:[1,0]
v_pk_mul_f32 v[94:95], v[94:95], v[132:133] op_sel_hi:[1,0]
v_lshlrev_b32 v48, 16, v12
v_lshlrev_b32 v64, 16, v20
v_lshlrev_b32 v80, 16, v28
v_lshlrev_b32 v96, 16, v36
v_and_b32 v49, s20, v12
v_and_b32 v65, s20, v20
v_and_b32 v81, s20, v28
v_and_b32 v97, s20, v36
v_pk_mul_f32 v[48:49], v[48:49], v[108:109] op_sel_hi:[1,0]
v_pk_mul_f32 v[64:65], v[64:65], v[116:117] op_sel_hi:[1,0]
v_pk_mul_f32 v[80:81], v[80:81], v[124:125] op_sel_hi:[1,0]
v_pk_mul_f32 v[96:97], v[96:97], v[132:133] op_sel_hi:[1,0]
v_lshlrev_b32 v50, 16, v13
v_lshlrev_b32 v66, 16, v21
v_lshlrev_b32 v82, 16, v29
v_lshlrev_b32 v98, 16, v37
v_and_b32 v51, s20, v13
v_and_b32 v67, s20, v21
v_and_b32 v83, s20, v29
v_and_b32 v99, s20, v37
v_pk_mul_f32 v[50:51], v[50:51], v[108:109] op_sel_hi:[1,0]
v_pk_mul_f32 v[66:67], v[66:67], v[116:117] op_sel_hi:[1,0]
v_pk_mul_f32 v[82:83], v[82:83], v[124:125] op_sel_hi:[1,0]
v_pk_mul_f32 v[98:99], v[98:99], v[132:133] op_sel_hi:[1,0]
v_lshlrev_b32 v52, 16, v14
v_lshlrev_b32 v68, 16, v22
v_lshlrev_b32 v84, 16, v30
v_lshlrev_b32 v100, 16, v38
v_and_b32 v53, s20, v14
v_and_b32 v69, s20, v22
v_and_b32 v85, s20, v30
v_and_b32 v101, s20, v38
v_pk_mul_f32 v[52:53], v[52:53], v[108:109] op_sel_hi:[1,0]
v_pk_mul_f32 v[68:69], v[68:69], v[116:117] op_sel_hi:[1,0]
v_pk_mul_f32 v[84:85], v[84:85], v[124:125] op_sel_hi:[1,0]
v_pk_mul_f32 v[100:101], v[100:101], v[132:133] op_sel_hi:[1,0]
v_lshlrev_b32 v54, 16, v15
v_lshlrev_b32 v70, 16, v23
v_lshlrev_b32 v86, 16, v31
v_lshlrev_b32 v102, 16, v39
v_and_b32 v55, s20, v15
v_and_b32 v71, s20, v23
v_and_b32 v87, s20, v31
v_and_b32 v103, s20, v39
v_pk_mul_f32 v[54:55], v[54:55], v[108:109] op_sel_hi:[1,0]
v_pk_mul_f32 v[70:71], v[70:71], v[116:117] op_sel_hi:[1,0]
v_pk_mul_f32 v[86:87], v[86:87], v[124:125] op_sel_hi:[1,0]
v_pk_mul_f32 v[102:103], v[102:103], v[132:133] op_sel_hi:[1,0]
v_cvt_pk_bf16_f32 v8, v40, v41
v_cvt_pk_bf16_f32 v16, v56, v57
v_cvt_pk_bf16_f32 v24, v72, v73
v_cvt_pk_bf16_f32 v32, v88, v89
v_cvt_pk_bf16_f32 v9, v42, v43
v_cvt_pk_bf16_f32 v17, v58, v59
v_cvt_pk_bf16_f32 v25, v74, v75
v_cvt_pk_bf16_f32 v33, v90, v91
v_cvt_pk_bf16_f32 v10, v44, v45
v_cvt_pk_bf16_f32 v18, v60, v61
v_cvt_pk_bf16_f32 v26, v76, v77
v_cvt_pk_bf16_f32 v34, v92, v93
v_cvt_pk_bf16_f32 v11, v46, v47
v_cvt_pk_bf16_f32 v19, v62, v63
v_cvt_pk_bf16_f32 v27, v78, v79
v_cvt_pk_bf16_f32 v35, v94, v95
v_cvt_pk_bf16_f32 v12, v48, v49
v_cvt_pk_bf16_f32 v20, v64, v65
v_cvt_pk_bf16_f32 v28, v80, v81
v_cvt_pk_bf16_f32 v36, v96, v97
v_cvt_pk_bf16_f32 v13, v50, v51
v_cvt_pk_bf16_f32 v21, v66, v67
v_cvt_pk_bf16_f32 v29, v82, v83
v_cvt_pk_bf16_f32 v37, v98, v99
v_cvt_pk_bf16_f32 v14, v52, v53
v_cvt_pk_bf16_f32 v22, v68, v69
v_cvt_pk_bf16_f32 v30, v84, v85
v_cvt_pk_bf16_f32 v38, v100, v101
v_cvt_pk_bf16_f32 v15, v54, v55
v_cvt_pk_bf16_f32 v23, v70, v71
v_cvt_pk_bf16_f32 v31, v86, v87
v_cvt_pk_bf16_f32 v39, v102, v103
s_mov_b64 s[24:25], exec
s_mov_b64 exec, s[22:23]
ds_write_b128 v7, v[8:11] offset:0
ds_write_b128 v7, v[12:15] offset:448
ds_write_b128 v7, v[16:19] offset:1824
ds_write_b128 v7, v[20:23] offset:2272
ds_write_b128 v7, v[24:27] offset:3648
ds_write_b128 v7, v[28:31] offset:4096
ds_write_b128 v7, v[32:35] offset:5472
ds_write_b128 v7, v[36:39] offset:5920
s_mov_b64 exec, s[24:25]
s_waitcnt lgkmcnt(0)
s_barrier
s_cmp_ge_u32 s19, 15
s_cbranch_scc1 .Lb1s_323
ds_read_b128 v[40:43], v5 offset:0
ds_read_b128 v[44:47], v5 offset:32
ds_read_b128 v[48:51], v5 offset:64
ds_read_b128 v[52:55], v5 offset:96
ds_read_b128 v[56:59], v5 offset:128
ds_read_b128 v[60:63], v5 offset:160
ds_read_b128 v[64:67], v5 offset:192
ds_read_b128 v[68:71], v5 offset:224
ds_read_b128 v[72:75], v5 offset:256
ds_read_b128 v[76:79], v5 offset:288
ds_read_b128 v[80:83], v5 offset:320
ds_read_b128 v[84:87], v5 offset:352
ds_read_b128 v[88:91], v5 offset:384
ds_read_b128 v[92:95], v5 offset:416
ds_read_b128 v[96:99], v5 offset:448
ds_read_b128 v[100:103], v5 offset:480
ds_read_b128 v[104:107], v5 offset:512
ds_read_b128 v[108:111], v5 offset:544
ds_read_b128 v[112:115], v5 offset:576
ds_read_b128 v[116:119], v5 offset:608
ds_read_b128 v[120:123], v5 offset:640
ds_read_b128 v[124:127], v5 offset:672
ds_read_b128 v[128:131], v5 offset:704
ds_read_b128 v[132:135], v5 offset:736
ds_read_b128 v[136:139], v5 offset:768
ds_read_b128 v[140:143], v5 offset:800
ds_read_b128 v[144:147], v5 offset:832
ds_read_b128 v[148:151], v5 offset:864
s_waitcnt lgkmcnt(15)
v_mfma_f32_32x32x16_bf16 v[8:23], v[40:43], a[0:3], 0
v_mfma_f32_32x32x16_bf16 v[8:23], v[44:47], a[4:7], v[8:23]
v_mfma_f32_32x32x16_bf16 v[8:23], v[48:51], a[8:11], v[8:23]
v_mfma_f32_32x32x16_bf16 v[8:23], v[52:55], a[12:15], v[8:23]
v_mfma_f32_32x32x16_bf16 v[8:23], v[56:59], a[16:19], v[8:23]
v_mfma_f32_32x32x16_bf16 v[8:23], v[60:63], a[20:23], v[8:23]
v_mfma_f32_32x32x16_bf16 v[8:23], v[64:67], a[24:27], v[8:23]
s_waitcnt lgkmcnt(14)
v_mfma_f32_32x32x16_bf16 v[8:23], v[68:71], a[28:31], v[8:23]
v_mfma_f32_32x32x16_bf16 v[8:23], v[72:75], a[32:35], v[8:23]
v_mfma_f32_32x32x16_bf16 v[8:23], v[76:79], a[36:39], v[8:23]
v_mfma_f32_32x32x16_bf16 v[8:23], v[80:83], a[40:43], v[8:23]
v_mfma_f32_32x32x16_bf16 v[8:23], v[84:87], a[44:47], v[8:23]
v_mfma_f32_32x32x16_bf16 v[8:23], v[88:91], a[48:51], v[8:23]
v_mfma_f32_32x32x16_bf16 v[8:23], v[92:95], a[52:55], v[8:23]
s_waitcnt lgkmcnt(7)
v_mfma_f32_32x32x16_bf16 v[8:23], v[96:99], a[56:59], v[8:23]
v_mfma_f32_32x32x16_bf16 v[8:23], v[100:103], a[60:63], v[8:23]
v_mfma_f32_32x32x16_bf16 v[8:23], v[104:107], a[64:67], v[8:23]
v_mfma_f32_32x32x16_bf16 v[8:23], v[108:111], a[68:71], v[8:23]
v_mfma_f32_32x32x16_bf16 v[8:23], v[112:115], a[72:75], v[8:23]
v_mfma_f32_32x32x16_bf16 v[8:23], v[116:119], a[76:79], v[8:23]
v_mfma_f32_32x32x16_bf16 v[8:23], v[120:123], a[80:83], v[8:23]
s_waitcnt lgkmcnt(0)
v_mfma_f32_32x32x16_bf16 v[8:23], v[124:127], a[84:87], v[8:23]
v_mfma_f32_32x32x16_bf16 v[8:23], v[128:131], a[88:91], v[8:23]
v_mfma_f32_32x32x16_bf16 v[8:23], v[132:135], a[92:95], v[8:23]
v_mfma_f32_32x32x16_bf16 v[8:23], v[136:139], a[96:99], v[8:23]
v_mfma_f32_32x32x16_bf16 v[8:23], v[140:143], a[100:103], v[8:23]
v_mfma_f32_32x32x16_bf16 v[8:23], v[144:147], a[104:107], v[8:23]
v_mfma_f32_32x32x16_bf16 v[8:23], v[148:151], a[108:111], v[8:23]
s_nop 7
s_nop 3
v_cvt_pk_bf16_f32 v24, v8, v9
v_cvt_pk_bf16_f32 v25, v10, v11
v_cvt_pk_bf16_f32 v26, v12, v13
v_cvt_pk_bf16_f32 v27, v14, v15
v_cvt_pk_bf16_f32 v28, v16, v17
v_cvt_pk_bf16_f32 v29, v18, v19
v_cvt_pk_bf16_f32 v30, v20, v21
v_cvt_pk_bf16_f32 v31, v22, v23
s_add_u32 s36, s38, 65536
s_nop 0
v_permlane32_swap_b32 v24, v26
v_permlane32_swap_b32 v25, v27
v_permlane32_swap_b32 v28, v30
v_permlane32_swap_b32 v29, v31
s_nop 1
v_permlane16_swap_b32 v24, v28
v_permlane16_swap_b32 v25, v29
v_permlane16_swap_b32 v26, v30
v_permlane16_swap_b32 v27, v31
buffer_store_dwordx4 v[24:27], v152, s[8:11], s38 offen sc1
buffer_store_dwordx4 v[28:31], v152, s[8:11], s36 offen sc1
.Lb1s_323:
s_lshl_b32 s37, s18, 4
s_lshl_b32 s36, s34, 2
s_add_u32 s37, s37, s36
s_add_u32 s37, s37, 68179968
s_cmp_ge_u32 s18, 56
s_cbranch_scc1 .Lb1n_337
s_waitcnt vmcnt(0)
s_barrier
buffer_store_dword v154, v153, s[8:11], s37 offen sc1
s_branch .Lb1n_338
.Lb1n_337:
s_barrier
.Lb1n_338:
s_add_u32 s18, s18, 4
s_cmp_lt_u32 s18, 64
s_cbranch_scc1 .Lb1l_322
s_waitcnt lgkmcnt(0)
s_barrier
s_mov_b32 s39, 8000
s_branch .Ljoin_258
.Ljoin_257:
s_waitcnt vmcnt(0) lgkmcnt(0)
s_barrier
s_mov_b32 s39, 8000
s_cmp_lg_u32 s17, 0
s_cbranch_scc1 .Lww_339
s_mov_b32 s24, 68184064
v_lshlrev_b32 v248, 4, v0
v_mov_b32 v252, 0x10000000
v_cmp_gt_u32 vcc, 34, v0
s_mov_b32 s25, s39
s_nop 0
v_cndmask_b32 v248, v252, v248, vcc
.Lwr_340:
buffer_load_dwordx4 v[252:255], v248, s[8:11], s24 offen sc1
s_waitcnt vmcnt(0)
s_mov_b32 s26, 0
v_cmp_eq_u32 vcc, 1, v252
s_nop 1
s_and_b32 vcc_lo, vcc_lo, 0xffffffff
s_and_b32 vcc_hi, vcc_hi, 0x3
s_bcnt1_i32_b64 s27, vcc
s_add_u32 s26, s26, s27
v_cmp_eq_u32 vcc, 1, v253
s_nop 1
s_and_b32 vcc_lo, vcc_lo, 0xffffffff
s_and_b32 vcc_hi, vcc_hi, 0x3
s_bcnt1_i32_b64 s27, vcc
s_add_u32 s26, s26, s27
v_cmp_eq_u32 vcc, 1, v254
s_nop 1
s_and_b32 vcc_lo, vcc_lo, 0xffffffff
s_and_b32 vcc_hi, vcc_hi, 0x3
s_bcnt1_i32_b64 s27, vcc
s_add_u32 s26, s26, s27
v_cmp_eq_u32 vcc, 1, v255
s_nop 1
s_and_b32 vcc_lo, vcc_lo, 0xffffffff
s_and_b32 vcc_hi, vcc_hi, 0x3
s_bcnt1_i32_b64 s27, vcc
s_add_u32 s26, s26, s27
s_cmp_eq_u32 s26, 136
s_cbranch_scc1 .Lwo_341
s_sleep 8
s_sub_u32 s25, s25, 1
s_cbranch_scc0 .Lwr_340
s_mov_b32 s39, 0
.Lwo_341:
.Lww_339:
s_barrier
v_lshlrev_b32 v1, 4, v0
s_mul_i32 s24, s63, 29696
s_add_u32 s24, s24, 63242240
buffer_load_dwordx4 a[128:131], v1, s[8:11], s24 offen offset:0
buffer_load_dwordx4 a[132:135], v1, s[8:11], s24 offen offset:1024
buffer_load_dwordx4 a[136:139], v1, s[8:11], s24 offen offset:2048
buffer_load_dwordx4 a[140:143], v1, s[8:11], s24 offen offset:3072
s_add_u32 s24, s24, 4096
buffer_load_dwordx4 a[144:147], v1, s[8:11], s24 offen offset:0
buffer_load_dwordx4 a[148:151], v1, s[8:11], s24 offen offset:1024
buffer_load_dwordx4 a[152:155], v1, s[8:11], s24 offen offset:2048
buffer_load_dwordx4 a[156:159], v1, s[8:11], s24 offen offset:3072
s_add_u32 s24, s24, 4096
buffer_load_dwordx4 a[160:163], v1, s[8:11], s24 offen offset:0
buffer_load_dwordx4 a[164:167], v1, s[8:11], s24 offen offset:1024
buffer_load_dwordx4 a[168:171], v1, s[8:11], s24 offen offset:2048
buffer_load_dwordx4 a[172:175], v1, s[8:11], s24 offen offset:3072
s_add_u32 s24, s24, 4096
buffer_load_dwordx4 a[176:179], v1, s[8:11], s24 offen offset:0
buffer_load_dwordx4 a[180:183], v1, s[8:11], s24 offen offset:1024
buffer_load_dwordx4 a[184:187], v1, s[8:11], s24 offen offset:2048
buffer_load_dwordx4 a[188:191], v1, s[8:11], s24 offen offset:3072
s_add_u32 s24, s24, 4096
buffer_load_dwordx4 a[192:195], v1, s[8:11], s24 offen offset:0
buffer_load_dwordx4 a[196:199], v1, s[8:11], s24 offen offset:1024
buffer_load_dwordx4 a[200:203], v1, s[8:11], s24 offen offset:2048
buffer_load_dwordx4 a[204:207], v1, s[8:11], s24 offen offset:3072
s_add_u32 s24, s24, 4096
buffer_load_dwordx4 a[208:211], v1, s[8:11], s24 offen offset:0
buffer_load_dwordx4 a[212:215], v1, s[8:11], s24 offen offset:1024
buffer_load_dwordx4 a[216:219], v1, s[8:11], s24 offen offset:2048
buffer_load_dwordx4 a[220:223], v1, s[8:11], s24 offen offset:3072
s_add_u32 s24, s24, 4096
buffer_load_dwordx4 a[224:227], v1, s[8:11], s24 offen offset:0
buffer_load_dwordx4 a[228:231], v1, s[8:11], s24 offen offset:1024
buffer_load_dwordx4 a[232:235], v1, s[8:11], s24 offen offset:2048
buffer_load_dwordx4 a[236:239], v1, s[8:11], s24 offen offset:3072
s_add_u32 s24, s24, 4096
buffer_load_dwordx4 a[240:243], v1, s[8:11], s24 offen offset:0
s_lshl_b32 s28, s58, 13
s_lshl_b32 s29, s17, 11
s_add_u32 s28, s28, s29
s_add_u32 s28, s28, 63660032
buffer_load_dwordx4 v[228:231], v1, s[8:11], s28 offen
buffer_load_dwordx4 v[232:235], v1, s[8:11], s28 offen offset:1024
v_and_b32 v5, 15, v0
v_lshrrev_b32 v6, 4, v0
s_lshl_b32 s29, s17, 4
v_add_u32 v7, s29, v5
v_cvt_f32_u32 v8, v7
v_cvt_f32_u32 v9, v6
v_cvt_f32_u32 v10, v5
v_mul_f32 v11, 0x3c800000, v8
v_mul_f32 v162, 0x41000000, v9
v_add_f32 v156, 0x0, v162
v_mul_f32 v156, v156, v11
v_fract_f32 v156, v156
v_add_f32 v157, 0x3f800000, v162
v_mul_f32 v157, v157, v11
v_fract_f32 v157, v157
v_cos_f32 v158, v156
v_cos_f32 v159, v157
v_sin_f32 v160, v156
v_sin_f32 v161, v157
s_nop 0
v_cvt_pk_bf16_f32 v164, v158, v159
v_cvt_pk_bf16_f32 v172, v160, v161
v_add_f32 v156, 0x40000000, v162
v_mul_f32 v156, v156, v11
v_fract_f32 v156, v156
v_add_f32 v157, 0x40400000, v162
v_mul_f32 v157, v157, v11
v_fract_f32 v157, v157
v_cos_f32 v158, v156
v_cos_f32 v159, v157
v_sin_f32 v160, v156
v_sin_f32 v161, v157
s_nop 0
v_cvt_pk_bf16_f32 v165, v158, v159
v_cvt_pk_bf16_f32 v173, v160, v161
v_add_f32 v156, 0x40800000, v162
v_mul_f32 v156, v156, v11
v_fract_f32 v156, v156
v_add_f32 v157, 0x40a00000, v162
v_mul_f32 v157, v157, v11
v_fract_f32 v157, v157
v_cos_f32 v158, v156
v_cos_f32 v159, v157
v_sin_f32 v160, v156
v_sin_f32 v161, v157
s_nop 0
v_cvt_pk_bf16_f32 v166, v158, v159
v_cvt_pk_bf16_f32 v174, v160, v161
v_add_f32 v156, 0x40c00000, v162
v_mul_f32 v156, v156, v11
v_fract_f32 v156, v156
v_add_f32 v157, 0x40e00000, v162
v_mul_f32 v157, v157, v11
v_fract_f32 v157, v157
v_cos_f32 v158, v156
v_cos_f32 v159, v157
v_sin_f32 v160, v156
v_sin_f32 v161, v157
s_nop 0
v_cvt_pk_bf16_f32 v167, v158, v159
v_cvt_pk_bf16_f32 v175, v160, v161
v_add_f32 v156, 0x42000000, v162
v_mul_f32 v156, v156, v11
v_fract_f32 v156, v156
v_add_f32 v157, 0x42040000, v162
v_mul_f32 v157, v157, v11
v_fract_f32 v157, v157
v_cos_f32 v158, v156
v_cos_f32 v159, v157
v_sin_f32 v160, v156
v_sin_f32 v161, v157
s_nop 0
v_cvt_pk_bf16_f32 v168, v158, v159
v_cvt_pk_bf16_f32 v176, v160, v161
v_add_f32 v156, 0x42080000, v162
v_mul_f32 v156, v156, v11
v_fract_f32 v156, v156
v_add_f32 v157, 0x420c0000, v162
v_mul_f32 v157, v157, v11
v_fract_f32 v157, v157
v_cos_f32 v158, v156
v_cos_f32 v159, v157
v_sin_f32 v160, v156
v_sin_f32 v161, v157
s_nop 0
v_cvt_pk_bf16_f32 v169, v158, v159
v_cvt_pk_bf16_f32 v177, v160, v161
v_add_f32 v156, 0x42100000, v162
v_mul_f32 v156, v156, v11
v_fract_f32 v156, v156
v_add_f32 v157, 0x42140000, v162
v_mul_f32 v157, v157, v11
v_fract_f32 v157, v157
v_cos_f32 v158, v156
v_cos_f32 v159, v157
v_sin_f32 v160, v156
v_sin_f32 v161, v157
s_nop 0
v_cvt_pk_bf16_f32 v170, v158, v159
v_cvt_pk_bf16_f32 v178, v160, v161
v_add_f32 v156, 0x42180000, v162
v_mul_f32 v156, v156, v11
v_fract_f32 v156, v156
v_add_f32 v157, 0x421c0000, v162
v_mul_f32 v157, v157, v11
v_fract_f32 v157, v157
v_cos_f32 v158, v156
v_cos_f32 v159, v157
v_sin_f32 v160, v156
v_sin_f32 v161, v157
s_nop 0
v_cvt_pk_bf16_f32 v171, v158, v159
v_cvt_pk_bf16_f32 v179, v160, v161
v_xor_b32 v180, 0x80008000, v172
v_xor_b32 v181, 0x80008000, v173
v_xor_b32 v182, 0x80008000, v174
v_xor_b32 v183, 0x80008000, v175
v_xor_b32 v184, 0x80008000, v176
v_xor_b32 v185, 0x80008000, v177
v_xor_b32 v186, 0x80008000, v178
v_xor_b32 v187, 0x80008000, v179
v_mul_f32 v162, 4.0, v9
v_add_f32 v156, 0x0, v162
v_add_f32 v163, 0x0, v10
v_mul_f32 v156, v156, v163
v_mul_f32 v156, 0x3d000000, v156
v_fract_f32 v156, v156
v_add_f32 v157, 0x3f800000, v162
v_add_f32 v163, 0x0, v10
v_mul_f32 v157, v157, v163
v_mul_f32 v157, 0x3d000000, v157
v_fract_f32 v157, v157
v_cos_f32 v158, v156
v_cos_f32 v159, v157
v_sin_f32 v160, v156
v_sin_f32 v161, v157
s_nop 0
v_cvt_pk_bf16_f32 v188, v158, v159
v_cvt_pk_bf16_f32 v196, v160, v161
v_add_f32 v156, 0x40000000, v162
v_add_f32 v163, 0x0, v10
v_mul_f32 v156, v156, v163
v_mul_f32 v156, 0x3d000000, v156
v_fract_f32 v156, v156
v_add_f32 v157, 0x40400000, v162
v_add_f32 v163, 0x0, v10
v_mul_f32 v157, v157, v163
v_mul_f32 v157, 0x3d000000, v157
v_fract_f32 v157, v157
v_cos_f32 v158, v156
v_cos_f32 v159, v157
v_sin_f32 v160, v156
v_sin_f32 v161, v157
s_nop 0
v_cvt_pk_bf16_f32 v189, v158, v159
v_cvt_pk_bf16_f32 v197, v160, v161
v_add_f32 v156, 0x41800000, v162
v_add_f32 v163, 0x0, v10
v_mul_f32 v156, v156, v163
v_mul_f32 v156, 0x3d000000, v156
v_fract_f32 v156, v156
v_add_f32 v157, 0x41880000, v162
v_add_f32 v163, 0x0, v10
v_mul_f32 v157, v157, v163
v_mul_f32 v157, 0x3d000000, v157
v_fract_f32 v157, v157
v_cos_f32 v158, v156
v_cos_f32 v159, v157
v_sin_f32 v160, v156
v_sin_f32 v161, v157
s_nop 0
v_cvt_pk_bf16_f32 v190, v158, v159
v_cvt_pk_bf16_f32 v198, v160, v161
v_add_f32 v156, 0x41900000, v162
v_add_f32 v163, 0x0, v10
v_mul_f32 v156, v156, v163
v_mul_f32 v156, 0x3d000000, v156
v_fract_f32 v156, v156
v_add_f32 v157, 0x41980000, v162
v_add_f32 v163, 0x0, v10
v_mul_f32 v157, v157, v163
v_mul_f32 v157, 0x3d000000, v157
v_fract_f32 v157, v157
v_cos_f32 v158, v156
v_cos_f32 v159, v157
v_sin_f32 v160, v156
v_sin_f32 v161, v157
s_nop 0
v_cvt_pk_bf16_f32 v191, v158, v159
v_cvt_pk_bf16_f32 v199, v160, v161
v_add_f32 v156, 0x0, v162
v_add_f32 v163, 0x41800000, v10
v_mul_f32 v156, v156, v163
v_mul_f32 v156, 0x3d000000, v156
v_fract_f32 v156, v156
v_add_f32 v157, 0x3f800000, v162
v_add_f32 v163, 0x41800000, v10
v_mul_f32 v157, v157, v163
v_mul_f32 v157, 0x3d000000, v157
v_fract_f32 v157, v157
v_cos_f32 v158, v156
v_cos_f32 v159, v157
v_sin_f32 v160, v156
v_sin_f32 v161, v157
s_nop 0
v_cvt_pk_bf16_f32 v192, v158, v159
v_cvt_pk_bf16_f32 v200, v160, v161
v_add_f32 v156, 0x40000000, v162
v_add_f32 v163, 0x41800000, v10
v_mul_f32 v156, v156, v163
v_mul_f32 v156, 0x3d000000, v156
v_fract_f32 v156, v156
v_add_f32 v157, 0x40400000, v162
v_add_f32 v163, 0x41800000, v10
v_mul_f32 v157, v157, v163
v_mul_f32 v157, 0x3d000000, v157
v_fract_f32 v157, v157
v_cos_f32 v158, v156
v_cos_f32 v159, v157
v_sin_f32 v160, v156
v_sin_f32 v161, v157
s_nop 0
v_cvt_pk_bf16_f32 v193, v158, v159
v_cvt_pk_bf16_f32 v201, v160, v161
v_add_f32 v156, 0x41800000, v162
v_add_f32 v163, 0x41800000, v10
v_mul_f32 v156, v156, v163
v_mul_f32 v156, 0x3d000000, v156
v_fract_f32 v156, v156
v_add_f32 v157, 0x41880000, v162
v_add_f32 v163, 0x41800000, v10
v_mul_f32 v157, v157, v163
v_mul_f32 v157, 0x3d000000, v157
v_fract_f32 v157, v157
v_cos_f32 v158, v156
v_cos_f32 v159, v157
v_sin_f32 v160, v156
v_sin_f32 v161, v157
s_nop 0
v_cvt_pk_bf16_f32 v194, v158, v159
v_cvt_pk_bf16_f32 v202, v160, v161
v_add_f32 v156, 0x41900000, v162
v_add_f32 v163, 0x41800000, v10
v_mul_f32 v156, v156, v163
v_mul_f32 v156, 0x3d000000, v156
v_fract_f32 v156, v156
v_add_f32 v157, 0x41980000, v162
v_add_f32 v163, 0x41800000, v10
v_mul_f32 v157, v157, v163
v_mul_f32 v157, 0x3d000000, v157
v_fract_f32 v157, v157
v_cos_f32 v158, v156
v_cos_f32 v159, v157
v_sin_f32 v160, v156
v_sin_f32 v161, v157
s_nop 0
v_cvt_pk_bf16_f32 v195, v158, v159
v_cvt_pk_bf16_f32 v203, v160, v161
v_xor_b32 v204, 0x80008000, v196
v_xor_b32 v205, 0x80008000, v197
v_xor_b32 v206, 0x80008000, v198
v_xor_b32 v207, 0x80008000, v199
v_xor_b32 v208, 0x80008000, v200
v_xor_b32 v209, 0x80008000, v201
v_xor_b32 v210, 0x80008000, v202
v_xor_b32 v211, 0x80008000, v203
v_mul_f32 v11, 0x3a000000, v8
v_add_f32 v156, 0x0, v162
v_mul_f32 v156, v156, v11
v_cos_f32 v212, v156
v_sin_f32 v220, v156
v_add_f32 v156, 0x3f800000, v162
v_mul_f32 v156, v156, v11
v_cos_f32 v213, v156
v_sin_f32 v221, v156
v_add_f32 v156, 0x40000000, v162
v_mul_f32 v156, v156, v11
v_cos_f32 v214, v156
v_sin_f32 v222, v156
v_add_f32 v156, 0x40400000, v162
v_mul_f32 v156, v156, v11
v_cos_f32 v215, v156
v_sin_f32 v223, v156
v_add_f32 v156, 0x41800000, v162
v_mul_f32 v156, v156, v11
v_cos_f32 v216, v156
v_sin_f32 v224, v156
v_add_f32 v156, 0x41880000, v162
v_mul_f32 v156, v156, v11
v_cos_f32 v217, v156
v_sin_f32 v225, v156
v_add_f32 v156, 0x41900000, v162
v_mul_f32 v156, v156, v11
v_cos_f32 v218, v156
v_sin_f32 v226, v156
v_add_f32 v156, 0x41980000, v162
v_mul_f32 v156, v156, v11
v_cos_f32 v219, v156
v_sin_f32 v227, v156
s_cmp_lt_u32 s58, 160
s_cbranch_scc1 .Ldwe_343
s_cmp_lt_u32 s58, 176
s_cbranch_scc1 .Ldwe_342
.Ldwe_343:
s_and_b32 s18, s58, 3
s_lshr_b32 s21, s58, 2
s_cmp_ge_u32 s58, 64
s_cbranch_scc1 .Ldq_344
s_and_b32 s21, s58, 31
s_lshr_b32 s21, s21, 1
s_and_b32 s18, s58, 1
s_cmp_lt_u32 s58, 32
s_cselect_b32 s16, 2, 0
s_add_u32 s18, s18, s16
.Ldq_344:
s_lshr_b32 s16, s21, 2
s_and_b32 s19, s21, 3
v_lshlrev_b32 v1, 4, v0
s_lshl_b32 s24, s16, 2
s_add_u32 s24, s24, s19
s_lshl_b32 s25, s24, 2
s_add_u32 s25, s25, s17
s_mul_i32 s26, s25, 28672
s_add_u32 s26, s26, 6422528
buffer_load_dwordx4 a[0:3], v1, s[8:11], s26 offen offset:0
buffer_load_dwordx4 a[4:7], v1, s[8:11], s26 offen offset:1024
buffer_load_dwordx4 a[8:11], v1, s[8:11], s26 offen offset:2048
buffer_load_dwordx4 a[12:15], v1, s[8:11], s26 offen offset:3072
s_add_u32 s26, s26, 4096
buffer_load_dwordx4 a[16:19], v1, s[8:11], s26 offen offset:0
buffer_load_dwordx4 a[20:23], v1, s[8:11], s26 offen offset:1024
buffer_load_dwordx4 a[24:27], v1, s[8:11], s26 offen offset:2048
buffer_load_dwordx4 a[28:31], v1, s[8:11], s26 offen offset:3072
s_add_u32 s26, s26, 4096
buffer_load_dwordx4 a[32:35], v1, s[8:11], s26 offen offset:0
buffer_load_dwordx4 a[36:39], v1, s[8:11], s26 offen offset:1024
buffer_load_dwordx4 a[40:43], v1, s[8:11], s26 offen offset:2048
buffer_load_dwordx4 a[44:47], v1, s[8:11], s26 offen offset:3072
s_add_u32 s26, s26, 4096
buffer_load_dwordx4 a[48:51], v1, s[8:11], s26 offen offset:0
buffer_load_dwordx4 a[52:55], v1, s[8:11], s26 offen offset:1024
buffer_load_dwordx4 a[56:59], v1, s[8:11], s26 offen offset:2048
buffer_load_dwordx4 a[60:63], v1, s[8:11], s26 offen offset:3072
s_add_u32 s26, s26, 4096
buffer_load_dwordx4 a[64:67], v1, s[8:11], s26 offen offset:0
buffer_load_dwordx4 a[68:71], v1, s[8:11], s26 offen offset:1024
buffer_load_dwordx4 a[72:75], v1, s[8:11], s26 offen offset:2048
buffer_load_dwordx4 a[76:79], v1, s[8:11], s26 offen offset:3072
s_add_u32 s26, s26, 4096
buffer_load_dwordx4 a[80:83], v1, s[8:11], s26 offen offset:0
buffer_load_dwordx4 a[84:87], v1, s[8:11], s26 offen offset:1024
buffer_load_dwordx4 a[88:91], v1, s[8:11], s26 offen offset:2048
buffer_load_dwordx4 a[92:95], v1, s[8:11], s26 offen offset:3072
s_add_u32 s26, s26, 4096
buffer_load_dwordx4 a[96:99], v1, s[8:11], s26 offen offset:0
buffer_load_dwordx4 a[100:103], v1, s[8:11], s26 offen offset:1024
buffer_load_dwordx4 a[104:107], v1, s[8:11], s26 offen offset:2048
buffer_load_dwordx4 a[108:111], v1, s[8:11], s26 offen offset:3072
s_add_u32 s26, s26, 4096
.Ldwe_342:
.Ljoin_258:
v_lshlrev_b32 v1, 4, v0
v_and_b32 v5, 15, v0
v_lshrrev_b32 v6, 4, v0
s_lshl_b32 s29, s17, 4
v_add_u32 v7, s29, v5
v_lshlrev_b32 v2, 9, v6
v_lshrrev_b32 v156, 2, v5
v_lshlrev_b32 v156, 6, v156
v_and_b32 v157, 3, v0
v_lshlrev_b32 v157, 3, v157
v_add3_u32 v2, v2, v156, v157
v_lshlrev_b32 v3, 6, v7
v_lshlrev_b32 v156, 3, v6
v_add_u32 v3, v3, v156
v_lshlrev_b32 v4, 6, v7
v_and_b32 v156, 1, v6
v_lshlrev_b32 v156, 5, v156
v_lshrrev_b32 v157, 1, v6
v_lshlrev_b32 v157, 4, v157
v_add3_u32 v4, v4, v156, v157
s_cmp_ge_u32 s58, 208
s_cbranch_scc1 .Lnobf_345
s_cmp_lg_u32 s17, 0
s_cbranch_scc1 .Lww_347
s_mov_b32 s24, 68180800
v_lshlrev_b32 v248, 2, v0
v_mov_b32 v252, 0x10000000
v_cmp_gt_u32 vcc, 16, v0
s_mov_b32 s25, s39
s_nop 0
v_cndmask_b32 v248, v252, v248, vcc
.Lwr_348:
buffer_load_dword v252, v248, s[8:11], s24 offen sc1
s_waitcnt vmcnt(0)
v_cmp_eq_u32 vcc, 1, v252
s_nop 1
s_bcnt1_i32_b64 s26, vcc
s_cmp_eq_u32 s26, 16
s_cbranch_scc1 .Lwo_349
s_sleep 2
s_sub_u32 s25, s25, 1
s_cbranch_scc0 .Lwr_348
s_mov_b32 s39, 0
.Lwo_349:
.Lww_347:
s_barrier
.Lpfa_346:
.Lnobf_345:
s_cmp_eq_u32 s17, 3
s_cselect_b32 s28, 32, 64
v_mov_b32 v156, 0x10000000
v_cmp_gt_u32 vcc, s28, v0
s_nop 1
v_cndmask_b32 v156, v156, v1, vcc
s_mul_i32 s24, s58, 4096
s_lshl_b32 s25, s17, 10
s_add_u32 s26, s24, s25
s_add_u32 s26, s26, 58462208
s_mov_b32 m0, s25
s_add_u32 s27, s26, 921600
buffer_load_dwordx4 v156, s[8:11], s26 offen lds
s_add_u32 m0, s25, 4096
s_nop 0
buffer_load_dwordx4 v156, s[8:11], s27 offen lds
s_cmp_lg_u32 s17, 3
s_cbranch_scc1 .Lftk_350
v_lshlrev_b32 v157, 3, v0
v_add_u32 v157, 3584, v157
s_add_u32 s28, s24, 58462208
s_add_u32 s29, s28, 921600
s_mov_b32 s30, s39
.Lftr_351:
buffer_load_dwordx2 v[158:159], v157, s[8:11], s28 offen sc1
buffer_load_dwordx2 v[160:161], v157, s[8:11], s29 offen sc1
s_waitcnt vmcnt(0)
v_max_u32 v162, v158, v159
v_max3_u32 v162, v162, v160, v161
v_cmp_eq_u32 vcc, -1, v162
s_cbranch_vccz .Lfto_352
s_sub_u32 s30, s30, 1
s_cbranch_scc0 .Lftr_351
s_mov_b32 s39, 0
.Lfto_352:
ds_write_b64 v157, v[158:159]
ds_write_b64 v157, v[160:161] offset:4096
s_waitcnt lgkmcnt(0)
.Lftk_350:
s_waitcnt vmcnt(0)
s_barrier
ds_read_b64_tr_b16 v[84:85], v2 offset:0
ds_read_b64_tr_b16 v[86:87], v2 offset:256
ds_read_b64_tr_b16 v[88:89], v2 offset:2048
ds_read_b64_tr_b16 v[90:91], v2 offset:2304
ds_read_b64_tr_b16 v[92:93], v2 offset:32
ds_read_b64_tr_b16 v[94:95], v2 offset:288
ds_read_b64_tr_b16 v[96:97], v2 offset:2080
ds_read_b64_tr_b16 v[98:99], v2 offset:2336
ds_read_b64_tr_b16 v[100:101], v2 offset:4096
ds_read_b64_tr_b16 v[102:103], v2 offset:4352
ds_read_b64_tr_b16 v[104:105], v2 offset:6144
ds_read_b64_tr_b16 v[106:107], v2 offset:6400
ds_read_b64_tr_b16 v[108:109], v2 offset:4128
ds_read_b64_tr_b16 v[110:111], v2 offset:4384
ds_read_b64_tr_b16 v[112:113], v2 offset:6176
ds_read_b64_tr_b16 v[114:115], v2 offset:6432
s_waitcnt lgkmcnt(0)
v_mfma_f32_16x16x32_bf16 v[116:119], v[84:87], v[164:167], 0
v_mfma_f32_16x16x32_bf16 v[124:127], v[100:103], v[164:167], 0
v_mfma_f32_16x16x32_bf16 v[120:123], v[92:95], v[164:167], 0
v_mfma_f32_16x16x32_bf16 v[128:131], v[108:111], v[164:167], 0
v_mfma_f32_16x16x32_bf16 v[116:119], v[88:91], v[168:171], v[116:119]
v_mfma_f32_16x16x32_bf16 v[124:127], v[104:107], v[168:171], v[124:127]
v_mfma_f32_16x16x32_bf16 v[120:123], v[96:99], v[168:171], v[120:123]
v_mfma_f32_16x16x32_bf16 v[128:131], v[112:115], v[168:171], v[128:131]
v_mfma_f32_16x16x32_bf16 v[116:119], v[100:103], v[172:175], v[116:119]
v_mfma_f32_16x16x32_bf16 v[124:127], v[84:87], v[180:183], v[124:127]
v_mfma_f32_16x16x32_bf16 v[120:123], v[108:111], v[172:175], v[120:123]
v_mfma_f32_16x16x32_bf16 v[128:131], v[92:95], v[180:183], v[128:131]
v_mfma_f32_16x16x32_bf16 v[116:119], v[104:107], v[176:179], v[116:119]
v_mfma_f32_16x16x32_bf16 v[124:127], v[88:91], v[184:187], v[124:127]
v_mfma_f32_16x16x32_bf16 v[120:123], v[112:115], v[176:179], v[120:123]
v_mfma_f32_16x16x32_bf16 v[128:131], v[96:99], v[184:187], v[128:131]
s_nop 7
v_mul_f32 v156, v116, v212
v_mul_f32 v157, v124, v212
v_fma_f32 v156, v124, v220, v156
v_fma_f32 v124, -v116, v220, v157
v_mov_b32 v116, v156
v_mul_f32 v156, v117, v213
v_mul_f32 v157, v125, v213
v_fma_f32 v156, v125, v221, v156
v_fma_f32 v125, -v117, v221, v157
v_mov_b32 v117, v156
v_mul_f32 v156, v118, v214
v_mul_f32 v157, v126, v214
v_fma_f32 v156, v126, v222, v156
v_fma_f32 v126, -v118, v222, v157
v_mov_b32 v118, v156
v_mul_f32 v156, v119, v215
v_mul_f32 v157, v127, v215
v_fma_f32 v156, v127, v223, v156
v_fma_f32 v127, -v119, v223, v157
v_mov_b32 v119, v156
v_mul_f32 v156, v120, v216
v_mul_f32 v157, v128, v216
v_fma_f32 v156, v128, v224, v156
v_fma_f32 v128, -v120, v224, v157
v_mov_b32 v120, v156
v_mul_f32 v156, v121, v217
v_mul_f32 v157, v129, v217
v_fma_f32 v156, v129, v225, v156
v_fma_f32 v129, -v121, v225, v157
v_mov_b32 v121, v156
v_mul_f32 v156, v122, v218
v_mul_f32 v157, v130, v218
v_fma_f32 v156, v130, v226, v156
v_fma_f32 v130, -v122, v226, v157
v_mov_b32 v122, v156
v_mul_f32 v156, v123, v219
v_mul_f32 v157, v131, v219
v_fma_f32 v156, v131, v227, v156
v_fma_f32 v131, -v123, v227, v157
v_mov_b32 v123, v156
v_cvt_pk_bf16_f32 v132, v116, v117
v_cvt_pk_bf16_f32 v133, v118, v119
v_cvt_pk_bf16_f32 v134, v120, v121
v_cvt_pk_bf16_f32 v135, v122, v123
v_cvt_pk_bf16_f32 v136, v124, v125
v_cvt_pk_bf16_f32 v137, v126, v127
v_cvt_pk_bf16_f32 v138, v128, v129
v_cvt_pk_bf16_f32 v139, v130, v131
v_mul_f32 v212, 0x3a000000, v212
v_mul_f32 v220, 0x3a000000, v220
v_mul_f32 v213, 0x3a000000, v213
v_mul_f32 v221, 0x3a000000, v221
v_mul_f32 v214, 0x3a000000, v214
v_mul_f32 v222, 0x3a000000, v222
v_mul_f32 v215, 0x3a000000, v215
v_mul_f32 v223, 0x3a000000, v223
v_mul_f32 v216, 0x3a000000, v216
v_mul_f32 v224, 0x3a000000, v224
v_mul_f32 v217, 0x3a000000, v217
v_mul_f32 v225, 0x3a000000, v225
v_mul_f32 v218, 0x3a000000, v218
v_mul_f32 v226, 0x3a000000, v226
v_mul_f32 v219, 0x3a000000, v219
v_mul_f32 v227, 0x3a000000, v227
v_mfma_f32_16x16x32_bf16 v[140:143], v[188:191], v[132:135], 0
v_mfma_f32_16x16x32_bf16 v[148:151], v[188:191], v[136:139], 0
v_mfma_f32_16x16x32_bf16 v[144:147], v[192:195], v[132:135], 0
v_mfma_f32_16x16x32_bf16 v[152:155], v[192:195], v[136:139], 0
v_mfma_f32_16x16x32_bf16 v[140:143], v[196:199], v[136:139], v[140:143]
v_mfma_f32_16x16x32_bf16 v[148:151], v[204:207], v[132:135], v[148:151]
v_mfma_f32_16x16x32_bf16 v[144:147], v[200:203], v[136:139], v[144:147]
v_mfma_f32_16x16x32_bf16 v[152:155], v[208:211], v[132:135], v[152:155]
s_waitcnt vmcnt(0)
s_nop 6
v_lshlrev_b32 v156, 16, v228
v_and_b32 v157, 0xffff0000, v228
v_mul_f32 v158, v140, v156
v_mul_f32 v159, v148, v156
v_fma_f32 v158, -v148, v157, v158
v_fma_f32 v148, v140, v157, v159
v_mov_b32 v140, v158
v_lshlrev_b32 v156, 16, v229
v_and_b32 v157, 0xffff0000, v229
v_mul_f32 v158, v141, v156
v_mul_f32 v159, v149, v156
v_fma_f32 v158, -v149, v157, v158
v_fma_f32 v149, v141, v157, v159
v_mov_b32 v141, v158
v_lshlrev_b32 v156, 16, v230
v_and_b32 v157, 0xffff0000, v230
v_mul_f32 v158, v142, v156
v_mul_f32 v159, v150, v156
v_fma_f32 v158, -v150, v157, v158
v_fma_f32 v150, v142, v157, v159
v_mov_b32 v142, v158
v_lshlrev_b32 v156, 16, v231
v_and_b32 v157, 0xffff0000, v231
v_mul_f32 v158, v143, v156
v_mul_f32 v159, v151, v156
v_fma_f32 v158, -v151, v157, v158
v_fma_f32 v151, v143, v157, v159
v_mov_b32 v143, v158
v_lshlrev_b32 v156, 16, v232
v_and_b32 v157, 0xffff0000, v232
v_mul_f32 v158, v144, v156
v_mul_f32 v159, v152, v156
v_fma_f32 v158, -v152, v157, v158
v_fma_f32 v152, v144, v157, v159
v_mov_b32 v144, v158
v_lshlrev_b32 v156, 16, v233
v_and_b32 v157, 0xffff0000, v233
v_mul_f32 v158, v145, v156
v_mul_f32 v159, v153, v156
v_fma_f32 v158, -v153, v157, v158
v_fma_f32 v153, v145, v157, v159
v_mov_b32 v145, v158
v_lshlrev_b32 v156, 16, v234
v_and_b32 v157, 0xffff0000, v234
v_mul_f32 v158, v146, v156
v_mul_f32 v159, v154, v156
v_fma_f32 v158, -v154, v157, v158
v_fma_f32 v154, v146, v157, v159
v_mov_b32 v146, v158
v_lshlrev_b32 v156, 16, v235
v_and_b32 v157, 0xffff0000, v235
v_mul_f32 v158, v147, v156
v_mul_f32 v159, v155, v156
v_fma_f32 v158, -v155, v157, v158
v_fma_f32 v155, v147, v157, v159
v_mov_b32 v147, v158
v_cvt_pk_bf16_f32 v132, v140, v141
v_cvt_pk_bf16_f32 v133, v142, v143
v_cvt_pk_bf16_f32 v134, v144, v145
v_cvt_pk_bf16_f32 v135, v146, v147
v_cvt_pk_bf16_f32 v136, v148, v149
v_cvt_pk_bf16_f32 v137, v150, v151
v_cvt_pk_bf16_f32 v138, v152, v153
v_cvt_pk_bf16_f32 v139, v154, v155
s_nop 1
v_mfma_f32_16x16x32_bf16 v[116:119], v[188:191], v[132:135], 0
v_mfma_f32_16x16x32_bf16 v[124:127], v[188:191], v[136:139], 0
v_mfma_f32_16x16x32_bf16 v[120:123], v[192:195], v[132:135], 0
v_mfma_f32_16x16x32_bf16 v[128:131], v[192:195], v[136:139], 0
v_mfma_f32_16x16x32_bf16 v[116:119], v[204:207], v[136:139], v[116:119]
v_mfma_f32_16x16x32_bf16 v[124:127], v[196:199], v[132:135], v[124:127]
v_mfma_f32_16x16x32_bf16 v[120:123], v[208:211], v[136:139], v[120:123]
v_mfma_f32_16x16x32_bf16 v[128:131], v[200:203], v[132:135], v[128:131]
s_nop 7
v_mul_f32 v156, v116, v212
v_mul_f32 v157, v124, v212
v_fma_f32 v156, -v124, v220, v156
v_fma_f32 v124, v116, v220, v157
v_mov_b32 v116, v156
v_mul_f32 v156, v117, v213
v_mul_f32 v157, v125, v213
v_fma_f32 v156, -v125, v221, v156
v_fma_f32 v125, v117, v221, v157
v_mov_b32 v117, v156
v_mul_f32 v156, v118, v214
v_mul_f32 v157, v126, v214
v_fma_f32 v156, -v126, v222, v156
v_fma_f32 v126, v118, v222, v157
v_mov_b32 v118, v156
v_mul_f32 v156, v119, v215
v_mul_f32 v157, v127, v215
v_fma_f32 v156, -v127, v223, v156
v_fma_f32 v127, v119, v223, v157
v_mov_b32 v119, v156
v_mul_f32 v156, v120, v216
v_mul_f32 v157, v128, v216
v_fma_f32 v156, -v128, v224, v156
v_fma_f32 v128, v120, v224, v157
v_mov_b32 v120, v156
v_mul_f32 v156, v121, v217
v_mul_f32 v157, v129, v217
v_fma_f32 v156, -v129, v225, v156
v_fma_f32 v129, v121, v225, v157
v_mov_b32 v121, v156
v_mul_f32 v156, v122, v218
v_mul_f32 v157, v130, v218
v_fma_f32 v156, -v130, v226, v156
v_fma_f32 v130, v122, v226, v157
v_mov_b32 v122, v156
v_mul_f32 v156, v123, v219
v_mul_f32 v157, v131, v219
v_fma_f32 v156, -v131, v227, v156
v_fma_f32 v131, v123, v227, v157
v_mov_b32 v123, v156
v_cvt_pk_bf16_f32 v132, v116, v117
v_cvt_pk_bf16_f32 v133, v118, v119
v_cvt_pk_bf16_f32 v134, v120, v121
v_cvt_pk_bf16_f32 v135, v122, v123
v_cvt_pk_bf16_f32 v136, v124, v125
v_cvt_pk_bf16_f32 v137, v126, v127
v_cvt_pk_bf16_f32 v138, v128, v129
v_cvt_pk_bf16_f32 v139, v130, v131
ds_write_b64 v3, v[132:133] offset:8192
ds_write_b64 v3, v[134:135] offset:8224
ds_write_b64 v3, v[136:137] offset:12288
ds_write_b64 v3, v[138:139] offset:12320
s_waitcnt lgkmcnt(0)
s_barrier
ds_read_b64_tr_b16 v[84:85], v2 offset:8192
ds_read_b64_tr_b16 v[86:87], v2 offset:8448
ds_read_b64_tr_b16 v[88:89], v2 offset:10240
ds_read_b64_tr_b16 v[90:91], v2 offset:10496
ds_read_b64_tr_b16 v[92:93], v2 offset:8224
ds_read_b64_tr_b16 v[94:95], v2 offset:8480
ds_read_b64_tr_b16 v[96:97], v2 offset:10272
ds_read_b64_tr_b16 v[98:99], v2 offset:10528
ds_read_b64_tr_b16 v[100:101], v2 offset:12288
ds_read_b64_tr_b16 v[102:103], v2 offset:12544
ds_read_b64_tr_b16 v[104:105], v2 offset:14336
ds_read_b64_tr_b16 v[106:107], v2 offset:14592
ds_read_b64_tr_b16 v[108:109], v2 offset:12320
ds_read_b64_tr_b16 v[110:111], v2 offset:12576
ds_read_b64_tr_b16 v[112:113], v2 offset:14368
ds_read_b64_tr_b16 v[114:115], v2 offset:14624
s_waitcnt lgkmcnt(0)
v_mfma_f32_16x16x32_bf16 v[116:119], v[84:87], v[164:167], 0
v_mfma_f32_16x16x32_bf16 v[124:127], v[100:103], v[164:167], 0
v_mfma_f32_16x16x32_bf16 v[120:123], v[92:95], v[164:167], 0
v_mfma_f32_16x16x32_bf16 v[128:131], v[108:111], v[164:167], 0
v_mfma_f32_16x16x32_bf16 v[116:119], v[88:91], v[168:171], v[116:119]
v_mfma_f32_16x16x32_bf16 v[124:127], v[104:107], v[168:171], v[124:127]
v_mfma_f32_16x16x32_bf16 v[120:123], v[96:99], v[168:171], v[120:123]
v_mfma_f32_16x16x32_bf16 v[128:131], v[112:115], v[168:171], v[128:131]
v_mfma_f32_16x16x32_bf16 v[116:119], v[100:103], v[180:183], v[116:119]
v_mfma_f32_16x16x32_bf16 v[124:127], v[84:87], v[172:175], v[124:127]
v_mfma_f32_16x16x32_bf16 v[120:123], v[108:111], v[180:183], v[120:123]
v_mfma_f32_16x16x32_bf16 v[128:131], v[92:95], v[172:175], v[128:131]
v_mfma_f32_16x16x32_bf16 v[116:119], v[104:107], v[184:187], v[116:119]
v_mfma_f32_16x16x32_bf16 v[124:127], v[88:91], v[176:179], v[124:127]
v_mfma_f32_16x16x32_bf16 v[120:123], v[112:115], v[184:187], v[120:123]
v_mfma_f32_16x16x32_bf16 v[128:131], v[96:99], v[176:179], v[128:131]
s_mul_i32 s24, s58, 4096
s_add_u32 s24, s24, 60674048
s_add_u32 s25, s24, 921600
s_nop 5
v_cvt_pk_bf16_f32 v132, v116, v117
v_cvt_pk_bf16_f32 v133, v118, v119
v_cvt_pk_bf16_f32 v134, v120, v121
v_cvt_pk_bf16_f32 v135, v122, v123
s_nop 1
v_permlane16_swap_b32 v132, v134
v_permlane16_swap_b32 v133, v135
buffer_store_dwordx4 v[132:135], v4, s[8:11], s24 offen sc1
v_cvt_pk_bf16_f32 v136, v124, v125
v_cvt_pk_bf16_f32 v137, v126, v127
v_cvt_pk_bf16_f32 v138, v128, v129
v_cvt_pk_bf16_f32 v139, v130, v131
s_nop 1
v_permlane16_swap_b32 v136, v138
v_permlane16_swap_b32 v137, v139
buffer_store_dwordx4 v[136:139], v4, s[8:11], s25 offen sc1
s_mov_b32 s22, 56627200
v_lshrrev_b32 v4, 2, v0
v_mul_u32_u24 v4, 4096, v4
v_and_b32 v5, 3, v0
v_lshlrev_b32 v5, 4, v5
v_add_u32 v4, v4, v5
v_and_b32 v149, 15, v0
s_lshl_b32 s24, s62, 5
v_add_u32 v150, s24, v149
v_mul_u32_u24 v150, 896, v150
v_lshrrev_b32 v151, 5, v0
v_lshlrev_b32 v151, 4, v151
v_lshrrev_b32 v149, 4, v0
v_and_b32 v149, 1, v149
v_lshlrev_b32 v149, 5, v149
v_add_u32 v151, v151, v149
s_lshl_b32 s24, s63, 6
v_add3_u32 v148, v150, v151, s24
s_mov_b32 s27, 54792192
s_mov_b32 s28, 54806528
buffer_load_dwordx4 v[8:11], v148, s[8:11], s27 offen sc1
buffer_load_dwordx4 v[12:15], v148, s[8:11], s28 offen sc1
v_mov_b32 v32, 0
v_mov_b32 v33, 0
v_mov_b32 v34, 0
v_mov_b32 v35, 0
v_mov_b32 v36, 0
v_mov_b32 v37, 0
v_mov_b32 v38, 0
v_mov_b32 v39, 0
v_mov_b32 v40, 0
v_mov_b32 v41, 0
v_mov_b32 v42, 0
v_mov_b32 v43, 0
v_mov_b32 v44, 0
v_mov_b32 v45, 0
v_mov_b32 v46, 0
v_mov_b32 v47, 0
v_mov_b32 v48, 0
v_mov_b32 v49, 0
v_mov_b32 v50, 0
v_mov_b32 v51, 0
v_mov_b32 v52, 0
v_mov_b32 v53, 0
v_mov_b32 v54, 0
v_mov_b32 v55, 0
v_mov_b32 v56, 0
v_mov_b32 v57, 0
v_mov_b32 v58, 0
v_mov_b32 v59, 0
v_mov_b32 v60, 0
v_mov_b32 v61, 0
v_mov_b32 v62, 0
v_mov_b32 v63, 0
v_mov_b32 v64, 0
v_mov_b32 v65, 0
v_mov_b32 v66, 0
v_mov_b32 v67, 0
v_mov_b32 v68, 0
v_mov_b32 v69, 0
v_mov_b32 v70, 0
v_mov_b32 v71, 0
v_mov_b32 v72, 0
v_mov_b32 v73, 0
v_mov_b32 v74, 0
v_mov_b32 v75, 0
v_mov_b32 v76, 0
v_mov_b32 v77, 0
v_mov_b32 v78, 0
v_mov_b32 v79, 0
v_mov_b32 v80, 0
v_mov_b32 v81, 0
v_mov_b32 v82, 0
v_mov_b32 v83, 0
v_mov_b32 v84, 0
v_mov_b32 v85, 0
v_mov_b32 v86, 0
v_mov_b32 v87, 0
v_mov_b32 v88, 0
v_mov_b32 v89, 0
v_mov_b32 v90, 0
v_mov_b32 v91, 0
v_mov_b32 v92, 0
v_mov_b32 v93, 0
v_mov_b32 v94, 0
v_mov_b32 v95, 0
s_mov_b32 s27, s39
.Lb3p_353:
s_cmp_gt_u32 s61, 3
s_cbranch_scc1 .Lb3h_355
s_lshl_b32 s24, s60, 7
s_add_u32 s24, s24, 60674048
s_mul_i32 s25, s17, 65536
s_add_u32 s24, s24, s25
s_add_u32 s26, s24, 0
buffer_load_dwordx4 v[32:35], v4, s[8:11], s26 offen sc1
s_add_u32 s26, s24, 262144
buffer_load_dwordx4 v[36:39], v4, s[8:11], s26 offen sc1
s_add_u32 s26, s24, 524288
buffer_load_dwordx4 v[40:43], v4, s[8:11], s26 offen sc1
s_add_u32 s26, s24, 786432
buffer_load_dwordx4 v[44:47], v4, s[8:11], s26 offen sc1
s_add_u32 s26, s24, 1048576
buffer_load_dwordx4 v[48:51], v4, s[8:11], s26 offen sc1
s_add_u32 s26, s24, 1310720
buffer_load_dwordx4 v[52:55], v4, s[8:11], s26 offen sc1
s_add_u32 s26, s24, 1572864
buffer_load_dwordx4 v[56:59], v4, s[8:11], s26 offen sc1
s_cmp_ge_u32 s17, 1
s_cbranch_scc1 .Lb3s_363
s_add_u32 s26, s24, 1835008
buffer_load_dwordx4 v[60:63], v4, s[8:11], s26 offen sc1
.Lb3s_363:
.Lb3h_355:
s_cmp_lt_u32 s61, 3
s_cbranch_scc1 .Lb3h_364
s_lshl_b32 s24, s60, 7
s_add_u32 s24, s24, 60674112
s_mul_i32 s25, s17, 65536
s_add_u32 s24, s24, s25
s_add_u32 s26, s24, 0
buffer_load_dwordx4 v[64:67], v4, s[8:11], s26 offen sc1
s_add_u32 s26, s24, 262144
buffer_load_dwordx4 v[68:71], v4, s[8:11], s26 offen sc1
s_add_u32 s26, s24, 524288
buffer_load_dwordx4 v[72:75], v4, s[8:11], s26 offen sc1
s_add_u32 s26, s24, 786432
buffer_load_dwordx4 v[76:79], v4, s[8:11], s26 offen sc1
s_add_u32 s26, s24, 1048576
buffer_load_dwordx4 v[80:83], v4, s[8:11], s26 offen sc1
s_add_u32 s26, s24, 1310720
buffer_load_dwordx4 v[84:87], v4, s[8:11], s26 offen sc1
s_add_u32 s26, s24, 1572864
buffer_load_dwordx4 v[88:91], v4, s[8:11], s26 offen sc1
s_cmp_ge_u32 s17, 1
s_cbranch_scc1 .Lb3s_372
s_add_u32 s26, s24, 1835008
buffer_load_dwordx4 v[92:95], v4, s[8:11], s26 offen sc1
.Lb3s_372:
.Lb3h_364:
s_waitcnt vmcnt(0)
v_max_u32 v5, v32, v33
v_max3_u32 v5, v5, v34, v35
v_max3_u32 v5, v5, v36, v37
v_max3_u32 v5, v5, v38, v39
v_max3_u32 v5, v5, v40, v41
v_max3_u32 v5, v5, v42, v43
v_max3_u32 v5, v5, v44, v45
v_max3_u32 v5, v5, v46, v47
v_max3_u32 v5, v5, v48, v49
v_max3_u32 v5, v5, v50, v51
v_max3_u32 v5, v5, v52, v53
v_max3_u32 v5, v5, v54, v55
v_max3_u32 v5, v5, v56, v57
v_max3_u32 v5, v5, v58, v59
v_max3_u32 v5, v5, v60, v61
v_max3_u32 v5, v5, v62, v63
v_max3_u32 v5, v5, v64, v65
v_max3_u32 v5, v5, v66, v67
v_max3_u32 v5, v5, v68, v69
v_max3_u32 v5, v5, v70, v71
v_max3_u32 v5, v5, v72, v73
v_max3_u32 v5, v5, v74, v75
v_max3_u32 v5, v5, v76, v77
v_max3_u32 v5, v5, v78, v79
v_max3_u32 v5, v5, v80, v81
v_max3_u32 v5, v5, v82, v83
v_max3_u32 v5, v5, v84, v85
v_max3_u32 v5, v5, v86, v87
v_max3_u32 v5, v5, v88, v89
v_max3_u32 v5, v5, v90, v91
v_max3_u32 v5, v5, v92, v93
v_max3_u32 v5, v5, v94, v95
v_cmp_eq_u32 vcc, -1, v5
s_cbranch_vccz .Lb3o_354
s_sub_u32 s27, s27, 1
s_cbranch_scc0 .Lb3p_353
s_mov_b32 s39, 0
.Lb3o_354:
s_barrier
v_lshlrev_b32 v5, 4, v0
s_lshl_b32 s25, s17, 10
v_add_u32 v5, s25, v5
s_cmp_gt_u32 s61, 3
s_cbranch_scc1 .Lb3h_373
ds_write_b128 v5, v[32:35] offset:0
ds_write_b128 v5, v[36:39] offset:4096
ds_write_b128 v5, v[40:43] offset:8192
ds_write_b128 v5, v[44:47] offset:12288
ds_write_b128 v5, v[48:51] offset:16384
ds_write_b128 v5, v[52:55] offset:20480
ds_write_b128 v5, v[56:59] offset:24576
s_cmp_ge_u32 s17, 1
s_cbranch_scc1 .Lb3s_381
ds_write_b128 v5, v[60:63] offset:28672
.Lb3s_381:
.Lb3h_373:
s_cmp_lt_u32 s61, 3
s_cbranch_scc1 .Lb3h_382
ds_write_b128 v5, v[64:67] offset:29696
ds_write_b128 v5, v[68:71] offset:33792
ds_write_b128 v5, v[72:75] offset:37888
ds_write_b128 v5, v[76:79] offset:41984
ds_write_b128 v5, v[80:83] offset:46080
ds_write_b128 v5, v[84:87] offset:50176
ds_write_b128 v5, v[88:91] offset:54272
s_cmp_ge_u32 s17, 1
s_cbranch_scc1 .Lb3s_390
ds_write_b128 v5, v[92:95] offset:58368
.Lb3s_390:
.Lb3h_382:
v_lshrrev_b32 v5, 5, v0
v_lshlrev_b32 v5, 9, v5
v_lshrrev_b32 v6, 2, v0
v_and_b32 v6, 3, v6
v_lshlrev_b32 v6, 6, v6
v_add_u32 v5, v5, v6
v_lshrrev_b32 v6, 4, v0
v_and_b32 v6, 1, v6
v_lshlrev_b32 v6, 5, v6
v_and_b32 v7, 3, v0
v_lshlrev_b32 v7, 3, v7
v_add3_u32 v2, v5, v6, v7
s_and_b32 s24, s62, 1
s_mul_i32 s24, s24, 29696
v_add_u32 v2, s24, v2
s_waitcnt vmcnt(0) lgkmcnt(0)
s_barrier
ds_read_b64_tr_b16 v[32:33], v2 offset:0
ds_read_b64_tr_b16 v[34:35], v2 offset:256
ds_read_b64_tr_b16 v[36:37], v2 offset:1024
ds_read_b64_tr_b16 v[38:39], v2 offset:1280
ds_read_b64_tr_b16 v[40:41], v2 offset:2048
ds_read_b64_tr_b16 v[42:43], v2 offset:2304
ds_read_b64_tr_b16 v[44:45], v2 offset:3072
ds_read_b64_tr_b16 v[46:47], v2 offset:3328
ds_read_b64_tr_b16 v[48:49], v2 offset:4096
ds_read_b64_tr_b16 v[50:51], v2 offset:4352
ds_read_b64_tr_b16 v[52:53], v2 offset:5120
ds_read_b64_tr_b16 v[54:55], v2 offset:5376
ds_read_b64_tr_b16 v[56:57], v2 offset:6144
ds_read_b64_tr_b16 v[58:59], v2 offset:6400
s_waitcnt lgkmcnt(12)
v_mfma_f32_32x32x16_bf16 v[16:31], a[128:131], v[32:35], 0
ds_read_b64_tr_b16 v[60:61], v2 offset:7168
ds_read_b64_tr_b16 v[62:63], v2 offset:7424
s_waitcnt lgkmcnt(12)
v_mfma_f32_32x32x16_bf16 v[16:31], a[132:135], v[36:39], v[16:31]
ds_read_b64_tr_b16 v[64:65], v2 offset:8192
ds_read_b64_tr_b16 v[66:67], v2 offset:8448
s_waitcnt lgkmcnt(12)
v_mfma_f32_32x32x16_bf16 v[16:31], a[136:139], v[40:43], v[16:31]
ds_read_b64_tr_b16 v[68:69], v2 offset:9216
ds_read_b64_tr_b16 v[70:71], v2 offset:9472
s_waitcnt lgkmcnt(12)
v_mfma_f32_32x32x16_bf16 v[16:31], a[140:143], v[44:47], v[16:31]
ds_read_b64_tr_b16 v[72:73], v2 offset:10240
ds_read_b64_tr_b16 v[74:75], v2 offset:10496
s_waitcnt lgkmcnt(12)
v_mfma_f32_32x32x16_bf16 v[16:31], a[144:147], v[48:51], v[16:31]
ds_read_b64_tr_b16 v[76:77], v2 offset:11264
ds_read_b64_tr_b16 v[78:79], v2 offset:11520
s_waitcnt lgkmcnt(12)
v_mfma_f32_32x32x16_bf16 v[16:31], a[148:151], v[52:55], v[16:31]
ds_read_b64_tr_b16 v[80:81], v2 offset:12288
ds_read_b64_tr_b16 v[82:83], v2 offset:12544
s_waitcnt lgkmcnt(12)
v_mfma_f32_32x32x16_bf16 v[16:31], a[152:155], v[56:59], v[16:31]
ds_read_b64_tr_b16 v[84:85], v2 offset:13312
ds_read_b64_tr_b16 v[86:87], v2 offset:13568
s_waitcnt lgkmcnt(12)
v_mfma_f32_32x32x16_bf16 v[16:31], a[156:159], v[60:63], v[16:31]
ds_read_b64_tr_b16 v[88:89], v2 offset:14336
ds_read_b64_tr_b16 v[90:91], v2 offset:14592
s_waitcnt lgkmcnt(12)
v_mfma_f32_32x32x16_bf16 v[16:31], a[160:163], v[64:67], v[16:31]
ds_read_b64_tr_b16 v[92:93], v2 offset:15360
ds_read_b64_tr_b16 v[94:95], v2 offset:15616
s_waitcnt lgkmcnt(12)
v_mfma_f32_32x32x16_bf16 v[16:31], a[164:167], v[68:71], v[16:31]
ds_read_b64_tr_b16 v[96:97], v2 offset:16384
ds_read_b64_tr_b16 v[98:99], v2 offset:16640
s_waitcnt lgkmcnt(12)
v_mfma_f32_32x32x16_bf16 v[16:31], a[168:171], v[72:75], v[16:31]
ds_read_b64_tr_b16 v[100:101], v2 offset:17408
ds_read_b64_tr_b16 v[102:103], v2 offset:17664
s_waitcnt lgkmcnt(12)
v_mfma_f32_32x32x16_bf16 v[16:31], a[172:175], v[76:79], v[16:31]
ds_read_b64_tr_b16 v[104:105], v2 offset:18432
ds_read_b64_tr_b16 v[106:107], v2 offset:18688
s_waitcnt lgkmcnt(12)
v_mfma_f32_32x32x16_bf16 v[16:31], a[176:179], v[80:83], v[16:31]
ds_read_b64_tr_b16 v[108:109], v2 offset:19456
ds_read_b64_tr_b16 v[110:111], v2 offset:19712
s_waitcnt lgkmcnt(12)
v_mfma_f32_32x32x16_bf16 v[16:31], a[180:183], v[84:87], v[16:31]
ds_read_b64_tr_b16 v[112:113], v2 offset:20480
ds_read_b64_tr_b16 v[114:115], v2 offset:20736
s_waitcnt lgkmcnt(12)
v_mfma_f32_32x32x16_bf16 v[16:31], a[184:187], v[88:91], v[16:31]
ds_read_b64_tr_b16 v[116:117], v2 offset:21504
ds_read_b64_tr_b16 v[118:119], v2 offset:21760
s_waitcnt lgkmcnt(12)
v_mfma_f32_32x32x16_bf16 v[16:31], a[188:191], v[92:95], v[16:31]
ds_read_b64_tr_b16 v[120:121], v2 offset:22528
ds_read_b64_tr_b16 v[122:123], v2 offset:22784
s_waitcnt lgkmcnt(12)
v_mfma_f32_32x32x16_bf16 v[16:31], a[192:195], v[96:99], v[16:31]
ds_read_b64_tr_b16 v[124:125], v2 offset:23552
ds_read_b64_tr_b16 v[126:127], v2 offset:23808
s_waitcnt lgkmcnt(12)
v_mfma_f32_32x32x16_bf16 v[16:31], a[196:199], v[100:103], v[16:31]
ds_read_b64_tr_b16 v[128:129], v2 offset:24576
ds_read_b64_tr_b16 v[130:131], v2 offset:24832
s_waitcnt lgkmcnt(12)
v_mfma_f32_32x32x16_bf16 v[16:31], a[200:203], v[104:107], v[16:31]
ds_read_b64_tr_b16 v[132:133], v2 offset:25600
ds_read_b64_tr_b16 v[134:135], v2 offset:25856
s_waitcnt lgkmcnt(12)
v_mfma_f32_32x32x16_bf16 v[16:31], a[204:207], v[108:111], v[16:31]
ds_read_b64_tr_b16 v[136:137], v2 offset:26624
ds_read_b64_tr_b16 v[138:139], v2 offset:26880
s_waitcnt lgkmcnt(12)
v_mfma_f32_32x32x16_bf16 v[16:31], a[208:211], v[112:115], v[16:31]
ds_read_b64_tr_b16 v[140:141], v2 offset:27648
ds_read_b64_tr_b16 v[142:143], v2 offset:27904
s_waitcnt lgkmcnt(12)
v_mfma_f32_32x32x16_bf16 v[16:31], a[212:215], v[116:119], v[16:31]
ds_read_b64_tr_b16 v[144:145], v2 offset:28672
ds_read_b64_tr_b16 v[146:147], v2 offset:28928
s_waitcnt lgkmcnt(12)
v_mfma_f32_32x32x16_bf16 v[16:31], a[216:219], v[120:123], v[16:31]
s_waitcnt lgkmcnt(10)
v_mfma_f32_32x32x16_bf16 v[16:31], a[220:223], v[124:127], v[16:31]
s_waitcnt lgkmcnt(8)
v_mfma_f32_32x32x16_bf16 v[16:31], a[224:227], v[128:131], v[16:31]
s_waitcnt lgkmcnt(6)
v_mfma_f32_32x32x16_bf16 v[16:31], a[228:231], v[132:135], v[16:31]
s_waitcnt lgkmcnt(4)
v_mfma_f32_32x32x16_bf16 v[16:31], a[232:235], v[136:139], v[16:31]
s_waitcnt lgkmcnt(2)
v_mfma_f32_32x32x16_bf16 v[16:31], a[236:239], v[140:143], v[16:31]
s_waitcnt lgkmcnt(0)
v_mfma_f32_32x32x16_bf16 v[16:31], a[240:243], v[144:147], v[16:31]
s_nop 7
s_nop 3
v_cvt_pk_bf16_f32 v40, v16, v17
v_cvt_pk_bf16_f32 v41, v18, v19
v_cvt_pk_bf16_f32 v42, v20, v21
v_cvt_pk_bf16_f32 v43, v22, v23
v_cvt_pk_bf16_f32 v44, v24, v25
v_cvt_pk_bf16_f32 v45, v26, v27
v_cvt_pk_bf16_f32 v46, v28, v29
v_cvt_pk_bf16_f32 v47, v30, v31
s_nop 1
v_permlane32_swap_b32 v40, v42
v_permlane32_swap_b32 v41, v43
v_permlane32_swap_b32 v44, v46
v_permlane32_swap_b32 v45, v47
s_nop 1
v_permlane16_swap_b32 v40, v44
v_permlane16_swap_b32 v41, v45
v_permlane16_swap_b32 v42, v46
v_permlane16_swap_b32 v43, v47
s_add_u32 s23, s22, 14336
v_lshlrev_b32 v32, 16, v40
v_and_b32 v33, 0xffff0000, v40
v_lshlrev_b32 v34, 16, v8
v_and_b32 v35, 0xffff0000, v8
v_pk_add_f32 v[32:33], v[32:33], v[34:35]
v_cvt_pk_bf16_f32 v40, v32, v33
v_lshlrev_b32 v32, 16, v41
v_and_b32 v33, 0xffff0000, v41
v_lshlrev_b32 v34, 16, v9
v_and_b32 v35, 0xffff0000, v9
v_pk_add_f32 v[32:33], v[32:33], v[34:35]
v_cvt_pk_bf16_f32 v41, v32, v33
v_lshlrev_b32 v32, 16, v42
v_and_b32 v33, 0xffff0000, v42
v_lshlrev_b32 v34, 16, v10
v_and_b32 v35, 0xffff0000, v10
v_pk_add_f32 v[32:33], v[32:33], v[34:35]
v_cvt_pk_bf16_f32 v42, v32, v33
v_lshlrev_b32 v32, 16, v43
v_and_b32 v33, 0xffff0000, v43
v_lshlrev_b32 v34, 16, v11
v_and_b32 v35, 0xffff0000, v11
v_pk_add_f32 v[32:33], v[32:33], v[34:35]
v_cvt_pk_bf16_f32 v43, v32, v33
buffer_store_dwordx4 v[40:43], v148, s[8:11], s22 offen sc1
v_lshlrev_b32 v32, 16, v44
v_and_b32 v33, 0xffff0000, v44
v_lshlrev_b32 v34, 16, v12
v_and_b32 v35, 0xffff0000, v12
v_pk_add_f32 v[32:33], v[32:33], v[34:35]
v_cvt_pk_bf16_f32 v44, v32, v33
v_lshlrev_b32 v32, 16, v45
v_and_b32 v33, 0xffff0000, v45
v_lshlrev_b32 v34, 16, v13
v_and_b32 v35, 0xffff0000, v13
v_pk_add_f32 v[32:33], v[32:33], v[34:35]
v_cvt_pk_bf16_f32 v45, v32, v33
v_lshlrev_b32 v32, 16, v46
v_and_b32 v33, 0xffff0000, v46
v_lshlrev_b32 v34, 16, v14
v_and_b32 v35, 0xffff0000, v14
v_pk_add_f32 v[32:33], v[32:33], v[34:35]
v_cvt_pk_bf16_f32 v46, v32, v33
v_lshlrev_b32 v32, 16, v47
v_and_b32 v33, 0xffff0000, v47
v_lshlrev_b32 v34, 16, v15
v_and_b32 v35, 0xffff0000, v15
v_pk_add_f32 v[32:33], v[32:33], v[34:35]
v_cvt_pk_bf16_f32 v47, v32, v33
buffer_store_dwordx4 v[44:47], v148, s[8:11], s23 offen sc1
s_and_b32 s18, s58, 3
s_lshr_b32 s59, s58, 2
s_cmp_eq_u32 s18, 0
s_cbranch_scc1 .Lnln_391
s_cmp_eq_u32 s18, 3
s_cselect_b32 s19, 56, 0
s_cmp_eq_u32 s18, 1
s_cselect_b32 s19, 112, s19
s_add_u32 s59, s59, s19
s_cmp_ge_u32 s59, 128
s_cbranch_scc1 .Lnln_391
s_lshr_b32 s30, s59, 2
s_lshl_b32 s30, s30, 5
s_add_u32 s30, s30, 68182016
s_lshr_b32 s18, s59, 1
s_and_b32 s19, s59, 1
s_mov_b32 s20, 0xffff0000
v_and_b32 v2, 31, v0
v_cmp_gt_u32 s[22:23], 28, v2
s_lshl_b32 s24, s18, 5
s_lshl_b32 s25, s19, 4
s_add_u32 s24, s24, s25
s_lshl_b32 s25, s17, 2
s_add_u32 s24, s24, s25
v_lshrrev_b32 v3, 5, v0
v_add_u32 v4, s24, v3
v_mul_u32_u24 v4, 896, v4
v_lshlrev_b32 v5, 4, v2
v_add_u32 v4, v4, v5
v_mov_b32 v6, 0x10000000
v_cndmask_b32 v4, v6, v4, s[22:23]
v_add_u32 v7, s25, v3
v_mul_u32_u24 v7, 912, v7
v_add_u32 v7, v7, v5
s_mov_b32 s27, 56627200
s_barrier
s_mov_b32 s28, s39
.Llnr_392:
buffer_load_dwordx4 v[8:11], v4, s[8:11], s27 offen offset:0 sc1
buffer_load_dwordx4 v[12:15], v4, s[8:11], s27 offen offset:448 sc1
buffer_load_dwordx4 v[16:19], v4, s[8:11], s27 offen offset:1792 sc1
buffer_load_dwordx4 v[20:23], v4, s[8:11], s27 offen offset:2240 sc1
s_waitcnt vmcnt(0)
v_max_u32 v24, v8, v9
v_max3_u32 v24, v24, v10, v11
v_max3_u32 v24, v24, v12, v13
v_max3_u32 v24, v24, v14, v15
v_max3_u32 v24, v24, v16, v17
v_max3_u32 v24, v24, v18, v19
v_max3_u32 v24, v24, v20, v21
v_max3_u32 v24, v24, v22, v23
v_cmp_eq_u32 vcc, -1, v24
s_cbranch_vccz .Llno_393
s_sub_u32 s28, s28, 1
s_cbranch_scc0 .Llnr_392
s_mov_b32 s39, 0
.Llno_393:
v_lshlrev_b32 v24, 16, v8
v_lshlrev_b32 v40, 16, v16
v_and_b32 v25, s20, v8
v_and_b32 v41, s20, v16
v_lshlrev_b32 v26, 16, v9
v_lshlrev_b32 v42, 16, v17
v_and_b32 v27, s20, v9
v_and_b32 v43, s20, v17
v_lshlrev_b32 v28, 16, v10
v_lshlrev_b32 v44, 16, v18
v_and_b32 v29, s20, v10
v_and_b32 v45, s20, v18
v_lshlrev_b32 v30, 16, v11
v_lshlrev_b32 v46, 16, v19
v_and_b32 v31, s20, v11
v_and_b32 v47, s20, v19
v_lshlrev_b32 v32, 16, v12
v_lshlrev_b32 v48, 16, v20
v_and_b32 v33, s20, v12
v_and_b32 v49, s20, v20
v_lshlrev_b32 v34, 16, v13
v_lshlrev_b32 v50, 16, v21
v_and_b32 v35, s20, v13
v_and_b32 v51, s20, v21
v_lshlrev_b32 v36, 16, v14
v_lshlrev_b32 v52, 16, v22
v_and_b32 v37, s20, v14
v_and_b32 v53, s20, v22
v_lshlrev_b32 v38, 16, v15
v_lshlrev_b32 v54, 16, v23
v_and_b32 v39, s20, v15
v_and_b32 v55, s20, v23
v_pk_add_f32 v[56:57], v[24:25], v[26:27]
v_pk_add_f32 v[64:65], v[40:41], v[42:43]
v_pk_add_f32 v[58:59], v[28:29], v[30:31]
v_pk_add_f32 v[66:67], v[44:45], v[46:47]
v_pk_add_f32 v[60:61], v[32:33], v[34:35]
v_pk_add_f32 v[68:69], v[48:49], v[50:51]
v_pk_add_f32 v[62:63], v[36:37], v[38:39]
v_pk_add_f32 v[70:71], v[52:53], v[54:55]
v_pk_add_f32 v[56:57], v[56:57], v[58:59]
v_pk_add_f32 v[64:65], v[64:65], v[66:67]
v_pk_add_f32 v[60:61], v[60:61], v[62:63]
v_pk_add_f32 v[68:69], v[68:69], v[70:71]
v_pk_add_f32 v[56:57], v[56:57], v[60:61]
v_pk_add_f32 v[64:65], v[64:65], v[68:69]
v_add_f32 v56, v56, v57
v_add_f32 v64, v64, v65
s_nop 1
s_nop 1
v_add_f32_dpp v56, v56, v56 row_ror:8 row_mask:0xf bank_mask:0xf
v_add_f32_dpp v64, v64, v64 row_ror:8 row_mask:0xf bank_mask:0xf
s_nop 1
s_nop 1
v_add_f32_dpp v56, v56, v56 row_ror:4 row_mask:0xf bank_mask:0xf
v_add_f32_dpp v64, v64, v64 row_ror:4 row_mask:0xf bank_mask:0xf
s_nop 1
s_nop 1
v_add_f32_dpp v56, v56, v56 row_ror:2 row_mask:0xf bank_mask:0xf
v_add_f32_dpp v64, v64, v64 row_ror:2 row_mask:0xf bank_mask:0xf
s_nop 1
s_nop 1
v_add_f32_dpp v56, v56, v56 row_ror:1 row_mask:0xf bank_mask:0xf
v_add_f32_dpp v64, v64, v64 row_ror:1 row_mask:0xf bank_mask:0xf
s_nop 1
s_nop 1
v_mov_b32 v57, v56
v_mov_b32 v65, v64
s_nop 1
s_nop 1
v_permlane16_swap_b32 v56, v57
v_permlane16_swap_b32 v64, v65
v_add_f32 v56, v56, v57
v_add_f32 v64, v64, v65
v_mul_f32 v56, 0x3b124925, v56
v_mul_f32 v64, 0x3b124925, v64
v_cndmask_b32 v58, 0, v56, s[22:23]
v_cndmask_b32 v66, 0, v64, s[22:23]
v_pk_add_f32 v[8:9], v[24:25], v[58:59] op_sel_hi:[1,0] neg_lo:[0,1] neg_hi:[0,1]
v_pk_add_f32 v[16:17], v[40:41], v[66:67] op_sel_hi:[1,0] neg_lo:[0,1] neg_hi:[0,1]
v_pk_mul_f32 v[60:61], v[8:9], v[8:9]
v_pk_mul_f32 v[68:69], v[16:17], v[16:17]
v_pk_add_f32 v[10:11], v[26:27], v[58:59] op_sel_hi:[1,0] neg_lo:[0,1] neg_hi:[0,1]
v_pk_add_f32 v[18:19], v[42:43], v[66:67] op_sel_hi:[1,0] neg_lo:[0,1] neg_hi:[0,1]
v_pk_mul_f32 v[62:63], v[10:11], v[10:11]
v_pk_mul_f32 v[70:71], v[18:19], v[18:19]
v_pk_add_f32 v[12:13], v[28:29], v[58:59] op_sel_hi:[1,0] neg_lo:[0,1] neg_hi:[0,1]
v_pk_add_f32 v[20:21], v[44:45], v[66:67] op_sel_hi:[1,0] neg_lo:[0,1] neg_hi:[0,1]
v_pk_fma_f32 v[60:61], v[12:13], v[12:13], v[60:61]
v_pk_fma_f32 v[68:69], v[20:21], v[20:21], v[68:69]
v_pk_add_f32 v[14:15], v[30:31], v[58:59] op_sel_hi:[1,0] neg_lo:[0,1] neg_hi:[0,1]
v_pk_add_f32 v[22:23], v[46:47], v[66:67] op_sel_hi:[1,0] neg_lo:[0,1] neg_hi:[0,1]
v_pk_fma_f32 v[62:63], v[14:15], v[14:15], v[62:63]
v_pk_fma_f32 v[70:71], v[22:23], v[22:23], v[70:71]
v_pk_add_f32 v[8:9], v[32:33], v[58:59] op_sel_hi:[1,0] neg_lo:[0,1] neg_hi:[0,1]
v_pk_add_f32 v[16:17], v[48:49], v[66:67] op_sel_hi:[1,0] neg_lo:[0,1] neg_hi:[0,1]
v_pk_fma_f32 v[60:61], v[8:9], v[8:9], v[60:61]
v_pk_fma_f32 v[68:69], v[16:17], v[16:17], v[68:69]
v_pk_add_f32 v[10:11], v[34:35], v[58:59] op_sel_hi:[1,0] neg_lo:[0,1] neg_hi:[0,1]
v_pk_add_f32 v[18:19], v[50:51], v[66:67] op_sel_hi:[1,0] neg_lo:[0,1] neg_hi:[0,1]
v_pk_fma_f32 v[62:63], v[10:11], v[10:11], v[62:63]
v_pk_fma_f32 v[70:71], v[18:19], v[18:19], v[70:71]
v_pk_add_f32 v[12:13], v[36:37], v[58:59] op_sel_hi:[1,0] neg_lo:[0,1] neg_hi:[0,1]
v_pk_add_f32 v[20:21], v[52:53], v[66:67] op_sel_hi:[1,0] neg_lo:[0,1] neg_hi:[0,1]
v_pk_fma_f32 v[60:61], v[12:13], v[12:13], v[60:61]
v_pk_fma_f32 v[68:69], v[20:21], v[20:21], v[68:69]
v_pk_add_f32 v[14:15], v[38:39], v[58:59] op_sel_hi:[1,0] neg_lo:[0,1] neg_hi:[0,1]
v_pk_add_f32 v[22:23], v[54:55], v[66:67] op_sel_hi:[1,0] neg_lo:[0,1] neg_hi:[0,1]
v_pk_fma_f32 v[62:63], v[14:15], v[14:15], v[62:63]
v_pk_fma_f32 v[70:71], v[22:23], v[22:23], v[70:71]
v_pk_add_f32 v[60:61], v[60:61], v[62:63]
v_pk_add_f32 v[68:69], v[68:69], v[70:71]
v_add_f32 v60, v60, v61
v_add_f32 v68, v68, v69
s_nop 1
s_nop 1
v_add_f32_dpp v60, v60, v60 row_ror:8 row_mask:0xf bank_mask:0xf
v_add_f32_dpp v68, v68, v68 row_ror:8 row_mask:0xf bank_mask:0xf
s_nop 1
s_nop 1
v_add_f32_dpp v60, v60, v60 row_ror:4 row_mask:0xf bank_mask:0xf
v_add_f32_dpp v68, v68, v68 row_ror:4 row_mask:0xf bank_mask:0xf
s_nop 1
s_nop 1
v_add_f32_dpp v60, v60, v60 row_ror:2 row_mask:0xf bank_mask:0xf
v_add_f32_dpp v68, v68, v68 row_ror:2 row_mask:0xf bank_mask:0xf
s_nop 1
s_nop 1
v_add_f32_dpp v60, v60, v60 row_ror:1 row_mask:0xf bank_mask:0xf
v_add_f32_dpp v68, v68, v68 row_ror:1 row_mask:0xf bank_mask:0xf
s_nop 1
s_nop 1
v_mov_b32 v61, v60
v_mov_b32 v69, v68
s_nop 1
s_nop 1
v_permlane16_swap_b32 v60, v61
v_permlane16_swap_b32 v68, v69
v_add_f32 v60, v60, v61
v_add_f32 v68, v68, v69
v_mul_f32 v60, 0x3b124925, v60
v_mul_f32 v68, 0x3b124925, v68
v_cvt_pk_bf16_f32 v56, v56, v56
v_cvt_pk_bf16_f32 v64, v64, v64
v_cvt_pk_bf16_f32 v60, v60, v60
v_cvt_pk_bf16_f32 v68, v68, v68
v_and_b32 v56, s20, v56
v_and_b32 v64, s20, v64
v_and_b32 v60, s20, v60
v_and_b32 v68, s20, v68
v_add_f32 v60, 0x3727c5ac, v60
v_add_f32 v68, 0x3727c5ac, v68
v_cvt_pk_bf16_f32 v60, v60, v60
v_cvt_pk_bf16_f32 v68, v68, v68
v_and_b32 v60, s20, v60
v_and_b32 v68, s20, v68
v_sqrt_f32 v60, v60
v_sqrt_f32 v68, v68
s_nop 0
s_nop 0
v_cvt_pk_bf16_f32 v60, v60, v60
v_cvt_pk_bf16_f32 v68, v68, v68
v_and_b32 v60, s20, v60
v_and_b32 v68, s20, v68
v_rcp_f32 v60, v60
v_rcp_f32 v68, v68
s_nop 0
s_nop 0
v_pk_add_f32 v[24:25], v[24:25], v[56:57] op_sel_hi:[1,0] neg_lo:[0,1] neg_hi:[0,1]
v_pk_add_f32 v[40:41], v[40:41], v[64:65] op_sel_hi:[1,0] neg_lo:[0,1] neg_hi:[0,1]
v_cvt_pk_bf16_f32 v8, v24, v25
v_cvt_pk_bf16_f32 v16, v40, v41
v_pk_add_f32 v[26:27], v[26:27], v[56:57] op_sel_hi:[1,0] neg_lo:[0,1] neg_hi:[0,1]
v_pk_add_f32 v[42:43], v[42:43], v[64:65] op_sel_hi:[1,0] neg_lo:[0,1] neg_hi:[0,1]
v_cvt_pk_bf16_f32 v9, v26, v27
v_cvt_pk_bf16_f32 v17, v42, v43
v_pk_add_f32 v[28:29], v[28:29], v[56:57] op_sel_hi:[1,0] neg_lo:[0,1] neg_hi:[0,1]
v_pk_add_f32 v[44:45], v[44:45], v[64:65] op_sel_hi:[1,0] neg_lo:[0,1] neg_hi:[0,1]
v_cvt_pk_bf16_f32 v10, v28, v29
v_cvt_pk_bf16_f32 v18, v44, v45
v_pk_add_f32 v[30:31], v[30:31], v[56:57] op_sel_hi:[1,0] neg_lo:[0,1] neg_hi:[0,1]
v_pk_add_f32 v[46:47], v[46:47], v[64:65] op_sel_hi:[1,0] neg_lo:[0,1] neg_hi:[0,1]
v_cvt_pk_bf16_f32 v11, v30, v31
v_cvt_pk_bf16_f32 v19, v46, v47
v_pk_add_f32 v[32:33], v[32:33], v[56:57] op_sel_hi:[1,0] neg_lo:[0,1] neg_hi:[0,1]
v_pk_add_f32 v[48:49], v[48:49], v[64:65] op_sel_hi:[1,0] neg_lo:[0,1] neg_hi:[0,1]
v_cvt_pk_bf16_f32 v12, v32, v33
v_cvt_pk_bf16_f32 v20, v48, v49
v_pk_add_f32 v[34:35], v[34:35], v[56:57] op_sel_hi:[1,0] neg_lo:[0,1] neg_hi:[0,1]
v_pk_add_f32 v[50:51], v[50:51], v[64:65] op_sel_hi:[1,0] neg_lo:[0,1] neg_hi:[0,1]
v_cvt_pk_bf16_f32 v13, v34, v35
v_cvt_pk_bf16_f32 v21, v50, v51
v_pk_add_f32 v[36:37], v[36:37], v[56:57] op_sel_hi:[1,0] neg_lo:[0,1] neg_hi:[0,1]
v_pk_add_f32 v[52:53], v[52:53], v[64:65] op_sel_hi:[1,0] neg_lo:[0,1] neg_hi:[0,1]
v_cvt_pk_bf16_f32 v14, v36, v37
v_cvt_pk_bf16_f32 v22, v52, v53
v_pk_add_f32 v[38:39], v[38:39], v[56:57] op_sel_hi:[1,0] neg_lo:[0,1] neg_hi:[0,1]
v_pk_add_f32 v[54:55], v[54:55], v[64:65] op_sel_hi:[1,0] neg_lo:[0,1] neg_hi:[0,1]
v_cvt_pk_bf16_f32 v15, v38, v39
v_cvt_pk_bf16_f32 v23, v54, v55
v_lshlrev_b32 v24, 16, v8
v_lshlrev_b32 v40, 16, v16
v_and_b32 v25, s20, v8
v_and_b32 v41, s20, v16
v_pk_mul_f32 v[24:25], v[24:25], v[60:61] op_sel_hi:[1,0]
v_pk_mul_f32 v[40:41], v[40:41], v[68:69] op_sel_hi:[1,0]
v_lshlrev_b32 v26, 16, v9
v_lshlrev_b32 v42, 16, v17
v_and_b32 v27, s20, v9
v_and_b32 v43, s20, v17
v_pk_mul_f32 v[26:27], v[26:27], v[60:61] op_sel_hi:[1,0]
v_pk_mul_f32 v[42:43], v[42:43], v[68:69] op_sel_hi:[1,0]
v_lshlrev_b32 v28, 16, v10
v_lshlrev_b32 v44, 16, v18
v_and_b32 v29, s20, v10
v_and_b32 v45, s20, v18
v_pk_mul_f32 v[28:29], v[28:29], v[60:61] op_sel_hi:[1,0]
v_pk_mul_f32 v[44:45], v[44:45], v[68:69] op_sel_hi:[1,0]
v_lshlrev_b32 v30, 16, v11
v_lshlrev_b32 v46, 16, v19
v_and_b32 v31, s20, v11
v_and_b32 v47, s20, v19
v_pk_mul_f32 v[30:31], v[30:31], v[60:61] op_sel_hi:[1,0]
v_pk_mul_f32 v[46:47], v[46:47], v[68:69] op_sel_hi:[1,0]
v_lshlrev_b32 v32, 16, v12
v_lshlrev_b32 v48, 16, v20
v_and_b32 v33, s20, v12
v_and_b32 v49, s20, v20
v_pk_mul_f32 v[32:33], v[32:33], v[60:61] op_sel_hi:[1,0]
v_pk_mul_f32 v[48:49], v[48:49], v[68:69] op_sel_hi:[1,0]
v_lshlrev_b32 v34, 16, v13
v_lshlrev_b32 v50, 16, v21
v_and_b32 v35, s20, v13
v_and_b32 v51, s20, v21
v_pk_mul_f32 v[34:35], v[34:35], v[60:61] op_sel_hi:[1,0]
v_pk_mul_f32 v[50:51], v[50:51], v[68:69] op_sel_hi:[1,0]
v_lshlrev_b32 v36, 16, v14
v_lshlrev_b32 v52, 16, v22
v_and_b32 v37, s20, v14
v_and_b32 v53, s20, v22
v_pk_mul_f32 v[36:37], v[36:37], v[60:61] op_sel_hi:[1,0]
v_pk_mul_f32 v[52:53], v[52:53], v[68:69] op_sel_hi:[1,0]
v_lshlrev_b32 v38, 16, v15
v_lshlrev_b32 v54, 16, v23
v_and_b32 v39, s20, v15
v_and_b32 v55, s20, v23
v_pk_mul_f32 v[38:39], v[38:39], v[60:61] op_sel_hi:[1,0]
v_pk_mul_f32 v[54:55], v[54:55], v[68:69] op_sel_hi:[1,0]
v_cvt_pk_bf16_f32 v8, v24, v25
v_cvt_pk_bf16_f32 v16, v40, v41
v_cvt_pk_bf16_f32 v9, v26, v27
v_cvt_pk_bf16_f32 v17, v42, v43
v_cvt_pk_bf16_f32 v10, v28, v29
v_cvt_pk_bf16_f32 v18, v44, v45
v_cvt_pk_bf16_f32 v11, v30, v31
v_cvt_pk_bf16_f32 v19, v46, v47
v_cvt_pk_bf16_f32 v12, v32, v33
v_cvt_pk_bf16_f32 v20, v48, v49
v_cvt_pk_bf16_f32 v13, v34, v35
v_cvt_pk_bf16_f32 v21, v50, v51
v_cvt_pk_bf16_f32 v14, v36, v37
v_cvt_pk_bf16_f32 v22, v52, v53
v_cvt_pk_bf16_f32 v15, v38, v39
v_cvt_pk_bf16_f32 v23, v54, v55
s_mov_b64 s[24:25], exec
s_mov_b64 exec, s[22:23]
ds_write_b128 v7, v[8:11] offset:0
ds_write_b128 v7, v[12:15] offset:448
ds_write_b128 v7, v[16:19] offset:1824
ds_write_b128 v7, v[20:23] offset:2272
s_mov_b64 exec, s[24:25]
s_waitcnt lgkmcnt(0)
s_barrier
v_and_b32 v8, 1, v0
v_lshrrev_b32 v9, 1, v0
v_and_b32 v9, 1, v9
v_lshlrev_b32 v9, 3, v9
v_add_u32 v8, v8, v9
v_lshrrev_b32 v9, 2, v0
v_and_b32 v9, 1, v9
v_lshlrev_b32 v9, 2, v9
v_add_u32 v8, v8, v9
v_lshrrev_b32 v9, 3, v0
v_and_b32 v9, 1, v9
v_lshlrev_b32 v9, 1, v9
v_add_u32 v8, v8, v9
v_mul_u32_u24 v8, 912, v8
s_mul_i32 s24, s17, 224
s_add_u32 s24, s24, 0
v_lshrrev_b32 v9, 4, v0
v_lshlrev_b32 v10, 4, v9
v_add3_u32 v10, v8, v10, s24
v_lshlrev_b32 v11, 3, v9
v_add3_u32 v11, v8, v11, s24
ds_read_b128 v[16:19], v10 offset:0
ds_read_b128 v[20:23], v10 offset:64
ds_read_b128 v[24:27], v10 offset:128
ds_read_b64 v[28:29], v11 offset:192
s_mul_i32 s24, s18, 28672
s_mul_i32 s25, s17, 7168
s_add_u32 s24, s24, s25
s_add_u32 s24, s24, 70221824
s_mul_i32 s25, s19, 3072
s_add_u32 s25, s25, s24
s_lshl_b32 s26, s19, 9
s_add_u32 s26, s26, s24
s_add_u32 s26, s26, 6144
v_lshlrev_b32 v12, 4, v0
v_lshlrev_b32 v13, 3, v0
s_waitcnt lgkmcnt(3)
buffer_store_dwordx4 v[16:19], v12, s[8:11], s25 offen offset:0 sc1
s_waitcnt lgkmcnt(2)
buffer_store_dwordx4 v[20:23], v12, s[8:11], s25 offen offset:1024 sc1
s_waitcnt lgkmcnt(1)
buffer_store_dwordx4 v[24:27], v12, s[8:11], s25 offen offset:2048 sc1
s_waitcnt lgkmcnt(0)
buffer_store_dwordx2 v[28:29], v13, s[8:11], s26 offen sc1
v_and_b32 v8, 7, v0
v_lshrrev_b32 v9, 2, v8
v_lshlrev_b32 v9, 2, v9
v_and_b32 v10, 3, v0
v_add_u32 v9, v9, v10
v_mul_u32_u24 v9, 912, v9
v_lshrrev_b32 v10, 5, v0
v_lshlrev_b32 v11, 6, v10
v_add_u32 v9, v9, v11
v_lshrrev_b32 v11, 4, v0
v_and_b32 v11, 1, v11
v_lshlrev_b32 v11, 5, v11
v_add_u32 v9, v9, v11
v_lshrrev_b32 v11, 3, v0
v_and_b32 v11, 1, v11
v_lshlrev_b32 v11, 3, v11
v_add3_u32 v9, v9, v11, 0
v_lshlrev_b32 v10, 10, v10
v_lshrrev_b32 v11, 3, v0
v_and_b32 v11, 3, v11
v_lshlrev_b32 v11, 8, v11
v_lshlrev_b32 v8, 4, v8
v_add3_u32 v10, v10, v11, v8
s_lshl_b32 s25, s19, 7
v_add_u32 v10, s25, v10
s_mul_i32 s24, s18, 28672
s_add_u32 s24, s24, 68386816
s_add_u32 s25, s17, 0
s_cmp_ge_u32 s25, 7
s_cselect_b32 s26, 6400, 0
s_lshl_b32 s27, s25, 7
s_add_u32 s26, s26, s27
v_add_u32 v11, s26, v9
s_lshl_b32 s25, s25, 11
s_add_u32 s25, s25, s24
ds_read2_b32 v[32:33], v11 offset0:0 offset1:4
ds_read2_b32 v[34:35], v11 offset0:1 offset1:5
s_waitcnt lgkmcnt(0)
buffer_store_dwordx4 v[32:35], v10, s[8:11], s25 offen sc1
s_nop 1
.Lxt_397:
s_add_u32 s25, s17, 4
s_cmp_ge_u32 s25, 7
s_cselect_b32 s26, 6400, 0
s_lshl_b32 s27, s25, 7
s_add_u32 s26, s26, s27
v_add_u32 v11, s26, v9
s_lshl_b32 s25, s25, 11
s_add_u32 s25, s25, s24
ds_read2_b32 v[32:33], v11 offset0:0 offset1:4
ds_read2_b32 v[34:35], v11 offset0:1 offset1:5
s_waitcnt lgkmcnt(0)
buffer_store_dwordx4 v[32:35], v10, s[8:11], s25 offen sc1
s_nop 1
.Lxt_398:
s_add_u32 s25, s17, 8
s_cmp_ge_u32 s25, 7
s_cselect_b32 s26, 6400, 0
s_lshl_b32 s27, s25, 7
s_add_u32 s26, s26, s27
v_add_u32 v11, s26, v9
s_lshl_b32 s25, s25, 11
s_add_u32 s25, s25, s24
ds_read2_b32 v[32:33], v11 offset0:0 offset1:4
ds_read2_b32 v[34:35], v11 offset0:1 offset1:5
s_waitcnt lgkmcnt(0)
buffer_store_dwordx4 v[32:35], v10, s[8:11], s25 offen sc1
s_nop 1
.Lxt_399:
s_add_u32 s25, s17, 12
s_cmp_ge_u32 s25, 14
s_cbranch_scc1 .Lxt_400
s_cmp_ge_u32 s25, 7
s_cselect_b32 s26, 6400, 0
s_lshl_b32 s27, s25, 7
s_add_u32 s26, s26, s27
v_add_u32 v11, s26, v9
s_lshl_b32 s25, s25, 11
s_add_u32 s25, s25, s24
ds_read2_b32 v[32:33], v11 offset0:0 offset1:4
ds_read2_b32 v[34:35], v11 offset0:1 offset1:5
s_waitcnt lgkmcnt(0)
buffer_store_dwordx4 v[32:35], v10, s[8:11], s25 offen sc1
s_nop 1
.Lxt_400:
s_lshl_b32 s25, s17, 6
v_add_u32 v12, s25, v0
s_lshr_b32 s24, s59, 1
s_mul_i32 s24, s24, 3584
s_and_b32 s26, s59, 1
s_lshl_b32 s26, s26, 2
s_add_u32 s24, s24, s26
s_add_u32 s24, s24, 118173696
v_lshlrev_b32 v13, 6, v12
v_add_u32 v14, s24, v13
s_lshl_b32 s24, s59, 2
s_add_u32 s24, s24, 118183936
v_add_u32 v15, s24, v13
v_mov_b32 v16, 0x10000000
s_cmp_lt_u32 s59, 8
s_cselect_b32 s24, 56, 0
v_cmp_gt_u32 vcc, s24, v12
s_cmp_lt_u32 s59, 4
s_cselect_b32 s24, 16, 0
v_cndmask_b32 v14, v16, v14, vcc
v_subrev_u32 v13, 64, v12
v_cmp_gt_u32 vcc, s24, v13
v_mov_b32 v16, 1
s_nop 0
v_cndmask_b32 v14, v14, v15, vcc
s_waitcnt vmcnt(0) lgkmcnt(0)
s_barrier
buffer_store_dword v16, v14, s[8:11], 0 offen sc1
s_lshl_b32 s24, s59, 2
s_add_u32 s26, s24, 118150144
s_add_u32 s24, s24, 118165504
s_lshl_b32 s25, s17, 6
v_add_u32 v4, s25, v0
v_cmp_gt_u32 vcc, 8, v4
v_lshlrev_b32 v4, 10, v4
v_mov_b32 v5, 0x10000000
v_cndmask_b32 v4, v5, v4, vcc
v_mov_b32 v5, 1
buffer_store_dword v5, v4, s[8:11], s24 offen sc1
v_mov_b32 v4, 0x10000000
s_lshl_b32 s25, s17, 6
v_add_u32 v6, s25, v0
v_cmp_eq_u32 vcc, 0, v6
s_nop 1
v_cndmask_b32 v4, v4, 0, vcc
buffer_store_dword v5, v4, s[8:11], s26 offen sc1
.Lnln_391:
s_cmp_lt_u32 s58, 160
s_cbranch_scc1 .Ldwl_401
s_cmp_lt_u32 s58, 176
s_cbranch_scc1 .Ldwl_402
s_cmp_lt_u32 s58, 208
s_cbranch_scc1 .Ldwl_401
.Ldwl_402:
s_and_b32 s18, s58, 3
s_lshr_b32 s21, s58, 2
s_cmp_ge_u32 s58, 64
s_cbranch_scc1 .Ldq_403
s_and_b32 s21, s58, 31
s_lshr_b32 s21, s21, 1
s_and_b32 s18, s58, 1
s_cmp_lt_u32 s58, 32
s_cselect_b32 s16, 2, 0
s_add_u32 s18, s18, s16
.Ldq_403:
s_lshr_b32 s16, s21, 2
s_and_b32 s19, s21, 3
v_lshlrev_b32 v1, 4, v0
s_lshl_b32 s24, s16, 2
s_add_u32 s24, s24, s19
s_lshl_b32 s25, s24, 2
s_add_u32 s25, s25, s17
s_mul_i32 s26, s25, 28672
s_add_u32 s26, s26, 6422528
buffer_load_dwordx4 a[0:3], v1, s[8:11], s26 offen offset:0
buffer_load_dwordx4 a[4:7], v1, s[8:11], s26 offen offset:1024
buffer_load_dwordx4 a[8:11], v1, s[8:11], s26 offen offset:2048
buffer_load_dwordx4 a[12:15], v1, s[8:11], s26 offen offset:3072
s_add_u32 s26, s26, 4096
buffer_load_dwordx4 a[16:19], v1, s[8:11], s26 offen offset:0
buffer_load_dwordx4 a[20:23], v1, s[8:11], s26 offen offset:1024
buffer_load_dwordx4 a[24:27], v1, s[8:11], s26 offen offset:2048
buffer_load_dwordx4 a[28:31], v1, s[8:11], s26 offen offset:3072
s_add_u32 s26, s26, 4096
buffer_load_dwordx4 a[32:35], v1, s[8:11], s26 offen offset:0
buffer_load_dwordx4 a[36:39], v1, s[8:11], s26 offen offset:1024
buffer_load_dwordx4 a[40:43], v1, s[8:11], s26 offen offset:2048
buffer_load_dwordx4 a[44:47], v1, s[8:11], s26 offen offset:3072
s_add_u32 s26, s26, 4096
buffer_load_dwordx4 a[48:51], v1, s[8:11], s26 offen offset:0
buffer_load_dwordx4 a[52:55], v1, s[8:11], s26 offen offset:1024
buffer_load_dwordx4 a[56:59], v1, s[8:11], s26 offen offset:2048
buffer_load_dwordx4 a[60:63], v1, s[8:11], s26 offen offset:3072
s_add_u32 s26, s26, 4096
buffer_load_dwordx4 a[64:67], v1, s[8:11], s26 offen offset:0
buffer_load_dwordx4 a[68:71], v1, s[8:11], s26 offen offset:1024
buffer_load_dwordx4 a[72:75], v1, s[8:11], s26 offen offset:2048
buffer_load_dwordx4 a[76:79], v1, s[8:11], s26 offen offset:3072
s_add_u32 s26, s26, 4096
buffer_load_dwordx4 a[80:83], v1, s[8:11], s26 offen offset:0
buffer_load_dwordx4 a[84:87], v1, s[8:11], s26 offen offset:1024
buffer_load_dwordx4 a[88:91], v1, s[8:11], s26 offen offset:2048
buffer_load_dwordx4 a[92:95], v1, s[8:11], s26 offen offset:3072
s_add_u32 s26, s26, 4096
buffer_load_dwordx4 a[96:99], v1, s[8:11], s26 offen offset:0
buffer_load_dwordx4 a[100:103], v1, s[8:11], s26 offen offset:1024
buffer_load_dwordx4 a[104:107], v1, s[8:11], s26 offen offset:2048
buffer_load_dwordx4 a[108:111], v1, s[8:11], s26 offen offset:3072
s_add_u32 s26, s26, 4096
.Ldwl_401:
s_and_b32 s18, s58, 3
s_lshr_b32 s21, s58, 2
s_cmp_ge_u32 s58, 64
s_cbranch_scc1 .Ldq_408
s_and_b32 s21, s58, 31
s_lshr_b32 s21, s21, 1
s_and_b32 s18, s58, 1
s_cmp_lt_u32 s58, 32
s_cselect_b32 s16, 2, 0
s_add_u32 s18, s18, s16
.Ldq_408:
s_lshr_b32 s16, s21, 2
s_and_b32 s19, s21, 3
s_mul_i32 s30, s18, 56
s_add_u32 s30, s30, s21
s_lshl_b32 s30, s30, 6
s_add_u32 s30, s30, 118173696
s_cmp_lg_u32 s17, 0
s_cbranch_scc1 .Lww_409
s_mov_b32 s24, s30
v_lshlrev_b32 v248, 2, v0
v_mov_b32 v252, 0x10000000
v_cmp_gt_u32 vcc, 2, v0
s_mov_b32 s25, s39
s_nop 0
v_cndmask_b32 v248, v252, v248, vcc
.Lwr_410:
buffer_load_dword v252, v248, s[8:11], s24 offen sc1
s_waitcnt vmcnt(0)
v_cmp_eq_u32 vcc, 1, v252
s_nop 1
s_bcnt1_i32_b64 s26, vcc
s_cmp_eq_u32 s26, 2
s_cbranch_scc1 .Lwo_411
s_sleep 1
s_sub_u32 s25, s25, 1
s_cbranch_scc0 .Lwr_410
s_mov_b32 s39, 0
.Lwo_411:
.Lww_409:
s_barrier
v_lshlrev_b32 v1, 4, v0
s_mul_i32 s33, s18, 28672
s_mul_i32 s38, s17, 7168
s_add_u32 s33, s33, s38
s_add_u32 s33, s33, 68386816
s_add_u32 m0, s38, 0
s_add_u32 s27, s33, 0
buffer_load_dwordx4 v1, s[8:11], s27 offen lds
s_add_u32 m0, s38, 1024
s_add_u32 s27, s33, 1024
buffer_load_dwordx4 v1, s[8:11], s27 offen lds
s_add_u32 m0, s38, 2048
s_add_u32 s27, s33, 2048
buffer_load_dwordx4 v1, s[8:11], s27 offen lds
s_add_u32 m0, s38, 3072
s_add_u32 s27, s33, 3072
buffer_load_dwordx4 v1, s[8:11], s27 offen lds
s_add_u32 m0, s38, 4096
s_add_u32 s27, s33, 4096
buffer_load_dwordx4 v1, s[8:11], s27 offen lds
s_add_u32 m0, s38, 5120
s_add_u32 s27, s33, 5120
buffer_load_dwordx4 v1, s[8:11], s27 offen lds
s_add_u32 m0, s38, 6144
s_add_u32 s27, s33, 6144
buffer_load_dwordx4 v1, s[8:11], s27 offen lds
s_lshl_b32 s24, s16, 2
s_add_u32 s24, s24, s19
v_lshrrev_b32 v5, 5, v0
v_lshlrev_b32 v5, 11, v5
v_and_b32 v6, 15, v0
v_lshlrev_b32 v6, 4, v6
v_lshrrev_b32 v7, 4, v0
v_and_b32 v7, 1, v7
v_lshlrev_b32 v7, 8, v7
v_add3_u32 v5, v5, v6, v7
s_lshr_b32 s25, s17, 1
s_lshl_b32 s25, s25, 10
s_and_b32 s26, s17, 1
s_lshl_b32 s26, s26, 9
s_add_u32 s25, s25, s26
v_add_u32 v3, s25, v5
s_mul_i32 s34, s18, 458752
s_lshl_b32 s24, s24, 13
s_add_u32 s34, s34, s24
s_add_u32 s34, s34, 72056832
s_add_u32 s39, s34, 4096
s_mul_i32 s40, s18, 224
s_lshl_b32 s25, s16, 4
s_add_u32 s40, s40, s25
s_lshl_b32 s25, s19, 2
s_add_u32 s40, s40, s25
s_add_u32 s40, s40, 118091776
s_lshl_b32 s25, s17, 6
v_add_u32 v6, s25, v0
v_mov_b32 v7, 0x10000000
v_cmp_eq_u32 vcc, 0, v6
v_mov_b32 v81, 1
s_nop 0
v_cndmask_b32 v80, v7, 0, vcc
s_waitcnt vmcnt(0) lgkmcnt(0)
s_barrier
ds_read_b128 v[84:87], v1 offset:0
ds_read_b128 v[88:91], v1 offset:14336
ds_read_b128 v[92:95], v1 offset:1024
ds_read_b128 v[96:99], v1 offset:15360
ds_read_b128 v[100:103], v1 offset:2048
ds_read_b128 v[104:107], v1 offset:16384
ds_read_b128 v[108:111], v1 offset:3072
ds_read_b128 v[112:115], v1 offset:17408
ds_read_b128 v[116:119], v1 offset:4096
ds_read_b128 v[120:123], v1 offset:18432
ds_read_b128 v[124:127], v1 offset:5120
ds_read_b128 v[128:131], v1 offset:19456
s_waitcnt lgkmcnt(10)
v_mfma_f32_16x16x32_bf16 v[40:43], v[84:87], a[0:3], 0
ds_read_b128 v[132:135], v1 offset:6144
ds_read_b128 v[136:139], v1 offset:20480
v_mfma_f32_16x16x32_bf16 v[44:47], v[88:91], a[0:3], 0
v_mfma_f32_16x16x32_bf16 v[48:51], v[84:87], a[56:59], 0
v_mfma_f32_16x16x32_bf16 v[52:55], v[88:91], a[56:59], 0
s_waitcnt lgkmcnt(10)
v_mfma_f32_16x16x32_bf16 v[40:43], v[92:95], a[4:7], v[40:43]
ds_read_b128 v[140:143], v1 offset:7168
ds_read_b128 v[144:147], v1 offset:21504
v_mfma_f32_16x16x32_bf16 v[44:47], v[96:99], a[4:7], v[44:47]
v_mfma_f32_16x16x32_bf16 v[48:51], v[92:95], a[60:63], v[48:51]
v_mfma_f32_16x16x32_bf16 v[52:55], v[96:99], a[60:63], v[52:55]
s_waitcnt lgkmcnt(10)
v_mfma_f32_16x16x32_bf16 v[40:43], v[100:103], a[8:11], v[40:43]
ds_read_b128 v[148:151], v1 offset:8192
ds_read_b128 v[152:155], v1 offset:22528
v_mfma_f32_16x16x32_bf16 v[44:47], v[104:107], a[8:11], v[44:47]
v_mfma_f32_16x16x32_bf16 v[48:51], v[100:103], a[64:67], v[48:51]
v_mfma_f32_16x16x32_bf16 v[52:55], v[104:107], a[64:67], v[52:55]
s_waitcnt lgkmcnt(10)
v_mfma_f32_16x16x32_bf16 v[40:43], v[108:111], a[12:15], v[40:43]
ds_read_b128 v[156:159], v1 offset:9216
ds_read_b128 v[160:163], v1 offset:23552
v_mfma_f32_16x16x32_bf16 v[44:47], v[112:115], a[12:15], v[44:47]
v_mfma_f32_16x16x32_bf16 v[48:51], v[108:111], a[68:71], v[48:51]
v_mfma_f32_16x16x32_bf16 v[52:55], v[112:115], a[68:71], v[52:55]
s_waitcnt lgkmcnt(10)
v_mfma_f32_16x16x32_bf16 v[40:43], v[116:119], a[16:19], v[40:43]
ds_read_b128 v[164:167], v1 offset:10240
ds_read_b128 v[168:171], v1 offset:24576
v_mfma_f32_16x16x32_bf16 v[44:47], v[120:123], a[16:19], v[44:47]
v_mfma_f32_16x16x32_bf16 v[48:51], v[116:119], a[72:75], v[48:51]
v_mfma_f32_16x16x32_bf16 v[52:55], v[120:123], a[72:75], v[52:55]
s_waitcnt lgkmcnt(10)
v_mfma_f32_16x16x32_bf16 v[40:43], v[124:127], a[20:23], v[40:43]
ds_read_b128 v[172:175], v1 offset:11264
ds_read_b128 v[176:179], v1 offset:25600
v_mfma_f32_16x16x32_bf16 v[44:47], v[128:131], a[20:23], v[44:47]
v_mfma_f32_16x16x32_bf16 v[48:51], v[124:127], a[76:79], v[48:51]
v_mfma_f32_16x16x32_bf16 v[52:55], v[128:131], a[76:79], v[52:55]
s_waitcnt lgkmcnt(10)
v_mfma_f32_16x16x32_bf16 v[40:43], v[132:135], a[24:27], v[40:43]
ds_read_b128 v[180:183], v1 offset:12288
ds_read_b128 v[184:187], v1 offset:26624
v_mfma_f32_16x16x32_bf16 v[44:47], v[136:139], a[24:27], v[44:47]
v_mfma_f32_16x16x32_bf16 v[48:51], v[132:135], a[80:83], v[48:51]
v_mfma_f32_16x16x32_bf16 v[52:55], v[136:139], a[80:83], v[52:55]
s_waitcnt lgkmcnt(10)
v_mfma_f32_16x16x32_bf16 v[40:43], v[140:143], a[28:31], v[40:43]
ds_read_b128 v[188:191], v1 offset:13312
ds_read_b128 v[192:195], v1 offset:27648
v_mfma_f32_16x16x32_bf16 v[44:47], v[144:147], a[28:31], v[44:47]
v_mfma_f32_16x16x32_bf16 v[48:51], v[140:143], a[84:87], v[48:51]
v_mfma_f32_16x16x32_bf16 v[52:55], v[144:147], a[84:87], v[52:55]
s_waitcnt lgkmcnt(10)
v_mfma_f32_16x16x32_bf16 v[40:43], v[148:151], a[32:35], v[40:43]
v_mfma_f32_16x16x32_bf16 v[44:47], v[152:155], a[32:35], v[44:47]
v_mfma_f32_16x16x32_bf16 v[48:51], v[148:151], a[88:91], v[48:51]
v_mfma_f32_16x16x32_bf16 v[52:55], v[152:155], a[88:91], v[52:55]
s_waitcnt lgkmcnt(8)
v_mfma_f32_16x16x32_bf16 v[40:43], v[156:159], a[36:39], v[40:43]
v_mfma_f32_16x16x32_bf16 v[44:47], v[160:163], a[36:39], v[44:47]
v_mfma_f32_16x16x32_bf16 v[48:51], v[156:159], a[92:95], v[48:51]
v_mfma_f32_16x16x32_bf16 v[52:55], v[160:163], a[92:95], v[52:55]
s_waitcnt lgkmcnt(6)
v_mfma_f32_16x16x32_bf16 v[40:43], v[164:167], a[40:43], v[40:43]
v_mfma_f32_16x16x32_bf16 v[44:47], v[168:171], a[40:43], v[44:47]
v_mfma_f32_16x16x32_bf16 v[48:51], v[164:167], a[96:99], v[48:51]
v_mfma_f32_16x16x32_bf16 v[52:55], v[168:171], a[96:99], v[52:55]
s_waitcnt lgkmcnt(4)
v_mfma_f32_16x16x32_bf16 v[40:43], v[172:175], a[44:47], v[40:43]
v_mfma_f32_16x16x32_bf16 v[44:47], v[176:179], a[44:47], v[44:47]
v_mfma_f32_16x16x32_bf16 v[48:51], v[172:175], a[100:103], v[48:51]
v_mfma_f32_16x16x32_bf16 v[52:55], v[176:179], a[100:103], v[52:55]
s_waitcnt lgkmcnt(2)
v_mfma_f32_16x16x32_bf16 v[40:43], v[180:183], a[48:51], v[40:43]
v_mfma_f32_16x16x32_bf16 v[44:47], v[184:187], a[48:51], v[44:47]
v_mfma_f32_16x16x32_bf16 v[48:51], v[180:183], a[104:107], v[48:51]
v_mfma_f32_16x16x32_bf16 v[52:55], v[184:187], a[104:107], v[52:55]
s_waitcnt lgkmcnt(0)
v_mfma_f32_16x16x32_bf16 v[40:43], v[188:191], a[52:55], v[40:43]
v_mfma_f32_16x16x32_bf16 v[44:47], v[192:195], a[52:55], v[44:47]
v_mfma_f32_16x16x32_bf16 v[48:51], v[188:191], a[108:111], v[48:51]
v_mfma_f32_16x16x32_bf16 v[52:55], v[192:195], a[108:111], v[52:55]
s_nop 7
v_cvt_pk_bf16_f32 v72, v40, v41
v_cvt_pk_bf16_f32 v73, v42, v43
v_cvt_pk_bf16_f32 v74, v44, v45
v_cvt_pk_bf16_f32 v75, v46, v47
buffer_store_dwordx4 v[72:75], v3, s[8:11], s34 offen sc1
v_cvt_pk_bf16_f32 v76, v48, v49
v_cvt_pk_bf16_f32 v77, v50, v51
v_cvt_pk_bf16_f32 v78, v52, v53
v_cvt_pk_bf16_f32 v79, v54, v55
buffer_store_dwordx4 v[76:79], v3, s[8:11], s39 offen sc1
s_waitcnt vmcnt(0)
s_barrier
buffer_store_dword v81, v80, s[8:11], s40 offen sc1
s_mov_b32 s39, 8000
s_and_b32 s30, s58, 7
s_lshl_b32 s30, s30, 10
s_add_u32 s30, s30, 118165504
s_cmp_lg_u32 s17, 0
s_cbranch_scc1 .Lww_412
s_mov_b32 s24, s30
v_lshlrev_b32 v248, 4, v0
v_mov_b32 v252, 0x10000000
v_cmp_gt_u32 vcc, 32, v0
s_mov_b32 s25, s39
s_nop 0
v_cndmask_b32 v248, v252, v248, vcc
.Lwr_413:
buffer_load_dwordx4 v[252:255], v248, s[8:11], s24 offen sc1
s_waitcnt vmcnt(0)
s_mov_b32 s26, 0
v_cmp_eq_u32 vcc, 1, v252
s_nop 1
s_and_b32 vcc_lo, vcc_lo, 0xffffffff
s_and_b32 vcc_hi, vcc_hi, 0x0
s_bcnt1_i32_b64 s27, vcc
s_add_u32 s26, s26, s27
v_cmp_eq_u32 vcc, 1, v253
s_nop 1
s_and_b32 vcc_lo, vcc_lo, 0xffffffff
s_and_b32 vcc_hi, vcc_hi, 0x0
s_bcnt1_i32_b64 s27, vcc
s_add_u32 s26, s26, s27
v_cmp_eq_u32 vcc, 1, v254
s_nop 1
s_and_b32 vcc_lo, vcc_lo, 0xffffffff
s_and_b32 vcc_hi, vcc_hi, 0x0
s_bcnt1_i32_b64 s27, vcc
s_add_u32 s26, s26, s27
v_cmp_eq_u32 vcc, 1, v255
s_nop 1
s_and_b32 vcc_lo, vcc_lo, 0xffffffff
s_and_b32 vcc_hi, vcc_hi, 0x0
s_bcnt1_i32_b64 s27, vcc
s_add_u32 s26, s26, s27
s_cmp_eq_u32 s26, 128
s_cbranch_scc1 .Lwo_414
s_sleep 2
s_sub_u32 s25, s25, 1
s_cbranch_scc0 .Lwr_413
s_mov_b32 s39, 0
.Lwo_414:
.Lww_412:
s_barrier
s_and_b32 s18, s58, 3
s_lshr_b32 s21, s58, 2
s_cmp_ge_u32 s58, 64
s_cbranch_scc1 .Ldq_415
s_and_b32 s21, s58, 31
s_lshr_b32 s21, s21, 1
s_and_b32 s18, s58, 1
s_cmp_lt_u32 s58, 32
s_cselect_b32 s16, 2, 0
s_add_u32 s18, s18, s16
.Ldq_415:
s_lshr_b32 s16, s21, 2
s_and_b32 s19, s21, 3
v_lshlrev_b32 v1, 4, v0
s_lshl_b32 s24, s16, 2
s_add_u32 s24, s24, s19
s_lshl_b32 s25, s24, 2
s_add_u32 s25, s25, s17
s_mul_i32 s32, s25, 28672
s_add_u32 s32, s32, 6422528
s_mul_i32 s33, s18, 28672
s_mul_i32 s26, s17, 7168
s_add_u32 s33, s33, s26
s_add_u32 s33, s33, 68386816
s_mov_b32 s38, s26
s_mov_b32 s36, s38
s_add_u32 m0, s36, 0
s_add_u32 s27, s33, 0
buffer_load_dwordx4 v1, s[8:11], s27 offen lds
s_add_u32 m0, s36, 1024
s_add_u32 s27, s33, 1024
buffer_load_dwordx4 v1, s[8:11], s27 offen lds
s_add_u32 m0, s36, 2048
s_add_u32 s27, s33, 2048
buffer_load_dwordx4 v1, s[8:11], s27 offen lds
s_add_u32 m0, s36, 3072
s_add_u32 s27, s33, 3072
buffer_load_dwordx4 v1, s[8:11], s27 offen lds
s_add_u32 m0, s36, 4096
s_add_u32 s27, s33, 4096
buffer_load_dwordx4 v1, s[8:11], s27 offen lds
s_add_u32 m0, s36, 5120
s_add_u32 s27, s33, 5120
buffer_load_dwordx4 v1, s[8:11], s27 offen lds
s_add_u32 m0, s36, 6144
s_add_u32 s27, s33, 6144
buffer_load_dwordx4 v1, s[8:11], s27 offen lds
s_add_u32 s33, s33, 114688
s_add_u32 s36, s38, 28672
s_add_u32 m0, s36, 0
s_add_u32 s27, s33, 0
buffer_load_dwordx4 v1, s[8:11], s27 offen lds
s_add_u32 m0, s36, 1024
s_add_u32 s27, s33, 1024
buffer_load_dwordx4 v1, s[8:11], s27 offen lds
s_add_u32 m0, s36, 2048
s_add_u32 s27, s33, 2048
buffer_load_dwordx4 v1, s[8:11], s27 offen lds
s_add_u32 m0, s36, 3072
s_add_u32 s27, s33, 3072
buffer_load_dwordx4 v1, s[8:11], s27 offen lds
s_add_u32 m0, s36, 4096
s_add_u32 s27, s33, 4096
buffer_load_dwordx4 v1, s[8:11], s27 offen lds
s_add_u32 m0, s36, 5120
s_add_u32 s27, s33, 5120
buffer_load_dwordx4 v1, s[8:11], s27 offen lds
s_add_u32 m0, s36, 6144
s_add_u32 s27, s33, 6144
buffer_load_dwordx4 v1, s[8:11], s27 offen lds
s_add_u32 s33, s33, 114688
s_add_u32 s36, s38, 57344
v_lshrrev_b32 v5, 5, v0
v_lshlrev_b32 v5, 11, v5
v_and_b32 v6, 15, v0
v_lshlrev_b32 v6, 4, v6
v_lshrrev_b32 v7, 4, v0
v_and_b32 v7, 1, v7
v_lshlrev_b32 v7, 8, v7
v_add3_u32 v5, v5, v6, v7
s_lshr_b32 s25, s17, 1
s_lshl_b32 s25, s25, 10
s_and_b32 s26, s17, 1
s_lshl_b32 s26, s26, 9
s_add_u32 s25, s25, s26
v_add_u32 v3, s25, v5
s_mul_i32 s34, s18, 458752
s_lshl_b32 s24, s24, 13
s_add_u32 s34, s34, s24
s_add_u32 s34, s34, 72056832
v_mov_b32 v2, v1
s_mul_i32 s40, s18, 224
s_lshl_b32 s25, s16, 4
s_add_u32 s40, s40, s25
s_lshl_b32 s25, s19, 2
s_add_u32 s40, s40, s25
s_add_u32 s40, s40, 118091776
s_lshl_b32 s25, s17, 6
v_add_u32 v6, s25, v0
v_mov_b32 v7, 0x10000000
v_cmp_eq_u32 vcc, 0, v6
v_mov_b32 v81, 1
s_nop 0
v_cndmask_b32 v80, v7, 0, vcc
v_add_u32 v4, 28672, v1
s_mov_b32 s35, 28672
s_mov_b32 s37, 0
s_waitcnt vmcnt(7)
s_barrier
ds_read_b128 v[8:11], v2 offset:0
ds_read_b128 v[12:15], v2 offset:14336
ds_read_b128 v[16:19], v2 offset:1024
ds_read_b128 v[20:23], v2 offset:15360
s_waitcnt vmcnt(0)
.Ldloop_416:
s_waitcnt lgkmcnt(2)
v_mfma_f32_16x16x32_bf16 v[40:43], v[8:11], a[0:3], 0
ds_read_b128 v[24:27], v2 offset:2048
v_mfma_f32_16x16x32_bf16 v[44:47], v[12:15], a[0:3], 0
ds_read_b128 v[28:31], v2 offset:16384
v_mfma_f32_16x16x32_bf16 v[48:51], v[8:11], a[56:59], 0
v_mfma_f32_16x16x32_bf16 v[52:55], v[12:15], a[56:59], 0
s_waitcnt lgkmcnt(2)
v_mfma_f32_16x16x32_bf16 v[40:43], v[16:19], a[4:7], v[40:43]
ds_read_b128 v[32:35], v2 offset:3072
ds_read_b128 v[36:39], v2 offset:17408
v_mfma_f32_16x16x32_bf16 v[44:47], v[20:23], a[4:7], v[44:47]
v_cvt_pk_bf16_f32 v72, v56, v57
v_cvt_pk_bf16_f32 v73, v58, v59
v_mfma_f32_16x16x32_bf16 v[48:51], v[16:19], a[60:63], v[48:51]
v_cvt_pk_bf16_f32 v74, v60, v61
v_mfma_f32_16x16x32_bf16 v[52:55], v[20:23], a[60:63], v[52:55]
v_cvt_pk_bf16_f32 v75, v62, v63
s_waitcnt lgkmcnt(2)
v_mfma_f32_16x16x32_bf16 v[40:43], v[24:27], a[8:11], v[40:43]
ds_read_b128 v[8:11], v2 offset:4096
ds_read_b128 v[12:15], v2 offset:18432
v_mfma_f32_16x16x32_bf16 v[44:47], v[28:31], a[8:11], v[44:47]
v_cvt_pk_bf16_f32 v76, v64, v65
v_cvt_pk_bf16_f32 v77, v66, v67
v_mfma_f32_16x16x32_bf16 v[48:51], v[24:27], a[64:67], v[48:51]
v_cvt_pk_bf16_f32 v78, v68, v69
v_mfma_f32_16x16x32_bf16 v[52:55], v[28:31], a[64:67], v[52:55]
v_cvt_pk_bf16_f32 v79, v70, v71
s_waitcnt lgkmcnt(2)
v_mfma_f32_16x16x32_bf16 v[40:43], v[32:35], a[12:15], v[40:43]
ds_read_b128 v[16:19], v2 offset:5120
ds_read_b128 v[20:23], v2 offset:19456
s_cmp_eq_u32 s37, 0
s_cbranch_scc1 .Ldns_417
buffer_store_dwordx4 v[72:75], v3, s[8:11], s34 offen sc1
s_add_u32 s39, s34, 4096
buffer_store_dwordx4 v[76:79], v3, s[8:11], s39 offen sc1
s_add_u32 s34, s34, 1835008
.Ldns_417:
v_mfma_f32_16x16x32_bf16 v[44:47], v[36:39], a[12:15], v[44:47]
v_mfma_f32_16x16x32_bf16 v[48:51], v[32:35], a[68:71], v[48:51]
v_mfma_f32_16x16x32_bf16 v[52:55], v[36:39], a[68:71], v[52:55]
s_waitcnt lgkmcnt(2)
v_mfma_f32_16x16x32_bf16 v[40:43], v[8:11], a[16:19], v[40:43]
ds_read_b128 v[24:27], v2 offset:6144
v_mfma_f32_16x16x32_bf16 v[44:47], v[12:15], a[16:19], v[44:47]
ds_read_b128 v[28:31], v2 offset:20480
v_mfma_f32_16x16x32_bf16 v[48:51], v[8:11], a[72:75], v[48:51]
v_mfma_f32_16x16x32_bf16 v[52:55], v[12:15], a[72:75], v[52:55]
s_waitcnt lgkmcnt(2)
v_mfma_f32_16x16x32_bf16 v[40:43], v[16:19], a[20:23], v[40:43]
ds_read_b128 v[32:35], v2 offset:7168
v_mfma_f32_16x16x32_bf16 v[44:47], v[20:23], a[20:23], v[44:47]
ds_read_b128 v[36:39], v2 offset:21504
v_mfma_f32_16x16x32_bf16 v[48:51], v[16:19], a[76:79], v[48:51]
v_mfma_f32_16x16x32_bf16 v[52:55], v[20:23], a[76:79], v[52:55]
s_waitcnt lgkmcnt(2)
v_mfma_f32_16x16x32_bf16 v[40:43], v[24:27], a[24:27], v[40:43]
ds_read_b128 v[8:11], v2 offset:8192
v_mfma_f32_16x16x32_bf16 v[44:47], v[28:31], a[24:27], v[44:47]
ds_read_b128 v[12:15], v2 offset:22528
v_mfma_f32_16x16x32_bf16 v[48:51], v[24:27], a[80:83], v[48:51]
v_mfma_f32_16x16x32_bf16 v[52:55], v[28:31], a[80:83], v[52:55]
s_waitcnt lgkmcnt(2)
v_mfma_f32_16x16x32_bf16 v[40:43], v[32:35], a[28:31], v[40:43]
ds_read_b128 v[16:19], v2 offset:9216
ds_read_b128 v[20:23], v2 offset:23552
s_waitcnt vmcnt(2)
s_barrier
s_cmp_eq_u32 s37, 0
s_cbranch_scc1 .Ldfl_418
buffer_store_dword v81, v80, s[8:11], s40 offen sc1
s_add_u32 s40, s40, 896
.Ldfl_418:
v_mfma_f32_16x16x32_bf16 v[44:47], v[36:39], a[28:31], v[44:47]
v_mfma_f32_16x16x32_bf16 v[48:51], v[32:35], a[84:87], v[48:51]
v_mfma_f32_16x16x32_bf16 v[52:55], v[36:39], a[84:87], v[52:55]
s_add_u32 s24, s37, 2
s_cmp_ge_u32 s24, 16
s_cselect_b32 s28, 0x10000000, 0
v_add_u32 v5, s28, v1
s_waitcnt lgkmcnt(2)
v_mfma_f32_16x16x32_bf16 v[40:43], v[8:11], a[32:35], v[40:43]
ds_read_b128 v[24:27], v2 offset:10240
ds_read_b128 v[28:31], v2 offset:24576
v_mfma_f32_16x16x32_bf16 v[44:47], v[12:15], a[32:35], v[44:47]
s_add_u32 m0, s36, 0
v_mfma_f32_16x16x32_bf16 v[48:51], v[8:11], a[88:91], v[48:51]
s_add_u32 s27, s33, 0
v_mfma_f32_16x16x32_bf16 v[52:55], v[12:15], a[88:91], v[52:55]
buffer_load_dwordx4 v5, s[8:11], s27 offen lds
s_waitcnt lgkmcnt(2)
v_mfma_f32_16x16x32_bf16 v[40:43], v[16:19], a[36:39], v[40:43]
ds_read_b128 v[32:35], v2 offset:11264
ds_read_b128 v[36:39], v2 offset:25600
v_mfma_f32_16x16x32_bf16 v[44:47], v[20:23], a[36:39], v[44:47]
s_add_u32 m0, s36, 1024
v_mfma_f32_16x16x32_bf16 v[48:51], v[16:19], a[92:95], v[48:51]
s_add_u32 s27, s33, 1024
v_mfma_f32_16x16x32_bf16 v[52:55], v[20:23], a[92:95], v[52:55]
buffer_load_dwordx4 v5, s[8:11], s27 offen lds
s_waitcnt lgkmcnt(2)
v_mfma_f32_16x16x32_bf16 v[40:43], v[24:27], a[40:43], v[40:43]
ds_read_b128 v[8:11], v2 offset:12288
ds_read_b128 v[12:15], v2 offset:26624
v_mfma_f32_16x16x32_bf16 v[44:47], v[28:31], a[40:43], v[44:47]
s_add_u32 m0, s36, 2048
v_mfma_f32_16x16x32_bf16 v[48:51], v[24:27], a[96:99], v[48:51]
s_add_u32 s27, s33, 2048
v_mfma_f32_16x16x32_bf16 v[52:55], v[28:31], a[96:99], v[52:55]
buffer_load_dwordx4 v5, s[8:11], s27 offen lds
s_waitcnt lgkmcnt(2)
v_mfma_f32_16x16x32_bf16 v[40:43], v[32:35], a[44:47], v[40:43]
ds_read_b128 v[16:19], v2 offset:13312
ds_read_b128 v[20:23], v2 offset:27648
v_mfma_f32_16x16x32_bf16 v[44:47], v[36:39], a[44:47], v[44:47]
s_add_u32 m0, s36, 3072
v_mfma_f32_16x16x32_bf16 v[48:51], v[32:35], a[100:103], v[48:51]
s_add_u32 s27, s33, 3072
v_mfma_f32_16x16x32_bf16 v[52:55], v[36:39], a[100:103], v[52:55]
buffer_load_dwordx4 v5, s[8:11], s27 offen lds
s_waitcnt lgkmcnt(2)
v_mfma_f32_16x16x32_bf16 v[40:43], v[8:11], a[48:51], v[40:43]
ds_read_b128 v[24:27], v4 offset:0
ds_read_b128 v[28:31], v4 offset:14336
v_mfma_f32_16x16x32_bf16 v[44:47], v[12:15], a[48:51], v[44:47]
s_add_u32 m0, s36, 4096
v_mfma_f32_16x16x32_bf16 v[48:51], v[8:11], a[104:107], v[48:51]
s_add_u32 s27, s33, 4096
v_mfma_f32_16x16x32_bf16 v[52:55], v[12:15], a[104:107], v[52:55]
buffer_load_dwordx4 v5, s[8:11], s27 offen lds
s_waitcnt lgkmcnt(2)
v_mfma_f32_16x16x32_bf16 v[40:43], v[16:19], a[52:55], v[40:43]
ds_read_b128 v[32:35], v4 offset:1024
ds_read_b128 v[36:39], v4 offset:15360
v_mfma_f32_16x16x32_bf16 v[44:47], v[20:23], a[52:55], v[44:47]
s_add_u32 m0, s36, 5120
s_add_u32 s27, s33, 5120
v_mfma_f32_16x16x32_bf16 v[48:51], v[16:19], a[108:111], v[48:51]
buffer_load_dwordx4 v5, s[8:11], s27 offen lds
s_add_u32 m0, s36, 6144
v_mfma_f32_16x16x32_bf16 v[52:55], v[20:23], a[108:111], v[52:55]
s_add_u32 s27, s33, 6144
buffer_load_dwordx4 v5, s[8:11], s27 offen lds
s_add_u32 s33, s33, 114688
v_mov_b32 v2, v4
s_add_u32 s35, s35, 28672
s_cmp_ge_u32 s35, 86016
s_cselect_b32 s35, 0, s35
v_add_u32 v4, s35, v1
s_add_u32 s24, s35, 28672
s_cmp_ge_u32 s24, 86016
s_cselect_b32 s24, 0, s24
s_add_u32 s36, s24, s38
s_waitcnt lgkmcnt(2)
v_mfma_f32_16x16x32_bf16 v[56:59], v[24:27], a[0:3], 0
ds_read_b128 v[8:11], v2 offset:2048
v_mfma_f32_16x16x32_bf16 v[60:63], v[28:31], a[0:3], 0
ds_read_b128 v[12:15], v2 offset:16384
v_mfma_f32_16x16x32_bf16 v[64:67], v[24:27], a[56:59], 0
v_mfma_f32_16x16x32_bf16 v[68:71], v[28:31], a[56:59], 0
s_waitcnt lgkmcnt(2)
v_mfma_f32_16x16x32_bf16 v[56:59], v[32:35], a[4:7], v[56:59]
ds_read_b128 v[16:19], v2 offset:3072
ds_read_b128 v[20:23], v2 offset:17408
v_mfma_f32_16x16x32_bf16 v[60:63], v[36:39], a[4:7], v[60:63]
v_cvt_pk_bf16_f32 v72, v40, v41
v_cvt_pk_bf16_f32 v73, v42, v43
v_mfma_f32_16x16x32_bf16 v[64:67], v[32:35], a[60:63], v[64:67]
v_cvt_pk_bf16_f32 v74, v44, v45
v_mfma_f32_16x16x32_bf16 v[68:71], v[36:39], a[60:63], v[68:71]
v_cvt_pk_bf16_f32 v75, v46, v47
s_waitcnt lgkmcnt(2)
v_mfma_f32_16x16x32_bf16 v[56:59], v[8:11], a[8:11], v[56:59]
ds_read_b128 v[24:27], v2 offset:4096
ds_read_b128 v[28:31], v2 offset:18432
v_mfma_f32_16x16x32_bf16 v[60:63], v[12:15], a[8:11], v[60:63]
v_cvt_pk_bf16_f32 v76, v48, v49
v_cvt_pk_bf16_f32 v77, v50, v51
v_mfma_f32_16x16x32_bf16 v[64:67], v[8:11], a[64:67], v[64:67]
v_cvt_pk_bf16_f32 v78, v52, v53
v_mfma_f32_16x16x32_bf16 v[68:71], v[12:15], a[64:67], v[68:71]
v_cvt_pk_bf16_f32 v79, v54, v55
s_waitcnt lgkmcnt(2)
v_mfma_f32_16x16x32_bf16 v[56:59], v[16:19], a[12:15], v[56:59]
ds_read_b128 v[32:35], v2 offset:5120
ds_read_b128 v[36:39], v2 offset:19456
buffer_store_dwordx4 v[72:75], v3, s[8:11], s34 offen sc1
s_add_u32 s39, s34, 4096
buffer_store_dwordx4 v[76:79], v3, s[8:11], s39 offen sc1
s_add_u32 s34, s34, 1835008
v_mfma_f32_16x16x32_bf16 v[60:63], v[20:23], a[12:15], v[60:63]
v_mfma_f32_16x16x32_bf16 v[64:67], v[16:19], a[68:71], v[64:67]
v_mfma_f32_16x16x32_bf16 v[68:71], v[20:23], a[68:71], v[68:71]
s_waitcnt lgkmcnt(2)
v_mfma_f32_16x16x32_bf16 v[56:59], v[24:27], a[16:19], v[56:59]
ds_read_b128 v[8:11], v2 offset:6144
v_mfma_f32_16x16x32_bf16 v[60:63], v[28:31], a[16:19], v[60:63]
ds_read_b128 v[12:15], v2 offset:20480
v_mfma_f32_16x16x32_bf16 v[64:67], v[24:27], a[72:75], v[64:67]
v_mfma_f32_16x16x32_bf16 v[68:71], v[28:31], a[72:75], v[68:71]
s_waitcnt lgkmcnt(2)
v_mfma_f32_16x16x32_bf16 v[56:59], v[32:35], a[20:23], v[56:59]
ds_read_b128 v[16:19], v2 offset:7168
v_mfma_f32_16x16x32_bf16 v[60:63], v[36:39], a[20:23], v[60:63]
ds_read_b128 v[20:23], v2 offset:21504
v_mfma_f32_16x16x32_bf16 v[64:67], v[32:35], a[76:79], v[64:67]
v_mfma_f32_16x16x32_bf16 v[68:71], v[36:39], a[76:79], v[68:71]
s_waitcnt lgkmcnt(2)
v_mfma_f32_16x16x32_bf16 v[56:59], v[8:11], a[24:27], v[56:59]
ds_read_b128 v[24:27], v2 offset:8192
v_mfma_f32_16x16x32_bf16 v[60:63], v[12:15], a[24:27], v[60:63]
ds_read_b128 v[28:31], v2 offset:22528
v_mfma_f32_16x16x32_bf16 v[64:67], v[8:11], a[80:83], v[64:67]
v_mfma_f32_16x16x32_bf16 v[68:71], v[12:15], a[80:83], v[68:71]
s_waitcnt lgkmcnt(2)
v_mfma_f32_16x16x32_bf16 v[56:59], v[16:19], a[28:31], v[56:59]
ds_read_b128 v[32:35], v2 offset:9216
ds_read_b128 v[36:39], v2 offset:23552
s_waitcnt vmcnt(2)
s_barrier
s_cmp_eq_u32 s37, 0
s_cbranch_scc1 .Ldfl_421
buffer_store_dword v81, v80, s[8:11], s40 offen sc1
s_add_u32 s40, s40, 896
.Ldfl_421:
v_mfma_f32_16x16x32_bf16 v[60:63], v[20:23], a[28:31], v[60:63]
v_mfma_f32_16x16x32_bf16 v[64:67], v[16:19], a[84:87], v[64:67]
v_mfma_f32_16x16x32_bf16 v[68:71], v[20:23], a[84:87], v[68:71]
s_add_u32 s24, s37, 3
s_cmp_ge_u32 s24, 16
s_cselect_b32 s28, 0x10000000, 0
v_add_u32 v5, s28, v1
s_waitcnt lgkmcnt(2)
v_mfma_f32_16x16x32_bf16 v[56:59], v[24:27], a[32:35], v[56:59]
ds_read_b128 v[8:11], v2 offset:10240
ds_read_b128 v[12:15], v2 offset:24576
v_mfma_f32_16x16x32_bf16 v[60:63], v[28:31], a[32:35], v[60:63]
s_add_u32 m0, s36, 0
v_mfma_f32_16x16x32_bf16 v[64:67], v[24:27], a[88:91], v[64:67]
s_add_u32 s27, s33, 0
v_mfma_f32_16x16x32_bf16 v[68:71], v[28:31], a[88:91], v[68:71]
buffer_load_dwordx4 v5, s[8:11], s27 offen lds
s_waitcnt lgkmcnt(2)
v_mfma_f32_16x16x32_bf16 v[56:59], v[32:35], a[36:39], v[56:59]
ds_read_b128 v[16:19], v2 offset:11264
ds_read_b128 v[20:23], v2 offset:25600
v_mfma_f32_16x16x32_bf16 v[60:63], v[36:39], a[36:39], v[60:63]
s_add_u32 m0, s36, 1024
v_mfma_f32_16x16x32_bf16 v[64:67], v[32:35], a[92:95], v[64:67]
s_add_u32 s27, s33, 1024
v_mfma_f32_16x16x32_bf16 v[68:71], v[36:39], a[92:95], v[68:71]
buffer_load_dwordx4 v5, s[8:11], s27 offen lds
s_waitcnt lgkmcnt(2)
v_mfma_f32_16x16x32_bf16 v[56:59], v[8:11], a[40:43], v[56:59]
ds_read_b128 v[24:27], v2 offset:12288
ds_read_b128 v[28:31], v2 offset:26624
v_mfma_f32_16x16x32_bf16 v[60:63], v[12:15], a[40:43], v[60:63]
s_add_u32 m0, s36, 2048
v_mfma_f32_16x16x32_bf16 v[64:67], v[8:11], a[96:99], v[64:67]
s_add_u32 s27, s33, 2048
v_mfma_f32_16x16x32_bf16 v[68:71], v[12:15], a[96:99], v[68:71]
buffer_load_dwordx4 v5, s[8:11], s27 offen lds
s_waitcnt lgkmcnt(2)
v_mfma_f32_16x16x32_bf16 v[56:59], v[16:19], a[44:47], v[56:59]
ds_read_b128 v[32:35], v2 offset:13312
ds_read_b128 v[36:39], v2 offset:27648
v_mfma_f32_16x16x32_bf16 v[60:63], v[20:23], a[44:47], v[60:63]
s_add_u32 m0, s36, 3072
v_mfma_f32_16x16x32_bf16 v[64:67], v[16:19], a[100:103], v[64:67]
s_add_u32 s27, s33, 3072
v_mfma_f32_16x16x32_bf16 v[68:71], v[20:23], a[100:103], v[68:71]
buffer_load_dwordx4 v5, s[8:11], s27 offen lds
s_waitcnt lgkmcnt(2)
v_mfma_f32_16x16x32_bf16 v[56:59], v[24:27], a[48:51], v[56:59]
ds_read_b128 v[8:11], v4 offset:0
ds_read_b128 v[12:15], v4 offset:14336
v_mfma_f32_16x16x32_bf16 v[60:63], v[28:31], a[48:51], v[60:63]
s_add_u32 m0, s36, 4096
v_mfma_f32_16x16x32_bf16 v[64:67], v[24:27], a[104:107], v[64:67]
s_add_u32 s27, s33, 4096
v_mfma_f32_16x16x32_bf16 v[68:71], v[28:31], a[104:107], v[68:71]
buffer_load_dwordx4 v5, s[8:11], s27 offen lds
s_waitcnt lgkmcnt(2)
v_mfma_f32_16x16x32_bf16 v[56:59], v[32:35], a[52:55], v[56:59]
ds_read_b128 v[16:19], v4 offset:1024
ds_read_b128 v[20:23], v4 offset:15360
v_mfma_f32_16x16x32_bf16 v[60:63], v[36:39], a[52:55], v[60:63]
s_add_u32 m0, s36, 5120
s_add_u32 s27, s33, 5120
v_mfma_f32_16x16x32_bf16 v[64:67], v[32:35], a[108:111], v[64:67]
buffer_load_dwordx4 v5, s[8:11], s27 offen lds
s_add_u32 m0, s36, 6144
v_mfma_f32_16x16x32_bf16 v[68:71], v[36:39], a[108:111], v[68:71]
s_add_u32 s27, s33, 6144
buffer_load_dwordx4 v5, s[8:11], s27 offen lds
s_add_u32 s33, s33, 114688
v_mov_b32 v2, v4
s_add_u32 s35, s35, 28672
s_cmp_ge_u32 s35, 86016
s_cselect_b32 s35, 0, s35
v_add_u32 v4, s35, v1
s_add_u32 s24, s35, 28672
s_cmp_ge_u32 s24, 86016
s_cselect_b32 s24, 0, s24
s_add_u32 s36, s24, s38
s_add_u32 s37, s37, 2
s_cmp_lt_u32 s37, 16
s_cbranch_scc1 .Ldloop_416
s_nop 7
v_cvt_pk_bf16_f32 v72, v56, v57
v_cvt_pk_bf16_f32 v73, v58, v59
v_cvt_pk_bf16_f32 v74, v60, v61
v_cvt_pk_bf16_f32 v75, v62, v63
v_cvt_pk_bf16_f32 v76, v64, v65
v_cvt_pk_bf16_f32 v77, v66, v67
v_cvt_pk_bf16_f32 v78, v68, v69
v_cvt_pk_bf16_f32 v79, v70, v71
buffer_store_dwordx4 v[72:75], v3, s[8:11], s34 offen sc1
s_add_u32 s39, s34, 4096
buffer_store_dwordx4 v[76:79], v3, s[8:11], s39 offen sc1
s_waitcnt vmcnt(0) lgkmcnt(0)
s_barrier
buffer_store_dword v81, v80, s[8:11], s40 offen sc1
s_add_u32 s40, s40, 896
buffer_store_dword v81, v80, s[8:11], s40 offen sc1
s_barrier
s_mov_b32 s39, 8000
s_cmp_ge_u32 s58, 112
s_cbranch_scc1 .Lj2_404
s_mul_i32 s16, s58, 147
s_lshr_b32 s16, s16, 10
s_mul_i32 s18, s16, 7
s_sub_u32 s18, s58, s18
s_cmp_eq_u32 s18, 0
s_cselect_b32 s19, 10, 9
v_lshlrev_b32 v1, 4, v0
s_lshl_b32 s24, s16, 2
s_add_u32 s24, s24, s17
s_mul_i32 s32, s24, 100352
s_add_u32 s32, s32, 0
s_mov_b32 s33, s18
s_mov_b32 s37, s33
s_mov_b32 s38, 0
v_mov_b32 v15, v1
s_cmp_eq_u32 s17, 3
s_cselect_b32 s24, 0x10000000, 0
v_add_u32 v14, s24, v1
s_mul_i32 s24, s37, 28672
s_mul_i32 s25, s17, 7168
s_add_u32 s24, s24, s25
s_mul_i32 s26, s38, 28672
s_add_u32 s26, s26, s25
s_mul_i32 s27, s37, 7168
s_lshl_b32 s29, s17, 10
s_add_u32 s27, s27, s29
s_lshl_b32 s28, s38, 13
s_add_u32 s28, s28, s29
s_add_u32 m0, s26, 0
s_add_u32 s30, s24, 68386816
buffer_load_dwordx4 v15, s[8:11], s30 offen lds
s_add_u32 m0, s26, 1024
s_add_u32 s30, s24, 68387840
buffer_load_dwordx4 v15, s[8:11], s30 offen lds
s_add_u32 m0, s26, 2048
s_add_u32 s30, s24, 68388864
buffer_load_dwordx4 v15, s[8:11], s30 offen lds
s_add_u32 m0, s26, 3072
s_add_u32 s30, s24, 68389888
buffer_load_dwordx4 v15, s[8:11], s30 offen lds
s_add_u32 m0, s26, 4096
s_add_u32 s30, s24, 68390912
buffer_load_dwordx4 v15, s[8:11], s30 offen lds
s_add_u32 m0, s26, 5120
s_add_u32 s30, s24, 68391936
buffer_load_dwordx4 v15, s[8:11], s30 offen lds
s_add_u32 m0, s26, 6144
s_add_u32 s30, s24, 68392960
buffer_load_dwordx4 v15, s[8:11], s30 offen lds
s_add_u32 m0, s26, 57344
s_add_u32 s30, s24, 70221824
buffer_load_dwordx4 v15, s[8:11], s30 offen lds
s_add_u32 m0, s26, 58368
s_add_u32 s30, s24, 70222848
buffer_load_dwordx4 v15, s[8:11], s30 offen lds
s_add_u32 m0, s26, 59392
s_add_u32 s30, s24, 70223872
buffer_load_dwordx4 v15, s[8:11], s30 offen lds
s_add_u32 m0, s26, 60416
s_add_u32 s30, s24, 70224896
buffer_load_dwordx4 v15, s[8:11], s30 offen lds
s_add_u32 m0, s26, 61440
s_add_u32 s30, s24, 70225920
buffer_load_dwordx4 v15, s[8:11], s30 offen lds
s_add_u32 m0, s26, 62464
s_add_u32 s30, s24, 70226944
buffer_load_dwordx4 v15, s[8:11], s30 offen lds
s_add_u32 m0, s26, 63488
s_add_u32 s30, s24, 70227968
buffer_load_dwordx4 v15, s[8:11], s30 offen lds
buffer_load_dwordx4 a[0:3], v1, s[8:11], s32 offen offset:0
buffer_load_dwordx4 a[4:7], v1, s[8:11], s32 offen offset:1024
buffer_load_dwordx4 a[8:11], v1, s[8:11], s32 offen offset:2048
buffer_load_dwordx4 a[12:15], v1, s[8:11], s32 offen offset:3072
s_add_u32 s32, s32, 4096
buffer_load_dwordx4 a[16:19], v1, s[8:11], s32 offen offset:0
buffer_load_dwordx4 a[20:23], v1, s[8:11], s32 offen offset:1024
buffer_load_dwordx4 a[24:27], v1, s[8:11], s32 offen offset:2048
buffer_load_dwordx4 a[28:31], v1, s[8:11], s32 offen offset:3072
s_add_u32 s32, s32, 4096
buffer_load_dwordx4 a[32:35], v1, s[8:11], s32 offen offset:0
buffer_load_dwordx4 a[36:39], v1, s[8:11], s32 offen offset:1024
buffer_load_dwordx4 a[40:43], v1, s[8:11], s32 offen offset:2048
buffer_load_dwordx4 a[44:47], v1, s[8:11], s32 offen offset:3072
s_add_u32 s32, s32, 4096
buffer_load_dwordx4 a[48:51], v1, s[8:11], s32 offen offset:0
buffer_load_dwordx4 a[52:55], v1, s[8:11], s32 offen offset:1024
buffer_load_dwordx4 a[56:59], v1, s[8:11], s32 offen offset:2048
buffer_load_dwordx4 a[60:63], v1, s[8:11], s32 offen offset:3072
s_add_u32 s32, s32, 4096
buffer_load_dwordx4 a[64:67], v1, s[8:11], s32 offen offset:0
buffer_load_dwordx4 a[68:71], v1, s[8:11], s32 offen offset:1024
buffer_load_dwordx4 a[72:75], v1, s[8:11], s32 offen offset:2048
buffer_load_dwordx4 a[76:79], v1, s[8:11], s32 offen offset:3072
s_add_u32 s32, s32, 4096
buffer_load_dwordx4 a[80:83], v1, s[8:11], s32 offen offset:0
buffer_load_dwordx4 a[84:87], v1, s[8:11], s32 offen offset:1024
buffer_load_dwordx4 a[88:91], v1, s[8:11], s32 offen offset:2048
buffer_load_dwordx4 a[92:95], v1, s[8:11], s32 offen offset:3072
s_add_u32 s32, s32, 4096
buffer_load_dwordx4 a[96:99], v1, s[8:11], s32 offen offset:0
buffer_load_dwordx4 a[100:103], v1, s[8:11], s32 offen offset:1024
buffer_load_dwordx4 a[104:107], v1, s[8:11], s32 offen offset:2048
buffer_load_dwordx4 a[108:111], v1, s[8:11], s32 offen offset:3072
s_add_u32 s32, s32, 4096
buffer_load_dwordx4 a[112:115], v1, s[8:11], s32 offen offset:0
buffer_load_dwordx4 a[116:119], v1, s[8:11], s32 offen offset:1024
buffer_load_dwordx4 a[120:123], v1, s[8:11], s32 offen offset:2048
buffer_load_dwordx4 a[124:127], v1, s[8:11], s32 offen offset:3072
s_add_u32 s32, s32, 4096
buffer_load_dwordx4 a[128:131], v1, s[8:11], s32 offen offset:0
buffer_load_dwordx4 a[132:135], v1, s[8:11], s32 offen offset:1024
buffer_load_dwordx4 a[136:139], v1, s[8:11], s32 offen offset:2048
buffer_load_dwordx4 a[140:143], v1, s[8:11], s32 offen offset:3072
s_add_u32 s32, s32, 4096
buffer_load_dwordx4 a[144:147], v1, s[8:11], s32 offen offset:0
buffer_load_dwordx4 a[148:151], v1, s[8:11], s32 offen offset:1024
buffer_load_dwordx4 a[152:155], v1, s[8:11], s32 offen offset:2048
buffer_load_dwordx4 a[156:159], v1, s[8:11], s32 offen offset:3072
s_add_u32 s32, s32, 4096
buffer_load_dwordx4 a[160:163], v1, s[8:11], s32 offen offset:0
s_waitcnt vmcnt(20)
buffer_load_dwordx4 a[164:167], v1, s[8:11], s32 offen offset:1024
buffer_load_dwordx4 a[168:171], v1, s[8:11], s32 offen offset:2048
buffer_load_dwordx4 a[172:175], v1, s[8:11], s32 offen offset:3072
s_add_u32 s32, s32, 4096
buffer_load_dwordx4 a[176:179], v1, s[8:11], s32 offen offset:0
buffer_load_dwordx4 a[180:183], v1, s[8:11], s32 offen offset:1024
buffer_load_dwordx4 a[184:187], v1, s[8:11], s32 offen offset:2048
buffer_load_dwordx4 a[188:191], v1, s[8:11], s32 offen offset:3072
s_add_u32 s32, s32, 4096
buffer_load_dwordx4 a[192:195], v1, s[8:11], s32 offen offset:0
buffer_load_dwordx4 a[196:199], v1, s[8:11], s32 offen offset:1024
buffer_load_dwordx4 a[200:203], v1, s[8:11], s32 offen offset:2048
buffer_load_dwordx4 a[204:207], v1, s[8:11], s32 offen offset:3072
s_add_u32 s32, s32, 4096
buffer_load_dwordx4 a[208:211], v1, s[8:11], s32 offen offset:0
buffer_load_dwordx4 a[212:215], v1, s[8:11], s32 offen offset:1024
buffer_load_dwordx4 a[216:219], v1, s[8:11], s32 offen offset:2048
buffer_load_dwordx4 a[220:223], v1, s[8:11], s32 offen offset:3072
s_add_u32 s32, s32, 4096
buffer_load_dwordx4 a[224:227], v1, s[8:11], s32 offen offset:0
buffer_load_dwordx4 a[228:231], v1, s[8:11], s32 offen offset:1024
buffer_load_dwordx4 a[232:235], v1, s[8:11], s32 offen offset:2048
buffer_load_dwordx4 a[236:239], v1, s[8:11], s32 offen offset:3072
s_add_u32 s32, s32, 4096
buffer_load_dwordx4 a[240:243], v1, s[8:11], s32 offen offset:0
buffer_load_dwordx4 a[244:247], v1, s[8:11], s32 offen offset:1024
buffer_load_dwordx4 a[248:251], v1, s[8:11], s32 offen offset:2048
buffer_load_dwordx4 a[252:255], v1, s[8:11], s32 offen offset:3072
s_add_u32 s32, s32, 4096
buffer_load_dwordx4 v[120:123], v1, s[8:11], s32 offen offset:0
buffer_load_dwordx4 v[124:127], v1, s[8:11], s32 offen offset:1024
buffer_load_dwordx4 v[128:131], v1, s[8:11], s32 offen offset:2048
buffer_load_dwordx4 v[132:135], v1, s[8:11], s32 offen offset:3072
s_add_u32 s32, s32, 4096
buffer_load_dwordx4 v[136:139], v1, s[8:11], s32 offen offset:0
buffer_load_dwordx4 v[140:143], v1, s[8:11], s32 offen offset:1024
buffer_load_dwordx4 v[144:147], v1, s[8:11], s32 offen offset:2048
buffer_load_dwordx4 v[148:151], v1, s[8:11], s32 offen offset:3072
s_add_u32 s32, s32, 4096
buffer_load_dwordx4 v[152:155], v1, s[8:11], s32 offen offset:0
buffer_load_dwordx4 v[156:159], v1, s[8:11], s32 offen offset:1024
buffer_load_dwordx4 v[160:163], v1, s[8:11], s32 offen offset:2048
buffer_load_dwordx4 v[164:167], v1, s[8:11], s32 offen offset:3072
s_add_u32 s32, s32, 4096
buffer_load_dwordx4 v[168:171], v1, s[8:11], s32 offen offset:0
buffer_load_dwordx4 v[172:175], v1, s[8:11], s32 offen offset:1024
buffer_load_dwordx4 v[176:179], v1, s[8:11], s32 offen offset:2048
buffer_load_dwordx4 v[180:183], v1, s[8:11], s32 offen offset:3072
s_add_u32 s32, s32, 4096
buffer_load_dwordx4 v[184:187], v1, s[8:11], s32 offen offset:0
s_waitcnt vmcnt(20)
buffer_load_dwordx4 v[188:191], v1, s[8:11], s32 offen offset:1024
buffer_load_dwordx4 v[192:195], v1, s[8:11], s32 offen offset:2048
buffer_load_dwordx4 v[196:199], v1, s[8:11], s32 offen offset:3072
s_add_u32 s32, s32, 4096
buffer_load_dwordx4 v[200:203], v1, s[8:11], s32 offen offset:0
buffer_load_dwordx4 v[204:207], v1, s[8:11], s32 offen offset:1024
buffer_load_dwordx4 v[208:211], v1, s[8:11], s32 offen offset:2048
buffer_load_dwordx4 v[212:215], v1, s[8:11], s32 offen offset:3072
s_add_u32 s32, s32, 4096
buffer_load_dwordx4 v[216:219], v1, s[8:11], s32 offen offset:0
buffer_load_dwordx4 v[220:223], v1, s[8:11], s32 offen offset:1024
buffer_load_dwordx4 v[224:227], v1, s[8:11], s32 offen offset:2048
buffer_load_dwordx4 v[228:231], v1, s[8:11], s32 offen offset:3072
s_add_u32 s32, s32, 4096
buffer_load_dwordx4 v[232:235], v1, s[8:11], s32 offen offset:0
buffer_load_dwordx4 v[236:239], v1, s[8:11], s32 offen offset:1024
buffer_load_dwordx4 v[240:243], v1, s[8:11], s32 offen offset:2048
buffer_load_dwordx4 v[244:247], v1, s[8:11], s32 offen offset:3072
s_add_u32 s32, s32, 4096
buffer_load_dwordx4 v[248:251], v1, s[8:11], s32 offen offset:0
buffer_load_dwordx4 v[252:255], v1, s[8:11], s32 offen offset:1024
v_and_b32 v11, 15, v0
v_lshrrev_b32 v12, 4, v0
v_and_b32 v13, 7, v0
v_lshlrev_b32 v13, 4, v13
s_mul_i32 s24, s17, 1792
s_add_u32 s24, s24, 0
v_lshlrev_b32 v3, 7, v12
v_add3_u32 v3, v3, v13, s24
v_lshrrev_b32 v4, 1, v12
v_lshlrev_b32 v4, 7, v4
v_and_b32 v2, 1, v12
v_lshlrev_b32 v2, 3, v2
s_add_u32 s24, s24, 1536
v_add3_u32 v4, v4, v13, s24
v_add_u32 v4, v4, v2
s_mul_i32 s24, s17, 7168
s_add_u32 s24, s24, 57344
v_add_u32 v5, s24, v1
s_add_u32 s24, s24, 6144
v_lshlrev_b32 v6, 3, v0
v_add_u32 v6, s24, v6
s_mul_i32 s24, s17, 6144
s_add_u32 s24, s24, 131072
v_add_u32 v7, s24, v1
s_and_b32 s25, s17, 1
s_lshl_b32 s24, s25, 10
s_add_u32 s24, s24, 131072
v_add_u32 v8, s24, v1
v_lshrrev_b32 v88, 3, v11
v_lshlrev_b32 v88, 4, v88
v_lshrrev_b32 v89, 2, v11
v_and_b32 v89, 1, v89
v_lshlrev_b32 v89, 2, v89
v_and_b32 v90, 3, v11
v_add3_u32 v88, v88, v89, v90
s_lshl_b32 s24, s25, 3
v_add_u32 v88, s24, v88
v_lshrrev_b32 v89, 1, v12
v_lshlrev_b32 v89, 1, v89
v_and_b32 v90, 1, v12
v_lshlrev_b32 v90, 2, v90
v_add_u32 v89, v89, v90
v_add_u32 v90, 0, v89
v_cmp_le_u32 s[40:41], v90, v88
v_add_u32 v90, 1, v89
v_cmp_le_u32 s[42:43], v90, v88
v_add_u32 v90, 8, v89
v_cmp_le_u32 s[44:45], v90, v88
v_add_u32 v90, 9, v89
v_cmp_le_u32 s[46:47], v90, v88
v_add_u32 v90, 16, v89
v_cmp_le_u32 s[48:49], v90, v88
v_add_u32 v90, 17, v89
v_cmp_le_u32 s[50:51], v90, v88
v_add_u32 v90, 24, v89
v_cmp_le_u32 s[52:53], v90, v88
v_add_u32 v90, 25, v89
v_cmp_le_u32 s[54:55], v90, v88
v_cmp_gt_u32 s[56:57], 2, v12
s_lshr_b32 s24, s16, 2
s_lshr_b32 s26, s16, 1
s_and_b32 s26, s26, 1
s_and_b32 s27, s16, 1
s_lshl_b32 s28, s24, 13
s_lshl_b32 s29, s26, 12
s_add_u32 s28, s28, s29
s_lshl_b32 s29, s25, 10
s_add_u32 s28, s28, s29
s_lshl_b32 s29, s27, 9
s_add_u32 s28, s28, s29
v_lshrrev_b32 v88, 5, v0
v_lshlrev_b32 v88, 11, v88
v_and_b32 v89, 31, v0
v_lshlrev_b32 v89, 4, v89
v_add3_u32 v9, v88, v89, s28
s_lshl_b32 s28, s24, 11
s_lshl_b32 s30, s25, 10
s_add_u32 s28, s28, s30
s_add_u32 s28, s28, s29
s_lshl_b32 s30, s26, 3
s_add_u32 s28, s28, s30
s_add_u32 s28, s28, 32768
v_add_u32 v89, s28, v89
v_mov_b32 v88, 0x10000000
v_cndmask_b32 v10, v88, v89, s[56:57]
s_mov_b32 s34, 0
s_mov_b32 s39, 4000
s_waitcnt vmcnt(0)
.Lj1loop_423:
s_barrier
s_mul_i32 s24, s38, 28672
v_add_u32 v2, s24, v1
s_xor_b32 s38, s38, 1
s_add_u32 s37, s33, 7
s_add_u32 s24, s34, 1
s_cmp_ge_u32 s24, s19
s_cselect_b32 s24, 0x10000000, 0
v_add_u32 v15, s24, v1
s_cmp_eq_u32 s17, 3
s_cselect_b32 s24, 0x10000000, s24
v_add_u32 v14, s24, v1
ds_read_b128 v[16:19], v2 offset:0
ds_read_b128 v[20:23], v2 offset:14336
s_waitcnt lgkmcnt(0)
v_mfma_f32_16x16x32_bf16 v[32:35], a[0:3], v[16:19], 0
ds_read_b128 v[24:27], v2 offset:1024
v_mfma_f32_16x16x32_bf16 v[36:39], a[0:3], v[20:23], 0
ds_read_b128 v[28:31], v2 offset:15360
v_mfma_f32_16x16x32_bf16 v[40:43], a[56:59], v[16:19], 0
s_mul_i32 s24, s37, 28672
v_mfma_f32_16x16x32_bf16 v[44:47], a[56:59], v[20:23], 0
s_mul_i32 s25, s17, 7168
v_mfma_f32_16x16x32_bf16 v[48:51], a[112:115], v[16:19], 0
s_add_u32 s24, s24, s25
v_mfma_f32_16x16x32_bf16 v[52:55], a[112:115], v[20:23], 0
s_mul_i32 s26, s38, 28672
v_mfma_f32_16x16x32_bf16 v[56:59], a[168:171], v[16:19], 0
s_add_u32 s26, s26, s25
v_mfma_f32_16x16x32_bf16 v[60:63], a[168:171], v[20:23], 0
s_mul_i32 s27, s37, 7168
v_mfma_f32_16x16x32_bf16 v[64:67], a[224:227], v[16:19], 0
s_lshl_b32 s29, s17, 10
v_mfma_f32_16x16x32_bf16 v[68:71], a[224:227], v[20:23], 0
s_add_u32 s27, s27, s29
v_mfma_f32_16x16x32_bf16 v[72:75], v[144:147], v[16:19], 0
v_mfma_f32_16x16x32_bf16 v[76:79], v[144:147], v[20:23], 0
v_mfma_f32_16x16x32_bf16 v[80:83], v[200:203], v[16:19], 0
v_mfma_f32_16x16x32_bf16 v[84:87], v[200:203], v[20:23], 0
s_waitcnt lgkmcnt(0)
v_mfma_f32_16x16x32_bf16 v[32:35], a[4:7], v[24:27], v[32:35]
ds_read_b128 v[16:19], v2 offset:2048
v_mfma_f32_16x16x32_bf16 v[36:39], a[4:7], v[28:31], v[36:39]
ds_read_b128 v[20:23], v2 offset:16384
v_mfma_f32_16x16x32_bf16 v[40:43], a[60:63], v[24:27], v[40:43]
s_lshl_b32 s28, s38, 13
v_mfma_f32_16x16x32_bf16 v[44:47], a[60:63], v[28:31], v[44:47]
s_add_u32 s28, s28, s29
v_mfma_f32_16x16x32_bf16 v[48:51], a[116:119], v[24:27], v[48:51]
s_add_u32 m0, s26, 0
v_mfma_f32_16x16x32_bf16 v[52:55], a[116:119], v[28:31], v[52:55]
s_add_u32 s30, s24, 68386816
v_mfma_f32_16x16x32_bf16 v[56:59], a[172:175], v[24:27], v[56:59]
buffer_load_dwordx4 v15, s[8:11], s30 offen lds
v_mfma_f32_16x16x32_bf16 v[60:63], a[172:175], v[28:31], v[60:63]
s_add_u32 m0, s26, 1024
v_mfma_f32_16x16x32_bf16 v[64:67], a[228:231], v[24:27], v[64:67]
s_add_u32 s30, s24, 68387840
v_mfma_f32_16x16x32_bf16 v[68:71], a[228:231], v[28:31], v[68:71]
buffer_load_dwordx4 v15, s[8:11], s30 offen lds
v_mfma_f32_16x16x32_bf16 v[72:75], v[148:151], v[24:27], v[72:75]
v_mfma_f32_16x16x32_bf16 v[76:79], v[148:151], v[28:31], v[76:79]
v_mfma_f32_16x16x32_bf16 v[80:83], v[204:207], v[24:27], v[80:83]
v_mfma_f32_16x16x32_bf16 v[84:87], v[204:207], v[28:31], v[84:87]
s_waitcnt lgkmcnt(0)
v_mfma_f32_16x16x32_bf16 v[32:35], a[8:11], v[16:19], v[32:35]
ds_read_b128 v[24:27], v2 offset:3072
v_mfma_f32_16x16x32_bf16 v[36:39], a[8:11], v[20:23], v[36:39]
ds_read_b128 v[28:31], v2 offset:17408
v_mfma_f32_16x16x32_bf16 v[40:43], a[64:67], v[16:19], v[40:43]
s_add_u32 m0, s26, 2048
v_mfma_f32_16x16x32_bf16 v[44:47], a[64:67], v[20:23], v[44:47]
s_add_u32 s30, s24, 68388864
v_mfma_f32_16x16x32_bf16 v[48:51], a[120:123], v[16:19], v[48:51]
buffer_load_dwordx4 v15, s[8:11], s30 offen lds
v_mfma_f32_16x16x32_bf16 v[52:55], a[120:123], v[20:23], v[52:55]
s_add_u32 m0, s26, 3072
v_mfma_f32_16x16x32_bf16 v[56:59], a[176:179], v[16:19], v[56:59]
s_add_u32 s30, s24, 68389888
v_mfma_f32_16x16x32_bf16 v[60:63], a[176:179], v[20:23], v[60:63]
buffer_load_dwordx4 v15, s[8:11], s30 offen lds
v_mfma_f32_16x16x32_bf16 v[64:67], a[232:235], v[16:19], v[64:67]
s_add_u32 m0, s26, 4096
v_mfma_f32_16x16x32_bf16 v[68:71], a[232:235], v[20:23], v[68:71]
s_add_u32 s30, s24, 68390912
v_mfma_f32_16x16x32_bf16 v[72:75], v[152:155], v[16:19], v[72:75]
v_mfma_f32_16x16x32_bf16 v[76:79], v[152:155], v[20:23], v[76:79]
v_mfma_f32_16x16x32_bf16 v[80:83], v[208:211], v[16:19], v[80:83]
v_mfma_f32_16x16x32_bf16 v[84:87], v[208:211], v[20:23], v[84:87]
s_waitcnt lgkmcnt(0)
v_mfma_f32_16x16x32_bf16 v[32:35], a[12:15], v[24:27], v[32:35]
ds_read_b128 v[16:19], v2 offset:4096
v_mfma_f32_16x16x32_bf16 v[36:39], a[12:15], v[28:31], v[36:39]
ds_read_b128 v[20:23], v2 offset:18432
v_mfma_f32_16x16x32_bf16 v[40:43], a[68:71], v[24:27], v[40:43]
buffer_load_dwordx4 v15, s[8:11], s30 offen lds
v_mfma_f32_16x16x32_bf16 v[44:47], a[68:71], v[28:31], v[44:47]
s_add_u32 m0, s26, 5120
v_mfma_f32_16x16x32_bf16 v[48:51], a[124:127], v[24:27], v[48:51]
s_add_u32 s30, s24, 68391936
v_mfma_f32_16x16x32_bf16 v[52:55], a[124:127], v[28:31], v[52:55]
buffer_load_dwordx4 v15, s[8:11], s30 offen lds
v_mfma_f32_16x16x32_bf16 v[56:59], a[180:183], v[24:27], v[56:59]
s_add_u32 m0, s26, 6144
v_mfma_f32_16x16x32_bf16 v[60:63], a[180:183], v[28:31], v[60:63]
s_add_u32 s30, s24, 68392960
v_mfma_f32_16x16x32_bf16 v[64:67], a[236:239], v[24:27], v[64:67]
buffer_load_dwordx4 v15, s[8:11], s30 offen lds
v_mfma_f32_16x16x32_bf16 v[68:71], a[236:239], v[28:31], v[68:71]
s_add_u32 m0, s26, 57344
v_mfma_f32_16x16x32_bf16 v[72:75], v[156:159], v[24:27], v[72:75]
v_mfma_f32_16x16x32_bf16 v[76:79], v[156:159], v[28:31], v[76:79]
v_mfma_f32_16x16x32_bf16 v[80:83], v[212:215], v[24:27], v[80:83]
v_mfma_f32_16x16x32_bf16 v[84:87], v[212:215], v[28:31], v[84:87]
s_waitcnt lgkmcnt(0)
v_mfma_f32_16x16x32_bf16 v[32:35], a[16:19], v[16:19], v[32:35]
ds_read_b128 v[24:27], v2 offset:5120
v_mfma_f32_16x16x32_bf16 v[36:39], a[16:19], v[20:23], v[36:39]
ds_read_b128 v[28:31], v2 offset:19456
v_mfma_f32_16x16x32_bf16 v[40:43], a[72:75], v[16:19], v[40:43]
s_add_u32 s30, s24, 70221824
v_mfma_f32_16x16x32_bf16 v[44:47], a[72:75], v[20:23], v[44:47]
buffer_load_dwordx4 v15, s[8:11], s30 offen lds
v_mfma_f32_16x16x32_bf16 v[48:51], a[128:131], v[16:19], v[48:51]
s_add_u32 m0, s26, 58368
v_mfma_f32_16x16x32_bf16 v[52:55], a[128:131], v[20:23], v[52:55]
s_add_u32 s30, s24, 70222848
v_mfma_f32_16x16x32_bf16 v[56:59], a[184:187], v[16:19], v[56:59]
buffer_load_dwordx4 v15, s[8:11], s30 offen lds
v_mfma_f32_16x16x32_bf16 v[60:63], a[184:187], v[20:23], v[60:63]
s_add_u32 m0, s26, 59392
v_mfma_f32_16x16x32_bf16 v[64:67], a[240:243], v[16:19], v[64:67]
s_add_u32 s30, s24, 70223872
v_mfma_f32_16x16x32_bf16 v[68:71], a[240:243], v[20:23], v[68:71]
buffer_load_dwordx4 v15, s[8:11], s30 offen lds
v_mfma_f32_16x16x32_bf16 v[72:75], v[160:163], v[16:19], v[72:75]
v_mfma_f32_16x16x32_bf16 v[76:79], v[160:163], v[20:23], v[76:79]
v_mfma_f32_16x16x32_bf16 v[80:83], v[216:219], v[16:19], v[80:83]
v_mfma_f32_16x16x32_bf16 v[84:87], v[216:219], v[20:23], v[84:87]
s_waitcnt lgkmcnt(0)
v_mfma_f32_16x16x32_bf16 v[32:35], a[20:23], v[24:27], v[32:35]
ds_read_b128 v[16:19], v2 offset:6144
v_mfma_f32_16x16x32_bf16 v[36:39], a[20:23], v[28:31], v[36:39]
ds_read_b128 v[20:23], v2 offset:20480
v_mfma_f32_16x16x32_bf16 v[40:43], a[76:79], v[24:27], v[40:43]
s_add_u32 m0, s26, 60416
v_mfma_f32_16x16x32_bf16 v[44:47], a[76:79], v[28:31], v[44:47]
s_add_u32 s30, s24, 70224896
v_mfma_f32_16x16x32_bf16 v[48:51], a[132:135], v[24:27], v[48:51]
buffer_load_dwordx4 v15, s[8:11], s30 offen lds
v_mfma_f32_16x16x32_bf16 v[52:55], a[132:135], v[28:31], v[52:55]
s_add_u32 m0, s26, 61440
v_mfma_f32_16x16x32_bf16 v[56:59], a[188:191], v[24:27], v[56:59]
s_add_u32 s30, s24, 70225920
v_mfma_f32_16x16x32_bf16 v[60:63], a[188:191], v[28:31], v[60:63]
buffer_load_dwordx4 v15, s[8:11], s30 offen lds
v_mfma_f32_16x16x32_bf16 v[64:67], a[244:247], v[24:27], v[64:67]
s_add_u32 m0, s26, 62464
v_mfma_f32_16x16x32_bf16 v[68:71], a[244:247], v[28:31], v[68:71]
s_add_u32 s30, s24, 70226944
v_mfma_f32_16x16x32_bf16 v[72:75], v[164:167], v[24:27], v[72:75]
v_mfma_f32_16x16x32_bf16 v[76:79], v[164:167], v[28:31], v[76:79]
v_mfma_f32_16x16x32_bf16 v[80:83], v[220:223], v[24:27], v[80:83]
v_mfma_f32_16x16x32_bf16 v[84:87], v[220:223], v[28:31], v[84:87]
s_waitcnt lgkmcnt(0)
v_mfma_f32_16x16x32_bf16 v[32:35], a[24:27], v[16:19], v[32:35]
ds_read_b128 v[24:27], v2 offset:7168
v_mfma_f32_16x16x32_bf16 v[36:39], a[24:27], v[20:23], v[36:39]
ds_read_b128 v[28:31], v2 offset:21504
v_mfma_f32_16x16x32_bf16 v[40:43], a[80:83], v[16:19], v[40:43]
buffer_load_dwordx4 v15, s[8:11], s30 offen lds
v_mfma_f32_16x16x32_bf16 v[44:47], a[80:83], v[20:23], v[44:47]
s_add_u32 m0, s26, 63488
v_mfma_f32_16x16x32_bf16 v[48:51], a[136:139], v[16:19], v[48:51]
s_add_u32 s30, s24, 70227968
v_mfma_f32_16x16x32_bf16 v[52:55], a[136:139], v[20:23], v[52:55]
buffer_load_dwordx4 v15, s[8:11], s30 offen lds
v_mfma_f32_16x16x32_bf16 v[56:59], a[192:195], v[16:19], v[56:59]
v_mfma_f32_16x16x32_bf16 v[60:63], a[192:195], v[20:23], v[60:63]
v_mfma_f32_16x16x32_bf16 v[64:67], a[248:251], v[16:19], v[64:67]
v_mfma_f32_16x16x32_bf16 v[68:71], a[248:251], v[20:23], v[68:71]
v_mfma_f32_16x16x32_bf16 v[72:75], v[168:171], v[16:19], v[72:75]
v_mfma_f32_16x16x32_bf16 v[76:79], v[168:171], v[20:23], v[76:79]
v_mfma_f32_16x16x32_bf16 v[80:83], v[224:227], v[16:19], v[80:83]
v_mfma_f32_16x16x32_bf16 v[84:87], v[224:227], v[20:23], v[84:87]
s_waitcnt lgkmcnt(0)
v_mfma_f32_16x16x32_bf16 v[32:35], a[28:31], v[24:27], v[32:35]
ds_read_b128 v[16:19], v2 offset:8192
v_mfma_f32_16x16x32_bf16 v[36:39], a[28:31], v[28:31], v[36:39]
ds_read_b128 v[20:23], v2 offset:22528
v_mfma_f32_16x16x32_bf16 v[40:43], a[84:87], v[24:27], v[40:43]
v_mfma_f32_16x16x32_bf16 v[44:47], a[84:87], v[28:31], v[44:47]
v_mfma_f32_16x16x32_bf16 v[48:51], a[140:143], v[24:27], v[48:51]
v_mfma_f32_16x16x32_bf16 v[52:55], a[140:143], v[28:31], v[52:55]
v_mfma_f32_16x16x32_bf16 v[56:59], a[196:199], v[24:27], v[56:59]
v_mfma_f32_16x16x32_bf16 v[60:63], a[196:199], v[28:31], v[60:63]
v_mfma_f32_16x16x32_bf16 v[64:67], a[252:255], v[24:27], v[64:67]
v_mfma_f32_16x16x32_bf16 v[68:71], a[252:255], v[28:31], v[68:71]
v_mfma_f32_16x16x32_bf16 v[72:75], v[172:175], v[24:27], v[72:75]
v_mfma_f32_16x16x32_bf16 v[76:79], v[172:175], v[28:31], v[76:79]
v_mfma_f32_16x16x32_bf16 v[80:83], v[228:231], v[24:27], v[80:83]
v_mfma_f32_16x16x32_bf16 v[84:87], v[228:231], v[28:31], v[84:87]
s_waitcnt lgkmcnt(0)
v_mfma_f32_16x16x32_bf16 v[32:35], a[32:35], v[16:19], v[32:35]
ds_read_b128 v[24:27], v2 offset:9216
v_mfma_f32_16x16x32_bf16 v[36:39], a[32:35], v[20:23], v[36:39]
ds_read_b128 v[28:31], v2 offset:23552
v_mfma_f32_16x16x32_bf16 v[40:43], a[88:91], v[16:19], v[40:43]
v_mfma_f32_16x16x32_bf16 v[44:47], a[88:91], v[20:23], v[44:47]
v_mfma_f32_16x16x32_bf16 v[48:51], a[144:147], v[16:19], v[48:51]
v_mfma_f32_16x16x32_bf16 v[52:55], a[144:147], v[20:23], v[52:55]
v_mfma_f32_16x16x32_bf16 v[56:59], a[200:203], v[16:19], v[56:59]
v_mfma_f32_16x16x32_bf16 v[60:63], a[200:203], v[20:23], v[60:63]
v_mfma_f32_16x16x32_bf16 v[64:67], v[120:123], v[16:19], v[64:67]
v_mfma_f32_16x16x32_bf16 v[68:71], v[120:123], v[20:23], v[68:71]
v_mfma_f32_16x16x32_bf16 v[72:75], v[176:179], v[16:19], v[72:75]
v_mfma_f32_16x16x32_bf16 v[76:79], v[176:179], v[20:23], v[76:79]
v_mfma_f32_16x16x32_bf16 v[80:83], v[232:235], v[16:19], v[80:83]
v_mfma_f32_16x16x32_bf16 v[84:87], v[232:235], v[20:23], v[84:87]
s_waitcnt lgkmcnt(0)
v_mfma_f32_16x16x32_bf16 v[32:35], a[36:39], v[24:27], v[32:35]
ds_read_b128 v[16:19], v2 offset:10240
v_mfma_f32_16x16x32_bf16 v[36:39], a[36:39], v[28:31], v[36:39]
ds_read_b128 v[20:23], v2 offset:24576
v_mfma_f32_16x16x32_bf16 v[40:43], a[92:95], v[24:27], v[40:43]
v_mfma_f32_16x16x32_bf16 v[44:47], a[92:95], v[28:31], v[44:47]
v_mfma_f32_16x16x32_bf16 v[48:51], a[148:151], v[24:27], v[48:51]
v_mfma_f32_16x16x32_bf16 v[52:55], a[148:151], v[28:31], v[52:55]
v_mfma_f32_16x16x32_bf16 v[56:59], a[204:207], v[24:27], v[56:59]
v_mfma_f32_16x16x32_bf16 v[60:63], a[204:207], v[28:31], v[60:63]
v_mfma_f32_16x16x32_bf16 v[64:67], v[124:127], v[24:27], v[64:67]
v_mfma_f32_16x16x32_bf16 v[68:71], v[124:127], v[28:31], v[68:71]
v_mfma_f32_16x16x32_bf16 v[72:75], v[180:183], v[24:27], v[72:75]
v_mfma_f32_16x16x32_bf16 v[76:79], v[180:183], v[28:31], v[76:79]
v_mfma_f32_16x16x32_bf16 v[80:83], v[236:239], v[24:27], v[80:83]
v_mfma_f32_16x16x32_bf16 v[84:87], v[236:239], v[28:31], v[84:87]
s_waitcnt lgkmcnt(0)
v_mfma_f32_16x16x32_bf16 v[32:35], a[40:43], v[16:19], v[32:35]
ds_read_b128 v[24:27], v2 offset:11264
v_mfma_f32_16x16x32_bf16 v[36:39], a[40:43], v[20:23], v[36:39]
ds_read_b128 v[28:31], v2 offset:25600
v_mfma_f32_16x16x32_bf16 v[40:43], a[96:99], v[16:19], v[40:43]
v_mfma_f32_16x16x32_bf16 v[44:47], a[96:99], v[20:23], v[44:47]
v_mfma_f32_16x16x32_bf16 v[48:51], a[152:155], v[16:19], v[48:51]
v_mfma_f32_16x16x32_bf16 v[52:55], a[152:155], v[20:23], v[52:55]
v_mfma_f32_16x16x32_bf16 v[56:59], a[208:211], v[16:19], v[56:59]
v_mfma_f32_16x16x32_bf16 v[60:63], a[208:211], v[20:23], v[60:63]
v_mfma_f32_16x16x32_bf16 v[64:67], v[128:131], v[16:19], v[64:67]
v_mfma_f32_16x16x32_bf16 v[68:71], v[128:131], v[20:23], v[68:71]
v_mfma_f32_16x16x32_bf16 v[72:75], v[184:187], v[16:19], v[72:75]
v_mfma_f32_16x16x32_bf16 v[76:79], v[184:187], v[20:23], v[76:79]
v_mfma_f32_16x16x32_bf16 v[80:83], v[240:243], v[16:19], v[80:83]
v_mfma_f32_16x16x32_bf16 v[84:87], v[240:243], v[20:23], v[84:87]
s_waitcnt lgkmcnt(0)
v_mfma_f32_16x16x32_bf16 v[32:35], a[44:47], v[24:27], v[32:35]
ds_read_b128 v[16:19], v2 offset:12288
v_mfma_f32_16x16x32_bf16 v[36:39], a[44:47], v[28:31], v[36:39]
ds_read_b128 v[20:23], v2 offset:26624
v_mfma_f32_16x16x32_bf16 v[40:43], a[100:103], v[24:27], v[40:43]
v_mfma_f32_16x16x32_bf16 v[44:47], a[100:103], v[28:31], v[44:47]
v_mfma_f32_16x16x32_bf16 v[48:51], a[156:159], v[24:27], v[48:51]
v_mfma_f32_16x16x32_bf16 v[52:55], a[156:159], v[28:31], v[52:55]
v_mfma_f32_16x16x32_bf16 v[56:59], a[212:215], v[24:27], v[56:59]
v_mfma_f32_16x16x32_bf16 v[60:63], a[212:215], v[28:31], v[60:63]
v_mfma_f32_16x16x32_bf16 v[64:67], v[132:135], v[24:27], v[64:67]
v_mfma_f32_16x16x32_bf16 v[68:71], v[132:135], v[28:31], v[68:71]
v_mfma_f32_16x16x32_bf16 v[72:75], v[188:191], v[24:27], v[72:75]
v_mfma_f32_16x16x32_bf16 v[76:79], v[188:191], v[28:31], v[76:79]
v_mfma_f32_16x16x32_bf16 v[80:83], v[244:247], v[24:27], v[80:83]
v_mfma_f32_16x16x32_bf16 v[84:87], v[244:247], v[28:31], v[84:87]
s_waitcnt lgkmcnt(0)
v_mfma_f32_16x16x32_bf16 v[32:35], a[48:51], v[16:19], v[32:35]
ds_read_b128 v[24:27], v2 offset:13312
v_mfma_f32_16x16x32_bf16 v[36:39], a[48:51], v[20:23], v[36:39]
ds_read_b128 v[28:31], v2 offset:27648
v_mfma_f32_16x16x32_bf16 v[40:43], a[104:107], v[16:19], v[40:43]
v_mfma_f32_16x16x32_bf16 v[44:47], a[104:107], v[20:23], v[44:47]
v_mfma_f32_16x16x32_bf16 v[48:51], a[160:163], v[16:19], v[48:51]
v_mfma_f32_16x16x32_bf16 v[52:55], a[160:163], v[20:23], v[52:55]
v_mfma_f32_16x16x32_bf16 v[56:59], a[216:219], v[16:19], v[56:59]
v_mfma_f32_16x16x32_bf16 v[60:63], a[216:219], v[20:23], v[60:63]
v_mfma_f32_16x16x32_bf16 v[64:67], v[136:139], v[16:19], v[64:67]
v_mfma_f32_16x16x32_bf16 v[68:71], v[136:139], v[20:23], v[68:71]
v_mfma_f32_16x16x32_bf16 v[72:75], v[192:195], v[16:19], v[72:75]
v_mfma_f32_16x16x32_bf16 v[76:79], v[192:195], v[20:23], v[76:79]
v_mfma_f32_16x16x32_bf16 v[80:83], v[248:251], v[16:19], v[80:83]
v_mfma_f32_16x16x32_bf16 v[84:87], v[248:251], v[20:23], v[84:87]
s_waitcnt lgkmcnt(0)
v_mfma_f32_16x16x32_bf16 v[32:35], a[52:55], v[24:27], v[32:35]
v_mfma_f32_16x16x32_bf16 v[36:39], a[52:55], v[28:31], v[36:39]
v_mfma_f32_16x16x32_bf16 v[40:43], a[108:111], v[24:27], v[40:43]
v_mfma_f32_16x16x32_bf16 v[44:47], a[108:111], v[28:31], v[44:47]
v_mfma_f32_16x16x32_bf16 v[48:51], a[164:167], v[24:27], v[48:51]
v_mfma_f32_16x16x32_bf16 v[52:55], a[164:167], v[28:31], v[52:55]
v_mfma_f32_16x16x32_bf16 v[56:59], a[220:223], v[24:27], v[56:59]
v_mfma_f32_16x16x32_bf16 v[60:63], a[220:223], v[28:31], v[60:63]
v_mfma_f32_16x16x32_bf16 v[64:67], v[140:143], v[24:27], v[64:67]
v_mfma_f32_16x16x32_bf16 v[68:71], v[140:143], v[28:31], v[68:71]
v_mfma_f32_16x16x32_bf16 v[72:75], v[196:199], v[24:27], v[72:75]
v_mfma_f32_16x16x32_bf16 v[76:79], v[196:199], v[28:31], v[76:79]
v_mfma_f32_16x16x32_bf16 v[80:83], v[252:255], v[24:27], v[80:83]
v_mfma_f32_16x16x32_bf16 v[84:87], v[252:255], v[28:31], v[84:87]
s_xor_b32 s24, s38, 1
s_lshl_b32 s25, s24, 13
s_mul_i32 s24, s24, 28672
v_add_u32 v11, s25, v3
v_add_u32 v12, s25, v4
v_add_u32 v13, s24, v5
v_add_u32 v2, s24, v6
ds_read_b128 v[100:103], v13 offset:0
ds_read_b128 v[104:107], v13 offset:1024
ds_read_b128 v[108:111], v13 offset:2048
ds_read_b128 v[112:115], v13 offset:3072
ds_read_b128 v[116:119], v13 offset:4096
ds_read_b128 v[16:19], v13 offset:5120
ds_read_b64 v[22:23], v2 offset:0
ds_read_b64 v[24:25], v2 offset:512
v_cvt_pk_bf16_f32 v32, v32, v33
v_cvt_pk_bf16_f32 v33, v34, v35
v_cvt_pk_bf16_f32 v34, v40, v41
v_cvt_pk_bf16_f32 v35, v42, v43
v_cvt_pk_bf16_f32 v36, v36, v37
v_cvt_pk_bf16_f32 v37, v38, v39
v_cvt_pk_bf16_f32 v38, v44, v45
v_cvt_pk_bf16_f32 v39, v46, v47
v_cvt_pk_bf16_f32 v48, v48, v49
v_cvt_pk_bf16_f32 v49, v50, v51
v_cvt_pk_bf16_f32 v50, v56, v57
v_cvt_pk_bf16_f32 v51, v58, v59
v_cvt_pk_bf16_f32 v52, v52, v53
v_cvt_pk_bf16_f32 v53, v54, v55
v_cvt_pk_bf16_f32 v54, v60, v61
v_cvt_pk_bf16_f32 v55, v62, v63
v_cvt_pk_bf16_f32 v64, v64, v65
v_cvt_pk_bf16_f32 v65, v66, v67
v_cvt_pk_bf16_f32 v66, v72, v73
v_cvt_pk_bf16_f32 v67, v74, v75
v_cvt_pk_bf16_f32 v68, v68, v69
v_cvt_pk_bf16_f32 v69, v70, v71
v_cvt_pk_bf16_f32 v70, v76, v77
v_cvt_pk_bf16_f32 v71, v78, v79
v_cvt_pk_bf16_f32 v80, v80, v81
v_cvt_pk_bf16_f32 v81, v82, v83
v_cvt_pk_bf16_f32 v84, v84, v85
v_cvt_pk_bf16_f32 v85, v86, v87
s_waitcnt lgkmcnt(0)
v_mfma_f32_16x16x32_bf16 v[56:59], v[100:103], v[32:35], 0
v_mfma_f32_16x16x32_bf16 v[60:63], v[100:103], v[36:39], 0
v_mfma_f32_16x16x32_bf16 v[72:75], v[112:115], v[32:35], 0
v_mfma_f32_16x16x32_bf16 v[76:79], v[112:115], v[36:39], 0
v_mfma_f32_16x16x32_bf16 v[56:59], v[104:107], v[48:51], v[56:59]
v_mfma_f32_16x16x32_bf16 v[60:63], v[104:107], v[52:55], v[60:63]
v_mfma_f32_16x16x32_bf16 v[72:75], v[116:119], v[48:51], v[72:75]
v_mfma_f32_16x16x32_bf16 v[76:79], v[116:119], v[52:55], v[76:79]
v_mfma_f32_16x16x32_bf16 v[56:59], v[108:111], v[64:67], v[56:59]
v_mfma_f32_16x16x32_bf16 v[60:63], v[108:111], v[68:71], v[60:63]
v_mfma_f32_16x16x32_bf16 v[72:75], v[16:19], v[64:67], v[72:75]
v_mfma_f32_16x16x32_bf16 v[76:79], v[16:19], v[68:71], v[76:79]
v_mfma_f32_16x16x16_bf16 v[56:59], v[22:23], v[80:81], v[56:59]
v_mfma_f32_16x16x16_bf16 v[60:63], v[22:23], v[84:85], v[60:63]
v_mfma_f32_16x16x16_bf16 v[72:75], v[24:25], v[80:81], v[72:75]
v_mfma_f32_16x16x16_bf16 v[76:79], v[24:25], v[84:85], v[76:79]
s_lshl_b32 s24, s33, 6
s_add_u32 s24, s24, 118108160
s_cmp_ge_u32 s33, 56
s_cselect_b32 s25, 64, 0
s_sub_u32 s24, s24, s25
s_mul_i32 s25, s33, 7168
s_add_u32 s25, s25, 101486592
v_lshlrev_b32 v11, 2, v0
s_mov_b32 s26, s39
.Lj1p_424:
buffer_load_dword v12, v11, s[8:11], s24 offen sc1
s_waitcnt vmcnt(0)
v_cmp_eq_u32 vcc, 1, v12
s_nop 1
s_and_b32 s27, vcc_lo, 0x3fff
s_cmp_eq_u32 s27, 0x3fff
s_cbranch_scc1 .Lj1o_425
s_sleep 2
s_sub_u32 s26, s26, 1
s_cbranch_scc0 .Lj1p_424
s_mov_b32 s39, 0
.Lj1o_425:
s_mov_b32 s26, s39
.Lj1r_426:
buffer_load_dwordx4 v[88:91], v3, s[8:11], s25 offen offset:0 sc1
buffer_load_dwordx4 v[92:95], v3, s[8:11], s25 offen offset:512 sc1
buffer_load_dwordx4 v[96:99], v3, s[8:11], s25 offen offset:1024 sc1
buffer_load_dwordx2 v[20:21], v4, s[8:11], s25 offen sc1
s_waitcnt vmcnt(0)
v_max_u32 v12, v88, v89
v_max3_u32 v12, v12, v90, v91
v_max3_u32 v12, v12, v92, v93
v_max3_u32 v12, v12, v94, v95
v_max3_u32 v12, v12, v96, v97
v_max3_u32 v12, v12, v98, v99
v_max3_u32 v12, v12, v20, v21
v_cmp_eq_u32 vcc, -1, v12
s_cbranch_vccz .Lj1q_427
s_sub_u32 s26, s26, 1
s_cbranch_scc0 .Lj1r_426
s_mov_b32 s39, 0
.Lj1q_427:
v_mfma_f32_16x16x32_bf16 v[40:43], v[88:91], v[32:35], 0
v_mfma_f32_16x16x32_bf16 v[44:47], v[88:91], v[36:39], 0
v_mfma_f32_16x16x32_bf16 v[40:43], v[92:95], v[48:51], v[40:43]
v_mfma_f32_16x16x32_bf16 v[44:47], v[92:95], v[52:55], v[44:47]
v_mfma_f32_16x16x32_bf16 v[40:43], v[96:99], v[64:67], v[40:43]
v_mfma_f32_16x16x32_bf16 v[44:47], v[96:99], v[68:71], v[44:47]
v_mfma_f32_16x16x16_bf16 v[40:43], v[20:21], v[80:81], v[40:43]
v_mfma_f32_16x16x16_bf16 v[44:47], v[20:21], v[84:85], v[44:47]
s_nop 4
s_nop 2
s_nop 0
ds_write_b128 v7, v[40:43] offset:0
ds_write_b128 v7, v[44:47] offset:1024
ds_write_b128 v7, v[56:59] offset:2048
ds_write_b128 v7, v[60:63] offset:3072
ds_write_b128 v7, v[72:75] offset:4096
ds_write_b128 v7, v[76:79] offset:5120
s_mul_i32 s35, s33, 40960
s_add_u32 s35, s35, 115470336
s_waitcnt lgkmcnt(0)
s_barrier
s_cmp_ge_u32 s17, 2
s_cbranch_scc1 .Lj1ns_428
ds_read_b128 v[88:91], v8 offset:0
ds_read_b128 v[92:95], v8 offset:2048
ds_read_b128 v[96:99], v8 offset:4096
ds_read_b128 v[100:103], v8 offset:6144
ds_read_b128 v[104:107], v8 offset:8192
ds_read_b128 v[108:111], v8 offset:10240
ds_read_b128 v[112:115], v8 offset:12288
ds_read_b128 v[116:119], v8 offset:14336
ds_read_b128 v[16:19], v8 offset:16384
ds_read_b128 v[20:23], v8 offset:18432
ds_read_b128 v[24:27], v8 offset:20480
ds_read_b128 v[28:31], v8 offset:22528
s_waitcnt lgkmcnt(6)
v_pk_add_f32 v[88:89], v[88:89], v[100:101]
v_pk_add_f32 v[90:91], v[90:91], v[102:103]
v_pk_add_f32 v[92:93], v[92:93], v[104:105]
v_pk_add_f32 v[94:95], v[94:95], v[106:107]
v_pk_add_f32 v[96:97], v[96:97], v[108:109]
v_pk_add_f32 v[98:99], v[98:99], v[110:111]
s_waitcnt lgkmcnt(0)
v_pk_add_f32 v[112:113], v[112:113], v[20:21]
v_pk_add_f32 v[114:115], v[114:115], v[22:23]
v_pk_add_f32 v[116:117], v[116:117], v[24:25]
v_pk_add_f32 v[118:119], v[118:119], v[26:27]
v_pk_add_f32 v[16:17], v[16:17], v[28:29]
v_pk_add_f32 v[18:19], v[18:19], v[30:31]
v_pk_add_f32 v[88:89], v[88:89], v[112:113]
v_pk_add_f32 v[90:91], v[90:91], v[114:115]
v_pk_add_f32 v[92:93], v[92:93], v[116:117]
v_pk_add_f32 v[94:95], v[94:95], v[118:119]
v_pk_add_f32 v[96:97], v[96:97], v[16:17]
v_pk_add_f32 v[98:99], v[98:99], v[18:19]
v_mov_b32 v101, 0xf149f2ca
v_cndmask_b32 v88, v101, v88, s[56:57]
v_cndmask_b32 v89, v101, v89, s[56:57]
v_cndmask_b32 v90, v101, v90, s[56:57]
v_cndmask_b32 v91, v101, v91, s[56:57]
v_cndmask_b32 v92, v101, v92, s[40:41]
v_cndmask_b32 v93, v101, v93, s[42:43]
v_cndmask_b32 v94, v101, v94, s[44:45]
v_cndmask_b32 v95, v101, v95, s[46:47]
v_cndmask_b32 v96, v101, v96, s[48:49]
v_cndmask_b32 v97, v101, v97, s[50:51]
v_cndmask_b32 v98, v101, v98, s[52:53]
v_cndmask_b32 v99, v101, v99, s[54:55]
v_max3_f32 v100, v88, v89, v90
v_max3_f32 v100, v100, v91, v92
v_max3_f32 v100, v100, v93, v94
v_max3_f32 v100, v100, v95, v96
v_max3_f32 v100, v100, v97, v98
v_max_f32 v100, v100, v99
v_mov_b32 v101, v100
s_nop 1
v_permlane16_swap_b32 v100, v101
v_max_f32 v100, v100, v101
v_mov_b32 v101, v100
s_nop 1
v_permlane32_swap_b32 v100, v101
v_max_f32 v100, v100, v101
v_pk_add_f32 v[88:89], v[88:89], v[100:101] op_sel_hi:[1,0] neg_lo:[0,1] neg_hi:[0,1]
v_pk_add_f32 v[90:91], v[90:91], v[100:101] op_sel_hi:[1,0] neg_lo:[0,1] neg_hi:[0,1]
v_pk_add_f32 v[92:93], v[92:93], v[100:101] op_sel_hi:[1,0] neg_lo:[0,1] neg_hi:[0,1]
v_pk_add_f32 v[94:95], v[94:95], v[100:101] op_sel_hi:[1,0] neg_lo:[0,1] neg_hi:[0,1]
v_pk_add_f32 v[96:97], v[96:97], v[100:101] op_sel_hi:[1,0] neg_lo:[0,1] neg_hi:[0,1]
v_pk_add_f32 v[98:99], v[98:99], v[100:101] op_sel_hi:[1,0] neg_lo:[0,1] neg_hi:[0,1]
v_exp_f32 v88, v88
v_exp_f32 v89, v89
v_exp_f32 v90, v90
v_exp_f32 v91, v91
v_exp_f32 v92, v92
v_exp_f32 v93, v93
v_exp_f32 v94, v94
v_exp_f32 v95, v95
v_exp_f32 v96, v96
v_exp_f32 v97, v97
v_exp_f32 v98, v98
v_exp_f32 v99, v99
v_pk_add_f32 v[102:103], v[88:89], v[90:91]
v_pk_add_f32 v[104:105], v[92:93], v[94:95]
v_pk_add_f32 v[106:107], v[96:97], v[98:99]
v_pk_add_f32 v[102:103], v[102:103], v[104:105]
v_pk_add_f32 v[102:103], v[102:103], v[106:107]
v_add_f32 v100, v102, v103
v_mov_b32 v101, v100
s_nop 1
v_permlane16_swap_b32 v100, v101
v_add_f32 v100, v100, v101
v_mov_b32 v101, v100
s_nop 1
v_permlane32_swap_b32 v100, v101
v_add_f32 v100, v100, v101
v_rcp_f32 v100, v100
s_nop 0
v_pk_mul_f32 v[88:89], v[88:89], v[100:101] op_sel_hi:[1,0]
v_pk_mul_f32 v[90:91], v[90:91], v[100:101] op_sel_hi:[1,0]
v_pk_mul_f32 v[92:93], v[92:93], v[100:101] op_sel_hi:[1,0]
v_pk_mul_f32 v[94:95], v[94:95], v[100:101] op_sel_hi:[1,0]
v_pk_mul_f32 v[96:97], v[96:97], v[100:101] op_sel_hi:[1,0]
v_pk_mul_f32 v[98:99], v[98:99], v[100:101] op_sel_hi:[1,0]
v_cvt_pk_bf16_f32 v102, v88, v89
v_cvt_pk_bf16_f32 v103, v90, v91
v_cvt_pk_bf16_f32 v108, v92, v93
v_cvt_pk_bf16_f32 v109, v96, v97
v_cvt_pk_bf16_f32 v110, v94, v95
v_cvt_pk_bf16_f32 v111, v98, v99
buffer_store_dwordx2 v[102:103], v10, s[8:11], s35 offen sc1
s_nop 0
v_permlane32_swap_b32 v108, v109
v_permlane32_swap_b32 v110, v111
buffer_store_dwordx4 v[108:111], v9, s[8:11], s35 offen sc1
s_lshl_b32 s24, s33, 7
s_lshl_b32 s25, s16, 3
s_add_u32 s24, s24, s25
s_lshl_b32 s25, s17, 2
s_add_u32 s24, s24, s25
s_add_u32 s24, s24, 118116352
v_mov_b32 v100, 0x10000000
v_cmp_eq_u32 vcc, 0, v0
v_mov_b32 v101, 1
s_nop 0
v_cndmask_b32 v100, v100, 0, vcc
s_waitcnt vmcnt(0)
buffer_store_dword v101, v100, s[8:11], s24 offen sc1
s_branch .Lj1j_429
.Lj1ns_428:
s_waitcnt vmcnt(0)
.Lj1j_429:
s_mov_b32 s33, s37
s_add_u32 s34, s34, 1
s_cmp_lt_u32 s34, s19
s_cbranch_scc1 .Lj1loop_423
s_waitcnt vmcnt(0)
s_branch .Ljoin_406
.Lj2_404:
s_cmp_ge_u32 s58, 208
s_cbranch_scc1 .Lb1_405
s_sub_u32 s16, s58, 112
s_mov_b32 s22, 56627200
s_mov_b32 s19, 109285376
s_mov_b32 s32, s16
s_mov_b32 s39, 4000
v_lshlrev_b32 v1, 4, v0
v_lshlrev_b32 v4, 2, v0
.Lj2loop_430:
s_lshr_b32 s33, s32, 2
s_and_b32 s34, s32, 3
s_lshl_b32 s34, s34, 2
s_add_u32 s34, s34, s17
s_cmp_ge_u32 s34, 14
s_cbranch_scc1 .Lj2idle_431
s_mul_i32 s24, s33, 14
s_add_u32 s24, s24, s34
s_lshl_b32 s25, s24, 4
s_add_u32 s25, s25, 118091776
s_mov_b32 s30, s39
.Lj2p_434:
buffer_load_dword v5, v4, s[8:11], s25 offen sc1
s_waitcnt vmcnt(0)
v_cmp_eq_u32 vcc, 1, v5
s_nop 1
s_and_b32 s31, vcc_lo, 0xf
s_cmp_eq_u32 s31, 0xf
s_cbranch_scc1 .Lj2o_435
s_sleep 2
s_sub_u32 s30, s30, 1
s_cbranch_scc0 .Lj2p_434
s_mov_b32 s39, 0
.Lj2o_435:
s_lshl_b32 s35, s24, 4
s_add_u32 s35, s35, 118128640
s_lshl_b32 s25, s24, 13
s_add_u32 s25, s25, 101945344
s_lshl_b32 s24, s24, 15
s_add_u32 s24, s24, 72056832
buffer_load_dwordx4 a[0:3], v1, s[8:11], s24 offen offset:0 sc1
buffer_load_dwordx4 a[4:7], v1, s[8:11], s24 offen offset:1024 sc1
buffer_load_dwordx4 a[8:11], v1, s[8:11], s24 offen offset:2048 sc1
buffer_load_dwordx4 a[12:15], v1, s[8:11], s24 offen offset:3072 sc1
s_add_u32 s24, s24, 4096
buffer_load_dwordx4 a[16:19], v1, s[8:11], s24 offen offset:0 sc1
buffer_load_dwordx4 a[20:23], v1, s[8:11], s24 offen offset:1024 sc1
buffer_load_dwordx4 a[24:27], v1, s[8:11], s24 offen offset:2048 sc1
buffer_load_dwordx4 a[28:31], v1, s[8:11], s24 offen offset:3072 sc1
s_add_u32 s24, s24, 4096
buffer_load_dwordx4 a[32:35], v1, s[8:11], s24 offen offset:0 sc1
buffer_load_dwordx4 a[36:39], v1, s[8:11], s24 offen offset:1024 sc1
buffer_load_dwordx4 a[40:43], v1, s[8:11], s24 offen offset:2048 sc1
buffer_load_dwordx4 a[44:47], v1, s[8:11], s24 offen offset:3072 sc1
s_add_u32 s24, s24, 4096
buffer_load_dwordx4 a[48:51], v1, s[8:11], s24 offen offset:0 sc1
buffer_load_dwordx4 a[52:55], v1, s[8:11], s24 offen offset:1024 sc1
buffer_load_dwordx4 a[56:59], v1, s[8:11], s24 offen offset:2048 sc1
buffer_load_dwordx4 a[60:63], v1, s[8:11], s24 offen offset:3072 sc1
s_add_u32 s24, s24, 4096
buffer_load_dwordx4 a[64:67], v1, s[8:11], s24 offen offset:0 sc1
buffer_load_dwordx4 a[68:71], v1, s[8:11], s24 offen offset:1024 sc1
buffer_load_dwordx4 a[72:75], v1, s[8:11], s24 offen offset:2048 sc1
buffer_load_dwordx4 a[76:79], v1, s[8:11], s24 offen offset:3072 sc1
s_add_u32 s24, s24, 4096
buffer_load_dwordx4 a[80:83], v1, s[8:11], s24 offen offset:0 sc1
buffer_load_dwordx4 a[84:87], v1, s[8:11], s24 offen offset:1024 sc1
buffer_load_dwordx4 a[88:91], v1, s[8:11], s24 offen offset:2048 sc1
buffer_load_dwordx4 a[92:95], v1, s[8:11], s24 offen offset:3072 sc1
s_add_u32 s24, s24, 4096
buffer_load_dwordx4 a[96:99], v1, s[8:11], s24 offen offset:0 sc1
buffer_load_dwordx4 a[100:103], v1, s[8:11], s24 offen offset:1024 sc1
buffer_load_dwordx4 a[104:107], v1, s[8:11], s24 offen offset:2048 sc1
buffer_load_dwordx4 a[108:111], v1, s[8:11], s24 offen offset:3072 sc1
s_add_u32 s24, s24, 4096
buffer_load_dwordx4 a[112:115], v1, s[8:11], s24 offen offset:0 sc1
buffer_load_dwordx4 a[116:119], v1, s[8:11], s24 offen offset:1024 sc1
buffer_load_dwordx4 a[120:123], v1, s[8:11], s24 offen offset:2048 sc1
buffer_load_dwordx4 a[124:127], v1, s[8:11], s24 offen offset:3072 sc1
s_add_u32 s24, s24, 4096
v_and_b32 v6, 15, v0
v_lshrrev_b32 v5, 3, v6
v_lshlrev_b32 v5, 4, v5
v_lshrrev_b32 v7, 2, v6
v_and_b32 v7, 1, v7
v_lshlrev_b32 v7, 2, v7
v_and_b32 v6, 3, v6
v_add3_u32 v5, v5, v7, v6
s_lshl_b32 s24, s33, 5
v_add_u32 v5, s24, v5
v_mul_u32_u24 v5, 896, v5
v_lshrrev_b32 v6, 4, v0
v_and_b32 v7, 1, v6
v_lshlrev_b32 v7, 5, v7
v_lshrrev_b32 v6, 1, v6
v_lshlrev_b32 v6, 4, v6
v_add3_u32 v5, v5, v6, v7
s_lshl_b32 s24, s34, 6
v_add_u32 v3, s24, v5
v_add_u32 v2, 7168, v3
buffer_load_dwordx4 v[8:11], v3, s[8:11], s22 offen sc1
buffer_load_dwordx4 v[12:15], v2, s[8:11], s22 offen sc1
.Lj2idle_431:
s_add_u32 s26, s33, 1
s_lshl_b32 s26, s26, 6
s_add_u32 s26, s26, 118108160
s_lshl_b32 s27, s33, 7
s_add_u32 s27, s27, 118116352
s_cmp_ge_u32 s33, 56
s_cbranch_scc1 .Lj2f_436
s_mov_b32 s30, s39
.Lj2p_438:
buffer_load_dword v5, v4, s[8:11], s27 offen sc1
s_waitcnt vmcnt(0)
v_cmp_eq_u32 vcc, 1, v5
s_nop 1
s_and_b32 s31, vcc_lo, 0xffffffff
s_cmp_eq_u32 s31, 0xffffffff
s_cbranch_scc1 .Lj2o_439
s_sleep 2
s_sub_u32 s30, s30, 1
s_cbranch_scc0 .Lj2p_438
s_mov_b32 s39, 0
.Lj2o_439:
s_branch .Lj2j_437
.Lj2f_436:
s_lshl_b32 s27, s33, 6
s_add_u32 s27, s27, 118108096
s_mov_b32 s30, s39
.Lj2p_440:
buffer_load_dword v5, v4, s[8:11], s27 offen sc1
s_waitcnt vmcnt(0)
v_cmp_eq_u32 vcc, 1, v5
s_nop 1
s_and_b32 s31, vcc_lo, 0x3fff
s_cmp_eq_u32 s31, 0x3fff
s_cbranch_scc1 .Lj2o_441
s_sleep 2
s_sub_u32 s30, s30, 1
s_cbranch_scc0 .Lj2p_440
s_mov_b32 s39, 0
.Lj2o_441:
.Lj2j_437:
s_mul_i32 s24, s33, 40960
s_mul_i32 s28, s17, 10240
s_add_u32 s24, s24, s28
s_add_u32 s24, s24, 115470336
v_add_u32 v6, s28, v1
s_add_u32 s26, s24, 4096
s_add_u32 s27, s24, 8192
s_mov_b32 s30, s39
.Lj2r_442:
buffer_load_dwordx4 v[72:75], v1, s[8:11], s24 offen offset:0 sc1
buffer_load_dwordx4 v[76:79], v1, s[8:11], s24 offen offset:1024 sc1
buffer_load_dwordx4 v[80:83], v1, s[8:11], s24 offen offset:2048 sc1
buffer_load_dwordx4 v[84:87], v1, s[8:11], s24 offen offset:3072 sc1
buffer_load_dwordx4 v[88:91], v1, s[8:11], s26 offen offset:0 sc1
buffer_load_dwordx4 v[92:95], v1, s[8:11], s26 offen offset:1024 sc1
buffer_load_dwordx4 v[96:99], v1, s[8:11], s26 offen offset:2048 sc1
buffer_load_dwordx4 v[100:103], v1, s[8:11], s26 offen offset:3072 sc1
buffer_load_dwordx4 v[104:107], v1, s[8:11], s27 offen offset:0 sc1
buffer_load_dwordx4 v[108:111], v1, s[8:11], s27 offen offset:1024 sc1
s_waitcnt vmcnt(0)
v_max_u32 v5, v72, v73
v_max3_u32 v5, v5, v74, v75
v_max3_u32 v5, v5, v76, v77
v_max3_u32 v5, v5, v78, v79
v_max3_u32 v5, v5, v80, v81
v_max3_u32 v5, v5, v82, v83
v_max3_u32 v5, v5, v84, v85
v_max3_u32 v5, v5, v86, v87
v_max3_u32 v5, v5, v88, v89
v_max3_u32 v5, v5, v90, v91
v_max3_u32 v5, v5, v92, v93
v_max3_u32 v5, v5, v94, v95
v_max3_u32 v5, v5, v96, v97
v_max3_u32 v5, v5, v98, v99
v_max3_u32 v5, v5, v100, v101
v_max3_u32 v5, v5, v102, v103
v_max3_u32 v5, v5, v104, v105
v_max3_u32 v5, v5, v106, v107
v_max3_u32 v5, v5, v108, v109
v_max3_u32 v5, v5, v110, v111
v_cmp_eq_u32 vcc, -1, v5
s_cbranch_vccz .Lj2q_443
s_sub_u32 s30, s30, 1
s_cbranch_scc0 .Lj2r_442
s_mov_b32 s39, 0
.Lj2q_443:
s_barrier
ds_write_b128 v6, v[72:75] offset:0
ds_write_b128 v6, v[76:79] offset:1024
ds_write_b128 v6, v[80:83] offset:2048
ds_write_b128 v6, v[84:87] offset:3072
ds_write_b128 v6, v[88:91] offset:4096
ds_write_b128 v6, v[92:95] offset:5120
ds_write_b128 v6, v[96:99] offset:6144
ds_write_b128 v6, v[100:103] offset:7168
ds_write_b128 v6, v[104:107] offset:8192
ds_write_b128 v6, v[108:111] offset:9216
s_cmp_ge_u32 s34, 14
s_cbranch_scc1 .Lj2w_444
s_cmp_ge_u32 s33, 56
s_cbranch_scc1 .Lj2nw_445
s_mov_b32 s30, s39
.Lj2p_446:
buffer_load_dword v5, v4, s[8:11], s35 offen sc1
s_waitcnt vmcnt(0)
v_cmp_eq_u32 vcc, 1, v5
s_nop 1
s_and_b32 s31, vcc_lo, 0xf
s_cmp_eq_u32 s31, 0xf
s_cbranch_scc1 .Lj2o_447
s_sleep 2
s_sub_u32 s30, s30, 1
s_cbranch_scc0 .Lj2p_446
s_mov_b32 s39, 0
.Lj2o_447:
.Lj2nw_445:
s_add_u32 s29, s25, 4096
buffer_load_dwordx4 v[112:115], v1, s[8:11], s25 offen offset:0 sc1
buffer_load_dwordx4 v[116:119], v1, s[8:11], s25 offen offset:1024 sc1
buffer_load_dwordx4 v[120:123], v1, s[8:11], s25 offen offset:2048 sc1
buffer_load_dwordx4 v[124:127], v1, s[8:11], s25 offen offset:3072 sc1
buffer_load_dwordx4 v[128:131], v1, s[8:11], s29 offen offset:0 sc1
buffer_load_dwordx4 v[132:135], v1, s[8:11], s29 offen offset:1024 sc1
buffer_load_dwordx4 v[136:139], v1, s[8:11], s29 offen offset:2048 sc1
buffer_load_dwordx4 v[140:143], v1, s[8:11], s29 offen offset:3072 sc1
.Lj2w_444:
s_waitcnt lgkmcnt(0)
s_barrier
s_cmp_ge_u32 s34, 14
s_cbranch_scc1 .Lj2next_432
ds_read_b128 v[16:19], v1 offset:0
ds_read_b128 v[20:23], v1 offset:1024
ds_read_b128 v[24:27], v1 offset:2048
ds_read_b128 v[28:31], v1 offset:3072
s_waitcnt lgkmcnt(2)
v_mfma_f32_16x16x32_bf16 v[48:51], a[0:3], v[16:19], 0
ds_read_b128 v[32:35], v1 offset:4096
v_mfma_f32_16x16x32_bf16 v[52:55], a[0:3], v[20:23], 0
ds_read_b128 v[36:39], v1 offset:5120
v_mfma_f32_16x16x32_bf16 v[56:59], a[16:19], v[16:19], 0
v_mfma_f32_16x16x32_bf16 v[60:63], a[16:19], v[20:23], 0
s_waitcnt lgkmcnt(2)
v_mfma_f32_16x16x32_bf16 v[48:51], a[8:11], v[24:27], v[48:51]
ds_read_b128 v[40:43], v1 offset:6144
v_mfma_f32_16x16x32_bf16 v[52:55], a[8:11], v[28:31], v[52:55]
ds_read_b128 v[44:47], v1 offset:7168
v_mfma_f32_16x16x32_bf16 v[56:59], a[24:27], v[24:27], v[56:59]
v_mfma_f32_16x16x32_bf16 v[60:63], a[24:27], v[28:31], v[60:63]
s_waitcnt lgkmcnt(2)
v_mfma_f32_16x16x32_bf16 v[48:51], a[4:7], v[32:35], v[48:51]
ds_read_b128 v[16:19], v1 offset:8192
v_mfma_f32_16x16x32_bf16 v[52:55], a[4:7], v[36:39], v[52:55]
ds_read_b128 v[20:23], v1 offset:9216
v_mfma_f32_16x16x32_bf16 v[56:59], a[20:23], v[32:35], v[56:59]
v_mfma_f32_16x16x32_bf16 v[60:63], a[20:23], v[36:39], v[60:63]
s_waitcnt lgkmcnt(2)
v_mfma_f32_16x16x32_bf16 v[48:51], a[12:15], v[40:43], v[48:51]
ds_read_b128 v[24:27], v1 offset:10240
v_mfma_f32_16x16x32_bf16 v[52:55], a[12:15], v[44:47], v[52:55]
ds_read_b128 v[28:31], v1 offset:11264
v_mfma_f32_16x16x32_bf16 v[56:59], a[28:31], v[40:43], v[56:59]
v_mfma_f32_16x16x32_bf16 v[60:63], a[28:31], v[44:47], v[60:63]
s_waitcnt lgkmcnt(2)
v_mfma_f32_16x16x32_bf16 v[48:51], a[32:35], v[16:19], v[48:51]
ds_read_b128 v[32:35], v1 offset:12288
v_mfma_f32_16x16x32_bf16 v[52:55], a[32:35], v[20:23], v[52:55]
ds_read_b128 v[36:39], v1 offset:13312
v_mfma_f32_16x16x32_bf16 v[56:59], a[48:51], v[16:19], v[56:59]
v_mfma_f32_16x16x32_bf16 v[60:63], a[48:51], v[20:23], v[60:63]
s_waitcnt lgkmcnt(2)
v_mfma_f32_16x16x32_bf16 v[48:51], a[40:43], v[24:27], v[48:51]
ds_read_b128 v[40:43], v1 offset:14336
v_mfma_f32_16x16x32_bf16 v[52:55], a[40:43], v[28:31], v[52:55]
ds_read_b128 v[44:47], v1 offset:15360
v_mfma_f32_16x16x32_bf16 v[56:59], a[56:59], v[24:27], v[56:59]
v_mfma_f32_16x16x32_bf16 v[60:63], a[56:59], v[28:31], v[60:63]
s_waitcnt lgkmcnt(2)
v_mfma_f32_16x16x32_bf16 v[48:51], a[36:39], v[32:35], v[48:51]
ds_read_b128 v[16:19], v1 offset:16384
v_mfma_f32_16x16x32_bf16 v[52:55], a[36:39], v[36:39], v[52:55]
ds_read_b128 v[20:23], v1 offset:17408
v_mfma_f32_16x16x32_bf16 v[56:59], a[52:55], v[32:35], v[56:59]
v_mfma_f32_16x16x32_bf16 v[60:63], a[52:55], v[36:39], v[60:63]
s_waitcnt lgkmcnt(2)
v_mfma_f32_16x16x32_bf16 v[48:51], a[44:47], v[40:43], v[48:51]
ds_read_b128 v[24:27], v1 offset:18432
v_mfma_f32_16x16x32_bf16 v[52:55], a[44:47], v[44:47], v[52:55]
ds_read_b128 v[28:31], v1 offset:19456
v_mfma_f32_16x16x32_bf16 v[56:59], a[60:63], v[40:43], v[56:59]
v_mfma_f32_16x16x32_bf16 v[60:63], a[60:63], v[44:47], v[60:63]
s_waitcnt lgkmcnt(2)
v_mfma_f32_16x16x32_bf16 v[48:51], a[64:67], v[16:19], v[48:51]
ds_read_b128 v[32:35], v1 offset:20480
v_mfma_f32_16x16x32_bf16 v[52:55], a[64:67], v[20:23], v[52:55]
ds_read_b128 v[36:39], v1 offset:21504
v_mfma_f32_16x16x32_bf16 v[56:59], a[80:83], v[16:19], v[56:59]
v_mfma_f32_16x16x32_bf16 v[60:63], a[80:83], v[20:23], v[60:63]
s_waitcnt lgkmcnt(2)
v_mfma_f32_16x16x32_bf16 v[48:51], a[72:75], v[24:27], v[48:51]
ds_read_b128 v[40:43], v1 offset:22528
v_mfma_f32_16x16x32_bf16 v[52:55], a[72:75], v[28:31], v[52:55]
ds_read_b128 v[44:47], v1 offset:23552
v_mfma_f32_16x16x32_bf16 v[56:59], a[88:91], v[24:27], v[56:59]
v_mfma_f32_16x16x32_bf16 v[60:63], a[88:91], v[28:31], v[60:63]
s_waitcnt lgkmcnt(2)
v_mfma_f32_16x16x32_bf16 v[48:51], a[68:71], v[32:35], v[48:51]
ds_read_b128 v[16:19], v1 offset:24576
v_mfma_f32_16x16x32_bf16 v[52:55], a[68:71], v[36:39], v[52:55]
ds_read_b128 v[20:23], v1 offset:25600
v_mfma_f32_16x16x32_bf16 v[56:59], a[84:87], v[32:35], v[56:59]
v_mfma_f32_16x16x32_bf16 v[60:63], a[84:87], v[36:39], v[60:63]
s_waitcnt lgkmcnt(2)
v_mfma_f32_16x16x32_bf16 v[48:51], a[76:79], v[40:43], v[48:51]
ds_read_b128 v[24:27], v1 offset:26624
v_mfma_f32_16x16x32_bf16 v[52:55], a[76:79], v[44:47], v[52:55]
ds_read_b128 v[28:31], v1 offset:27648
v_mfma_f32_16x16x32_bf16 v[56:59], a[92:95], v[40:43], v[56:59]
v_mfma_f32_16x16x32_bf16 v[60:63], a[92:95], v[44:47], v[60:63]
s_waitcnt lgkmcnt(2)
v_mfma_f32_16x16x32_bf16 v[48:51], a[96:99], v[16:19], v[48:51]
ds_read_b128 v[32:35], v1 offset:28672
v_mfma_f32_16x16x32_bf16 v[52:55], a[96:99], v[20:23], v[52:55]
ds_read_b128 v[36:39], v1 offset:29696
v_mfma_f32_16x16x32_bf16 v[56:59], a[112:115], v[16:19], v[56:59]
v_mfma_f32_16x16x32_bf16 v[60:63], a[112:115], v[20:23], v[60:63]
s_waitcnt lgkmcnt(2)
v_mfma_f32_16x16x32_bf16 v[48:51], a[104:107], v[24:27], v[48:51]
ds_read_b128 v[40:43], v1 offset:30720
v_mfma_f32_16x16x32_bf16 v[52:55], a[104:107], v[28:31], v[52:55]
ds_read_b128 v[44:47], v1 offset:31744
v_mfma_f32_16x16x32_bf16 v[56:59], a[120:123], v[24:27], v[56:59]
v_mfma_f32_16x16x32_bf16 v[60:63], a[120:123], v[28:31], v[60:63]
s_waitcnt lgkmcnt(2)
v_mfma_f32_16x16x32_bf16 v[48:51], a[100:103], v[32:35], v[48:51]
ds_read_b128 v[16:19], v1 offset:32768
v_mfma_f32_16x16x32_bf16 v[52:55], a[100:103], v[36:39], v[52:55]
ds_read_b128 v[20:23], v1 offset:33792
v_mfma_f32_16x16x32_bf16 v[56:59], a[116:119], v[32:35], v[56:59]
v_mfma_f32_16x16x32_bf16 v[60:63], a[116:119], v[36:39], v[60:63]
s_waitcnt lgkmcnt(2)
v_mfma_f32_16x16x32_bf16 v[48:51], a[108:111], v[40:43], v[48:51]
ds_read_b128 v[24:27], v1 offset:34816
v_mfma_f32_16x16x32_bf16 v[52:55], a[108:111], v[44:47], v[52:55]
ds_read_b128 v[28:31], v1 offset:35840
v_mfma_f32_16x16x32_bf16 v[56:59], a[124:127], v[40:43], v[56:59]
v_mfma_f32_16x16x32_bf16 v[60:63], a[124:127], v[44:47], v[60:63]
s_waitcnt vmcnt(0)
s_mov_b32 s30, s39
.Lj2c_448:
v_max_u32 v5, v112, v113
v_max3_u32 v5, v5, v114, v115
v_max3_u32 v5, v5, v116, v117
v_max3_u32 v5, v5, v118, v119
v_max3_u32 v5, v5, v120, v121
v_max3_u32 v5, v5, v122, v123
v_max3_u32 v5, v5, v124, v125
v_max3_u32 v5, v5, v126, v127
v_max3_u32 v5, v5, v128, v129
v_max3_u32 v5, v5, v130, v131
v_max3_u32 v5, v5, v132, v133
v_max3_u32 v5, v5, v134, v135
v_max3_u32 v5, v5, v136, v137
v_max3_u32 v5, v5, v138, v139
v_max3_u32 v5, v5, v140, v141
v_max3_u32 v5, v5, v142, v143
v_cmp_eq_u32 vcc, -1, v5
s_cbranch_vccz .Lj2k_449
s_sub_u32 s30, s30, 1
s_cbranch_scc1 .Lj2t_450
buffer_load_dwordx4 v[112:115], v1, s[8:11], s25 offen offset:0 sc1
buffer_load_dwordx4 v[116:119], v1, s[8:11], s25 offen offset:1024 sc1
buffer_load_dwordx4 v[120:123], v1, s[8:11], s25 offen offset:2048 sc1
buffer_load_dwordx4 v[124:127], v1, s[8:11], s25 offen offset:3072 sc1
buffer_load_dwordx4 v[128:131], v1, s[8:11], s29 offen offset:0 sc1
buffer_load_dwordx4 v[132:135], v1, s[8:11], s29 offen offset:1024 sc1
buffer_load_dwordx4 v[136:139], v1, s[8:11], s29 offen offset:2048 sc1
buffer_load_dwordx4 v[140:143], v1, s[8:11], s29 offen offset:3072 sc1
s_waitcnt vmcnt(0)
s_branch .Lj2c_448
.Lj2t_450:
s_mov_b32 s39, 0
.Lj2k_449:
s_waitcnt lgkmcnt(2)
v_mfma_f32_16x16x32_bf16 v[48:51], v[112:115], v[16:19], v[48:51]
ds_read_b128 v[32:35], v1 offset:36864
v_mfma_f32_16x16x32_bf16 v[52:55], v[112:115], v[20:23], v[52:55]
ds_read_b128 v[36:39], v1 offset:37888
v_mfma_f32_16x16x32_bf16 v[56:59], v[116:119], v[16:19], v[56:59]
v_mfma_f32_16x16x32_bf16 v[60:63], v[116:119], v[20:23], v[60:63]
s_waitcnt lgkmcnt(2)
v_mfma_f32_16x16x32_bf16 v[48:51], v[120:123], v[24:27], v[48:51]
ds_read_b128 v[40:43], v1 offset:38912
v_mfma_f32_16x16x32_bf16 v[52:55], v[120:123], v[28:31], v[52:55]
ds_read_b128 v[44:47], v1 offset:39936
v_mfma_f32_16x16x32_bf16 v[56:59], v[124:127], v[24:27], v[56:59]
v_mfma_f32_16x16x32_bf16 v[60:63], v[124:127], v[28:31], v[60:63]
s_waitcnt lgkmcnt(2)
v_mfma_f32_16x16x32_bf16 v[48:51], v[128:131], v[32:35], v[48:51]
v_mfma_f32_16x16x32_bf16 v[52:55], v[128:131], v[36:39], v[52:55]
v_mfma_f32_16x16x32_bf16 v[56:59], v[132:135], v[32:35], v[56:59]
v_mfma_f32_16x16x32_bf16 v[60:63], v[132:135], v[36:39], v[60:63]
s_waitcnt lgkmcnt(0)
v_mfma_f32_16x16x32_bf16 v[48:51], v[136:139], v[40:43], v[48:51]
v_mfma_f32_16x16x32_bf16 v[52:55], v[136:139], v[44:47], v[52:55]
v_mfma_f32_16x16x32_bf16 v[56:59], v[140:143], v[40:43], v[56:59]
v_mfma_f32_16x16x32_bf16 v[60:63], v[140:143], v[44:47], v[60:63]
s_nop 7
v_cvt_pk_bf16_f32 v64, v48, v49
v_cvt_pk_bf16_f32 v65, v50, v51
v_cvt_pk_bf16_f32 v66, v56, v57
v_cvt_pk_bf16_f32 v67, v58, v59
s_nop 1
v_permlane16_swap_b32 v64, v66
v_permlane16_swap_b32 v65, v67
v_lshlrev_b32 v16, 16, v64
v_and_b32 v17, 0xffff0000, v64
v_lshlrev_b32 v18, 16, v8
v_and_b32 v19, 0xffff0000, v8
v_pk_add_f32 v[16:17], v[16:17], v[18:19]
v_cvt_pk_bf16_f32 v64, v16, v17
v_lshlrev_b32 v16, 16, v65
v_and_b32 v17, 0xffff0000, v65
v_lshlrev_b32 v18, 16, v9
v_and_b32 v19, 0xffff0000, v9
v_pk_add_f32 v[16:17], v[16:17], v[18:19]
v_cvt_pk_bf16_f32 v65, v16, v17
v_lshlrev_b32 v16, 16, v66
v_and_b32 v17, 0xffff0000, v66
v_lshlrev_b32 v18, 16, v10
v_and_b32 v19, 0xffff0000, v10
v_pk_add_f32 v[16:17], v[16:17], v[18:19]
v_cvt_pk_bf16_f32 v66, v16, v17
v_lshlrev_b32 v16, 16, v67
v_and_b32 v17, 0xffff0000, v67
v_lshlrev_b32 v18, 16, v11
v_and_b32 v19, 0xffff0000, v11
v_pk_add_f32 v[16:17], v[16:17], v[18:19]
v_cvt_pk_bf16_f32 v67, v16, v17
buffer_store_dwordx4 v[64:67], v3, s[8:11], s19 offen sc1
v_cvt_pk_bf16_f32 v68, v52, v53
v_cvt_pk_bf16_f32 v69, v54, v55
v_cvt_pk_bf16_f32 v70, v60, v61
v_cvt_pk_bf16_f32 v71, v62, v63
s_nop 1
v_permlane16_swap_b32 v68, v70
v_permlane16_swap_b32 v69, v71
v_lshlrev_b32 v16, 16, v68
v_and_b32 v17, 0xffff0000, v68
v_lshlrev_b32 v18, 16, v12
v_and_b32 v19, 0xffff0000, v12
v_pk_add_f32 v[16:17], v[16:17], v[18:19]
v_cvt_pk_bf16_f32 v68, v16, v17
v_lshlrev_b32 v16, 16, v69
v_and_b32 v17, 0xffff0000, v69
v_lshlrev_b32 v18, 16, v13
v_and_b32 v19, 0xffff0000, v13
v_pk_add_f32 v[16:17], v[16:17], v[18:19]
v_cvt_pk_bf16_f32 v69, v16, v17
v_lshlrev_b32 v16, 16, v70
v_and_b32 v17, 0xffff0000, v70
v_lshlrev_b32 v18, 16, v14
v_and_b32 v19, 0xffff0000, v14
v_pk_add_f32 v[16:17], v[16:17], v[18:19]
v_cvt_pk_bf16_f32 v70, v16, v17
v_lshlrev_b32 v16, 16, v71
v_and_b32 v17, 0xffff0000, v71
v_lshlrev_b32 v18, 16, v15
v_and_b32 v19, 0xffff0000, v15
v_pk_add_f32 v[16:17], v[16:17], v[18:19]
v_cvt_pk_bf16_f32 v71, v16, v17
buffer_store_dwordx4 v[68:71], v2, s[8:11], s19 offen sc1
s_lshl_b32 s24, s33, 6
s_lshl_b32 s25, s34, 2
s_add_u32 s24, s24, s25
s_add_u32 s24, s24, 118142976
v_mov_b32 v5, 0x10000000
v_cmp_eq_u32 vcc, 0, v0
v_mov_b32 v6, 1
s_nop 0
v_cndmask_b32 v5, v5, 0, vcc
s_waitcnt vmcnt(0)
buffer_store_dword v6, v5, s[8:11], s24 offen sc1
.Lj2next_432:
s_add_u32 s32, s32, 96
s_cmp_lt_u32 s32, 256
s_cbranch_scc1 .Lj2loop_430
s_waitcnt vmcnt(0)
s_branch .Ljoin_406
.Lb1_405:
s_mov_b32 s39, 8000
v_lshlrev_b32 v1, 4, v0
s_mul_i32 s24, s63, 29696
s_add_u32 s24, s24, 63242240
buffer_load_dwordx4 a[128:131], v1, s[8:11], s24 offen offset:0
buffer_load_dwordx4 a[132:135], v1, s[8:11], s24 offen offset:1024
buffer_load_dwordx4 a[136:139], v1, s[8:11], s24 offen offset:2048
buffer_load_dwordx4 a[140:143], v1, s[8:11], s24 offen offset:3072
s_add_u32 s24, s24, 4096
buffer_load_dwordx4 a[144:147], v1, s[8:11], s24 offen offset:0
buffer_load_dwordx4 a[148:151], v1, s[8:11], s24 offen offset:1024
buffer_load_dwordx4 a[152:155], v1, s[8:11], s24 offen offset:2048
buffer_load_dwordx4 a[156:159], v1, s[8:11], s24 offen offset:3072
s_add_u32 s24, s24, 4096
buffer_load_dwordx4 a[160:163], v1, s[8:11], s24 offen offset:0
buffer_load_dwordx4 a[164:167], v1, s[8:11], s24 offen offset:1024
buffer_load_dwordx4 a[168:171], v1, s[8:11], s24 offen offset:2048
buffer_load_dwordx4 a[172:175], v1, s[8:11], s24 offen offset:3072
s_add_u32 s24, s24, 4096
buffer_load_dwordx4 a[176:179], v1, s[8:11], s24 offen offset:0
buffer_load_dwordx4 a[180:183], v1, s[8:11], s24 offen offset:1024
buffer_load_dwordx4 a[184:187], v1, s[8:11], s24 offen offset:2048
buffer_load_dwordx4 a[188:191], v1, s[8:11], s24 offen offset:3072
s_add_u32 s24, s24, 4096
buffer_load_dwordx4 a[192:195], v1, s[8:11], s24 offen offset:0
buffer_load_dwordx4 a[196:199], v1, s[8:11], s24 offen offset:1024
buffer_load_dwordx4 a[200:203], v1, s[8:11], s24 offen offset:2048
buffer_load_dwordx4 a[204:207], v1, s[8:11], s24 offen offset:3072
s_add_u32 s24, s24, 4096
buffer_load_dwordx4 a[208:211], v1, s[8:11], s24 offen offset:0
buffer_load_dwordx4 a[212:215], v1, s[8:11], s24 offen offset:1024
buffer_load_dwordx4 a[216:219], v1, s[8:11], s24 offen offset:2048
buffer_load_dwordx4 a[220:223], v1, s[8:11], s24 offen offset:3072
s_add_u32 s24, s24, 4096
buffer_load_dwordx4 a[224:227], v1, s[8:11], s24 offen offset:0
buffer_load_dwordx4 a[228:231], v1, s[8:11], s24 offen offset:1024
buffer_load_dwordx4 a[232:235], v1, s[8:11], s24 offen offset:2048
buffer_load_dwordx4 a[236:239], v1, s[8:11], s24 offen offset:3072
s_add_u32 s24, s24, 4096
buffer_load_dwordx4 a[240:243], v1, s[8:11], s24 offen offset:0
s_lshl_b32 s28, s58, 13
s_lshl_b32 s29, s17, 11
s_add_u32 s28, s28, s29
s_add_u32 s28, s28, 63660032
buffer_load_dwordx4 v[228:231], v1, s[8:11], s28 offen
buffer_load_dwordx4 v[232:235], v1, s[8:11], s28 offen offset:1024
v_and_b32 v5, 15, v0
v_lshrrev_b32 v6, 4, v0
s_lshl_b32 s29, s17, 4
v_add_u32 v7, s29, v5
v_cvt_f32_u32 v8, v7
v_cvt_f32_u32 v9, v6
v_cvt_f32_u32 v10, v5
v_mul_f32 v11, 0x3c800000, v8
v_mul_f32 v162, 0x41000000, v9
v_add_f32 v156, 0x0, v162
v_mul_f32 v156, v156, v11
v_fract_f32 v156, v156
v_add_f32 v157, 0x3f800000, v162
v_mul_f32 v157, v157, v11
v_fract_f32 v157, v157
v_cos_f32 v158, v156
v_cos_f32 v159, v157
v_sin_f32 v160, v156
v_sin_f32 v161, v157
s_nop 0
v_cvt_pk_bf16_f32 v164, v158, v159
v_cvt_pk_bf16_f32 v172, v160, v161
v_add_f32 v156, 0x40000000, v162
v_mul_f32 v156, v156, v11
v_fract_f32 v156, v156
v_add_f32 v157, 0x40400000, v162
v_mul_f32 v157, v157, v11
v_fract_f32 v157, v157
v_cos_f32 v158, v156
v_cos_f32 v159, v157
v_sin_f32 v160, v156
v_sin_f32 v161, v157
s_nop 0
v_cvt_pk_bf16_f32 v165, v158, v159
v_cvt_pk_bf16_f32 v173, v160, v161
v_add_f32 v156, 0x40800000, v162
v_mul_f32 v156, v156, v11
v_fract_f32 v156, v156
v_add_f32 v157, 0x40a00000, v162
v_mul_f32 v157, v157, v11
v_fract_f32 v157, v157
v_cos_f32 v158, v156
v_cos_f32 v159, v157
v_sin_f32 v160, v156
v_sin_f32 v161, v157
s_nop 0
v_cvt_pk_bf16_f32 v166, v158, v159
v_cvt_pk_bf16_f32 v174, v160, v161
v_add_f32 v156, 0x40c00000, v162
v_mul_f32 v156, v156, v11
v_fract_f32 v156, v156
v_add_f32 v157, 0x40e00000, v162
v_mul_f32 v157, v157, v11
v_fract_f32 v157, v157
v_cos_f32 v158, v156
v_cos_f32 v159, v157
v_sin_f32 v160, v156
v_sin_f32 v161, v157
s_nop 0
v_cvt_pk_bf16_f32 v167, v158, v159
v_cvt_pk_bf16_f32 v175, v160, v161
v_add_f32 v156, 0x42000000, v162
v_mul_f32 v156, v156, v11
v_fract_f32 v156, v156
v_add_f32 v157, 0x42040000, v162
v_mul_f32 v157, v157, v11
v_fract_f32 v157, v157
v_cos_f32 v158, v156
v_cos_f32 v159, v157
v_sin_f32 v160, v156
v_sin_f32 v161, v157
s_nop 0
v_cvt_pk_bf16_f32 v168, v158, v159
v_cvt_pk_bf16_f32 v176, v160, v161
v_add_f32 v156, 0x42080000, v162
v_mul_f32 v156, v156, v11
v_fract_f32 v156, v156
v_add_f32 v157, 0x420c0000, v162
v_mul_f32 v157, v157, v11
v_fract_f32 v157, v157
v_cos_f32 v158, v156
v_cos_f32 v159, v157
v_sin_f32 v160, v156
v_sin_f32 v161, v157
s_nop 0
v_cvt_pk_bf16_f32 v169, v158, v159
v_cvt_pk_bf16_f32 v177, v160, v161
v_add_f32 v156, 0x42100000, v162
v_mul_f32 v156, v156, v11
v_fract_f32 v156, v156
v_add_f32 v157, 0x42140000, v162
v_mul_f32 v157, v157, v11
v_fract_f32 v157, v157
v_cos_f32 v158, v156
v_cos_f32 v159, v157
v_sin_f32 v160, v156
v_sin_f32 v161, v157
s_nop 0
v_cvt_pk_bf16_f32 v170, v158, v159
v_cvt_pk_bf16_f32 v178, v160, v161
v_add_f32 v156, 0x42180000, v162
v_mul_f32 v156, v156, v11
v_fract_f32 v156, v156
v_add_f32 v157, 0x421c0000, v162
v_mul_f32 v157, v157, v11
v_fract_f32 v157, v157
v_cos_f32 v158, v156
v_cos_f32 v159, v157
v_sin_f32 v160, v156
v_sin_f32 v161, v157
s_nop 0
v_cvt_pk_bf16_f32 v171, v158, v159
v_cvt_pk_bf16_f32 v179, v160, v161
v_xor_b32 v180, 0x80008000, v172
v_xor_b32 v181, 0x80008000, v173
v_xor_b32 v182, 0x80008000, v174
v_xor_b32 v183, 0x80008000, v175
v_xor_b32 v184, 0x80008000, v176
v_xor_b32 v185, 0x80008000, v177
v_xor_b32 v186, 0x80008000, v178
v_xor_b32 v187, 0x80008000, v179
v_mul_f32 v162, 4.0, v9
v_add_f32 v156, 0x0, v162
v_add_f32 v163, 0x0, v10
v_mul_f32 v156, v156, v163
v_mul_f32 v156, 0x3d000000, v156
v_fract_f32 v156, v156
v_add_f32 v157, 0x3f800000, v162
v_add_f32 v163, 0x0, v10
v_mul_f32 v157, v157, v163
v_mul_f32 v157, 0x3d000000, v157
v_fract_f32 v157, v157
v_cos_f32 v158, v156
v_cos_f32 v159, v157
v_sin_f32 v160, v156
v_sin_f32 v161, v157
s_nop 0
v_cvt_pk_bf16_f32 v188, v158, v159
v_cvt_pk_bf16_f32 v196, v160, v161
v_add_f32 v156, 0x40000000, v162
v_add_f32 v163, 0x0, v10
v_mul_f32 v156, v156, v163
v_mul_f32 v156, 0x3d000000, v156
v_fract_f32 v156, v156
v_add_f32 v157, 0x40400000, v162
v_add_f32 v163, 0x0, v10
v_mul_f32 v157, v157, v163
v_mul_f32 v157, 0x3d000000, v157
v_fract_f32 v157, v157
v_cos_f32 v158, v156
v_cos_f32 v159, v157
v_sin_f32 v160, v156
v_sin_f32 v161, v157
s_nop 0
v_cvt_pk_bf16_f32 v189, v158, v159
v_cvt_pk_bf16_f32 v197, v160, v161
v_add_f32 v156, 0x41800000, v162
v_add_f32 v163, 0x0, v10
v_mul_f32 v156, v156, v163
v_mul_f32 v156, 0x3d000000, v156
v_fract_f32 v156, v156
v_add_f32 v157, 0x41880000, v162
v_add_f32 v163, 0x0, v10
v_mul_f32 v157, v157, v163
v_mul_f32 v157, 0x3d000000, v157
v_fract_f32 v157, v157
v_cos_f32 v158, v156
v_cos_f32 v159, v157
v_sin_f32 v160, v156
v_sin_f32 v161, v157
s_nop 0
v_cvt_pk_bf16_f32 v190, v158, v159
v_cvt_pk_bf16_f32 v198, v160, v161
v_add_f32 v156, 0x41900000, v162
v_add_f32 v163, 0x0, v10
v_mul_f32 v156, v156, v163
v_mul_f32 v156, 0x3d000000, v156
v_fract_f32 v156, v156
v_add_f32 v157, 0x41980000, v162
v_add_f32 v163, 0x0, v10
v_mul_f32 v157, v157, v163
v_mul_f32 v157, 0x3d000000, v157
v_fract_f32 v157, v157
v_cos_f32 v158, v156
v_cos_f32 v159, v157
v_sin_f32 v160, v156
v_sin_f32 v161, v157
s_nop 0
v_cvt_pk_bf16_f32 v191, v158, v159
v_cvt_pk_bf16_f32 v199, v160, v161
v_add_f32 v156, 0x0, v162
v_add_f32 v163, 0x41800000, v10
v_mul_f32 v156, v156, v163
v_mul_f32 v156, 0x3d000000, v156
v_fract_f32 v156, v156
v_add_f32 v157, 0x3f800000, v162
v_add_f32 v163, 0x41800000, v10
v_mul_f32 v157, v157, v163
v_mul_f32 v157, 0x3d000000, v157
v_fract_f32 v157, v157
v_cos_f32 v158, v156
v_cos_f32 v159, v157
v_sin_f32 v160, v156
v_sin_f32 v161, v157
s_nop 0
v_cvt_pk_bf16_f32 v192, v158, v159
v_cvt_pk_bf16_f32 v200, v160, v161
v_add_f32 v156, 0x40000000, v162
v_add_f32 v163, 0x41800000, v10
v_mul_f32 v156, v156, v163
v_mul_f32 v156, 0x3d000000, v156
v_fract_f32 v156, v156
v_add_f32 v157, 0x40400000, v162
v_add_f32 v163, 0x41800000, v10
v_mul_f32 v157, v157, v163
v_mul_f32 v157, 0x3d000000, v157
v_fract_f32 v157, v157
v_cos_f32 v158, v156
v_cos_f32 v159, v157
v_sin_f32 v160, v156
v_sin_f32 v161, v157
s_nop 0
v_cvt_pk_bf16_f32 v193, v158, v159
v_cvt_pk_bf16_f32 v201, v160, v161
v_add_f32 v156, 0x41800000, v162
v_add_f32 v163, 0x41800000, v10
v_mul_f32 v156, v156, v163
v_mul_f32 v156, 0x3d000000, v156
v_fract_f32 v156, v156
v_add_f32 v157, 0x41880000, v162
v_add_f32 v163, 0x41800000, v10
v_mul_f32 v157, v157, v163
v_mul_f32 v157, 0x3d000000, v157
v_fract_f32 v157, v157
v_cos_f32 v158, v156
v_cos_f32 v159, v157
v_sin_f32 v160, v156
v_sin_f32 v161, v157
s_nop 0
v_cvt_pk_bf16_f32 v194, v158, v159
v_cvt_pk_bf16_f32 v202, v160, v161
v_add_f32 v156, 0x41900000, v162
v_add_f32 v163, 0x41800000, v10
v_mul_f32 v156, v156, v163
v_mul_f32 v156, 0x3d000000, v156
v_fract_f32 v156, v156
v_add_f32 v157, 0x41980000, v162
v_add_f32 v163, 0x41800000, v10
v_mul_f32 v157, v157, v163
v_mul_f32 v157, 0x3d000000, v157
v_fract_f32 v157, v157
v_cos_f32 v158, v156
v_cos_f32 v159, v157
v_sin_f32 v160, v156
v_sin_f32 v161, v157
s_nop 0
v_cvt_pk_bf16_f32 v195, v158, v159
v_cvt_pk_bf16_f32 v203, v160, v161
v_xor_b32 v204, 0x80008000, v196
v_xor_b32 v205, 0x80008000, v197
v_xor_b32 v206, 0x80008000, v198
v_xor_b32 v207, 0x80008000, v199
v_xor_b32 v208, 0x80008000, v200
v_xor_b32 v209, 0x80008000, v201
v_xor_b32 v210, 0x80008000, v202
v_xor_b32 v211, 0x80008000, v203
v_mul_f32 v11, 0x3a000000, v8
v_add_f32 v156, 0x0, v162
v_mul_f32 v156, v156, v11
v_cos_f32 v212, v156
v_sin_f32 v220, v156
v_add_f32 v156, 0x3f800000, v162
v_mul_f32 v156, v156, v11
v_cos_f32 v213, v156
v_sin_f32 v221, v156
v_add_f32 v156, 0x40000000, v162
v_mul_f32 v156, v156, v11
v_cos_f32 v214, v156
v_sin_f32 v222, v156
v_add_f32 v156, 0x40400000, v162
v_mul_f32 v156, v156, v11
v_cos_f32 v215, v156
v_sin_f32 v223, v156
v_add_f32 v156, 0x41800000, v162
v_mul_f32 v156, v156, v11
v_cos_f32 v216, v156
v_sin_f32 v224, v156
v_add_f32 v156, 0x41880000, v162
v_mul_f32 v156, v156, v11
v_cos_f32 v217, v156
v_sin_f32 v225, v156
v_add_f32 v156, 0x41900000, v162
v_mul_f32 v156, v156, v11
v_cos_f32 v218, v156
v_sin_f32 v226, v156
v_add_f32 v156, 0x41980000, v162
v_mul_f32 v156, v156, v11
v_cos_f32 v219, v156
v_sin_f32 v227, v156
s_sub_u32 s16, s58, 208
s_and_b32 s34, s16, 3
s_lshr_b32 s18, s16, 2
s_lshl_b32 s19, s34, 2
s_add_u32 s19, s19, s17
s_mov_b32 s20, 0xffff0000
s_mov_b32 s39, 4000
v_and_b32 v2, 31, v0
v_cmp_gt_u32 s[22:23], 28, v2
v_lshlrev_b32 v155, 2, v0
s_mov_b32 s37, 68184192
s_mov_b32 s35, s39
.Lpf_453:
buffer_load_dword v156, v155, s[8:11], s37 offen sc1
s_waitcnt vmcnt(0)
v_cmp_eq_u32 vcc, 1, v156
s_nop 1
s_and_b32 s36, vcc_lo, vcc_hi
s_cmp_eq_u32 s36, -1
s_cbranch_scc1 .Lpo_454
s_sleep 8
s_sub_u32 s35, s35, 1
s_cbranch_scc0 .Lpf_453
s_mov_b32 s39, 0
.Lpo_454:
v_lshlrev_b32 v1, 4, v0
s_mul_i32 s28, s19, 28672
s_add_u32 s28, s28, 62812160
s_cmp_ge_u32 s19, 15
s_cselect_b32 s29, 0x10000000, 0
v_add_u32 v1, s29, v1
buffer_load_dwordx4 a[0:3], v1, s[8:11], s28 offen offset:0
buffer_load_dwordx4 a[4:7], v1, s[8:11], s28 offen offset:1024
buffer_load_dwordx4 a[8:11], v1, s[8:11], s28 offen offset:2048
buffer_load_dwordx4 a[12:15], v1, s[8:11], s28 offen offset:3072
s_add_u32 s28, s28, 4096
buffer_load_dwordx4 a[16:19], v1, s[8:11], s28 offen offset:0
buffer_load_dwordx4 a[20:23], v1, s[8:11], s28 offen offset:1024
buffer_load_dwordx4 a[24:27], v1, s[8:11], s28 offen offset:2048
buffer_load_dwordx4 a[28:31], v1, s[8:11], s28 offen offset:3072
s_add_u32 s28, s28, 4096
buffer_load_dwordx4 a[32:35], v1, s[8:11], s28 offen offset:0
buffer_load_dwordx4 a[36:39], v1, s[8:11], s28 offen offset:1024
buffer_load_dwordx4 a[40:43], v1, s[8:11], s28 offen offset:2048
buffer_load_dwordx4 a[44:47], v1, s[8:11], s28 offen offset:3072
s_add_u32 s28, s28, 4096
buffer_load_dwordx4 a[48:51], v1, s[8:11], s28 offen offset:0
buffer_load_dwordx4 a[52:55], v1, s[8:11], s28 offen offset:1024
buffer_load_dwordx4 a[56:59], v1, s[8:11], s28 offen offset:2048
buffer_load_dwordx4 a[60:63], v1, s[8:11], s28 offen offset:3072
s_add_u32 s28, s28, 4096
buffer_load_dwordx4 a[64:67], v1, s[8:11], s28 offen offset:0
buffer_load_dwordx4 a[68:71], v1, s[8:11], s28 offen offset:1024
buffer_load_dwordx4 a[72:75], v1, s[8:11], s28 offen offset:2048
buffer_load_dwordx4 a[76:79], v1, s[8:11], s28 offen offset:3072
s_add_u32 s28, s28, 4096
buffer_load_dwordx4 a[80:83], v1, s[8:11], s28 offen offset:0
buffer_load_dwordx4 a[84:87], v1, s[8:11], s28 offen offset:1024
buffer_load_dwordx4 a[88:91], v1, s[8:11], s28 offen offset:2048
buffer_load_dwordx4 a[92:95], v1, s[8:11], s28 offen offset:3072
s_add_u32 s28, s28, 4096
buffer_load_dwordx4 a[96:99], v1, s[8:11], s28 offen offset:0
buffer_load_dwordx4 a[100:103], v1, s[8:11], s28 offen offset:1024
buffer_load_dwordx4 a[104:107], v1, s[8:11], s28 offen offset:2048
buffer_load_dwordx4 a[108:111], v1, s[8:11], s28 offen offset:3072
s_add_u32 s28, s28, 4096
s_lshl_b32 s25, s17, 3
v_lshrrev_b32 v3, 5, v0
v_add_u32 v4, s25, v3
v_mul_u32_u24 v7, 912, v4
v_mul_u32_u24 v4, 896, v4
v_lshlrev_b32 v6, 4, v2
v_add_u32 v4, v4, v6
v_add_u32 v7, v7, v6
v_mov_b32 v6, 0x10000000
v_cndmask_b32 v4, v6, v4, s[22:23]
v_mul_u32_u24 v5, 912, v2
v_lshlrev_b32 v6, 4, v3
v_add_u32 v5, v5, v6
s_lshl_b32 s24, s19, 5
v_add_u32 v152, s24, v2
v_mul_u32_u24 v152, 4096, v152
v_add_u32 v152, v152, v6
v_and_b32 v152, 15, v0
v_add_u32 v152, s24, v152
v_mul_u32_u24 v152, 4096, v152
v_add_u32 v152, v152, v6
v_lshrrev_b32 v6, 4, v0
v_and_b32 v6, 1, v6
v_lshlrev_b32 v6, 5, v6
v_add_u32 v152, v152, v6
s_lshl_b32 s24, s17, 6
v_add_u32 v6, s24, v0
v_cmp_eq_u32 vcc, 0, v6
v_mov_b32 v6, 0x10000000
v_mov_b32 v154, 1
v_cndmask_b32 v153, v6, 0, vcc
.Lb1l_451:
s_lshl_b32 s37, s18, 6
s_cmp_ge_u32 s18, 56
s_cselect_b32 s36, 34816, 0
s_sub_u32 s37, s37, s36
s_add_u32 s37, s37, 118142976
s_mov_b32 s35, s39
.Lpf_455:
buffer_load_dword v156, v155, s[8:11], s37 offen sc1
s_waitcnt vmcnt(0)
v_cmp_eq_u32 vcc, 1, v156
s_nop 1
s_and_b32 s36, vcc_lo, 0x3fff
s_cmp_eq_u32 s36, 0x3fff
s_cbranch_scc1 .Lpo_456
s_sleep 2
s_sub_u32 s35, s35, 1
s_cbranch_scc0 .Lpf_455
s_mov_b32 s39, 0
.Lpo_456:
s_cmp_lt_u32 s18, 60
s_cbranch_scc1 .Lb1b_457
s_mov_b32 s37, 118147904
s_mov_b32 s35, s39
.Lpf_458:
buffer_load_dword v156, v155, s[8:11], s37 offen sc1
s_waitcnt vmcnt(0)
v_cmp_eq_u32 vcc, 1, v156
s_nop 1
s_and_b32 s36, vcc_lo, 0xffff
s_cmp_eq_u32 s36, 0xffff
s_cbranch_scc1 .Lpo_459
s_sleep 2
s_sub_u32 s35, s35, 1
s_cbranch_scc0 .Lpf_458
s_mov_b32 s39, 0
.Lpo_459:
.Lb1b_457:
s_mul_i32 s26, s18, 28672
s_add_u32 s26, s26, 109285376
s_add_u32 s27, s26, 3584
s_mov_b32 s35, s39
.Lb1r_460:
buffer_load_dwordx4 v[8:11], v4, s[8:11], s26 offen offset:0 sc1
buffer_load_dwordx4 v[12:15], v4, s[8:11], s26 offen offset:448 sc1
buffer_load_dwordx4 v[16:19], v4, s[8:11], s26 offen offset:1792 sc1
buffer_load_dwordx4 v[20:23], v4, s[8:11], s26 offen offset:2240 sc1
buffer_load_dwordx4 v[24:27], v4, s[8:11], s27 offen offset:0 sc1
buffer_load_dwordx4 v[28:31], v4, s[8:11], s27 offen offset:448 sc1
buffer_load_dwordx4 v[32:35], v4, s[8:11], s27 offen offset:1792 sc1
buffer_load_dwordx4 v[36:39], v4, s[8:11], s27 offen offset:2240 sc1
s_lshl_b32 s38, s18, 6
s_add_u32 s38, s38, 111120384
s_waitcnt vmcnt(0)
v_max_u32 v156, v8, v9
v_max3_u32 v156, v156, v10, v11
v_max3_u32 v156, v156, v12, v13
v_max3_u32 v156, v156, v14, v15
v_max3_u32 v156, v156, v16, v17
v_max3_u32 v156, v156, v18, v19
v_max3_u32 v156, v156, v20, v21
v_max3_u32 v156, v156, v22, v23
v_max3_u32 v156, v156, v24, v25
v_max3_u32 v156, v156, v26, v27
v_max3_u32 v156, v156, v28, v29
v_max3_u32 v156, v156, v30, v31
v_max3_u32 v156, v156, v32, v33
v_max3_u32 v156, v156, v34, v35
v_max3_u32 v156, v156, v36, v37
v_max3_u32 v156, v156, v38, v39
v_cmp_eq_u32 vcc, -1, v156
s_cbranch_vccz .Lb1o_461
s_sub_u32 s35, s35, 1
s_cbranch_scc0 .Lb1r_460
s_mov_b32 s39, 0
.Lb1o_461:
v_lshlrev_b32 v40, 16, v8
v_lshlrev_b32 v56, 16, v16
v_lshlrev_b32 v72, 16, v24
v_lshlrev_b32 v88, 16, v32
v_and_b32 v41, s20, v8
v_and_b32 v57, s20, v16
v_and_b32 v73, s20, v24
v_and_b32 v89, s20, v32
v_lshlrev_b32 v42, 16, v9
v_lshlrev_b32 v58, 16, v17
v_lshlrev_b32 v74, 16, v25
v_lshlrev_b32 v90, 16, v33
v_and_b32 v43, s20, v9
v_and_b32 v59, s20, v17
v_and_b32 v75, s20, v25
v_and_b32 v91, s20, v33
v_lshlrev_b32 v44, 16, v10
v_lshlrev_b32 v60, 16, v18
v_lshlrev_b32 v76, 16, v26
v_lshlrev_b32 v92, 16, v34
v_and_b32 v45, s20, v10
v_and_b32 v61, s20, v18
v_and_b32 v77, s20, v26
v_and_b32 v93, s20, v34
v_lshlrev_b32 v46, 16, v11
v_lshlrev_b32 v62, 16, v19
v_lshlrev_b32 v78, 16, v27
v_lshlrev_b32 v94, 16, v35
v_and_b32 v47, s20, v11
v_and_b32 v63, s20, v19
v_and_b32 v79, s20, v27
v_and_b32 v95, s20, v35
v_lshlrev_b32 v48, 16, v12
v_lshlrev_b32 v64, 16, v20
v_lshlrev_b32 v80, 16, v28
v_lshlrev_b32 v96, 16, v36
v_and_b32 v49, s20, v12
v_and_b32 v65, s20, v20
v_and_b32 v81, s20, v28
v_and_b32 v97, s20, v36
v_lshlrev_b32 v50, 16, v13
v_lshlrev_b32 v66, 16, v21
v_lshlrev_b32 v82, 16, v29
v_lshlrev_b32 v98, 16, v37
v_and_b32 v51, s20, v13
v_and_b32 v67, s20, v21
v_and_b32 v83, s20, v29
v_and_b32 v99, s20, v37
v_lshlrev_b32 v52, 16, v14
v_lshlrev_b32 v68, 16, v22
v_lshlrev_b32 v84, 16, v30
v_lshlrev_b32 v100, 16, v38
v_and_b32 v53, s20, v14
v_and_b32 v69, s20, v22
v_and_b32 v85, s20, v30
v_and_b32 v101, s20, v38
v_lshlrev_b32 v54, 16, v15
v_lshlrev_b32 v70, 16, v23
v_lshlrev_b32 v86, 16, v31
v_lshlrev_b32 v102, 16, v39
v_and_b32 v55, s20, v15
v_and_b32 v71, s20, v23
v_and_b32 v87, s20, v31
v_and_b32 v103, s20, v39
v_pk_add_f32 v[104:105], v[40:41], v[42:43]
v_pk_add_f32 v[112:113], v[56:57], v[58:59]
v_pk_add_f32 v[120:121], v[72:73], v[74:75]
v_pk_add_f32 v[128:129], v[88:89], v[90:91]
v_pk_add_f32 v[106:107], v[44:45], v[46:47]
v_pk_add_f32 v[114:115], v[60:61], v[62:63]
v_pk_add_f32 v[122:123], v[76:77], v[78:79]
v_pk_add_f32 v[130:131], v[92:93], v[94:95]
v_pk_add_f32 v[108:109], v[48:49], v[50:51]
v_pk_add_f32 v[116:117], v[64:65], v[66:67]
v_pk_add_f32 v[124:125], v[80:81], v[82:83]
v_pk_add_f32 v[132:133], v[96:97], v[98:99]
v_pk_add_f32 v[110:111], v[52:53], v[54:55]
v_pk_add_f32 v[118:119], v[68:69], v[70:71]
v_pk_add_f32 v[126:127], v[84:85], v[86:87]
v_pk_add_f32 v[134:135], v[100:101], v[102:103]
v_pk_add_f32 v[104:105], v[104:105], v[106:107]
v_pk_add_f32 v[112:113], v[112:113], v[114:115]
v_pk_add_f32 v[120:121], v[120:121], v[122:123]
v_pk_add_f32 v[128:129], v[128:129], v[130:131]
v_pk_add_f32 v[108:109], v[108:109], v[110:111]
v_pk_add_f32 v[116:117], v[116:117], v[118:119]
v_pk_add_f32 v[124:125], v[124:125], v[126:127]
v_pk_add_f32 v[132:133], v[132:133], v[134:135]
v_pk_add_f32 v[104:105], v[104:105], v[108:109]
v_pk_add_f32 v[112:113], v[112:113], v[116:117]
v_pk_add_f32 v[120:121], v[120:121], v[124:125]
v_pk_add_f32 v[128:129], v[128:129], v[132:133]
v_add_f32 v104, v104, v105
v_add_f32 v112, v112, v113
v_add_f32 v120, v120, v121
v_add_f32 v128, v128, v129
v_add_f32_dpp v104, v104, v104 row_ror:8 row_mask:0xf bank_mask:0xf
v_add_f32_dpp v112, v112, v112 row_ror:8 row_mask:0xf bank_mask:0xf
v_add_f32_dpp v120, v120, v120 row_ror:8 row_mask:0xf bank_mask:0xf
v_add_f32_dpp v128, v128, v128 row_ror:8 row_mask:0xf bank_mask:0xf
v_add_f32_dpp v104, v104, v104 row_ror:4 row_mask:0xf bank_mask:0xf
v_add_f32_dpp v112, v112, v112 row_ror:4 row_mask:0xf bank_mask:0xf
v_add_f32_dpp v120, v120, v120 row_ror:4 row_mask:0xf bank_mask:0xf
v_add_f32_dpp v128, v128, v128 row_ror:4 row_mask:0xf bank_mask:0xf
v_add_f32_dpp v104, v104, v104 row_ror:2 row_mask:0xf bank_mask:0xf
v_add_f32_dpp v112, v112, v112 row_ror:2 row_mask:0xf bank_mask:0xf
v_add_f32_dpp v120, v120, v120 row_ror:2 row_mask:0xf bank_mask:0xf
v_add_f32_dpp v128, v128, v128 row_ror:2 row_mask:0xf bank_mask:0xf
v_add_f32_dpp v104, v104, v104 row_ror:1 row_mask:0xf bank_mask:0xf
v_add_f32_dpp v112, v112, v112 row_ror:1 row_mask:0xf bank_mask:0xf
v_add_f32_dpp v120, v120, v120 row_ror:1 row_mask:0xf bank_mask:0xf
v_add_f32_dpp v128, v128, v128 row_ror:1 row_mask:0xf bank_mask:0xf
v_mov_b32 v105, v104
v_mov_b32 v113, v112
v_mov_b32 v121, v120
v_mov_b32 v129, v128
v_permlane16_swap_b32 v104, v105
v_permlane16_swap_b32 v112, v113
v_permlane16_swap_b32 v120, v121
v_permlane16_swap_b32 v128, v129
v_add_f32 v104, v104, v105
v_add_f32 v112, v112, v113
v_add_f32 v120, v120, v121
v_add_f32 v128, v128, v129
v_mul_f32 v104, 0x3b124925, v104
v_mul_f32 v112, 0x3b124925, v112
v_mul_f32 v120, 0x3b124925, v120
v_mul_f32 v128, 0x3b124925, v128
v_cndmask_b32 v106, 0, v104, s[22:23]
v_cndmask_b32 v114, 0, v112, s[22:23]
v_cndmask_b32 v122, 0, v120, s[22:23]
v_cndmask_b32 v130, 0, v128, s[22:23]
v_pk_add_f32 v[8:9], v[40:41], v[106:107] op_sel_hi:[1,0] neg_lo:[0,1] neg_hi:[0,1]
v_pk_add_f32 v[16:17], v[56:57], v[114:115] op_sel_hi:[1,0] neg_lo:[0,1] neg_hi:[0,1]
v_pk_add_f32 v[24:25], v[72:73], v[122:123] op_sel_hi:[1,0] neg_lo:[0,1] neg_hi:[0,1]
v_pk_add_f32 v[32:33], v[88:89], v[130:131] op_sel_hi:[1,0] neg_lo:[0,1] neg_hi:[0,1]
v_pk_mul_f32 v[108:109], v[8:9], v[8:9]
v_pk_mul_f32 v[116:117], v[16:17], v[16:17]
v_pk_mul_f32 v[124:125], v[24:25], v[24:25]
v_pk_mul_f32 v[132:133], v[32:33], v[32:33]
v_pk_add_f32 v[10:11], v[42:43], v[106:107] op_sel_hi:[1,0] neg_lo:[0,1] neg_hi:[0,1]
v_pk_add_f32 v[18:19], v[58:59], v[114:115] op_sel_hi:[1,0] neg_lo:[0,1] neg_hi:[0,1]
v_pk_add_f32 v[26:27], v[74:75], v[122:123] op_sel_hi:[1,0] neg_lo:[0,1] neg_hi:[0,1]
v_pk_add_f32 v[34:35], v[90:91], v[130:131] op_sel_hi:[1,0] neg_lo:[0,1] neg_hi:[0,1]
v_pk_mul_f32 v[110:111], v[10:11], v[10:11]
v_pk_mul_f32 v[118:119], v[18:19], v[18:19]
v_pk_mul_f32 v[126:127], v[26:27], v[26:27]
v_pk_mul_f32 v[134:135], v[34:35], v[34:35]
v_pk_add_f32 v[12:13], v[44:45], v[106:107] op_sel_hi:[1,0] neg_lo:[0,1] neg_hi:[0,1]
v_pk_add_f32 v[20:21], v[60:61], v[114:115] op_sel_hi:[1,0] neg_lo:[0,1] neg_hi:[0,1]
v_pk_add_f32 v[28:29], v[76:77], v[122:123] op_sel_hi:[1,0] neg_lo:[0,1] neg_hi:[0,1]
v_pk_add_f32 v[36:37], v[92:93], v[130:131] op_sel_hi:[1,0] neg_lo:[0,1] neg_hi:[0,1]
v_pk_fma_f32 v[108:109], v[12:13], v[12:13], v[108:109]
v_pk_fma_f32 v[116:117], v[20:21], v[20:21], v[116:117]
v_pk_fma_f32 v[124:125], v[28:29], v[28:29], v[124:125]
v_pk_fma_f32 v[132:133], v[36:37], v[36:37], v[132:133]
v_pk_add_f32 v[14:15], v[46:47], v[106:107] op_sel_hi:[1,0] neg_lo:[0,1] neg_hi:[0,1]
v_pk_add_f32 v[22:23], v[62:63], v[114:115] op_sel_hi:[1,0] neg_lo:[0,1] neg_hi:[0,1]
v_pk_add_f32 v[30:31], v[78:79], v[122:123] op_sel_hi:[1,0] neg_lo:[0,1] neg_hi:[0,1]
v_pk_add_f32 v[38:39], v[94:95], v[130:131] op_sel_hi:[1,0] neg_lo:[0,1] neg_hi:[0,1]
v_pk_fma_f32 v[110:111], v[14:15], v[14:15], v[110:111]
v_pk_fma_f32 v[118:119], v[22:23], v[22:23], v[118:119]
v_pk_fma_f32 v[126:127], v[30:31], v[30:31], v[126:127]
v_pk_fma_f32 v[134:135], v[38:39], v[38:39], v[134:135]
v_pk_add_f32 v[8:9], v[48:49], v[106:107] op_sel_hi:[1,0] neg_lo:[0,1] neg_hi:[0,1]
v_pk_add_f32 v[16:17], v[64:65], v[114:115] op_sel_hi:[1,0] neg_lo:[0,1] neg_hi:[0,1]
v_pk_add_f32 v[24:25], v[80:81], v[122:123] op_sel_hi:[1,0] neg_lo:[0,1] neg_hi:[0,1]
v_pk_add_f32 v[32:33], v[96:97], v[130:131] op_sel_hi:[1,0] neg_lo:[0,1] neg_hi:[0,1]
v_pk_fma_f32 v[108:109], v[8:9], v[8:9], v[108:109]
v_pk_fma_f32 v[116:117], v[16:17], v[16:17], v[116:117]
v_pk_fma_f32 v[124:125], v[24:25], v[24:25], v[124:125]
v_pk_fma_f32 v[132:133], v[32:33], v[32:33], v[132:133]
v_pk_add_f32 v[10:11], v[50:51], v[106:107] op_sel_hi:[1,0] neg_lo:[0,1] neg_hi:[0,1]
v_pk_add_f32 v[18:19], v[66:67], v[114:115] op_sel_hi:[1,0] neg_lo:[0,1] neg_hi:[0,1]
v_pk_add_f32 v[26:27], v[82:83], v[122:123] op_sel_hi:[1,0] neg_lo:[0,1] neg_hi:[0,1]
v_pk_add_f32 v[34:35], v[98:99], v[130:131] op_sel_hi:[1,0] neg_lo:[0,1] neg_hi:[0,1]
v_pk_fma_f32 v[110:111], v[10:11], v[10:11], v[110:111]
v_pk_fma_f32 v[118:119], v[18:19], v[18:19], v[118:119]
v_pk_fma_f32 v[126:127], v[26:27], v[26:27], v[126:127]
v_pk_fma_f32 v[134:135], v[34:35], v[34:35], v[134:135]
v_pk_add_f32 v[12:13], v[52:53], v[106:107] op_sel_hi:[1,0] neg_lo:[0,1] neg_hi:[0,1]
v_pk_add_f32 v[20:21], v[68:69], v[114:115] op_sel_hi:[1,0] neg_lo:[0,1] neg_hi:[0,1]
v_pk_add_f32 v[28:29], v[84:85], v[122:123] op_sel_hi:[1,0] neg_lo:[0,1] neg_hi:[0,1]
v_pk_add_f32 v[36:37], v[100:101], v[130:131] op_sel_hi:[1,0] neg_lo:[0,1] neg_hi:[0,1]
v_pk_fma_f32 v[108:109], v[12:13], v[12:13], v[108:109]
v_pk_fma_f32 v[116:117], v[20:21], v[20:21], v[116:117]
v_pk_fma_f32 v[124:125], v[28:29], v[28:29], v[124:125]
v_pk_fma_f32 v[132:133], v[36:37], v[36:37], v[132:133]
v_pk_add_f32 v[14:15], v[54:55], v[106:107] op_sel_hi:[1,0] neg_lo:[0,1] neg_hi:[0,1]
v_pk_add_f32 v[22:23], v[70:71], v[114:115] op_sel_hi:[1,0] neg_lo:[0,1] neg_hi:[0,1]
v_pk_add_f32 v[30:31], v[86:87], v[122:123] op_sel_hi:[1,0] neg_lo:[0,1] neg_hi:[0,1]
v_pk_add_f32 v[38:39], v[102:103], v[130:131] op_sel_hi:[1,0] neg_lo:[0,1] neg_hi:[0,1]
v_pk_fma_f32 v[110:111], v[14:15], v[14:15], v[110:111]
v_pk_fma_f32 v[118:119], v[22:23], v[22:23], v[118:119]
v_pk_fma_f32 v[126:127], v[30:31], v[30:31], v[126:127]
v_pk_fma_f32 v[134:135], v[38:39], v[38:39], v[134:135]
v_pk_add_f32 v[108:109], v[108:109], v[110:111]
v_pk_add_f32 v[116:117], v[116:117], v[118:119]
v_pk_add_f32 v[124:125], v[124:125], v[126:127]
v_pk_add_f32 v[132:133], v[132:133], v[134:135]
v_add_f32 v108, v108, v109
v_add_f32 v116, v116, v117
v_add_f32 v124, v124, v125
v_add_f32 v132, v132, v133
v_add_f32_dpp v108, v108, v108 row_ror:8 row_mask:0xf bank_mask:0xf
v_add_f32_dpp v116, v116, v116 row_ror:8 row_mask:0xf bank_mask:0xf
v_add_f32_dpp v124, v124, v124 row_ror:8 row_mask:0xf bank_mask:0xf
v_add_f32_dpp v132, v132, v132 row_ror:8 row_mask:0xf bank_mask:0xf
v_add_f32_dpp v108, v108, v108 row_ror:4 row_mask:0xf bank_mask:0xf
v_add_f32_dpp v116, v116, v116 row_ror:4 row_mask:0xf bank_mask:0xf
v_add_f32_dpp v124, v124, v124 row_ror:4 row_mask:0xf bank_mask:0xf
v_add_f32_dpp v132, v132, v132 row_ror:4 row_mask:0xf bank_mask:0xf
v_add_f32_dpp v108, v108, v108 row_ror:2 row_mask:0xf bank_mask:0xf
v_add_f32_dpp v116, v116, v116 row_ror:2 row_mask:0xf bank_mask:0xf
v_add_f32_dpp v124, v124, v124 row_ror:2 row_mask:0xf bank_mask:0xf
v_add_f32_dpp v132, v132, v132 row_ror:2 row_mask:0xf bank_mask:0xf
v_add_f32_dpp v108, v108, v108 row_ror:1 row_mask:0xf bank_mask:0xf
v_add_f32_dpp v116, v116, v116 row_ror:1 row_mask:0xf bank_mask:0xf
v_add_f32_dpp v124, v124, v124 row_ror:1 row_mask:0xf bank_mask:0xf
v_add_f32_dpp v132, v132, v132 row_ror:1 row_mask:0xf bank_mask:0xf
v_mov_b32 v109, v108
v_mov_b32 v117, v116
v_mov_b32 v125, v124
v_mov_b32 v133, v132
v_permlane16_swap_b32 v108, v109
v_permlane16_swap_b32 v116, v117
v_permlane16_swap_b32 v124, v125
v_permlane16_swap_b32 v132, v133
v_add_f32 v108, v108, v109
v_add_f32 v116, v116, v117
v_add_f32 v124, v124, v125
v_add_f32 v132, v132, v133
v_mul_f32 v108, 0x3b124925, v108
v_mul_f32 v116, 0x3b124925, v116
v_mul_f32 v124, 0x3b124925, v124
v_mul_f32 v132, 0x3b124925, v132
v_cvt_pk_bf16_f32 v104, v104, v104
v_cvt_pk_bf16_f32 v112, v112, v112
v_cvt_pk_bf16_f32 v120, v120, v120
v_cvt_pk_bf16_f32 v128, v128, v128
v_cvt_pk_bf16_f32 v108, v108, v108
v_cvt_pk_bf16_f32 v116, v116, v116
v_cvt_pk_bf16_f32 v124, v124, v124
v_cvt_pk_bf16_f32 v132, v132, v132
v_and_b32 v104, s20, v104
v_and_b32 v112, s20, v112
v_and_b32 v120, s20, v120
v_and_b32 v128, s20, v128
v_and_b32 v108, s20, v108
v_and_b32 v116, s20, v116
v_and_b32 v124, s20, v124
v_and_b32 v132, s20, v132
v_add_f32 v108, 0x3727c5ac, v108
v_add_f32 v116, 0x3727c5ac, v116
v_add_f32 v124, 0x3727c5ac, v124
v_add_f32 v132, 0x3727c5ac, v132
v_cvt_pk_bf16_f32 v108, v108, v108
v_cvt_pk_bf16_f32 v116, v116, v116
v_cvt_pk_bf16_f32 v124, v124, v124
v_cvt_pk_bf16_f32 v132, v132, v132
v_and_b32 v108, s20, v108
v_and_b32 v116, s20, v116
v_and_b32 v124, s20, v124
v_and_b32 v132, s20, v132
v_sqrt_f32 v108, v108
v_sqrt_f32 v116, v116
v_sqrt_f32 v124, v124
v_sqrt_f32 v132, v132
v_cvt_pk_bf16_f32 v108, v108, v108
v_cvt_pk_bf16_f32 v116, v116, v116
v_cvt_pk_bf16_f32 v124, v124, v124
v_cvt_pk_bf16_f32 v132, v132, v132
v_and_b32 v108, s20, v108
v_and_b32 v116, s20, v116
v_and_b32 v124, s20, v124
v_and_b32 v132, s20, v132
v_rcp_f32 v108, v108
v_rcp_f32 v116, v116
v_rcp_f32 v124, v124
v_rcp_f32 v132, v132
v_pk_add_f32 v[40:41], v[40:41], v[104:105] op_sel_hi:[1,0] neg_lo:[0,1] neg_hi:[0,1]
v_pk_add_f32 v[56:57], v[56:57], v[112:113] op_sel_hi:[1,0] neg_lo:[0,1] neg_hi:[0,1]
v_pk_add_f32 v[72:73], v[72:73], v[120:121] op_sel_hi:[1,0] neg_lo:[0,1] neg_hi:[0,1]
v_pk_add_f32 v[88:89], v[88:89], v[128:129] op_sel_hi:[1,0] neg_lo:[0,1] neg_hi:[0,1]
v_cvt_pk_bf16_f32 v8, v40, v41
v_cvt_pk_bf16_f32 v16, v56, v57
v_cvt_pk_bf16_f32 v24, v72, v73
v_cvt_pk_bf16_f32 v32, v88, v89
v_pk_add_f32 v[42:43], v[42:43], v[104:105] op_sel_hi:[1,0] neg_lo:[0,1] neg_hi:[0,1]
v_pk_add_f32 v[58:59], v[58:59], v[112:113] op_sel_hi:[1,0] neg_lo:[0,1] neg_hi:[0,1]
v_pk_add_f32 v[74:75], v[74:75], v[120:121] op_sel_hi:[1,0] neg_lo:[0,1] neg_hi:[0,1]
v_pk_add_f32 v[90:91], v[90:91], v[128:129] op_sel_hi:[1,0] neg_lo:[0,1] neg_hi:[0,1]
v_cvt_pk_bf16_f32 v9, v42, v43
v_cvt_pk_bf16_f32 v17, v58, v59
v_cvt_pk_bf16_f32 v25, v74, v75
v_cvt_pk_bf16_f32 v33, v90, v91
v_pk_add_f32 v[44:45], v[44:45], v[104:105] op_sel_hi:[1,0] neg_lo:[0,1] neg_hi:[0,1]
v_pk_add_f32 v[60:61], v[60:61], v[112:113] op_sel_hi:[1,0] neg_lo:[0,1] neg_hi:[0,1]
v_pk_add_f32 v[76:77], v[76:77], v[120:121] op_sel_hi:[1,0] neg_lo:[0,1] neg_hi:[0,1]
v_pk_add_f32 v[92:93], v[92:93], v[128:129] op_sel_hi:[1,0] neg_lo:[0,1] neg_hi:[0,1]
v_cvt_pk_bf16_f32 v10, v44, v45
v_cvt_pk_bf16_f32 v18, v60, v61
v_cvt_pk_bf16_f32 v26, v76, v77
v_cvt_pk_bf16_f32 v34, v92, v93
v_pk_add_f32 v[46:47], v[46:47], v[104:105] op_sel_hi:[1,0] neg_lo:[0,1] neg_hi:[0,1]
v_pk_add_f32 v[62:63], v[62:63], v[112:113] op_sel_hi:[1,0] neg_lo:[0,1] neg_hi:[0,1]
v_pk_add_f32 v[78:79], v[78:79], v[120:121] op_sel_hi:[1,0] neg_lo:[0,1] neg_hi:[0,1]
v_pk_add_f32 v[94:95], v[94:95], v[128:129] op_sel_hi:[1,0] neg_lo:[0,1] neg_hi:[0,1]
v_cvt_pk_bf16_f32 v11, v46, v47
v_cvt_pk_bf16_f32 v19, v62, v63
v_cvt_pk_bf16_f32 v27, v78, v79
v_cvt_pk_bf16_f32 v35, v94, v95
v_pk_add_f32 v[48:49], v[48:49], v[104:105] op_sel_hi:[1,0] neg_lo:[0,1] neg_hi:[0,1]
v_pk_add_f32 v[64:65], v[64:65], v[112:113] op_sel_hi:[1,0] neg_lo:[0,1] neg_hi:[0,1]
v_pk_add_f32 v[80:81], v[80:81], v[120:121] op_sel_hi:[1,0] neg_lo:[0,1] neg_hi:[0,1]
v_pk_add_f32 v[96:97], v[96:97], v[128:129] op_sel_hi:[1,0] neg_lo:[0,1] neg_hi:[0,1]
v_cvt_pk_bf16_f32 v12, v48, v49
v_cvt_pk_bf16_f32 v20, v64, v65
v_cvt_pk_bf16_f32 v28, v80, v81
v_cvt_pk_bf16_f32 v36, v96, v97
v_pk_add_f32 v[50:51], v[50:51], v[104:105] op_sel_hi:[1,0] neg_lo:[0,1] neg_hi:[0,1]
v_pk_add_f32 v[66:67], v[66:67], v[112:113] op_sel_hi:[1,0] neg_lo:[0,1] neg_hi:[0,1]
v_pk_add_f32 v[82:83], v[82:83], v[120:121] op_sel_hi:[1,0] neg_lo:[0,1] neg_hi:[0,1]
v_pk_add_f32 v[98:99], v[98:99], v[128:129] op_sel_hi:[1,0] neg_lo:[0,1] neg_hi:[0,1]
v_cvt_pk_bf16_f32 v13, v50, v51
v_cvt_pk_bf16_f32 v21, v66, v67
v_cvt_pk_bf16_f32 v29, v82, v83
v_cvt_pk_bf16_f32 v37, v98, v99
v_pk_add_f32 v[52:53], v[52:53], v[104:105] op_sel_hi:[1,0] neg_lo:[0,1] neg_hi:[0,1]
v_pk_add_f32 v[68:69], v[68:69], v[112:113] op_sel_hi:[1,0] neg_lo:[0,1] neg_hi:[0,1]
v_pk_add_f32 v[84:85], v[84:85], v[120:121] op_sel_hi:[1,0] neg_lo:[0,1] neg_hi:[0,1]
v_pk_add_f32 v[100:101], v[100:101], v[128:129] op_sel_hi:[1,0] neg_lo:[0,1] neg_hi:[0,1]
v_cvt_pk_bf16_f32 v14, v52, v53
v_cvt_pk_bf16_f32 v22, v68, v69
v_cvt_pk_bf16_f32 v30, v84, v85
v_cvt_pk_bf16_f32 v38, v100, v101
v_pk_add_f32 v[54:55], v[54:55], v[104:105] op_sel_hi:[1,0] neg_lo:[0,1] neg_hi:[0,1]
v_pk_add_f32 v[70:71], v[70:71], v[112:113] op_sel_hi:[1,0] neg_lo:[0,1] neg_hi:[0,1]
v_pk_add_f32 v[86:87], v[86:87], v[120:121] op_sel_hi:[1,0] neg_lo:[0,1] neg_hi:[0,1]
v_pk_add_f32 v[102:103], v[102:103], v[128:129] op_sel_hi:[1,0] neg_lo:[0,1] neg_hi:[0,1]
v_cvt_pk_bf16_f32 v15, v54, v55
v_cvt_pk_bf16_f32 v23, v70, v71
v_cvt_pk_bf16_f32 v31, v86, v87
v_cvt_pk_bf16_f32 v39, v102, v103
v_lshlrev_b32 v40, 16, v8
v_lshlrev_b32 v56, 16, v16
v_lshlrev_b32 v72, 16, v24
v_lshlrev_b32 v88, 16, v32
v_and_b32 v41, s20, v8
v_and_b32 v57, s20, v16
v_and_b32 v73, s20, v24
v_and_b32 v89, s20, v32
v_pk_mul_f32 v[40:41], v[40:41], v[108:109] op_sel_hi:[1,0]
v_pk_mul_f32 v[56:57], v[56:57], v[116:117] op_sel_hi:[1,0]
v_pk_mul_f32 v[72:73], v[72:73], v[124:125] op_sel_hi:[1,0]
v_pk_mul_f32 v[88:89], v[88:89], v[132:133] op_sel_hi:[1,0]
v_lshlrev_b32 v42, 16, v9
v_lshlrev_b32 v58, 16, v17
v_lshlrev_b32 v74, 16, v25
v_lshlrev_b32 v90, 16, v33
v_and_b32 v43, s20, v9
v_and_b32 v59, s20, v17
v_and_b32 v75, s20, v25
v_and_b32 v91, s20, v33
v_pk_mul_f32 v[42:43], v[42:43], v[108:109] op_sel_hi:[1,0]
v_pk_mul_f32 v[58:59], v[58:59], v[116:117] op_sel_hi:[1,0]
v_pk_mul_f32 v[74:75], v[74:75], v[124:125] op_sel_hi:[1,0]
v_pk_mul_f32 v[90:91], v[90:91], v[132:133] op_sel_hi:[1,0]
v_lshlrev_b32 v44, 16, v10
v_lshlrev_b32 v60, 16, v18
v_lshlrev_b32 v76, 16, v26
v_lshlrev_b32 v92, 16, v34
v_and_b32 v45, s20, v10
v_and_b32 v61, s20, v18
v_and_b32 v77, s20, v26
v_and_b32 v93, s20, v34
v_pk_mul_f32 v[44:45], v[44:45], v[108:109] op_sel_hi:[1,0]
v_pk_mul_f32 v[60:61], v[60:61], v[116:117] op_sel_hi:[1,0]
v_pk_mul_f32 v[76:77], v[76:77], v[124:125] op_sel_hi:[1,0]
v_pk_mul_f32 v[92:93], v[92:93], v[132:133] op_sel_hi:[1,0]
v_lshlrev_b32 v46, 16, v11
v_lshlrev_b32 v62, 16, v19
v_lshlrev_b32 v78, 16, v27
v_lshlrev_b32 v94, 16, v35
v_and_b32 v47, s20, v11
v_and_b32 v63, s20, v19
v_and_b32 v79, s20, v27
v_and_b32 v95, s20, v35
v_pk_mul_f32 v[46:47], v[46:47], v[108:109] op_sel_hi:[1,0]
v_pk_mul_f32 v[62:63], v[62:63], v[116:117] op_sel_hi:[1,0]
v_pk_mul_f32 v[78:79], v[78:79], v[124:125] op_sel_hi:[1,0]
v_pk_mul_f32 v[94:95], v[94:95], v[132:133] op_sel_hi:[1,0]
v_lshlrev_b32 v48, 16, v12
v_lshlrev_b32 v64, 16, v20
v_lshlrev_b32 v80, 16, v28
v_lshlrev_b32 v96, 16, v36
v_and_b32 v49, s20, v12
v_and_b32 v65, s20, v20
v_and_b32 v81, s20, v28
v_and_b32 v97, s20, v36
v_pk_mul_f32 v[48:49], v[48:49], v[108:109] op_sel_hi:[1,0]
v_pk_mul_f32 v[64:65], v[64:65], v[116:117] op_sel_hi:[1,0]
v_pk_mul_f32 v[80:81], v[80:81], v[124:125] op_sel_hi:[1,0]
v_pk_mul_f32 v[96:97], v[96:97], v[132:133] op_sel_hi:[1,0]
v_lshlrev_b32 v50, 16, v13
v_lshlrev_b32 v66, 16, v21
v_lshlrev_b32 v82, 16, v29
v_lshlrev_b32 v98, 16, v37
v_and_b32 v51, s20, v13
v_and_b32 v67, s20, v21
v_and_b32 v83, s20, v29
v_and_b32 v99, s20, v37
v_pk_mul_f32 v[50:51], v[50:51], v[108:109] op_sel_hi:[1,0]
v_pk_mul_f32 v[66:67], v[66:67], v[116:117] op_sel_hi:[1,0]
v_pk_mul_f32 v[82:83], v[82:83], v[124:125] op_sel_hi:[1,0]
v_pk_mul_f32 v[98:99], v[98:99], v[132:133] op_sel_hi:[1,0]
v_lshlrev_b32 v52, 16, v14
v_lshlrev_b32 v68, 16, v22
v_lshlrev_b32 v84, 16, v30
v_lshlrev_b32 v100, 16, v38
v_and_b32 v53, s20, v14
v_and_b32 v69, s20, v22
v_and_b32 v85, s20, v30
v_and_b32 v101, s20, v38
v_pk_mul_f32 v[52:53], v[52:53], v[108:109] op_sel_hi:[1,0]
v_pk_mul_f32 v[68:69], v[68:69], v[116:117] op_sel_hi:[1,0]
v_pk_mul_f32 v[84:85], v[84:85], v[124:125] op_sel_hi:[1,0]
v_pk_mul_f32 v[100:101], v[100:101], v[132:133] op_sel_hi:[1,0]
v_lshlrev_b32 v54, 16, v15
v_lshlrev_b32 v70, 16, v23
v_lshlrev_b32 v86, 16, v31
v_lshlrev_b32 v102, 16, v39
v_and_b32 v55, s20, v15
v_and_b32 v71, s20, v23
v_and_b32 v87, s20, v31
v_and_b32 v103, s20, v39
v_pk_mul_f32 v[54:55], v[54:55], v[108:109] op_sel_hi:[1,0]
v_pk_mul_f32 v[70:71], v[70:71], v[116:117] op_sel_hi:[1,0]
v_pk_mul_f32 v[86:87], v[86:87], v[124:125] op_sel_hi:[1,0]
v_pk_mul_f32 v[102:103], v[102:103], v[132:133] op_sel_hi:[1,0]
v_cvt_pk_bf16_f32 v8, v40, v41
v_cvt_pk_bf16_f32 v16, v56, v57
v_cvt_pk_bf16_f32 v24, v72, v73
v_cvt_pk_bf16_f32 v32, v88, v89
v_cvt_pk_bf16_f32 v9, v42, v43
v_cvt_pk_bf16_f32 v17, v58, v59
v_cvt_pk_bf16_f32 v25, v74, v75
v_cvt_pk_bf16_f32 v33, v90, v91
v_cvt_pk_bf16_f32 v10, v44, v45
v_cvt_pk_bf16_f32 v18, v60, v61
v_cvt_pk_bf16_f32 v26, v76, v77
v_cvt_pk_bf16_f32 v34, v92, v93
v_cvt_pk_bf16_f32 v11, v46, v47
v_cvt_pk_bf16_f32 v19, v62, v63
v_cvt_pk_bf16_f32 v27, v78, v79
v_cvt_pk_bf16_f32 v35, v94, v95
v_cvt_pk_bf16_f32 v12, v48, v49
v_cvt_pk_bf16_f32 v20, v64, v65
v_cvt_pk_bf16_f32 v28, v80, v81
v_cvt_pk_bf16_f32 v36, v96, v97
v_cvt_pk_bf16_f32 v13, v50, v51
v_cvt_pk_bf16_f32 v21, v66, v67
v_cvt_pk_bf16_f32 v29, v82, v83
v_cvt_pk_bf16_f32 v37, v98, v99
v_cvt_pk_bf16_f32 v14, v52, v53
v_cvt_pk_bf16_f32 v22, v68, v69
v_cvt_pk_bf16_f32 v30, v84, v85
v_cvt_pk_bf16_f32 v38, v100, v101
v_cvt_pk_bf16_f32 v15, v54, v55
v_cvt_pk_bf16_f32 v23, v70, v71
v_cvt_pk_bf16_f32 v31, v86, v87
v_cvt_pk_bf16_f32 v39, v102, v103
s_mov_b64 s[24:25], exec
s_mov_b64 exec, s[22:23]
ds_write_b128 v7, v[8:11] offset:0
ds_write_b128 v7, v[12:15] offset:448
ds_write_b128 v7, v[16:19] offset:1824
ds_write_b128 v7, v[20:23] offset:2272
ds_write_b128 v7, v[24:27] offset:3648
ds_write_b128 v7, v[28:31] offset:4096
ds_write_b128 v7, v[32:35] offset:5472
ds_write_b128 v7, v[36:39] offset:5920
s_mov_b64 exec, s[24:25]
s_waitcnt lgkmcnt(0)
s_barrier
s_cmp_ge_u32 s19, 15
s_cbranch_scc1 .Lb1s_452
ds_read_b128 v[40:43], v5 offset:0
ds_read_b128 v[44:47], v5 offset:32
ds_read_b128 v[48:51], v5 offset:64
ds_read_b128 v[52:55], v5 offset:96
ds_read_b128 v[56:59], v5 offset:128
ds_read_b128 v[60:63], v5 offset:160
ds_read_b128 v[64:67], v5 offset:192
ds_read_b128 v[68:71], v5 offset:224
ds_read_b128 v[72:75], v5 offset:256
ds_read_b128 v[76:79], v5 offset:288
ds_read_b128 v[80:83], v5 offset:320
ds_read_b128 v[84:87], v5 offset:352
ds_read_b128 v[88:91], v5 offset:384
ds_read_b128 v[92:95], v5 offset:416
ds_read_b128 v[96:99], v5 offset:448
ds_read_b128 v[100:103], v5 offset:480
ds_read_b128 v[104:107], v5 offset:512
ds_read_b128 v[108:111], v5 offset:544
ds_read_b128 v[112:115], v5 offset:576
ds_read_b128 v[116:119], v5 offset:608
ds_read_b128 v[120:123], v5 offset:640
ds_read_b128 v[124:127], v5 offset:672
ds_read_b128 v[128:131], v5 offset:704
ds_read_b128 v[132:135], v5 offset:736
ds_read_b128 v[136:139], v5 offset:768
ds_read_b128 v[140:143], v5 offset:800
ds_read_b128 v[144:147], v5 offset:832
ds_read_b128 v[148:151], v5 offset:864
s_waitcnt lgkmcnt(15)
v_mfma_f32_32x32x16_bf16 v[8:23], v[40:43], a[0:3], 0
v_mfma_f32_32x32x16_bf16 v[8:23], v[44:47], a[4:7], v[8:23]
v_mfma_f32_32x32x16_bf16 v[8:23], v[48:51], a[8:11], v[8:23]
v_mfma_f32_32x32x16_bf16 v[8:23], v[52:55], a[12:15], v[8:23]
v_mfma_f32_32x32x16_bf16 v[8:23], v[56:59], a[16:19], v[8:23]
v_mfma_f32_32x32x16_bf16 v[8:23], v[60:63], a[20:23], v[8:23]
v_mfma_f32_32x32x16_bf16 v[8:23], v[64:67], a[24:27], v[8:23]
s_waitcnt lgkmcnt(14)
v_mfma_f32_32x32x16_bf16 v[8:23], v[68:71], a[28:31], v[8:23]
v_mfma_f32_32x32x16_bf16 v[8:23], v[72:75], a[32:35], v[8:23]
v_mfma_f32_32x32x16_bf16 v[8:23], v[76:79], a[36:39], v[8:23]
v_mfma_f32_32x32x16_bf16 v[8:23], v[80:83], a[40:43], v[8:23]
v_mfma_f32_32x32x16_bf16 v[8:23], v[84:87], a[44:47], v[8:23]
v_mfma_f32_32x32x16_bf16 v[8:23], v[88:91], a[48:51], v[8:23]
v_mfma_f32_32x32x16_bf16 v[8:23], v[92:95], a[52:55], v[8:23]
s_waitcnt lgkmcnt(7)
v_mfma_f32_32x32x16_bf16 v[8:23], v[96:99], a[56:59], v[8:23]
v_mfma_f32_32x32x16_bf16 v[8:23], v[100:103], a[60:63], v[8:23]
v_mfma_f32_32x32x16_bf16 v[8:23], v[104:107], a[64:67], v[8:23]
v_mfma_f32_32x32x16_bf16 v[8:23], v[108:111], a[68:71], v[8:23]
v_mfma_f32_32x32x16_bf16 v[8:23], v[112:115], a[72:75], v[8:23]
v_mfma_f32_32x32x16_bf16 v[8:23], v[116:119], a[76:79], v[8:23]
v_mfma_f32_32x32x16_bf16 v[8:23], v[120:123], a[80:83], v[8:23]
s_waitcnt lgkmcnt(0)
v_mfma_f32_32x32x16_bf16 v[8:23], v[124:127], a[84:87], v[8:23]
v_mfma_f32_32x32x16_bf16 v[8:23], v[128:131], a[88:91], v[8:23]
v_mfma_f32_32x32x16_bf16 v[8:23], v[132:135], a[92:95], v[8:23]
v_mfma_f32_32x32x16_bf16 v[8:23], v[136:139], a[96:99], v[8:23]
v_mfma_f32_32x32x16_bf16 v[8:23], v[140:143], a[100:103], v[8:23]
v_mfma_f32_32x32x16_bf16 v[8:23], v[144:147], a[104:107], v[8:23]
v_mfma_f32_32x32x16_bf16 v[8:23], v[148:151], a[108:111], v[8:23]
s_nop 7
s_nop 3
v_cvt_pk_bf16_f32 v24, v8, v9
v_cvt_pk_bf16_f32 v25, v10, v11
v_cvt_pk_bf16_f32 v26, v12, v13
v_cvt_pk_bf16_f32 v27, v14, v15
v_cvt_pk_bf16_f32 v28, v16, v17
v_cvt_pk_bf16_f32 v29, v18, v19
v_cvt_pk_bf16_f32 v30, v20, v21
v_cvt_pk_bf16_f32 v31, v22, v23
s_add_u32 s36, s38, 65536
s_nop 0
v_permlane32_swap_b32 v24, v26
v_permlane32_swap_b32 v25, v27
v_permlane32_swap_b32 v28, v30
v_permlane32_swap_b32 v29, v31
s_nop 1
v_permlane16_swap_b32 v24, v28
v_permlane16_swap_b32 v25, v29
v_permlane16_swap_b32 v26, v30
v_permlane16_swap_b32 v27, v31
buffer_store_dwordx4 v[24:27], v152, s[8:11], s38 offen sc1
buffer_store_dwordx4 v[28:31], v152, s[8:11], s36 offen sc1
.Lb1s_452:
s_lshl_b32 s37, s18, 4
s_lshl_b32 s36, s34, 2
s_add_u32 s37, s37, s36
s_add_u32 s37, s37, 118147072
s_cmp_ge_u32 s18, 56
s_cbranch_scc1 .Lb1n_466
s_waitcnt vmcnt(0)
s_barrier
buffer_store_dword v154, v153, s[8:11], s37 offen sc1
s_branch .Lb1n_467
.Lb1n_466:
s_barrier
.Lb1n_467:
s_add_u32 s18, s18, 4
s_cmp_lt_u32 s18, 64
s_cbranch_scc1 .Lb1l_451
s_waitcnt lgkmcnt(0)
s_barrier
s_mov_b32 s39, 8000
s_branch .Ljoin_407
.Ljoin_406:
s_waitcnt vmcnt(0) lgkmcnt(0)
s_barrier
s_mov_b32 s39, 8000
v_lshlrev_b32 v1, 4, v0
s_mul_i32 s24, s63, 29696
s_add_u32 s24, s24, 63242240
buffer_load_dwordx4 a[128:131], v1, s[8:11], s24 offen offset:0
buffer_load_dwordx4 a[132:135], v1, s[8:11], s24 offen offset:1024
buffer_load_dwordx4 a[136:139], v1, s[8:11], s24 offen offset:2048
buffer_load_dwordx4 a[140:143], v1, s[8:11], s24 offen offset:3072
s_add_u32 s24, s24, 4096
buffer_load_dwordx4 a[144:147], v1, s[8:11], s24 offen offset:0
buffer_load_dwordx4 a[148:151], v1, s[8:11], s24 offen offset:1024
buffer_load_dwordx4 a[152:155], v1, s[8:11], s24 offen offset:2048
buffer_load_dwordx4 a[156:159], v1, s[8:11], s24 offen offset:3072
s_add_u32 s24, s24, 4096
buffer_load_dwordx4 a[160:163], v1, s[8:11], s24 offen offset:0
buffer_load_dwordx4 a[164:167], v1, s[8:11], s24 offen offset:1024
buffer_load_dwordx4 a[168:171], v1, s[8:11], s24 offen offset:2048
buffer_load_dwordx4 a[172:175], v1, s[8:11], s24 offen offset:3072
s_add_u32 s24, s24, 4096
buffer_load_dwordx4 a[176:179], v1, s[8:11], s24 offen offset:0
buffer_load_dwordx4 a[180:183], v1, s[8:11], s24 offen offset:1024
buffer_load_dwordx4 a[184:187], v1, s[8:11], s24 offen offset:2048
buffer_load_dwordx4 a[188:191], v1, s[8:11], s24 offen offset:3072
s_add_u32 s24, s24, 4096
buffer_load_dwordx4 a[192:195], v1, s[8:11], s24 offen offset:0
buffer_load_dwordx4 a[196:199], v1, s[8:11], s24 offen offset:1024
buffer_load_dwordx4 a[200:203], v1, s[8:11], s24 offen offset:2048
buffer_load_dwordx4 a[204:207], v1, s[8:11], s24 offen offset:3072
s_add_u32 s24, s24, 4096
buffer_load_dwordx4 a[208:211], v1, s[8:11], s24 offen offset:0
buffer_load_dwordx4 a[212:215], v1, s[8:11], s24 offen offset:1024
buffer_load_dwordx4 a[216:219], v1, s[8:11], s24 offen offset:2048
buffer_load_dwordx4 a[220:223], v1, s[8:11], s24 offen offset:3072
s_add_u32 s24, s24, 4096
buffer_load_dwordx4 a[224:227], v1, s[8:11], s24 offen offset:0
buffer_load_dwordx4 a[228:231], v1, s[8:11], s24 offen offset:1024
buffer_load_dwordx4 a[232:235], v1, s[8:11], s24 offen offset:2048
buffer_load_dwordx4 a[236:239], v1, s[8:11], s24 offen offset:3072
s_add_u32 s24, s24, 4096
buffer_load_dwordx4 a[240:243], v1, s[8:11], s24 offen offset:0
s_lshl_b32 s28, s58, 13
s_lshl_b32 s29, s17, 11
s_add_u32 s28, s28, s29
s_add_u32 s28, s28, 63660032
buffer_load_dwordx4 v[228:231], v1, s[8:11], s28 offen
buffer_load_dwordx4 v[232:235], v1, s[8:11], s28 offen offset:1024
v_and_b32 v5, 15, v0
v_lshrrev_b32 v6, 4, v0
s_lshl_b32 s29, s17, 4
v_add_u32 v7, s29, v5
v_cvt_f32_u32 v8, v7
v_cvt_f32_u32 v9, v6
v_cvt_f32_u32 v10, v5
v_mul_f32 v11, 0x3c800000, v8
v_mul_f32 v162, 0x41000000, v9
v_add_f32 v156, 0x0, v162
v_mul_f32 v156, v156, v11
v_fract_f32 v156, v156
v_add_f32 v157, 0x3f800000, v162
v_mul_f32 v157, v157, v11
v_fract_f32 v157, v157
v_cos_f32 v158, v156
v_cos_f32 v159, v157
v_sin_f32 v160, v156
v_sin_f32 v161, v157
s_nop 0
v_cvt_pk_bf16_f32 v164, v158, v159
v_cvt_pk_bf16_f32 v172, v160, v161
v_add_f32 v156, 0x40000000, v162
v_mul_f32 v156, v156, v11
v_fract_f32 v156, v156
v_add_f32 v157, 0x40400000, v162
v_mul_f32 v157, v157, v11
v_fract_f32 v157, v157
v_cos_f32 v158, v156
v_cos_f32 v159, v157
v_sin_f32 v160, v156
v_sin_f32 v161, v157
s_nop 0
v_cvt_pk_bf16_f32 v165, v158, v159
v_cvt_pk_bf16_f32 v173, v160, v161
v_add_f32 v156, 0x40800000, v162
v_mul_f32 v156, v156, v11
v_fract_f32 v156, v156
v_add_f32 v157, 0x40a00000, v162
v_mul_f32 v157, v157, v11
v_fract_f32 v157, v157
v_cos_f32 v158, v156
v_cos_f32 v159, v157
v_sin_f32 v160, v156
v_sin_f32 v161, v157
s_nop 0
v_cvt_pk_bf16_f32 v166, v158, v159
v_cvt_pk_bf16_f32 v174, v160, v161
v_add_f32 v156, 0x40c00000, v162
v_mul_f32 v156, v156, v11
v_fract_f32 v156, v156
v_add_f32 v157, 0x40e00000, v162
v_mul_f32 v157, v157, v11
v_fract_f32 v157, v157
v_cos_f32 v158, v156
v_cos_f32 v159, v157
v_sin_f32 v160, v156
v_sin_f32 v161, v157
s_nop 0
v_cvt_pk_bf16_f32 v167, v158, v159
v_cvt_pk_bf16_f32 v175, v160, v161
v_add_f32 v156, 0x42000000, v162
v_mul_f32 v156, v156, v11
v_fract_f32 v156, v156
v_add_f32 v157, 0x42040000, v162
v_mul_f32 v157, v157, v11
v_fract_f32 v157, v157
v_cos_f32 v158, v156
v_cos_f32 v159, v157
v_sin_f32 v160, v156
v_sin_f32 v161, v157
s_nop 0
v_cvt_pk_bf16_f32 v168, v158, v159
v_cvt_pk_bf16_f32 v176, v160, v161
v_add_f32 v156, 0x42080000, v162
v_mul_f32 v156, v156, v11
v_fract_f32 v156, v156
v_add_f32 v157, 0x420c0000, v162
v_mul_f32 v157, v157, v11
v_fract_f32 v157, v157
v_cos_f32 v158, v156
v_cos_f32 v159, v157
v_sin_f32 v160, v156
v_sin_f32 v161, v157
s_nop 0
v_cvt_pk_bf16_f32 v169, v158, v159
v_cvt_pk_bf16_f32 v177, v160, v161
v_add_f32 v156, 0x42100000, v162
v_mul_f32 v156, v156, v11
v_fract_f32 v156, v156
v_add_f32 v157, 0x42140000, v162
v_mul_f32 v157, v157, v11
v_fract_f32 v157, v157
v_cos_f32 v158, v156
v_cos_f32 v159, v157
v_sin_f32 v160, v156
v_sin_f32 v161, v157
s_nop 0
v_cvt_pk_bf16_f32 v170, v158, v159
v_cvt_pk_bf16_f32 v178, v160, v161
v_add_f32 v156, 0x42180000, v162
v_mul_f32 v156, v156, v11
v_fract_f32 v156, v156
v_add_f32 v157, 0x421c0000, v162
v_mul_f32 v157, v157, v11
v_fract_f32 v157, v157
v_cos_f32 v158, v156
v_cos_f32 v159, v157
v_sin_f32 v160, v156
v_sin_f32 v161, v157
s_nop 0
v_cvt_pk_bf16_f32 v171, v158, v159
v_cvt_pk_bf16_f32 v179, v160, v161
v_xor_b32 v180, 0x80008000, v172
v_xor_b32 v181, 0x80008000, v173
v_xor_b32 v182, 0x80008000, v174
v_xor_b32 v183, 0x80008000, v175
v_xor_b32 v184, 0x80008000, v176
v_xor_b32 v185, 0x80008000, v177
v_xor_b32 v186, 0x80008000, v178
v_xor_b32 v187, 0x80008000, v179
v_mul_f32 v162, 4.0, v9
v_add_f32 v156, 0x0, v162
v_add_f32 v163, 0x0, v10
v_mul_f32 v156, v156, v163
v_mul_f32 v156, 0x3d000000, v156
v_fract_f32 v156, v156
v_add_f32 v157, 0x3f800000, v162
v_add_f32 v163, 0x0, v10
v_mul_f32 v157, v157, v163
v_mul_f32 v157, 0x3d000000, v157
v_fract_f32 v157, v157
v_cos_f32 v158, v156
v_cos_f32 v159, v157
v_sin_f32 v160, v156
v_sin_f32 v161, v157
s_nop 0
v_cvt_pk_bf16_f32 v188, v158, v159
v_cvt_pk_bf16_f32 v196, v160, v161
v_add_f32 v156, 0x40000000, v162
v_add_f32 v163, 0x0, v10
v_mul_f32 v156, v156, v163
v_mul_f32 v156, 0x3d000000, v156
v_fract_f32 v156, v156
v_add_f32 v157, 0x40400000, v162
v_add_f32 v163, 0x0, v10
v_mul_f32 v157, v157, v163
v_mul_f32 v157, 0x3d000000, v157
v_fract_f32 v157, v157
v_cos_f32 v158, v156
v_cos_f32 v159, v157
v_sin_f32 v160, v156
v_sin_f32 v161, v157
s_nop 0
v_cvt_pk_bf16_f32 v189, v158, v159
v_cvt_pk_bf16_f32 v197, v160, v161
v_add_f32 v156, 0x41800000, v162
v_add_f32 v163, 0x0, v10
v_mul_f32 v156, v156, v163
v_mul_f32 v156, 0x3d000000, v156
v_fract_f32 v156, v156
v_add_f32 v157, 0x41880000, v162
v_add_f32 v163, 0x0, v10
v_mul_f32 v157, v157, v163
v_mul_f32 v157, 0x3d000000, v157
v_fract_f32 v157, v157
v_cos_f32 v158, v156
v_cos_f32 v159, v157
v_sin_f32 v160, v156
v_sin_f32 v161, v157
s_nop 0
v_cvt_pk_bf16_f32 v190, v158, v159
v_cvt_pk_bf16_f32 v198, v160, v161
v_add_f32 v156, 0x41900000, v162
v_add_f32 v163, 0x0, v10
v_mul_f32 v156, v156, v163
v_mul_f32 v156, 0x3d000000, v156
v_fract_f32 v156, v156
v_add_f32 v157, 0x41980000, v162
v_add_f32 v163, 0x0, v10
v_mul_f32 v157, v157, v163
v_mul_f32 v157, 0x3d000000, v157
v_fract_f32 v157, v157
v_cos_f32 v158, v156
v_cos_f32 v159, v157
v_sin_f32 v160, v156
v_sin_f32 v161, v157
s_nop 0
v_cvt_pk_bf16_f32 v191, v158, v159
v_cvt_pk_bf16_f32 v199, v160, v161
v_add_f32 v156, 0x0, v162
v_add_f32 v163, 0x41800000, v10
v_mul_f32 v156, v156, v163
v_mul_f32 v156, 0x3d000000, v156
v_fract_f32 v156, v156
v_add_f32 v157, 0x3f800000, v162
v_add_f32 v163, 0x41800000, v10
v_mul_f32 v157, v157, v163
v_mul_f32 v157, 0x3d000000, v157
v_fract_f32 v157, v157
v_cos_f32 v158, v156
v_cos_f32 v159, v157
v_sin_f32 v160, v156
v_sin_f32 v161, v157
s_nop 0
v_cvt_pk_bf16_f32 v192, v158, v159
v_cvt_pk_bf16_f32 v200, v160, v161
v_add_f32 v156, 0x40000000, v162
v_add_f32 v163, 0x41800000, v10
v_mul_f32 v156, v156, v163
v_mul_f32 v156, 0x3d000000, v156
v_fract_f32 v156, v156
v_add_f32 v157, 0x40400000, v162
v_add_f32 v163, 0x41800000, v10
v_mul_f32 v157, v157, v163
v_mul_f32 v157, 0x3d000000, v157
v_fract_f32 v157, v157
v_cos_f32 v158, v156
v_cos_f32 v159, v157
v_sin_f32 v160, v156
v_sin_f32 v161, v157
s_nop 0
v_cvt_pk_bf16_f32 v193, v158, v159
v_cvt_pk_bf16_f32 v201, v160, v161
v_add_f32 v156, 0x41800000, v162
v_add_f32 v163, 0x41800000, v10
v_mul_f32 v156, v156, v163
v_mul_f32 v156, 0x3d000000, v156
v_fract_f32 v156, v156
v_add_f32 v157, 0x41880000, v162
v_add_f32 v163, 0x41800000, v10
v_mul_f32 v157, v157, v163
v_mul_f32 v157, 0x3d000000, v157
v_fract_f32 v157, v157
v_cos_f32 v158, v156
v_cos_f32 v159, v157
v_sin_f32 v160, v156
v_sin_f32 v161, v157
s_nop 0
v_cvt_pk_bf16_f32 v194, v158, v159
v_cvt_pk_bf16_f32 v202, v160, v161
v_add_f32 v156, 0x41900000, v162
v_add_f32 v163, 0x41800000, v10
v_mul_f32 v156, v156, v163
v_mul_f32 v156, 0x3d000000, v156
v_fract_f32 v156, v156
v_add_f32 v157, 0x41980000, v162
v_add_f32 v163, 0x41800000, v10
v_mul_f32 v157, v157, v163
v_mul_f32 v157, 0x3d000000, v157
v_fract_f32 v157, v157
v_cos_f32 v158, v156
v_cos_f32 v159, v157
v_sin_f32 v160, v156
v_sin_f32 v161, v157
s_nop 0
v_cvt_pk_bf16_f32 v195, v158, v159
v_cvt_pk_bf16_f32 v203, v160, v161
v_xor_b32 v204, 0x80008000, v196
v_xor_b32 v205, 0x80008000, v197
v_xor_b32 v206, 0x80008000, v198
v_xor_b32 v207, 0x80008000, v199
v_xor_b32 v208, 0x80008000, v200
v_xor_b32 v209, 0x80008000, v201
v_xor_b32 v210, 0x80008000, v202
v_xor_b32 v211, 0x80008000, v203
v_mul_f32 v11, 0x3a000000, v8
v_add_f32 v156, 0x0, v162
v_mul_f32 v156, v156, v11
v_cos_f32 v212, v156
v_sin_f32 v220, v156
v_add_f32 v156, 0x3f800000, v162
v_mul_f32 v156, v156, v11
v_cos_f32 v213, v156
v_sin_f32 v221, v156
v_add_f32 v156, 0x40000000, v162
v_mul_f32 v156, v156, v11
v_cos_f32 v214, v156
v_sin_f32 v222, v156
v_add_f32 v156, 0x40400000, v162
v_mul_f32 v156, v156, v11
v_cos_f32 v215, v156
v_sin_f32 v223, v156
v_add_f32 v156, 0x41800000, v162
v_mul_f32 v156, v156, v11
v_cos_f32 v216, v156
v_sin_f32 v224, v156
v_add_f32 v156, 0x41880000, v162
v_mul_f32 v156, v156, v11
v_cos_f32 v217, v156
v_sin_f32 v225, v156
v_add_f32 v156, 0x41900000, v162
v_mul_f32 v156, v156, v11
v_cos_f32 v218, v156
v_sin_f32 v226, v156
v_add_f32 v156, 0x41980000, v162
v_mul_f32 v156, v156, v11
v_cos_f32 v219, v156
v_sin_f32 v227, v156
.Ljoin_407:
v_lshlrev_b32 v1, 4, v0
v_and_b32 v5, 15, v0
v_lshrrev_b32 v6, 4, v0
s_lshl_b32 s29, s17, 4
v_add_u32 v7, s29, v5
v_lshlrev_b32 v2, 9, v6
v_lshrrev_b32 v156, 2, v5
v_lshlrev_b32 v156, 6, v156
v_and_b32 v157, 3, v0
v_lshlrev_b32 v157, 3, v157
v_add3_u32 v2, v2, v156, v157
v_lshlrev_b32 v3, 6, v7
v_lshlrev_b32 v156, 3, v6
v_add_u32 v3, v3, v156
v_lshlrev_b32 v4, 6, v7
v_and_b32 v156, 1, v6
v_lshlrev_b32 v156, 5, v156
v_lshrrev_b32 v157, 1, v6
v_lshlrev_b32 v157, 4, v157
v_add3_u32 v4, v4, v156, v157
s_cmp_ge_u32 s58, 208
s_cbranch_scc1 .Lnobf_468
s_cmp_lg_u32 s17, 0
s_cbranch_scc1 .Lww_470
s_mov_b32 s24, 118147904
v_lshlrev_b32 v248, 2, v0
v_mov_b32 v252, 0x10000000
v_cmp_gt_u32 vcc, 16, v0
s_mov_b32 s25, s39
s_nop 0
v_cndmask_b32 v248, v252, v248, vcc
.Lwr_471:
buffer_load_dword v252, v248, s[8:11], s24 offen sc1
s_waitcnt vmcnt(0)
v_cmp_eq_u32 vcc, 1, v252
s_nop 1
s_bcnt1_i32_b64 s26, vcc
s_cmp_eq_u32 s26, 16
s_cbranch_scc1 .Lwo_472
s_sleep 2
s_sub_u32 s25, s25, 1
s_cbranch_scc0 .Lwr_471
s_mov_b32 s39, 0
.Lwo_472:
.Lww_470:
s_barrier
.Lpfa_469:
.Lnobf_468:
s_cmp_eq_u32 s17, 3
s_cselect_b32 s28, 32, 64
v_mov_b32 v156, 0x10000000
v_cmp_gt_u32 vcc, s28, v0
s_nop 1
v_cndmask_b32 v156, v156, v1, vcc
s_mul_i32 s24, s58, 4096
s_lshl_b32 s25, s17, 10
s_add_u32 s26, s24, s25
s_add_u32 s26, s26, 111120384
s_mov_b32 m0, s25
s_add_u32 s27, s26, 921600
buffer_load_dwordx4 v156, s[8:11], s26 offen lds
s_add_u32 m0, s25, 4096
s_nop 0
buffer_load_dwordx4 v156, s[8:11], s27 offen lds
s_cmp_lg_u32 s17, 3
s_cbranch_scc1 .Lftk_473
v_lshlrev_b32 v157, 3, v0
v_add_u32 v157, 3584, v157
s_add_u32 s28, s24, 111120384
s_add_u32 s29, s28, 921600
s_mov_b32 s30, s39
.Lftr_474:
buffer_load_dwordx2 v[158:159], v157, s[8:11], s28 offen sc1
buffer_load_dwordx2 v[160:161], v157, s[8:11], s29 offen sc1
s_waitcnt vmcnt(0)
v_max_u32 v162, v158, v159
v_max3_u32 v162, v162, v160, v161
v_cmp_eq_u32 vcc, -1, v162
s_cbranch_vccz .Lfto_475
s_sub_u32 s30, s30, 1
s_cbranch_scc0 .Lftr_474
s_mov_b32 s39, 0
.Lfto_475:
ds_write_b64 v157, v[158:159]
ds_write_b64 v157, v[160:161] offset:4096
s_waitcnt lgkmcnt(0)
.Lftk_473:
s_waitcnt vmcnt(0)
s_barrier
ds_read_b64_tr_b16 v[84:85], v2 offset:0
ds_read_b64_tr_b16 v[86:87], v2 offset:256
ds_read_b64_tr_b16 v[88:89], v2 offset:2048
ds_read_b64_tr_b16 v[90:91], v2 offset:2304
ds_read_b64_tr_b16 v[92:93], v2 offset:32
ds_read_b64_tr_b16 v[94:95], v2 offset:288
ds_read_b64_tr_b16 v[96:97], v2 offset:2080
ds_read_b64_tr_b16 v[98:99], v2 offset:2336
ds_read_b64_tr_b16 v[100:101], v2 offset:4096
ds_read_b64_tr_b16 v[102:103], v2 offset:4352
ds_read_b64_tr_b16 v[104:105], v2 offset:6144
ds_read_b64_tr_b16 v[106:107], v2 offset:6400
ds_read_b64_tr_b16 v[108:109], v2 offset:4128
ds_read_b64_tr_b16 v[110:111], v2 offset:4384
ds_read_b64_tr_b16 v[112:113], v2 offset:6176
ds_read_b64_tr_b16 v[114:115], v2 offset:6432
s_waitcnt lgkmcnt(0)
v_mfma_f32_16x16x32_bf16 v[116:119], v[84:87], v[164:167], 0
v_mfma_f32_16x16x32_bf16 v[124:127], v[100:103], v[164:167], 0
v_mfma_f32_16x16x32_bf16 v[120:123], v[92:95], v[164:167], 0
v_mfma_f32_16x16x32_bf16 v[128:131], v[108:111], v[164:167], 0
v_mfma_f32_16x16x32_bf16 v[116:119], v[88:91], v[168:171], v[116:119]
v_mfma_f32_16x16x32_bf16 v[124:127], v[104:107], v[168:171], v[124:127]
v_mfma_f32_16x16x32_bf16 v[120:123], v[96:99], v[168:171], v[120:123]
v_mfma_f32_16x16x32_bf16 v[128:131], v[112:115], v[168:171], v[128:131]
v_mfma_f32_16x16x32_bf16 v[116:119], v[100:103], v[172:175], v[116:119]
v_mfma_f32_16x16x32_bf16 v[124:127], v[84:87], v[180:183], v[124:127]
v_mfma_f32_16x16x32_bf16 v[120:123], v[108:111], v[172:175], v[120:123]
v_mfma_f32_16x16x32_bf16 v[128:131], v[92:95], v[180:183], v[128:131]
v_mfma_f32_16x16x32_bf16 v[116:119], v[104:107], v[176:179], v[116:119]
v_mfma_f32_16x16x32_bf16 v[124:127], v[88:91], v[184:187], v[124:127]
v_mfma_f32_16x16x32_bf16 v[120:123], v[112:115], v[176:179], v[120:123]
v_mfma_f32_16x16x32_bf16 v[128:131], v[96:99], v[184:187], v[128:131]
s_nop 7
v_mul_f32 v156, v116, v212
v_mul_f32 v157, v124, v212
v_fma_f32 v156, v124, v220, v156
v_fma_f32 v124, -v116, v220, v157
v_mov_b32 v116, v156
v_mul_f32 v156, v117, v213
v_mul_f32 v157, v125, v213
v_fma_f32 v156, v125, v221, v156
v_fma_f32 v125, -v117, v221, v157
v_mov_b32 v117, v156
v_mul_f32 v156, v118, v214
v_mul_f32 v157, v126, v214
v_fma_f32 v156, v126, v222, v156
v_fma_f32 v126, -v118, v222, v157
v_mov_b32 v118, v156
v_mul_f32 v156, v119, v215
v_mul_f32 v157, v127, v215
v_fma_f32 v156, v127, v223, v156
v_fma_f32 v127, -v119, v223, v157
v_mov_b32 v119, v156
v_mul_f32 v156, v120, v216
v_mul_f32 v157, v128, v216
v_fma_f32 v156, v128, v224, v156
v_fma_f32 v128, -v120, v224, v157
v_mov_b32 v120, v156
v_mul_f32 v156, v121, v217
v_mul_f32 v157, v129, v217
v_fma_f32 v156, v129, v225, v156
v_fma_f32 v129, -v121, v225, v157
v_mov_b32 v121, v156
v_mul_f32 v156, v122, v218
v_mul_f32 v157, v130, v218
v_fma_f32 v156, v130, v226, v156
v_fma_f32 v130, -v122, v226, v157
v_mov_b32 v122, v156
v_mul_f32 v156, v123, v219
v_mul_f32 v157, v131, v219
v_fma_f32 v156, v131, v227, v156
v_fma_f32 v131, -v123, v227, v157
v_mov_b32 v123, v156
v_cvt_pk_bf16_f32 v132, v116, v117
v_cvt_pk_bf16_f32 v133, v118, v119
v_cvt_pk_bf16_f32 v134, v120, v121
v_cvt_pk_bf16_f32 v135, v122, v123
v_cvt_pk_bf16_f32 v136, v124, v125
v_cvt_pk_bf16_f32 v137, v126, v127
v_cvt_pk_bf16_f32 v138, v128, v129
v_cvt_pk_bf16_f32 v139, v130, v131
v_mul_f32 v212, 0x3a000000, v212
v_mul_f32 v220, 0x3a000000, v220
v_mul_f32 v213, 0x3a000000, v213
v_mul_f32 v221, 0x3a000000, v221
v_mul_f32 v214, 0x3a000000, v214
v_mul_f32 v222, 0x3a000000, v222
v_mul_f32 v215, 0x3a000000, v215
v_mul_f32 v223, 0x3a000000, v223
v_mul_f32 v216, 0x3a000000, v216
v_mul_f32 v224, 0x3a000000, v224
v_mul_f32 v217, 0x3a000000, v217
v_mul_f32 v225, 0x3a000000, v225
v_mul_f32 v218, 0x3a000000, v218
v_mul_f32 v226, 0x3a000000, v226
v_mul_f32 v219, 0x3a000000, v219
v_mul_f32 v227, 0x3a000000, v227
v_mfma_f32_16x16x32_bf16 v[140:143], v[188:191], v[132:135], 0
v_mfma_f32_16x16x32_bf16 v[148:151], v[188:191], v[136:139], 0
v_mfma_f32_16x16x32_bf16 v[144:147], v[192:195], v[132:135], 0
v_mfma_f32_16x16x32_bf16 v[152:155], v[192:195], v[136:139], 0
v_mfma_f32_16x16x32_bf16 v[140:143], v[196:199], v[136:139], v[140:143]
v_mfma_f32_16x16x32_bf16 v[148:151], v[204:207], v[132:135], v[148:151]
v_mfma_f32_16x16x32_bf16 v[144:147], v[200:203], v[136:139], v[144:147]
v_mfma_f32_16x16x32_bf16 v[152:155], v[208:211], v[132:135], v[152:155]
s_waitcnt vmcnt(0)
s_nop 6
v_lshlrev_b32 v156, 16, v228
v_and_b32 v157, 0xffff0000, v228
v_mul_f32 v158, v140, v156
v_mul_f32 v159, v148, v156
v_fma_f32 v158, -v148, v157, v158
v_fma_f32 v148, v140, v157, v159
v_mov_b32 v140, v158
v_lshlrev_b32 v156, 16, v229
v_and_b32 v157, 0xffff0000, v229
v_mul_f32 v158, v141, v156
v_mul_f32 v159, v149, v156
v_fma_f32 v158, -v149, v157, v158
v_fma_f32 v149, v141, v157, v159
v_mov_b32 v141, v158
v_lshlrev_b32 v156, 16, v230
v_and_b32 v157, 0xffff0000, v230
v_mul_f32 v158, v142, v156
v_mul_f32 v159, v150, v156
v_fma_f32 v158, -v150, v157, v158
v_fma_f32 v150, v142, v157, v159
v_mov_b32 v142, v158
v_lshlrev_b32 v156, 16, v231
v_and_b32 v157, 0xffff0000, v231
v_mul_f32 v158, v143, v156
v_mul_f32 v159, v151, v156
v_fma_f32 v158, -v151, v157, v158
v_fma_f32 v151, v143, v157, v159
v_mov_b32 v143, v158
v_lshlrev_b32 v156, 16, v232
v_and_b32 v157, 0xffff0000, v232
v_mul_f32 v158, v144, v156
v_mul_f32 v159, v152, v156
v_fma_f32 v158, -v152, v157, v158
v_fma_f32 v152, v144, v157, v159
v_mov_b32 v144, v158
v_lshlrev_b32 v156, 16, v233
v_and_b32 v157, 0xffff0000, v233
v_mul_f32 v158, v145, v156
v_mul_f32 v159, v153, v156
v_fma_f32 v158, -v153, v157, v158
v_fma_f32 v153, v145, v157, v159
v_mov_b32 v145, v158
v_lshlrev_b32 v156, 16, v234
v_and_b32 v157, 0xffff0000, v234
v_mul_f32 v158, v146, v156
v_mul_f32 v159, v154, v156
v_fma_f32 v158, -v154, v157, v158
v_fma_f32 v154, v146, v157, v159
v_mov_b32 v146, v158
v_lshlrev_b32 v156, 16, v235
v_and_b32 v157, 0xffff0000, v235
v_mul_f32 v158, v147, v156
v_mul_f32 v159, v155, v156
v_fma_f32 v158, -v155, v157, v158
v_fma_f32 v155, v147, v157, v159
v_mov_b32 v147, v158
v_cvt_pk_bf16_f32 v132, v140, v141
v_cvt_pk_bf16_f32 v133, v142, v143
v_cvt_pk_bf16_f32 v134, v144, v145
v_cvt_pk_bf16_f32 v135, v146, v147
v_cvt_pk_bf16_f32 v136, v148, v149
v_cvt_pk_bf16_f32 v137, v150, v151
v_cvt_pk_bf16_f32 v138, v152, v153
v_cvt_pk_bf16_f32 v139, v154, v155
s_nop 1
v_mfma_f32_16x16x32_bf16 v[116:119], v[188:191], v[132:135], 0
v_mfma_f32_16x16x32_bf16 v[124:127], v[188:191], v[136:139], 0
v_mfma_f32_16x16x32_bf16 v[120:123], v[192:195], v[132:135], 0
v_mfma_f32_16x16x32_bf16 v[128:131], v[192:195], v[136:139], 0
v_mfma_f32_16x16x32_bf16 v[116:119], v[204:207], v[136:139], v[116:119]
v_mfma_f32_16x16x32_bf16 v[124:127], v[196:199], v[132:135], v[124:127]
v_mfma_f32_16x16x32_bf16 v[120:123], v[208:211], v[136:139], v[120:123]
v_mfma_f32_16x16x32_bf16 v[128:131], v[200:203], v[132:135], v[128:131]
s_nop 7
v_mul_f32 v156, v116, v212
v_mul_f32 v157, v124, v212
v_fma_f32 v156, -v124, v220, v156
v_fma_f32 v124, v116, v220, v157
v_mov_b32 v116, v156
v_mul_f32 v156, v117, v213
v_mul_f32 v157, v125, v213
v_fma_f32 v156, -v125, v221, v156
v_fma_f32 v125, v117, v221, v157
v_mov_b32 v117, v156
v_mul_f32 v156, v118, v214
v_mul_f32 v157, v126, v214
v_fma_f32 v156, -v126, v222, v156
v_fma_f32 v126, v118, v222, v157
v_mov_b32 v118, v156
v_mul_f32 v156, v119, v215
v_mul_f32 v157, v127, v215
v_fma_f32 v156, -v127, v223, v156
v_fma_f32 v127, v119, v223, v157
v_mov_b32 v119, v156
v_mul_f32 v156, v120, v216
v_mul_f32 v157, v128, v216
v_fma_f32 v156, -v128, v224, v156
v_fma_f32 v128, v120, v224, v157
v_mov_b32 v120, v156
v_mul_f32 v156, v121, v217
v_mul_f32 v157, v129, v217
v_fma_f32 v156, -v129, v225, v156
v_fma_f32 v129, v121, v225, v157
v_mov_b32 v121, v156
v_mul_f32 v156, v122, v218
v_mul_f32 v157, v130, v218
v_fma_f32 v156, -v130, v226, v156
v_fma_f32 v130, v122, v226, v157
v_mov_b32 v122, v156
v_mul_f32 v156, v123, v219
v_mul_f32 v157, v131, v219
v_fma_f32 v156, -v131, v227, v156
v_fma_f32 v131, v123, v227, v157
v_mov_b32 v123, v156
v_cvt_pk_bf16_f32 v132, v116, v117
v_cvt_pk_bf16_f32 v133, v118, v119
v_cvt_pk_bf16_f32 v134, v120, v121
v_cvt_pk_bf16_f32 v135, v122, v123
v_cvt_pk_bf16_f32 v136, v124, v125
v_cvt_pk_bf16_f32 v137, v126, v127
v_cvt_pk_bf16_f32 v138, v128, v129
v_cvt_pk_bf16_f32 v139, v130, v131
ds_write_b64 v3, v[132:133] offset:8192
ds_write_b64 v3, v[134:135] offset:8224
ds_write_b64 v3, v[136:137] offset:12288
ds_write_b64 v3, v[138:139] offset:12320
s_waitcnt lgkmcnt(0)
s_barrier
ds_read_b64_tr_b16 v[84:85], v2 offset:8192
ds_read_b64_tr_b16 v[86:87], v2 offset:8448
ds_read_b64_tr_b16 v[88:89], v2 offset:10240
ds_read_b64_tr_b16 v[90:91], v2 offset:10496
ds_read_b64_tr_b16 v[92:93], v2 offset:8224
ds_read_b64_tr_b16 v[94:95], v2 offset:8480
ds_read_b64_tr_b16 v[96:97], v2 offset:10272
ds_read_b64_tr_b16 v[98:99], v2 offset:10528
ds_read_b64_tr_b16 v[100:101], v2 offset:12288
ds_read_b64_tr_b16 v[102:103], v2 offset:12544
ds_read_b64_tr_b16 v[104:105], v2 offset:14336
ds_read_b64_tr_b16 v[106:107], v2 offset:14592
ds_read_b64_tr_b16 v[108:109], v2 offset:12320
ds_read_b64_tr_b16 v[110:111], v2 offset:12576
ds_read_b64_tr_b16 v[112:113], v2 offset:14368
ds_read_b64_tr_b16 v[114:115], v2 offset:14624
s_waitcnt lgkmcnt(0)
v_mfma_f32_16x16x32_bf16 v[116:119], v[84:87], v[164:167], 0
v_mfma_f32_16x16x32_bf16 v[124:127], v[100:103], v[164:167], 0
v_mfma_f32_16x16x32_bf16 v[120:123], v[92:95], v[164:167], 0
v_mfma_f32_16x16x32_bf16 v[128:131], v[108:111], v[164:167], 0
v_mfma_f32_16x16x32_bf16 v[116:119], v[88:91], v[168:171], v[116:119]
v_mfma_f32_16x16x32_bf16 v[124:127], v[104:107], v[168:171], v[124:127]
v_mfma_f32_16x16x32_bf16 v[120:123], v[96:99], v[168:171], v[120:123]
v_mfma_f32_16x16x32_bf16 v[128:131], v[112:115], v[168:171], v[128:131]
v_mfma_f32_16x16x32_bf16 v[116:119], v[100:103], v[180:183], v[116:119]
v_mfma_f32_16x16x32_bf16 v[124:127], v[84:87], v[172:175], v[124:127]
v_mfma_f32_16x16x32_bf16 v[120:123], v[108:111], v[180:183], v[120:123]
v_mfma_f32_16x16x32_bf16 v[128:131], v[92:95], v[172:175], v[128:131]
v_mfma_f32_16x16x32_bf16 v[116:119], v[104:107], v[184:187], v[116:119]
v_mfma_f32_16x16x32_bf16 v[124:127], v[88:91], v[176:179], v[124:127]
v_mfma_f32_16x16x32_bf16 v[120:123], v[112:115], v[184:187], v[120:123]
v_mfma_f32_16x16x32_bf16 v[128:131], v[96:99], v[176:179], v[128:131]
s_mul_i32 s24, s58, 4096
s_add_u32 s24, s24, 113332224
s_add_u32 s25, s24, 921600
s_nop 5
v_cvt_pk_bf16_f32 v132, v116, v117
v_cvt_pk_bf16_f32 v133, v118, v119
v_cvt_pk_bf16_f32 v134, v120, v121
v_cvt_pk_bf16_f32 v135, v122, v123
s_nop 1
v_permlane16_swap_b32 v132, v134
v_permlane16_swap_b32 v133, v135
buffer_store_dwordx4 v[132:135], v4, s[8:11], s24 offen sc1
v_cvt_pk_bf16_f32 v136, v124, v125
v_cvt_pk_bf16_f32 v137, v126, v127
v_cvt_pk_bf16_f32 v138, v128, v129
v_cvt_pk_bf16_f32 v139, v130, v131
s_nop 1
v_permlane16_swap_b32 v136, v138
v_permlane16_swap_b32 v137, v139
buffer_store_dwordx4 v[136:139], v4, s[8:11], s25 offen sc1
s_load_dwordx2 s[6:7], s[0:1], 80
s_waitcnt lgkmcnt(0)
s_mov_b32 s12, s6
s_mov_b32 s13, s7
s_mov_b32 s14, 1835008
s_mov_b32 s15, 0x00020000
v_lshrrev_b32 v4, 2, v0
v_mul_u32_u24 v4, 4096, v4
v_and_b32 v5, 3, v0
v_lshlrev_b32 v5, 4, v5
v_add_u32 v4, v4, v5
v_and_b32 v149, 15, v0
s_lshl_b32 s24, s62, 5
v_add_u32 v150, s24, v149
v_mul_u32_u24 v150, 896, v150
v_lshrrev_b32 v151, 5, v0
v_lshlrev_b32 v151, 4, v151
v_lshrrev_b32 v149, 4, v0
v_and_b32 v149, 1, v149
v_lshlrev_b32 v149, 5, v149
v_add_u32 v151, v151, v149
s_lshl_b32 s24, s63, 6
v_add3_u32 v148, v150, v151, s24
s_mov_b32 s27, 109285376
s_mov_b32 s28, 109299712
buffer_load_dwordx4 v[8:11], v148, s[8:11], s27 offen sc1
buffer_load_dwordx4 v[12:15], v148, s[8:11], s28 offen sc1
v_mov_b32 v32, 0
v_mov_b32 v33, 0
v_mov_b32 v34, 0
v_mov_b32 v35, 0
v_mov_b32 v36, 0
v_mov_b32 v37, 0
v_mov_b32 v38, 0
v_mov_b32 v39, 0
v_mov_b32 v40, 0
v_mov_b32 v41, 0
v_mov_b32 v42, 0
v_mov_b32 v43, 0
v_mov_b32 v44, 0
v_mov_b32 v45, 0
v_mov_b32 v46, 0
v_mov_b32 v47, 0
v_mov_b32 v48, 0
v_mov_b32 v49, 0
v_mov_b32 v50, 0
v_mov_b32 v51, 0
v_mov_b32 v52, 0
v_mov_b32 v53, 0
v_mov_b32 v54, 0
v_mov_b32 v55, 0
v_mov_b32 v56, 0
v_mov_b32 v57, 0
v_mov_b32 v58, 0
v_mov_b32 v59, 0
v_mov_b32 v60, 0
v_mov_b32 v61, 0
v_mov_b32 v62, 0
v_mov_b32 v63, 0
v_mov_b32 v64, 0
v_mov_b32 v65, 0
v_mov_b32 v66, 0
v_mov_b32 v67, 0
v_mov_b32 v68, 0
v_mov_b32 v69, 0
v_mov_b32 v70, 0
v_mov_b32 v71, 0
v_mov_b32 v72, 0
v_mov_b32 v73, 0
v_mov_b32 v74, 0
v_mov_b32 v75, 0
v_mov_b32 v76, 0
v_mov_b32 v77, 0
v_mov_b32 v78, 0
v_mov_b32 v79, 0
v_mov_b32 v80, 0
v_mov_b32 v81, 0
v_mov_b32 v82, 0
v_mov_b32 v83, 0
v_mov_b32 v84, 0
v_mov_b32 v85, 0
v_mov_b32 v86, 0
v_mov_b32 v87, 0
v_mov_b32 v88, 0
v_mov_b32 v89, 0
v_mov_b32 v90, 0
v_mov_b32 v91, 0
v_mov_b32 v92, 0
v_mov_b32 v93, 0
v_mov_b32 v94, 0
v_mov_b32 v95, 0
s_mov_b32 s27, s39
.Lb3p_476:
s_cmp_gt_u32 s61, 3
s_cbranch_scc1 .Lb3h_478
s_lshl_b32 s24, s60, 7
s_add_u32 s24, s24, 113332224
s_mul_i32 s25, s17, 65536
s_add_u32 s24, s24, s25
s_add_u32 s26, s24, 0
buffer_load_dwordx4 v[32:35], v4, s[8:11], s26 offen sc1
s_add_u32 s26, s24, 262144
buffer_load_dwordx4 v[36:39], v4, s[8:11], s26 offen sc1
s_add_u32 s26, s24, 524288
buffer_load_dwordx4 v[40:43], v4, s[8:11], s26 offen sc1
s_add_u32 s26, s24, 786432
buffer_load_dwordx4 v[44:47], v4, s[8:11], s26 offen sc1
s_add_u32 s26, s24, 1048576
buffer_load_dwordx4 v[48:51], v4, s[8:11], s26 offen sc1
s_add_u32 s26, s24, 1310720
buffer_load_dwordx4 v[52:55], v4, s[8:11], s26 offen sc1
s_add_u32 s26, s24, 1572864
buffer_load_dwordx4 v[56:59], v4, s[8:11], s26 offen sc1
s_cmp_ge_u32 s17, 1
s_cbranch_scc1 .Lb3s_486
s_add_u32 s26, s24, 1835008
buffer_load_dwordx4 v[60:63], v4, s[8:11], s26 offen sc1
.Lb3s_486:
.Lb3h_478:
s_cmp_lt_u32 s61, 3
s_cbranch_scc1 .Lb3h_487
s_lshl_b32 s24, s60, 7
s_add_u32 s24, s24, 113332288
s_mul_i32 s25, s17, 65536
s_add_u32 s24, s24, s25
s_add_u32 s26, s24, 0
buffer_load_dwordx4 v[64:67], v4, s[8:11], s26 offen sc1
s_add_u32 s26, s24, 262144
buffer_load_dwordx4 v[68:71], v4, s[8:11], s26 offen sc1
s_add_u32 s26, s24, 524288
buffer_load_dwordx4 v[72:75], v4, s[8:11], s26 offen sc1
s_add_u32 s26, s24, 786432
buffer_load_dwordx4 v[76:79], v4, s[8:11], s26 offen sc1
s_add_u32 s26, s24, 1048576
buffer_load_dwordx4 v[80:83], v4, s[8:11], s26 offen sc1
s_add_u32 s26, s24, 1310720
buffer_load_dwordx4 v[84:87], v4, s[8:11], s26 offen sc1
s_add_u32 s26, s24, 1572864
buffer_load_dwordx4 v[88:91], v4, s[8:11], s26 offen sc1
s_cmp_ge_u32 s17, 1
s_cbranch_scc1 .Lb3s_495
s_add_u32 s26, s24, 1835008
buffer_load_dwordx4 v[92:95], v4, s[8:11], s26 offen sc1
.Lb3s_495:
.Lb3h_487:
s_waitcnt vmcnt(0)
v_max_u32 v5, v32, v33
v_max3_u32 v5, v5, v34, v35
v_max3_u32 v5, v5, v36, v37
v_max3_u32 v5, v5, v38, v39
v_max3_u32 v5, v5, v40, v41
v_max3_u32 v5, v5, v42, v43
v_max3_u32 v5, v5, v44, v45
v_max3_u32 v5, v5, v46, v47
v_max3_u32 v5, v5, v48, v49
v_max3_u32 v5, v5, v50, v51
v_max3_u32 v5, v5, v52, v53
v_max3_u32 v5, v5, v54, v55
v_max3_u32 v5, v5, v56, v57
v_max3_u32 v5, v5, v58, v59
v_max3_u32 v5, v5, v60, v61
v_max3_u32 v5, v5, v62, v63
v_max3_u32 v5, v5, v64, v65
v_max3_u32 v5, v5, v66, v67
v_max3_u32 v5, v5, v68, v69
v_max3_u32 v5, v5, v70, v71
v_max3_u32 v5, v5, v72, v73
v_max3_u32 v5, v5, v74, v75
v_max3_u32 v5, v5, v76, v77
v_max3_u32 v5, v5, v78, v79
v_max3_u32 v5, v5, v80, v81
v_max3_u32 v5, v5, v82, v83
v_max3_u32 v5, v5, v84, v85
v_max3_u32 v5, v5, v86, v87
v_max3_u32 v5, v5, v88, v89
v_max3_u32 v5, v5, v90, v91
v_max3_u32 v5, v5, v92, v93
v_max3_u32 v5, v5, v94, v95
v_cmp_eq_u32 vcc, -1, v5
s_cbranch_vccz .Lb3o_477
s_sub_u32 s27, s27, 1
s_cbranch_scc0 .Lb3p_476
s_mov_b32 s39, 0
.Lb3o_477:
s_barrier
v_lshlrev_b32 v5, 4, v0
s_lshl_b32 s25, s17, 10
v_add_u32 v5, s25, v5
s_cmp_gt_u32 s61, 3
s_cbranch_scc1 .Lb3h_496
ds_write_b128 v5, v[32:35] offset:0
ds_write_b128 v5, v[36:39] offset:4096
ds_write_b128 v5, v[40:43] offset:8192
ds_write_b128 v5, v[44:47] offset:12288
ds_write_b128 v5, v[48:51] offset:16384
ds_write_b128 v5, v[52:55] offset:20480
ds_write_b128 v5, v[56:59] offset:24576
s_cmp_ge_u32 s17, 1
s_cbranch_scc1 .Lb3s_504
ds_write_b128 v5, v[60:63] offset:28672
.Lb3s_504:
.Lb3h_496:
s_cmp_lt_u32 s61, 3
s_cbranch_scc1 .Lb3h_505
ds_write_b128 v5, v[64:67] offset:29696
ds_write_b128 v5, v[68:71] offset:33792
ds_write_b128 v5, v[72:75] offset:37888
ds_write_b128 v5, v[76:79] offset:41984
ds_write_b128 v5, v[80:83] offset:46080
ds_write_b128 v5, v[84:87] offset:50176
ds_write_b128 v5, v[88:91] offset:54272
s_cmp_ge_u32 s17, 1
s_cbranch_scc1 .Lb3s_513
ds_write_b128 v5, v[92:95] offset:58368
.Lb3s_513:
.Lb3h_505:
v_lshrrev_b32 v5, 5, v0
v_lshlrev_b32 v5, 9, v5
v_lshrrev_b32 v6, 2, v0
v_and_b32 v6, 3, v6
v_lshlrev_b32 v6, 6, v6
v_add_u32 v5, v5, v6
v_lshrrev_b32 v6, 4, v0
v_and_b32 v6, 1, v6
v_lshlrev_b32 v6, 5, v6
v_and_b32 v7, 3, v0
v_lshlrev_b32 v7, 3, v7
v_add3_u32 v2, v5, v6, v7
s_and_b32 s24, s62, 1
s_mul_i32 s24, s24, 29696
v_add_u32 v2, s24, v2
s_waitcnt vmcnt(0) lgkmcnt(0)
s_barrier
ds_read_b64_tr_b16 v[32:33], v2 offset:0
ds_read_b64_tr_b16 v[34:35], v2 offset:256
ds_read_b64_tr_b16 v[36:37], v2 offset:1024
ds_read_b64_tr_b16 v[38:39], v2 offset:1280
ds_read_b64_tr_b16 v[40:41], v2 offset:2048
ds_read_b64_tr_b16 v[42:43], v2 offset:2304
ds_read_b64_tr_b16 v[44:45], v2 offset:3072
ds_read_b64_tr_b16 v[46:47], v2 offset:3328
ds_read_b64_tr_b16 v[48:49], v2 offset:4096
ds_read_b64_tr_b16 v[50:51], v2 offset:4352
ds_read_b64_tr_b16 v[52:53], v2 offset:5120
ds_read_b64_tr_b16 v[54:55], v2 offset:5376
ds_read_b64_tr_b16 v[56:57], v2 offset:6144
ds_read_b64_tr_b16 v[58:59], v2 offset:6400
s_waitcnt lgkmcnt(12)
v_mfma_f32_32x32x16_bf16 v[16:31], a[128:131], v[32:35], 0
ds_read_b64_tr_b16 v[60:61], v2 offset:7168
ds_read_b64_tr_b16 v[62:63], v2 offset:7424
s_waitcnt lgkmcnt(12)
v_mfma_f32_32x32x16_bf16 v[16:31], a[132:135], v[36:39], v[16:31]
ds_read_b64_tr_b16 v[64:65], v2 offset:8192
ds_read_b64_tr_b16 v[66:67], v2 offset:8448
s_waitcnt lgkmcnt(12)
v_mfma_f32_32x32x16_bf16 v[16:31], a[136:139], v[40:43], v[16:31]
ds_read_b64_tr_b16 v[68:69], v2 offset:9216
ds_read_b64_tr_b16 v[70:71], v2 offset:9472
s_waitcnt lgkmcnt(12)
v_mfma_f32_32x32x16_bf16 v[16:31], a[140:143], v[44:47], v[16:31]
ds_read_b64_tr_b16 v[72:73], v2 offset:10240
ds_read_b64_tr_b16 v[74:75], v2 offset:10496
s_waitcnt lgkmcnt(12)
v_mfma_f32_32x32x16_bf16 v[16:31], a[144:147], v[48:51], v[16:31]
ds_read_b64_tr_b16 v[76:77], v2 offset:11264
ds_read_b64_tr_b16 v[78:79], v2 offset:11520
s_waitcnt lgkmcnt(12)
v_mfma_f32_32x32x16_bf16 v[16:31], a[148:151], v[52:55], v[16:31]
ds_read_b64_tr_b16 v[80:81], v2 offset:12288
ds_read_b64_tr_b16 v[82:83], v2 offset:12544
s_waitcnt lgkmcnt(12)
v_mfma_f32_32x32x16_bf16 v[16:31], a[152:155], v[56:59], v[16:31]
ds_read_b64_tr_b16 v[84:85], v2 offset:13312
ds_read_b64_tr_b16 v[86:87], v2 offset:13568
s_waitcnt lgkmcnt(12)
v_mfma_f32_32x32x16_bf16 v[16:31], a[156:159], v[60:63], v[16:31]
ds_read_b64_tr_b16 v[88:89], v2 offset:14336
ds_read_b64_tr_b16 v[90:91], v2 offset:14592
s_waitcnt lgkmcnt(12)
v_mfma_f32_32x32x16_bf16 v[16:31], a[160:163], v[64:67], v[16:31]
ds_read_b64_tr_b16 v[92:93], v2 offset:15360
ds_read_b64_tr_b16 v[94:95], v2 offset:15616
s_waitcnt lgkmcnt(12)
v_mfma_f32_32x32x16_bf16 v[16:31], a[164:167], v[68:71], v[16:31]
ds_read_b64_tr_b16 v[96:97], v2 offset:16384
ds_read_b64_tr_b16 v[98:99], v2 offset:16640
s_waitcnt lgkmcnt(12)
v_mfma_f32_32x32x16_bf16 v[16:31], a[168:171], v[72:75], v[16:31]
ds_read_b64_tr_b16 v[100:101], v2 offset:17408
ds_read_b64_tr_b16 v[102:103], v2 offset:17664
s_waitcnt lgkmcnt(12)
v_mfma_f32_32x32x16_bf16 v[16:31], a[172:175], v[76:79], v[16:31]
ds_read_b64_tr_b16 v[104:105], v2 offset:18432
ds_read_b64_tr_b16 v[106:107], v2 offset:18688
s_waitcnt lgkmcnt(12)
v_mfma_f32_32x32x16_bf16 v[16:31], a[176:179], v[80:83], v[16:31]
ds_read_b64_tr_b16 v[108:109], v2 offset:19456
ds_read_b64_tr_b16 v[110:111], v2 offset:19712
s_waitcnt lgkmcnt(12)
v_mfma_f32_32x32x16_bf16 v[16:31], a[180:183], v[84:87], v[16:31]
ds_read_b64_tr_b16 v[112:113], v2 offset:20480
ds_read_b64_tr_b16 v[114:115], v2 offset:20736
s_waitcnt lgkmcnt(12)
v_mfma_f32_32x32x16_bf16 v[16:31], a[184:187], v[88:91], v[16:31]
ds_read_b64_tr_b16 v[116:117], v2 offset:21504
ds_read_b64_tr_b16 v[118:119], v2 offset:21760
s_waitcnt lgkmcnt(12)
v_mfma_f32_32x32x16_bf16 v[16:31], a[188:191], v[92:95], v[16:31]
ds_read_b64_tr_b16 v[120:121], v2 offset:22528
ds_read_b64_tr_b16 v[122:123], v2 offset:22784
s_waitcnt lgkmcnt(12)
v_mfma_f32_32x32x16_bf16 v[16:31], a[192:195], v[96:99], v[16:31]
ds_read_b64_tr_b16 v[124:125], v2 offset:23552
ds_read_b64_tr_b16 v[126:127], v2 offset:23808
s_waitcnt lgkmcnt(12)
v_mfma_f32_32x32x16_bf16 v[16:31], a[196:199], v[100:103], v[16:31]
ds_read_b64_tr_b16 v[128:129], v2 offset:24576
ds_read_b64_tr_b16 v[130:131], v2 offset:24832
s_waitcnt lgkmcnt(12)
v_mfma_f32_32x32x16_bf16 v[16:31], a[200:203], v[104:107], v[16:31]
ds_read_b64_tr_b16 v[132:133], v2 offset:25600
ds_read_b64_tr_b16 v[134:135], v2 offset:25856
s_waitcnt lgkmcnt(12)
v_mfma_f32_32x32x16_bf16 v[16:31], a[204:207], v[108:111], v[16:31]
ds_read_b64_tr_b16 v[136:137], v2 offset:26624
ds_read_b64_tr_b16 v[138:139], v2 offset:26880
s_waitcnt lgkmcnt(12)
v_mfma_f32_32x32x16_bf16 v[16:31], a[208:211], v[112:115], v[16:31]
ds_read_b64_tr_b16 v[140:141], v2 offset:27648
ds_read_b64_tr_b16 v[142:143], v2 offset:27904
s_waitcnt lgkmcnt(12)
v_mfma_f32_32x32x16_bf16 v[16:31], a[212:215], v[116:119], v[16:31]
ds_read_b64_tr_b16 v[144:145], v2 offset:28672
ds_read_b64_tr_b16 v[146:147], v2 offset:28928
s_waitcnt lgkmcnt(12)
v_mfma_f32_32x32x16_bf16 v[16:31], a[216:219], v[120:123], v[16:31]
s_waitcnt lgkmcnt(10)
v_mfma_f32_32x32x16_bf16 v[16:31], a[220:223], v[124:127], v[16:31]
s_waitcnt lgkmcnt(8)
v_mfma_f32_32x32x16_bf16 v[16:31], a[224:227], v[128:131], v[16:31]
s_waitcnt lgkmcnt(6)
v_mfma_f32_32x32x16_bf16 v[16:31], a[228:231], v[132:135], v[16:31]
s_waitcnt lgkmcnt(4)
v_mfma_f32_32x32x16_bf16 v[16:31], a[232:235], v[136:139], v[16:31]
s_waitcnt lgkmcnt(2)
v_mfma_f32_32x32x16_bf16 v[16:31], a[236:239], v[140:143], v[16:31]
s_waitcnt lgkmcnt(0)
v_mfma_f32_32x32x16_bf16 v[16:31], a[240:243], v[144:147], v[16:31]
s_nop 7
s_nop 3
v_cvt_pk_bf16_f32 v40, v16, v17
v_cvt_pk_bf16_f32 v41, v18, v19
v_cvt_pk_bf16_f32 v42, v20, v21
v_cvt_pk_bf16_f32 v43, v22, v23
v_cvt_pk_bf16_f32 v44, v24, v25
v_cvt_pk_bf16_f32 v45, v26, v27
v_cvt_pk_bf16_f32 v46, v28, v29
v_cvt_pk_bf16_f32 v47, v30, v31
s_nop 1
v_permlane32_swap_b32 v40, v42
v_permlane32_swap_b32 v41, v43
v_permlane32_swap_b32 v44, v46
v_permlane32_swap_b32 v45, v47
s_nop 1
v_permlane16_swap_b32 v40, v44
v_permlane16_swap_b32 v41, v45
v_permlane16_swap_b32 v42, v46
v_permlane16_swap_b32 v43, v47
s_mov_b32 s23, 14336
v_lshlrev_b32 v32, 16, v40
v_and_b32 v33, 0xffff0000, v40
v_lshlrev_b32 v34, 16, v8
v_and_b32 v35, 0xffff0000, v8
v_pk_add_f32 v[32:33], v[32:33], v[34:35]
v_cvt_pk_bf16_f32 v40, v32, v33
v_lshlrev_b32 v32, 16, v41
v_and_b32 v33, 0xffff0000, v41
v_lshlrev_b32 v34, 16, v9
v_and_b32 v35, 0xffff0000, v9
v_pk_add_f32 v[32:33], v[32:33], v[34:35]
v_cvt_pk_bf16_f32 v41, v32, v33
v_lshlrev_b32 v32, 16, v42
v_and_b32 v33, 0xffff0000, v42
v_lshlrev_b32 v34, 16, v10
v_and_b32 v35, 0xffff0000, v10
v_pk_add_f32 v[32:33], v[32:33], v[34:35]
v_cvt_pk_bf16_f32 v42, v32, v33
v_lshlrev_b32 v32, 16, v43
v_and_b32 v33, 0xffff0000, v43
v_lshlrev_b32 v34, 16, v11
v_and_b32 v35, 0xffff0000, v11
v_pk_add_f32 v[32:33], v[32:33], v[34:35]
v_cvt_pk_bf16_f32 v43, v32, v33
buffer_store_dwordx4 v[40:43], v148, s[12:15], 0 offen sc1
v_lshlrev_b32 v32, 16, v44
v_and_b32 v33, 0xffff0000, v44
v_lshlrev_b32 v34, 16, v12
v_and_b32 v35, 0xffff0000, v12
v_pk_add_f32 v[32:33], v[32:33], v[34:35]
v_cvt_pk_bf16_f32 v44, v32, v33
v_lshlrev_b32 v32, 16, v45
v_and_b32 v33, 0xffff0000, v45
v_lshlrev_b32 v34, 16, v13
v_and_b32 v35, 0xffff0000, v13
v_pk_add_f32 v[32:33], v[32:33], v[34:35]
v_cvt_pk_bf16_f32 v45, v32, v33
v_lshlrev_b32 v32, 16, v46
v_and_b32 v33, 0xffff0000, v46
v_lshlrev_b32 v34, 16, v14
v_and_b32 v35, 0xffff0000, v14
v_pk_add_f32 v[32:33], v[32:33], v[34:35]
v_cvt_pk_bf16_f32 v46, v32, v33
v_lshlrev_b32 v32, 16, v47
v_and_b32 v33, 0xffff0000, v47
v_lshlrev_b32 v34, 16, v15
v_and_b32 v35, 0xffff0000, v15
v_pk_add_f32 v[32:33], v[32:33], v[34:35]
v_cvt_pk_bf16_f32 v47, v32, v33
buffer_store_dwordx4 v[44:47], v148, s[12:15], s23 offen sc1
s_waitcnt vmcnt(0)
mega_kernel_exit:
s_endpgm
.section .rodata,"a"
.p2align 6
.amdhsa_kernel mega_kernel
.amdhsa_next_free_vgpr 512
.amdhsa_next_free_sgpr 102
.amdhsa_accum_offset 256
.amdhsa_group_segment_fixed_size 0
.amdhsa_kernarg_size 104
.amdhsa_user_sgpr_count 2
.amdhsa_user_sgpr_kernarg_segment_ptr 1
.amdhsa_system_sgpr_workgroup_id_x 1
.end_amdhsa_kernel
.text
```
